```python
import torch

def _softmax(x, axis=-1):
    return torch.softmax(x, dim=axis)
def _gelu(x):
    return torch.nn.functional.gelu(x, approximate="tanh")
def _silu(x):
    return torch.nn.functional.silu(x)
def _sigmoid(x):
    return torch.sigmoid(x)
def _layernorm(x, axis=-1, eps=1e-5):
    m = x.mean(dim=axis, keepdim=True)
    v = x.var(dim=axis, keepdim=True, unbiased=False)
    return (x - m) / torch.sqrt(v + eps)
def _scatter_add(tgt, idx, src, axis=0):
    return tgt.clone().index_add_(axis, idx, src)
def _segment_sum(src, seg, n):
    out = torch.zeros((n,) + src.shape[1:], dtype=src.dtype)
    return out.index_add_(0, seg, src)
def _pad(x, pw):
    flat = tuple(v for pair in reversed(pw) for v in pair)
    return torch.nn.functional.pad(x, flat)

kernel_name = 'gated_mix__compressed_kv_cla__dense_activation_relu__prompt'

def setup_inputs():

    _w = (lambda a: (lambda t: t.to(torch.bfloat16) if t.is_floating_point() else t)(torch.as_tensor(a)))
    def _A_setup():
        B, H, Sq, Sk, D, M = 1, 16, 2048, 2048, 256, 448
        Dc = 4 * D
        return {
            "x": _w((lambda *s: torch.randn(*s, dtype=torch.bfloat16) * 0.05)(B, Sq, M)),
            "c_kv": _w((lambda *s: torch.randn(*s, dtype=torch.bfloat16) * 0.8)(B, Sk, Dc)),
            "w_q": _w((lambda *s: torch.randn(*s, dtype=torch.bfloat16) * 6.4)(M, H, D) * (M ** -0.5)),
            "w_uk": _w((lambda *s: torch.randn(*s, dtype=torch.bfloat16) * 6.4)(Dc, H, D) * (Dc ** -0.5)),
            "w_uv": _w((lambda *s: torch.randn(*s, dtype=torch.bfloat16) * 0.8)(Dc, H, D) * (Dc ** -0.5)),
            "w_o": _w((lambda *s: torch.randn(*s, dtype=torch.bfloat16) * 0.8)(H, D, M) * ((H * D) ** -0.5)),
        }
    _A_in = _A_setup()

    def _B_setup():
        B, S, D, Dff = 1, 2048, 448, 1792
        return {
            "x": _w((lambda *s: torch.randn(*s, dtype=torch.bfloat16) * 0.05)(B, S, D)),
            "w1": _w((lambda *s: torch.randn(*s, dtype=torch.bfloat16) * 0.05)(D, Dff)),
            "w2": _w((lambda *s: torch.randn(*s, dtype=torch.bfloat16) * 0.05)(Dff, D)),
        }
    _B_in = _B_setup()

    return {
        "A_x": _A_in["x"],
        "A_c_kv": _A_in["c_kv"],
        "A_w_q": _A_in["w_q"],
        "A_w_uk": _A_in["w_uk"],
        "A_w_uv": _A_in["w_uv"],
        "A_w_o": _A_in["w_o"],
        "B_x": _B_in["x"],
        "B_w1": _B_in["w1"],
        "B_w2": _B_in["w2"],
        "gate_w": _w((lambda *s: torch.randn(*s, dtype=torch.bfloat16) * 0.05)(448) * 16.0),
    }

def reference(A_x, A_c_kv, A_w_q, A_w_uk, A_w_uv, A_w_o, B_x, B_w1, B_w2, gate_w):
    def _A_ref(x, c_kv, w_q, w_uk, w_uv, w_o):
        B, Sq, M = x.shape[0], x.shape[1], x.shape[2]
        Sk = c_kv.shape[1]
        H, D = w_q.shape[1], w_q.shape[2]
        q = torch.einsum("bqm,mhd->bhqd", x, w_q)
        k = torch.einsum("bkc,chd->bhkd", c_kv, w_uk)
        v = torch.einsum("bkc,chd->bhkd", c_kv, w_uv)
        scores = torch.einsum("bhqd,bhkd->bhqk", q, k) * (D ** -0.5)
        off = Sk - Sq
        qi = torch.arange(Sq)[:, None]
        kj = torch.arange(Sk)[None, :]
        cmask = kj <= (qi + off)
        scores = torch.where(cmask[None, None], scores, -1e9)
        p = _softmax(scores, axis=-1)
        ctx = torch.einsum("bhqk,bhkd->bhqd", p, v)
        return torch.einsum("bhqd,hdm->bqm", ctx, w_o)

    def _B_ref(x, w1, w2):
        h = torch.einsum("bsd,df->bsf", x, w1)
        zero = torch.zeros_like(h)
        h = torch.maximum(h, zero)
        return torch.einsum("bsf,fd->bsd", h, w2)

    x = A_x
    g = _sigmoid((x * gate_w).sum(-1, keepdims=True))
    a = _A_ref(x, A_c_kv, A_w_q, A_w_uk, A_w_uv, A_w_o)
    b = _B_ref(x, B_w1, B_w2)
    return g * a + (1 - g) * b
```

```asm
; @launch kernel=mega_kernel grid=(256,1,1) block=(256,1,1) lds=163840
; @launch kernel=k3_kernel grid=(256,1,1) block=(448,1,1) lds=0
.amdgcn_target "amdgcn-amd-amdhsa--gfx950"
.text
.macro M dk,d,ak,a,bk,b
v_mfma_f32_16x16x32_bf16 \dk[\d:\d+3], \ak[\a:\a+3], \bk[\b:\b+3], \dk[\d:\d+3]
.endm
.macro Z dk,d,ak,a,bk,b
v_mfma_f32_16x16x32_bf16 \dk[\d:\d+3], \ak[\a:\a+3], \bk[\b:\b+3], 0
.endm
.macro T d,v,o
ds_read_b64_tr_b16 a[\d:\d+1], v\v offset:\o
.endm
.macro R d,v,o
ds_read_b128 a[\d:\d+3], v\v offset:\o
.endm
.macro C v,s,so,o
buffer_load_dwordx4 v\v, s[\s:\s+3], \so offen offset:\o sc1 lds
.endm
.macro L v,s,so,o
buffer_load_dwordx4 v\v, s[\s:\s+3], \so offen offset:\o lds
.endm
.globl mega_kernel
.p2align 8
.type mega_kernel,@function
mega_kernel:
s_cmp_lt_u32 s2, 256
s_cbranch_scc1 MG_go
s_endpgm
MG_go:
s_load_dwordx2 s[4:5], s[0:1], 8
s_load_dwordx2 s[32:33], s[0:1], 24
s_load_dwordx2 s[34:35], s[0:1], 32
s_load_dwordx2 s[12:13], s[0:1], 96
s_load_dwordx2 s[16:17], s[0:1], 0
s_load_dwordx2 s[20:21], s[0:1], 72
s_load_dwordx2 s[68:69], s[0:1], 16
s_load_dwordx2 s[72:73], s[0:1], 56
s_load_dwordx2 s[76:77], s[0:1], 40
s_load_dwordx2 s[80:81], s[0:1], 64
s_load_dwordx2 s[84:85], s[0:1], 88
s_memrealtime s[44:45]
v_and_b32 v1, 63, v0
v_lshrrev_b32 v2, 6, v0
s_and_b32 s36, s2, 7
s_lshr_b32 s37, s2, 3
v_readfirstlane_b32 s24, v2
s_lshr_b32 s38, s37, 3
s_and_b32 s27, s37, 7
s_and_b32 s39, s38, 1
s_lshl_b32 s25, s36, 1
s_add_u32 s25, s25, s39
s_lshr_b32 s26, s38, 1
s_mov_b32 s6, 4194304
s_mov_b32 s7, 0x20000
s_mov_b32 s14, 268435456
s_mov_b32 s15, 0x20000
s_mov_b32 s18, 1835008
s_mov_b32 s19, 0x20000
s_mov_b32 s22, 896
s_mov_b32 s23, 0x20000
s_mov_b32 s70, 3670016
s_mov_b32 s71, 0x20000
s_mov_b32 s74, 1605632
s_mov_b32 s75, 0x20000
s_mov_b32 s78, 3670016
s_mov_b32 s79, 0x20000
s_mov_b32 s82, 1605632
s_mov_b32 s83, 0x20000
s_mov_b32 s86, 256
s_mov_b32 s87, 0x20000
v_lshlrev_b32 v24, 4, v1
s_lshl_b32 s40, s27, 8
s_lshl_b32 s41, s24, 6
s_add_u32 s40, s40, s41
s_lshl_b32 s40, s40, 11
v_lshrrev_b32 v25, 3, v1
v_lshlrev_b32 v25, 11, v25
v_add_u32 v25, s40, v25
v_and_b32 v26, 7, v1
v_lshrrev_b32 v27, 4, v1
v_xor_b32 v26, v26, v27
v_mov_b32 v27, v26
v_lshlrev_b32 v27, 4, v27
v_add_u32 v27, v27, v25
v_add_u32 v4, 0, v27
v_xor_b32 v27, 4, v26
v_lshlrev_b32 v27, 4, v27
v_add_u32 v27, v27, v25
v_add_u32 v5, 15360, v27
v_mov_b32 v27, v26
v_lshlrev_b32 v27, 4, v27
v_add_u32 v27, v27, v25
v_add_u32 v6, 30720, v27
v_xor_b32 v27, 4, v26
v_lshlrev_b32 v27, 4, v27
v_add_u32 v27, v27, v25
v_add_u32 v7, 46080, v27
v_lshrrev_b32 v25, 5, v1
v_and_b32 v26, 31, v1
v_lshrrev_b32 v26, 1, v26
v_and_b32 v28, 1, v1
s_and_b32 s41, s24, 1
s_lshl_b32 s41, s41, 2
s_lshl_b32 s42, s24, 16
s_lshl_b32 s43, s25, 9
s_add_u32 s42, s42, s43
v_add_u32 v27, 0, v25
v_and_b32 v29, 3, v27
v_or_b32 v29, s41, v29
v_xor_b32 v29, v29, v26
v_lshlrev_b32 v29, 1, v29
v_or_b32 v29, v29, v28
v_lshlrev_b32 v29, 4, v29
v_lshlrev_b32 v27, 13, v27
v_add_u32 v27, v27, v29
v_add_u32 v27, s42, v27
v_mov_b32 v8, v27
v_add_u32 v27, 2, v25
v_and_b32 v29, 3, v27
v_or_b32 v29, s41, v29
v_xor_b32 v29, v29, v26
v_lshlrev_b32 v29, 1, v29
v_or_b32 v29, v29, v28
v_lshlrev_b32 v29, 4, v29
v_lshlrev_b32 v27, 13, v27
v_add_u32 v27, v27, v29
v_add_u32 v27, s42, v27
v_subrev_u32 v9, 1024, v27
v_add_u32 v27, 4, v25
v_and_b32 v29, 3, v27
v_or_b32 v29, s41, v29
v_xor_b32 v29, v29, v26
v_lshlrev_b32 v29, 1, v29
v_or_b32 v29, v29, v28
v_lshlrev_b32 v29, 4, v29
v_lshlrev_b32 v27, 13, v27
v_add_u32 v27, v27, v29
v_add_u32 v27, s42, v27
v_subrev_u32 v10, 2048, v27
v_add_u32 v27, 6, v25
v_and_b32 v29, 3, v27
v_or_b32 v29, s41, v29
v_xor_b32 v29, v29, v26
v_lshlrev_b32 v29, 1, v29
v_or_b32 v29, v29, v28
v_lshlrev_b32 v29, 4, v29
v_lshlrev_b32 v27, 13, v27
v_add_u32 v27, v27, v29
v_add_u32 v27, s42, v27
v_subrev_u32 v11, 3072, v27
s_lshl_b32 s28, s24, 13
s_lshl_b32 s29, s24, 12
s_add_u32 s29, s29, 98304
s_waitcnt lgkmcnt(0)
s_cmp_eq_u32 s26, 0
s_cselect_b32 s8, s32, s34
s_cselect_b32 s9, s33, s35
s_mov_b32 s10, 8388608
s_mov_b32 s11, 0x20000
s_add_u32 m0, s28, 0
s_mov_b32 s30, 0
L 4,4,s30,0
L 5,4,s30,1024
L 6,4,s30,2048
L 7,4,s30,3072
s_add_u32 m0, s29, 0
s_mov_b32 s31, 0
L 8,8,s31,0
L 9,8,s31,1024
L 10,8,s31,2048
L 11,8,s31,3072
s_add_u32 m0, s28, 4096
s_mov_b32 s30, 65536
L 4,4,s30,0
L 5,4,s30,1024
L 6,4,s30,2048
L 7,4,s30,3072
s_add_u32 m0, s29, 16384
s_mov_b32 s31, 262144
L 8,8,s31,0
L 9,8,s31,1024
L 10,8,s31,2048
L 11,8,s31,3072
s_or_b32 s44, s44, 1
s_lshl_b32 s41, s36, 2
s_cmp_eq_u32 s37, 0
s_cselect_b32 s42, 1, 0
s_cmp_eq_u32 s24, 0
s_cselect_b32 s42, s42, 0
s_cmp_eq_u32 s42, 0
s_cbranch_scc1 MG_nolead
s_mov_b64 exec, 1
v_mov_b32 v3, s44
buffer_store_dword v3, off, s[84:87], s41 sc1
s_mov_b64 exec, -1
MG_nolead:
v_lshrrev_b32 v25, 4, v1
v_and_b32 v26, 15, v1
v_lshrrev_b32 v27, 2, v26
v_and_b32 v28, 3, v26
v_lshlrev_b32 v29, 3, v25
v_add_u32 v29, v29, v27
v_lshlrev_b32 v29, 9, v29
v_lshlrev_b32 v28, 3, v28
v_add_u32 v29, v29, v28
v_and_b32 v30, 1, v25
v_lshlrev_b32 v30, 2, v30
v_or_b32 v30, v30, v27
s_lshr_b32 s41, s24, 1
s_lshl_b32 s41, s41, 8
s_add_u32 s41, s41, 98304
v_add_u32 v29, s41, v29
v_xor_b32 v31, 0, v30
v_lshlrev_b32 v31, 5, v31
v_add_u32 v12, v29, v31
v_xor_b32 v31, 1, v30
v_lshlrev_b32 v31, 5, v31
v_add_u32 v13, v29, v31
v_xor_b32 v31, 2, v30
v_lshlrev_b32 v31, 5, v31
v_add_u32 v14, v29, v31
v_xor_b32 v31, 3, v30
v_lshlrev_b32 v31, 5, v31
v_add_u32 v15, v29, v31
v_xor_b32 v31, 4, v30
v_lshlrev_b32 v31, 5, v31
v_add_u32 v16, v29, v31
v_xor_b32 v31, 5, v30
v_lshlrev_b32 v31, 5, v31
v_add_u32 v17, v29, v31
v_xor_b32 v31, 6, v30
v_lshlrev_b32 v31, 5, v31
v_add_u32 v18, v29, v31
v_xor_b32 v31, 7, v30
v_lshlrev_b32 v31, 5, v31
v_add_u32 v19, v29, v31
v_lshrrev_b32 v27, 1, v26
v_xor_b32 v27, v27, v25
s_and_b32 s41, s24, 1
s_lshl_b32 s41, s41, 14
v_lshlrev_b32 v28, 7, v26
v_add_u32 v28, s41, v28
v_xor_b32 v29, 0, v27
v_lshlrev_b32 v29, 4, v29
v_add_u32 v20, v29, v28
v_add_u32 v21, 0x10000, v20
v_xor_b32 v29, 4, v27
v_lshlrev_b32 v29, 4, v29
v_add_u32 v22, v29, v28
v_add_u32 v23, 0x10000, v22
s_add_u32 m0, s28, 32768
s_mov_b32 s30, 128
L 4,4,s30,0
L 5,4,s30,1024
L 6,4,s30,2048
L 7,4,s30,3072
s_add_u32 m0, s28, 36864
s_mov_b32 s30, 65664
L 4,4,s30,0
L 5,4,s30,1024
L 6,4,s30,2048
L 7,4,s30,3072
s_add_u32 m0, s29, 32768
s_mov_b32 s31, 524288
L 8,8,s31,0
L 9,8,s31,1024
L 10,8,s31,2048
L 11,8,s31,3072
s_add_u32 m0, s29, 49152
s_mov_b32 s31, 786432
L 8,8,s31,0
L 9,8,s31,1024
L 10,8,s31,2048
L 11,8,s31,3072
s_add_u32 m0, s28, 65536
s_mov_b32 s30, 256
L 4,4,s30,0
L 5,4,s30,1024
L 6,4,s30,2048
L 7,4,s30,3072
s_waitcnt vmcnt(20)
s_barrier
s_cmp_lg_u32 s26, 0
s_cbranch_scc1 K1_V
R 32,20,0
T 0,12,0
T 2,12,2048
R 36,20,2048
T 4,13,0
T 6,13,2048
R 40,20,4096
T 8,14,0
T 10,14,2048
R 44,20,6144
T 12,15,0
T 14,15,2048
R 48,20,8192
T 16,16,0
T 18,16,2048
R 52,20,10240
T 20,17,0
T 22,17,2048
R 56,20,12288
T 24,18,0
T 26,18,2048
R 60,20,14336
T 28,19,0
T 30,19,2048
s_waitcnt lgkmcnt(0)
Z v,32,a,0,a,32
R 96,22,0
Z v,36,a,0,a,36
T 64,12,16384
Z v,40,a,0,a,40
s_add_u32 m0, s29, 0
s_lshl_b32 s47, s24, 12
Z v,44,a,0,a,44
T 66,12,18432
s_lshl_b32 s48, s2, 14
Z v,48,a,0,a,48
Z v,52,a,0,a,52
R 100,22,2048
s_add_u32 s47, s47, s48
Z v,56,a,0,a,56
s_mov_b32 s31, 1048576
v_lshlrev_b32 v25, 6, v1
Z v,60,a,0,a,60
T 68,13,16384
Z v,64,a,4,a,32
v_add_u32 v25, s47, v25
Z v,68,a,4,a,36
T 70,13,18432
Z v,72,a,4,a,40
v_subrev_u32 v26, 524288, v25
Z v,76,a,4,a,44
R 104,22,4096
L 8,8,s31,0
Z v,80,a,4,a,48
v_subrev_u32 v27, 1835008, v25
Z v,84,a,4,a,52
T 72,14,16384
v_subrev_u32 v28, 2588672, v25
Z v,88,a,4,a,56
v_lshrrev_b32 v29, 5, v1
Z v,92,a,4,a,60
T 74,14,18432
Z v,96,a,8,a,32
L 9,8,s31,1024
v_lshlrev_b32 v29, 5, v29
Z v,100,a,8,a,36
R 108,22,6144
Z v,104,a,8,a,40
v_lshrrev_b32 v30, 3, v1
Z v,108,a,8,a,44
T 76,15,16384
v_and_b32 v2, 3, v30
Z v,112,a,8,a,48
Z v,116,a,8,a,52
T 78,15,18432
L 10,8,s31,2048
Z v,120,a,8,a,56
v_add_u32 v29, v29, v2
Z v,124,a,8,a,60
R 112,22,8192
s_lshl_b32 s47, s24, 6
Z v,128,a,12,a,32
T 80,16,16384
s_lshl_b32 s48, s27, 2
Z v,132,a,12,a,36
Z v,136,a,12,a,40
T 82,16,18432
L 11,8,s31,3072
Z v,140,a,12,a,44
s_add_u32 s47, s47, s48
v_add_u32 v29, s47, v29
Z v,144,a,12,a,48
R 116,22,10240
Z v,148,a,12,a,52
v_lshlrev_b32 v29, 13, v29
Z v,152,a,12,a,56
T 84,17,16384
Z v,156,a,12,a,60
s_add_u32 m0, s28, 69632
v_and_b32 v3, 7, v1
Z v,160,a,16,a,32
T 86,17,18432
v_lshlrev_b32 v3, 6, v3
Z v,164,a,16,a,36
Z v,168,a,16,a,40
R 120,22,12288
s_lshl_b32 s48, s25, 9
Z v,172,a,16,a,44
s_mov_b32 s30, 65792
Z v,176,a,16,a,48
T 88,18,16384
v_add_u32 v29, s48, v29
Z v,180,a,16,a,52
v_add_u32 v29, v29, v3
Z v,184,a,16,a,56
T 90,18,18432
Z v,188,a,16,a,60
v_and_b32 v30, 1, v30
Z v,192,a,20,a,32
R 124,22,14336
L 4,4,s30,0
Z v,196,a,20,a,36
s_lshl_b32 s47, s27, 8
Z v,200,a,20,a,40
T 92,19,16384
s_lshl_b32 s48, s25, 4
Z v,204,a,20,a,44
Z v,208,a,20,a,48
T 94,19,18432
s_add_u32 s47, s47, s48
Z v,212,a,20,a,52
L 5,4,s30,1024
s_lshl_b32 s48, s26, 3
Z v,216,a,20,a,56
Z v,220,a,20,a,60
s_add_u32 s47, s47, s48
Z v,224,a,24,a,32
Z v,228,a,24,a,36
s_lshl_b32 s48, s24, 1
Z v,232,a,24,a,40
L 6,4,s30,2048
s_add_u32 s47, s47, s48
Z v,236,a,24,a,44
Z v,240,a,24,a,48
v_add_u32 v30, s47, v30
Z v,244,a,24,a,52
v_lshlrev_b32 v30, 11, v30
Z v,248,a,24,a,56
Z v,252,a,24,a,60
L 7,4,s30,3072
v_add_u32 v30, v30, v3
Z a,224,a,28,a,32
Z a,228,a,28,a,36
v_lshrrev_b32 v2, 4, v1
Z a,232,a,28,a,40
v_lshlrev_b32 v2, 9, v2
Z a,236,a,28,a,44
Z a,240,a,28,a,48
v_add_u32 v30, v30, v2
Z a,244,a,28,a,52
Z a,248,a,28,a,56
Z a,252,a,28,a,60
s_waitcnt vmcnt(16) lgkmcnt(0)
s_barrier
M v,32,a,64,a,96
R 32,20,32768
M v,36,a,64,a,100
T 0,12,32768
M v,40,a,64,a,104
s_add_u32 m0, s29, 16384
M v,44,a,64,a,108
T 2,12,34816
M v,48,a,64,a,112
M v,52,a,64,a,116
R 36,20,34816
s_mov_b32 s31, 1310720
M v,56,a,64,a,120
M v,60,a,64,a,124
T 4,13,32768
M v,64,a,68,a,96
M v,68,a,68,a,100
T 6,13,34816
L 8,8,s31,0
M v,72,a,68,a,104
M v,76,a,68,a,108
R 40,20,36864
M v,80,a,68,a,112
M v,84,a,68,a,116
T 8,14,32768
L 9,8,s31,1024
M v,88,a,68,a,120
M v,92,a,68,a,124
T 10,14,34816
M v,96,a,72,a,96
M v,100,a,72,a,100
R 44,20,38912
L 10,8,s31,2048
M v,104,a,72,a,104
M v,108,a,72,a,108
T 12,15,32768
M v,112,a,72,a,112
M v,116,a,72,a,116
T 14,15,34816
L 11,8,s31,3072
M v,120,a,72,a,120
M v,124,a,72,a,124
R 48,20,40960
M v,128,a,76,a,96
T 16,16,32768
M v,132,a,76,a,100
s_add_u32 m0, s28, 0
M v,136,a,76,a,104
T 18,16,34816
M v,140,a,76,a,108
M v,144,a,76,a,112
R 52,20,43008
M v,148,a,76,a,116
s_mov_b32 s30, 384
M v,152,a,76,a,120
T 20,17,32768
M v,156,a,76,a,124
M v,160,a,80,a,96
T 22,17,34816
L 4,4,s30,0
M v,164,a,80,a,100
M v,168,a,80,a,104
R 56,20,45056
M v,172,a,80,a,108
M v,176,a,80,a,112
T 24,18,32768
L 5,4,s30,1024
M v,180,a,80,a,116
M v,184,a,80,a,120
T 26,18,34816
M v,188,a,80,a,124
M v,192,a,84,a,96
R 60,20,47104
L 6,4,s30,2048
M v,196,a,84,a,100
M v,200,a,84,a,104
T 28,19,32768
M v,204,a,84,a,108
M v,208,a,84,a,112
T 30,19,34816
L 7,4,s30,3072
M v,212,a,84,a,116
M v,216,a,84,a,120
M v,220,a,84,a,124
M v,224,a,88,a,96
buffer_load_dword v31, v30, s[4:7], 0 offen
M v,228,a,88,a,100
M v,232,a,88,a,104
M v,236,a,88,a,108
M v,240,a,88,a,112
s_mov_b32 s44, 0
M v,244,a,88,a,116
M v,248,a,88,a,120
M v,252,a,88,a,124
M a,224,a,92,a,96
buffer_load_dword v31, v29, s[8:11], s44 offen
M a,228,a,92,a,100
M a,232,a,92,a,104
M a,236,a,92,a,108
M a,240,a,92,a,112
M a,244,a,92,a,116
M a,248,a,92,a,120
M a,252,a,92,a,124
s_waitcnt vmcnt(18) lgkmcnt(0)
s_barrier
M v,32,a,0,a,32
R 96,22,32768
M v,36,a,0,a,36
T 64,12,49152
M v,40,a,0,a,40
s_add_u32 m0, s29, 32768
M v,44,a,0,a,44
T 66,12,51200
M v,48,a,0,a,48
M v,52,a,0,a,52
R 100,22,34816
s_mov_b32 s31, 1572864
M v,56,a,0,a,56
M v,60,a,0,a,60
T 68,13,49152
M v,64,a,4,a,32
M v,68,a,4,a,36
T 70,13,51200
L 8,8,s31,0
M v,72,a,4,a,40
M v,76,a,4,a,44
R 104,22,36864
M v,80,a,4,a,48
M v,84,a,4,a,52
T 72,14,49152
L 9,8,s31,1024
M v,88,a,4,a,56
M v,92,a,4,a,60
T 74,14,51200
M v,96,a,8,a,32
M v,100,a,8,a,36
R 108,22,38912
L 10,8,s31,2048
M v,104,a,8,a,40
M v,108,a,8,a,44
T 76,15,49152
M v,112,a,8,a,48
M v,116,a,8,a,52
T 78,15,51200
L 11,8,s31,3072
M v,120,a,8,a,56
M v,124,a,8,a,60
R 112,22,40960
M v,128,a,12,a,32
T 80,16,49152
M v,132,a,12,a,36
s_add_u32 m0, s28, 4096
M v,136,a,12,a,40
T 82,16,51200
M v,140,a,12,a,44
M v,144,a,12,a,48
R 116,22,43008
M v,148,a,12,a,52
s_mov_b32 s30, 65920
M v,152,a,12,a,56
T 84,17,49152
M v,156,a,12,a,60
M v,160,a,16,a,32
T 86,17,51200
L 4,4,s30,0
M v,164,a,16,a,36
M v,168,a,16,a,40
R 120,22,45056
M v,172,a,16,a,44
M v,176,a,16,a,48
T 88,18,49152
L 5,4,s30,1024
M v,180,a,16,a,52
M v,184,a,16,a,56
T 90,18,51200
M v,188,a,16,a,60
M v,192,a,20,a,32
R 124,22,47104
L 6,4,s30,2048
M v,196,a,20,a,36
M v,200,a,20,a,40
T 92,19,49152
M v,204,a,20,a,44
M v,208,a,20,a,48
T 94,19,51200
L 7,4,s30,3072
M v,212,a,20,a,52
M v,216,a,20,a,56
M v,220,a,20,a,60
M v,224,a,24,a,32
s_mov_b32 s44, 2097152
M v,228,a,24,a,36
M v,232,a,24,a,40
M v,236,a,24,a,44
M v,240,a,24,a,48
buffer_load_dword v31, v29, s[8:11], s44 offen
M v,244,a,24,a,52
M v,248,a,24,a,56
M v,252,a,24,a,60
M a,224,a,28,a,32
buffer_load_dword v31, v25, s[16:19], 0 offen
M a,228,a,28,a,36
M a,232,a,28,a,40
M a,236,a,28,a,44
M a,240,a,28,a,48
M a,244,a,28,a,52
M a,248,a,28,a,56
M a,252,a,28,a,60
s_waitcnt vmcnt(20) lgkmcnt(0)
s_barrier
M v,32,a,64,a,96
R 32,21,0
M v,36,a,64,a,100
T 0,12,0
M v,40,a,64,a,104
s_add_u32 m0, s29, 49152
M v,44,a,64,a,108
T 2,12,2048
M v,48,a,64,a,112
M v,52,a,64,a,116
R 36,21,2048
M v,56,a,64,a,120
s_mov_b32 s31, 1835008
M v,60,a,64,a,124
T 4,13,0
M v,64,a,68,a,96
M v,68,a,68,a,100
T 6,13,2048
M v,72,a,68,a,104
L 8,8,s31,0
M v,76,a,68,a,108
R 40,21,4096
M v,80,a,68,a,112
M v,84,a,68,a,116
T 8,14,0
M v,88,a,68,a,120
M v,92,a,68,a,124
T 10,14,2048
L 9,8,s31,1024
M v,96,a,72,a,96
M v,100,a,72,a,100
R 44,21,6144
M v,104,a,72,a,104
M v,108,a,72,a,108
T 12,15,0
L 10,8,s31,2048
M v,112,a,72,a,112
M v,116,a,72,a,116
T 14,15,2048
M v,120,a,72,a,120
M v,124,a,72,a,124
R 48,21,8192
M v,128,a,76,a,96
T 16,16,0
L 11,8,s31,3072
M v,132,a,76,a,100
M v,136,a,76,a,104
T 18,16,2048
M v,140,a,76,a,108
M v,144,a,76,a,112
R 52,21,10240
s_add_u32 m0, s28, 32768
M v,148,a,76,a,116
M v,152,a,76,a,120
T 20,17,0
M v,156,a,76,a,124
M v,160,a,80,a,96
T 22,17,2048
M v,164,a,80,a,100
s_mov_b32 s30, 512
M v,168,a,80,a,104
R 56,21,12288
M v,172,a,80,a,108
M v,176,a,80,a,112
T 24,18,0
M v,180,a,80,a,116
L 4,4,s30,0
M v,184,a,80,a,120
T 26,18,2048
M v,188,a,80,a,124
M v,192,a,84,a,96
R 60,21,14336
M v,196,a,84,a,100
M v,200,a,84,a,104
T 28,19,0
L 5,4,s30,1024
M v,204,a,84,a,108
M v,208,a,84,a,112
T 30,19,2048
M v,212,a,84,a,116
M v,216,a,84,a,120
L 6,4,s30,2048
M v,220,a,84,a,124
M v,224,a,88,a,96
M v,228,a,88,a,100
M v,232,a,88,a,104
M v,236,a,88,a,108
L 7,4,s30,3072
M v,240,a,88,a,112
M v,244,a,88,a,116
M v,248,a,88,a,120
M v,252,a,88,a,124
buffer_load_dword v31, v25, s[68:71], 0 offen
M a,224,a,92,a,96
M a,228,a,92,a,100
M a,232,a,92,a,104
M a,236,a,92,a,108
M a,240,a,92,a,112
M a,244,a,92,a,116
M a,248,a,92,a,120
M a,252,a,92,a,124
s_waitcnt vmcnt(19) lgkmcnt(0)
s_barrier
M v,32,a,0,a,32
R 96,23,0
M v,36,a,0,a,36
T 64,12,16384
M v,40,a,0,a,40
s_add_u32 m0, s29, 0
M v,44,a,0,a,44
T 66,12,18432
M v,48,a,0,a,48
M v,52,a,0,a,52
R 100,23,2048
M v,56,a,0,a,56
s_mov_b32 s31, 2097152
M v,60,a,0,a,60
T 68,13,16384
M v,64,a,4,a,32
M v,68,a,4,a,36
T 70,13,18432
M v,72,a,4,a,40
L 8,8,s31,0
M v,76,a,4,a,44
R 104,23,4096
M v,80,a,4,a,48
M v,84,a,4,a,52
T 72,14,16384
M v,88,a,4,a,56
M v,92,a,4,a,60
T 74,14,18432
L 9,8,s31,1024
M v,96,a,8,a,32
M v,100,a,8,a,36
R 108,23,6144
M v,104,a,8,a,40
M v,108,a,8,a,44
T 76,15,16384
L 10,8,s31,2048
M v,112,a,8,a,48
M v,116,a,8,a,52
T 78,15,18432
M v,120,a,8,a,56
M v,124,a,8,a,60
R 112,23,8192
M v,128,a,12,a,32
T 80,16,16384
L 11,8,s31,3072
M v,132,a,12,a,36
M v,136,a,12,a,40
T 82,16,18432
M v,140,a,12,a,44
M v,144,a,12,a,48
R 116,23,10240
s_add_u32 m0, s28, 36864
M v,148,a,12,a,52
M v,152,a,12,a,56
T 84,17,16384
M v,156,a,12,a,60
M v,160,a,16,a,32
T 86,17,18432
M v,164,a,16,a,36
s_mov_b32 s30, 66048
M v,168,a,16,a,40
R 120,23,12288
M v,172,a,16,a,44
M v,176,a,16,a,48
T 88,18,16384
M v,180,a,16,a,52
L 4,4,s30,0
M v,184,a,16,a,56
T 90,18,18432
M v,188,a,16,a,60
M v,192,a,20,a,32
R 124,23,14336
M v,196,a,20,a,36
M v,200,a,20,a,40
T 92,19,16384
L 5,4,s30,1024
M v,204,a,20,a,44
M v,208,a,20,a,48
T 94,19,18432
M v,212,a,20,a,52
M v,216,a,20,a,56
L 6,4,s30,2048
M v,220,a,20,a,60
M v,224,a,24,a,32
M v,228,a,24,a,36
M v,232,a,24,a,40
M v,236,a,24,a,44
L 7,4,s30,3072
M v,240,a,24,a,48
M v,244,a,24,a,52
M v,248,a,24,a,56
M v,252,a,24,a,60
buffer_load_dword v31, v27, s[72:75], 0 offen
M a,224,a,28,a,32
M a,228,a,28,a,36
M a,232,a,28,a,40
M a,236,a,28,a,44
M a,240,a,28,a,48
M a,244,a,28,a,52
M a,248,a,28,a,56
M a,252,a,28,a,60
s_waitcnt vmcnt(18) lgkmcnt(0)
s_barrier
M v,32,a,64,a,96
R 32,20,0
M v,36,a,64,a,100
T 0,12,32768
M v,40,a,64,a,104
s_add_u32 m0, s29, 16384
M v,44,a,64,a,108
T 2,12,34816
M v,48,a,64,a,112
M v,52,a,64,a,116
R 36,20,2048
M v,56,a,64,a,120
s_mov_b32 s31, 2359296
M v,60,a,64,a,124
T 4,13,32768
M v,64,a,68,a,96
M v,68,a,68,a,100
T 6,13,34816
M v,72,a,68,a,104
L 8,8,s31,0
M v,76,a,68,a,108
R 40,20,4096
M v,80,a,68,a,112
M v,84,a,68,a,116
T 8,14,32768
M v,88,a,68,a,120
M v,92,a,68,a,124
T 10,14,34816
L 9,8,s31,1024
M v,96,a,72,a,96
M v,100,a,72,a,100
R 44,20,6144
M v,104,a,72,a,104
M v,108,a,72,a,108
T 12,15,32768
L 10,8,s31,2048
M v,112,a,72,a,112
M v,116,a,72,a,116
T 14,15,34816
M v,120,a,72,a,120
M v,124,a,72,a,124
R 48,20,8192
M v,128,a,76,a,96
T 16,16,32768
L 11,8,s31,3072
M v,132,a,76,a,100
M v,136,a,76,a,104
T 18,16,34816
M v,140,a,76,a,108
M v,144,a,76,a,112
R 52,20,10240
s_add_u32 m0, s28, 65536
M v,148,a,76,a,116
M v,152,a,76,a,120
T 20,17,32768
M v,156,a,76,a,124
M v,160,a,80,a,96
T 22,17,34816
M v,164,a,80,a,100
s_mov_b32 s30, 640
M v,168,a,80,a,104
R 56,20,12288
M v,172,a,80,a,108
M v,176,a,80,a,112
T 24,18,32768
M v,180,a,80,a,116
L 4,4,s30,0
M v,184,a,80,a,120
T 26,18,34816
M v,188,a,80,a,124
M v,192,a,84,a,96
R 60,20,14336
M v,196,a,84,a,100
M v,200,a,84,a,104
T 28,19,32768
L 5,4,s30,1024
M v,204,a,84,a,108
M v,208,a,84,a,112
T 30,19,34816
M v,212,a,84,a,116
M v,216,a,84,a,120
L 6,4,s30,2048
M v,220,a,84,a,124
M v,224,a,88,a,96
M v,228,a,88,a,100
M v,232,a,88,a,104
M v,236,a,88,a,108
L 7,4,s30,3072
M v,240,a,88,a,112
M v,244,a,88,a,116
M v,248,a,88,a,120
M v,252,a,88,a,124
buffer_load_dword v31, v26, s[76:79], 0 offen
M a,224,a,92,a,96
M a,228,a,92,a,100
M a,232,a,92,a,104
M a,236,a,92,a,108
M a,240,a,92,a,112
M a,244,a,92,a,116
M a,248,a,92,a,120
M a,252,a,92,a,124
s_waitcnt vmcnt(18) lgkmcnt(0)
s_barrier
M v,32,a,0,a,32
R 96,22,0
M v,36,a,0,a,36
T 64,12,49152
M v,40,a,0,a,40
s_add_u32 m0, s29, 32768
M v,44,a,0,a,44
T 66,12,51200
M v,48,a,0,a,48
M v,52,a,0,a,52
R 100,22,2048
M v,56,a,0,a,56
s_mov_b32 s31, 2621440
M v,60,a,0,a,60
T 68,13,49152
M v,64,a,4,a,32
M v,68,a,4,a,36
T 70,13,51200
M v,72,a,4,a,40
L 8,8,s31,0
M v,76,a,4,a,44
R 104,22,4096
M v,80,a,4,a,48
M v,84,a,4,a,52
T 72,14,49152
M v,88,a,4,a,56
M v,92,a,4,a,60
T 74,14,51200
L 9,8,s31,1024
M v,96,a,8,a,32
M v,100,a,8,a,36
R 108,22,6144
M v,104,a,8,a,40
M v,108,a,8,a,44
T 76,15,49152
L 10,8,s31,2048
M v,112,a,8,a,48
M v,116,a,8,a,52
T 78,15,51200
M v,120,a,8,a,56
M v,124,a,8,a,60
R 112,22,8192
M v,128,a,12,a,32
T 80,16,49152
L 11,8,s31,3072
M v,132,a,12,a,36
M v,136,a,12,a,40
T 82,16,51200
M v,140,a,12,a,44
M v,144,a,12,a,48
R 116,22,10240
s_add_u32 m0, s28, 69632
M v,148,a,12,a,52
M v,152,a,12,a,56
T 84,17,49152
M v,156,a,12,a,60
M v,160,a,16,a,32
T 86,17,51200
M v,164,a,16,a,36
s_mov_b32 s30, 66176
M v,168,a,16,a,40
R 120,22,12288
M v,172,a,16,a,44
M v,176,a,16,a,48
T 88,18,49152
M v,180,a,16,a,52
L 4,4,s30,0
M v,184,a,16,a,56
T 90,18,51200
M v,188,a,16,a,60
M v,192,a,20,a,32
R 124,22,14336
M v,196,a,20,a,36
M v,200,a,20,a,40
T 92,19,49152
L 5,4,s30,1024
M v,204,a,20,a,44
M v,208,a,20,a,48
T 94,19,51200
M v,212,a,20,a,52
M v,216,a,20,a,56
L 6,4,s30,2048
M v,220,a,20,a,60
M v,224,a,24,a,32
M v,228,a,24,a,36
M v,232,a,24,a,40
M v,236,a,24,a,44
L 7,4,s30,3072
M v,240,a,24,a,48
M v,244,a,24,a,52
M v,248,a,24,a,56
M v,252,a,24,a,60
buffer_load_dword v31, v28, s[80:83], 0 offen
M a,224,a,28,a,32
M a,228,a,28,a,36
M a,232,a,28,a,40
M a,236,a,28,a,44
M a,240,a,28,a,48
M a,244,a,28,a,52
M a,248,a,28,a,56
M a,252,a,28,a,60
s_waitcnt vmcnt(18) lgkmcnt(0)
s_barrier
M v,32,a,64,a,96
R 32,20,32768
M v,36,a,64,a,100
T 0,12,0
M v,40,a,64,a,104
s_add_u32 m0, s29, 49152
M v,44,a,64,a,108
T 2,12,2048
M v,48,a,64,a,112
M v,52,a,64,a,116
R 36,20,34816
M v,56,a,64,a,120
s_mov_b32 s31, 2883584
M v,60,a,64,a,124
T 4,13,0
M v,64,a,68,a,96
M v,68,a,68,a,100
T 6,13,2048
M v,72,a,68,a,104
M v,76,a,68,a,108
R 40,20,36864
L 8,8,s31,0
M v,80,a,68,a,112
M v,84,a,68,a,116
T 8,14,0
M v,88,a,68,a,120
M v,92,a,68,a,124
T 10,14,2048
M v,96,a,72,a,96
L 9,8,s31,1024
M v,100,a,72,a,100
R 44,20,38912
M v,104,a,72,a,104
M v,108,a,72,a,108
T 12,15,0
M v,112,a,72,a,112
M v,116,a,72,a,116
T 14,15,2048
L 10,8,s31,2048
M v,120,a,72,a,120
M v,124,a,72,a,124
R 48,20,40960
M v,128,a,76,a,96
T 16,16,0
M v,132,a,76,a,100
M v,136,a,76,a,104
T 18,16,2048
L 11,8,s31,3072
M v,140,a,76,a,108
M v,144,a,76,a,112
R 52,20,43008
M v,148,a,76,a,116
M v,152,a,76,a,120
T 20,17,0
M v,156,a,76,a,124
s_add_u32 m0, s28, 0
M v,160,a,80,a,96
T 22,17,2048
M v,164,a,80,a,100
M v,168,a,80,a,104
R 56,20,45056
M v,172,a,80,a,108
s_mov_b32 s30, 768
M v,176,a,80,a,112
T 24,18,0
M v,180,a,80,a,116
M v,184,a,80,a,120
T 26,18,2048
M v,188,a,80,a,124
M v,192,a,84,a,96
R 60,20,47104
L 4,4,s30,0
M v,196,a,84,a,100
M v,200,a,84,a,104
T 28,19,0
M v,204,a,84,a,108
M v,208,a,84,a,112
T 30,19,2048
M v,212,a,84,a,116
L 5,4,s30,1024
M v,216,a,84,a,120
M v,220,a,84,a,124
M v,224,a,88,a,96
M v,228,a,88,a,100
M v,232,a,88,a,104
L 6,4,s30,2048
M v,236,a,88,a,108
M v,240,a,88,a,112
M v,244,a,88,a,116
M v,248,a,88,a,120
M v,252,a,88,a,124
L 7,4,s30,3072
M a,224,a,92,a,96
M a,228,a,92,a,100
M a,232,a,92,a,104
M a,236,a,92,a,108
M a,240,a,92,a,112
M a,244,a,92,a,116
M a,248,a,92,a,120
M a,252,a,92,a,124
s_waitcnt vmcnt(17) lgkmcnt(0)
s_barrier
M v,32,a,0,a,32
R 96,22,32768
M v,36,a,0,a,36
T 64,12,16384
M v,40,a,0,a,40
s_add_u32 m0, s29, 0
M v,44,a,0,a,44
T 66,12,18432
M v,48,a,0,a,48
M v,52,a,0,a,52
R 100,22,34816
M v,56,a,0,a,56
s_mov_b32 s31, 3145728
M v,60,a,0,a,60
T 68,13,16384
M v,64,a,4,a,32
M v,68,a,4,a,36
T 70,13,18432
M v,72,a,4,a,40
L 8,8,s31,0
M v,76,a,4,a,44
R 104,22,36864
M v,80,a,4,a,48
M v,84,a,4,a,52
T 72,14,16384
M v,88,a,4,a,56
L 9,8,s31,1024
M v,92,a,4,a,60
T 74,14,18432
M v,96,a,8,a,32
M v,100,a,8,a,36
R 108,22,38912
M v,104,a,8,a,40
L 10,8,s31,2048
M v,108,a,8,a,44
T 76,15,16384
M v,112,a,8,a,48
M v,116,a,8,a,52
T 78,15,18432
M v,120,a,8,a,56
L 11,8,s31,3072
M v,124,a,8,a,60
R 112,22,40960
M v,128,a,12,a,32
T 80,16,16384
M v,132,a,12,a,36
M v,136,a,12,a,40
T 82,16,18432
s_add_u32 m0, s28, 4096
M v,140,a,12,a,44
M v,144,a,12,a,48
R 116,22,43008
M v,148,a,12,a,52
M v,152,a,12,a,56
T 84,17,16384
M v,156,a,12,a,60
s_mov_b32 s30, 66304
M v,160,a,16,a,32
T 86,17,18432
M v,164,a,16,a,36
M v,168,a,16,a,40
R 120,22,45056
M v,172,a,16,a,44
L 4,4,s30,0
M v,176,a,16,a,48
T 88,18,16384
M v,180,a,16,a,52
M v,184,a,16,a,56
T 90,18,18432
M v,188,a,16,a,60
L 5,4,s30,1024
M v,192,a,20,a,32
R 124,22,47104
M v,196,a,20,a,36
M v,200,a,20,a,40
T 92,19,16384
M v,204,a,20,a,44
L 6,4,s30,2048
M v,208,a,20,a,48
T 94,19,18432
M v,212,a,20,a,52
M v,216,a,20,a,56
M v,220,a,20,a,60
L 7,4,s30,3072
M v,224,a,24,a,32
M v,228,a,24,a,36
M v,232,a,24,a,40
M v,236,a,24,a,44
s_mov_b32 s44, 4194304
M v,240,a,24,a,48
M v,244,a,24,a,52
M v,248,a,24,a,56
M v,252,a,24,a,60
buffer_load_dword v31, v29, s[8:11], s44 offen
M a,224,a,28,a,32
M a,228,a,28,a,36
M a,232,a,28,a,40
M a,236,a,28,a,44
M a,240,a,28,a,48
M a,244,a,28,a,52
M a,248,a,28,a,56
M a,252,a,28,a,60
s_waitcnt vmcnt(17) lgkmcnt(0)
s_barrier
M v,32,a,64,a,96
R 32,21,0
M v,36,a,64,a,100
T 0,12,32768
M v,40,a,64,a,104
s_add_u32 m0, s29, 16384
M v,44,a,64,a,108
T 2,12,34816
M v,48,a,64,a,112
M v,52,a,64,a,116
R 36,21,2048
M v,56,a,64,a,120
s_mov_b32 s31, 3407872
M v,60,a,64,a,124
T 4,13,32768
M v,64,a,68,a,96
M v,68,a,68,a,100
T 6,13,34816
M v,72,a,68,a,104
M v,76,a,68,a,108
R 40,21,4096
L 8,8,s31,0
M v,80,a,68,a,112
M v,84,a,68,a,116
T 8,14,32768
M v,88,a,68,a,120
M v,92,a,68,a,124
T 10,14,34816
M v,96,a,72,a,96
L 9,8,s31,1024
M v,100,a,72,a,100
R 44,21,6144
M v,104,a,72,a,104
M v,108,a,72,a,108
T 12,15,32768
M v,112,a,72,a,112
M v,116,a,72,a,116
T 14,15,34816
L 10,8,s31,2048
M v,120,a,72,a,120
M v,124,a,72,a,124
R 48,21,8192
M v,128,a,76,a,96
T 16,16,32768
M v,132,a,76,a,100
M v,136,a,76,a,104
T 18,16,34816
L 11,8,s31,3072
M v,140,a,76,a,108
M v,144,a,76,a,112
R 52,21,10240
M v,148,a,76,a,116
M v,152,a,76,a,120
T 20,17,32768
M v,156,a,76,a,124
s_add_u32 m0, s28, 32768
M v,160,a,80,a,96
T 22,17,34816
M v,164,a,80,a,100
M v,168,a,80,a,104
R 56,21,12288
M v,172,a,80,a,108
s_mov_b32 s30, 896
M v,176,a,80,a,112
T 24,18,32768
M v,180,a,80,a,116
M v,184,a,80,a,120
T 26,18,34816
M v,188,a,80,a,124
M v,192,a,84,a,96
R 60,21,14336
L 4,4,s30,0
M v,196,a,84,a,100
M v,200,a,84,a,104
T 28,19,32768
M v,204,a,84,a,108
M v,208,a,84,a,112
T 30,19,34816
M v,212,a,84,a,116
L 5,4,s30,1024
M v,216,a,84,a,120
M v,220,a,84,a,124
M v,224,a,88,a,96
M v,228,a,88,a,100
M v,232,a,88,a,104
L 6,4,s30,2048
M v,236,a,88,a,108
M v,240,a,88,a,112
M v,244,a,88,a,116
M v,248,a,88,a,120
M v,252,a,88,a,124
L 7,4,s30,3072
M a,224,a,92,a,96
M a,228,a,92,a,100
M a,232,a,92,a,104
M a,236,a,92,a,108
M a,240,a,92,a,112
M a,244,a,92,a,116
M a,248,a,92,a,120
M a,252,a,92,a,124
s_waitcnt vmcnt(17) lgkmcnt(0)
s_barrier
M v,32,a,0,a,32
R 96,23,0
M v,36,a,0,a,36
T 64,12,49152
M v,40,a,0,a,40
s_add_u32 m0, s29, 32768
s_lshl_b32 s40, s25, 21
M v,44,a,0,a,44
T 66,12,51200
M v,48,a,0,a,48
M v,52,a,0,a,52
R 100,23,2048
M v,56,a,0,a,56
s_mov_b32 s31, 3670016
s_lshl_b32 s41, s27, 18
M v,60,a,0,a,60
T 68,13,49152
M v,64,a,4,a,32
M v,68,a,4,a,36
T 70,13,51200
M v,72,a,4,a,40
M v,76,a,4,a,44
R 104,23,4096
L 8,8,s31,0
M v,80,a,4,a,48
s_add_u32 s40, s40, s41
M v,84,a,4,a,52
T 72,14,49152
M v,88,a,4,a,56
M v,92,a,4,a,60
T 74,14,51200
s_add_u32 s40, s40, 1048576
M v,96,a,8,a,32
L 9,8,s31,1024
M v,100,a,8,a,36
R 108,23,6144
M v,104,a,8,a,40
M v,108,a,8,a,44
T 76,15,49152
M v,112,a,8,a,48
s_and_b32 s41, s24, 1
M v,116,a,8,a,52
T 78,15,51200
L 10,8,s31,2048
M v,120,a,8,a,56
M v,124,a,8,a,60
R 112,23,8192
M v,128,a,12,a,32
T 80,16,49152
M v,132,a,12,a,36
s_lshl_b32 s41, s41, 17
M v,136,a,12,a,40
T 82,16,51200
L 11,8,s31,3072
M v,140,a,12,a,44
M v,144,a,12,a,48
R 116,23,10240
M v,148,a,12,a,52
s_add_u32 s40, s40, s41
M v,152,a,12,a,56
T 84,17,49152
M v,156,a,12,a,60
s_add_u32 m0, s28, 36864
M v,160,a,16,a,32
T 86,17,51200
M v,164,a,16,a,36
M v,168,a,16,a,40
R 120,23,12288
s_lshr_b32 s41, s24, 1
M v,172,a,16,a,44
s_mov_b32 s30, 66432
M v,176,a,16,a,48
T 88,18,49152
M v,180,a,16,a,52
M v,184,a,16,a,56
T 90,18,51200
s_lshl_b32 s41, s41, 12
M v,188,a,16,a,60
M v,192,a,20,a,32
R 124,23,14336
L 4,4,s30,0
M v,196,a,20,a,36
M v,200,a,20,a,40
T 92,19,49152
M v,204,a,20,a,44
s_add_u32 s40, s40, s41
M v,208,a,20,a,48
T 94,19,51200
M v,212,a,20,a,52
L 5,4,s30,1024
M v,216,a,20,a,56
M v,220,a,20,a,60
M v,224,a,24,a,32
s_mov_b32 s41, 8192
M v,228,a,24,a,36
M v,232,a,24,a,40
L 6,4,s30,2048
M v,236,a,24,a,44
M v,240,a,24,a,48
s_mov_b32 s42, 24576
M v,244,a,24,a,52
M v,248,a,24,a,56
M v,252,a,24,a,60
L 7,4,s30,3072
M a,224,a,28,a,32
M a,228,a,28,a,36
s_mov_b32 s43, 4294861824
M a,232,a,28,a,40
M a,236,a,28,a,44
M a,240,a,28,a,48
M a,244,a,28,a,52
M a,248,a,28,a,56
M a,252,a,28,a,60
s_waitcnt vmcnt(16) lgkmcnt(0)
s_barrier
M v,32,a,64,a,96
R 32,20,0
M v,36,a,64,a,100
T 0,12,0
M v,40,a,64,a,104
s_add_u32 m0, s29, 49152
s_and_b32 s47, s2, 7
M v,44,a,64,a,108
T 2,12,2048
M v,48,a,64,a,112
M v,52,a,64,a,116
R 36,20,2048
s_lshr_b32 s48, s2, 3
M v,56,a,64,a,120
s_mov_b32 s31, 3932160
M v,60,a,64,a,124
T 4,13,0
M v,64,a,68,a,96
M v,68,a,68,a,100
T 6,13,2048
s_and_b32 s25, s48, 1
M v,72,a,68,a,104
M v,76,a,68,a,108
R 40,20,4096
L 8,8,s31,0
M v,80,a,68,a,112
s_lshl_b32 s47, s47, 1
M v,84,a,68,a,116
T 8,14,0
M v,88,a,68,a,120
M v,92,a,68,a,124
T 10,14,2048
M v,96,a,72,a,96
L 9,8,s31,1024
s_add_u32 s25, s25, s47
M v,100,a,72,a,100
R 44,20,6144
M v,104,a,72,a,104
M v,108,a,72,a,108
T 12,15,0
s_lshr_b32 s26, s48, 1
M v,112,a,72,a,112
M v,116,a,72,a,116
T 14,15,2048
L 10,8,s31,2048
M v,120,a,72,a,120
M v,124,a,72,a,124
R 48,20,8192
s_lshl_b32 s27, s26, 7
M v,128,a,76,a,96
T 16,16,0
M v,132,a,76,a,100
M v,136,a,76,a,104
T 18,16,2048
L 11,8,s31,3072
M v,140,a,76,a,108
s_lshl_b32 s32, s24, 12
M v,144,a,76,a,112
R 52,20,10240
M v,148,a,76,a,116
M v,152,a,76,a,120
T 20,17,0
s_mov_b32 s36, 14336
M v,156,a,76,a,124
s_add_u32 m0, s28, 65536
M v,160,a,80,a,96
T 22,17,2048
M v,164,a,80,a,100
s_lshl_b32 s47, s24, 5
M v,168,a,80,a,104
R 56,20,12288
M v,172,a,80,a,108
s_mov_b32 s30, 1024
M v,176,a,80,a,112
T 24,18,0
M v,180,a,80,a,116
s_add_u32 s47, s47, s27
M v,184,a,80,a,120
T 26,18,2048
M v,188,a,80,a,124
M v,192,a,84,a,96
R 60,20,14336
L 4,4,s30,0
M v,196,a,84,a,100
v_lshrrev_b32 v2, 4, v1
M v,200,a,84,a,104
T 28,19,0
M v,204,a,84,a,108
M v,208,a,84,a,112
T 30,19,2048
v_and_b32 v3, 15, v1
M v,212,a,84,a,116
L 5,4,s30,1024
M v,216,a,84,a,120
M v,220,a,84,a,124
v_add_u32 v3, s47, v3
M v,224,a,88,a,96
M v,228,a,88,a,100
M v,232,a,88,a,104
L 6,4,s30,2048
M v,236,a,88,a,108
v_mul_u32_u24 v0, 896, v3
M v,240,a,88,a,112
M v,244,a,88,a,116
M v,248,a,88,a,120
v_lshlrev_b32 v2, 4, v2
M v,252,a,88,a,124
L 7,4,s30,3072
M a,224,a,92,a,96
M a,228,a,92,a,100
M a,232,a,92,a,104
v_add_u32 v0, v0, v2
M a,236,a,92,a,108
M a,240,a,92,a,112
M a,244,a,92,a,116
M a,248,a,92,a,120
M a,252,a,92,a,124
s_waitcnt vmcnt(16) lgkmcnt(0)
s_barrier
M v,32,a,0,a,32
R 96,22,0
M v,36,a,0,a,36
T 64,12,16384
M v,40,a,0,a,40
s_add_u32 m0, s29, 0
s_and_b32 s47, s2, 7
M v,44,a,0,a,44
T 66,12,18432
M v,48,a,0,a,48
M v,52,a,0,a,52
R 100,22,2048
M v,56,a,0,a,56
s_mov_b32 s31, 4194304
M v,60,a,0,a,60
T 68,13,16384
s_lshr_b32 s48, s2, 3
M v,64,a,4,a,32
M v,68,a,4,a,36
T 70,13,18432
M v,72,a,4,a,40
M v,76,a,4,a,44
R 104,22,4096
L 8,8,s31,0
M v,80,a,4,a,48
s_lshl_b32 s47, s47, 7
M v,84,a,4,a,52
T 72,14,16384
M v,88,a,4,a,56
M v,92,a,4,a,60
T 74,14,18432
M v,96,a,8,a,32
L 9,8,s31,1024
M v,100,a,8,a,36
R 108,22,6144
s_add_u32 s91, s47, 35651584
M v,104,a,8,a,40
M v,108,a,8,a,44
T 76,15,16384
M v,112,a,8,a,48
M v,116,a,8,a,52
T 78,15,18432
L 10,8,s31,2048
M v,120,a,8,a,56
s_lshl_b32 s48, s48, 2
M v,124,a,8,a,60
R 112,22,8192
M v,128,a,12,a,32
T 80,16,16384
M v,132,a,12,a,36
M v,136,a,12,a,40
T 82,16,18432
L 11,8,s31,3072
M v,140,a,12,a,44
s_add_u32 s48, s48, s91
M v,144,a,12,a,48
R 116,22,10240
M v,148,a,12,a,52
M v,152,a,12,a,56
T 84,17,16384
M v,156,a,12,a,60
s_add_u32 m0, s28, 69632
M v,160,a,16,a,32
T 86,17,18432
s_cmp_eq_u32 s24, 0
s_cselect_b32 s89, s48, 0
M v,164,a,16,a,36
M v,168,a,16,a,40
R 120,22,12288
M v,172,a,16,a,44
s_mov_b32 s30, 66560
M v,176,a,16,a,48
T 88,18,16384
M v,180,a,16,a,52
s_mov_b32 s37, 0x53800000
M v,184,a,16,a,56
T 90,18,18432
M v,188,a,16,a,60
M v,192,a,20,a,32
R 124,22,14336
L 4,4,s30,0
M v,196,a,20,a,36
M v,200,a,20,a,40
T 92,19,16384
s_mul_i32 s38, s25, 229376
M v,204,a,20,a,44
M v,208,a,20,a,48
T 94,19,18432
M v,212,a,20,a,52
L 5,4,s30,1024
M v,216,a,20,a,56
M v,220,a,20,a,60
s_mul_i32 s39, s25, 100352
M v,224,a,24,a,32
M v,228,a,24,a,36
M v,232,a,24,a,40
L 6,4,s30,2048
M v,236,a,24,a,44
M v,240,a,24,a,48
s_mov_b32 s64, 0x3db8aa3b
M v,244,a,24,a,52
M v,248,a,24,a,56
M v,252,a,24,a,60
L 7,4,s30,3072
M a,224,a,28,a,32
M a,228,a,28,a,36
s_mov_b32 s65, 0x3db8aa3b
M a,232,a,28,a,40
M a,236,a,28,a,44
M a,240,a,28,a,48
M a,244,a,28,a,52
M a,248,a,28,a,56
M a,252,a,28,a,60
s_waitcnt vmcnt(16) lgkmcnt(0)
s_barrier
M v,32,a,64,a,96
R 32,20,32768
M v,36,a,64,a,100
T 0,12,32768
M v,40,a,64,a,104
s_add_u32 m0, s29, 16384
s_mov_b32 s88, 0
M v,44,a,64,a,108
T 2,12,34816
M v,48,a,64,a,112
M v,52,a,64,a,116
R 36,20,34816
s_cmp_le_u32 s26, 6
s_cselect_b32 s88, 1, s88
M v,56,a,64,a,120
s_mov_b32 s31, 4456448
M v,60,a,64,a,124
T 4,13,32768
M v,64,a,68,a,96
s_cmp_ge_u32 s26, 9
s_cselect_b32 s88, 2, s88
M v,68,a,68,a,100
T 6,13,34816
M v,72,a,68,a,104
L 8,8,s31,0
M v,76,a,68,a,108
R 40,20,36864
s_sub_u32 s47, 15, s26
M v,80,a,68,a,112
M v,84,a,68,a,116
T 8,14,32768
M v,88,a,68,a,120
L 9,8,s31,1024
s_min_u32 s47, s47, s26
M v,92,a,68,a,124
T 10,14,34816
M v,96,a,72,a,96
M v,100,a,72,a,100
R 44,20,38912
s_lshl_b32 s48, s47, 2
M v,104,a,72,a,104
L 10,8,s31,2048
M v,108,a,72,a,108
T 12,15,32768
M v,112,a,72,a,112
s_sub_i32 s48, 28, s48
M v,116,a,72,a,116
T 14,15,34816
M v,120,a,72,a,120
L 11,8,s31,3072
M v,124,a,72,a,124
R 48,20,40960
s_max_i32 s48, s48, 4
M v,128,a,76,a,96
T 16,16,32768
M v,132,a,76,a,100
M v,136,a,76,a,104
T 18,16,34816
s_add_u32 m0, s28, 0
M v,140,a,76,a,108
s_cmp_eq_u32 s88, 0
s_cselect_b32 s48, 0, s48
M v,144,a,76,a,112
R 52,20,43008
M v,148,a,76,a,116
s_add_u32 s49, s26, 1
M v,152,a,76,a,120
T 20,17,32768
M v,156,a,76,a,124
s_mov_b32 s30, 1152
M v,160,a,80,a,96
T 22,17,34816
s_lshl_b32 s49, s49, 2
M v,164,a,80,a,100
M v,168,a,80,a,104
R 56,20,45056
M v,172,a,80,a,108
L 4,4,s30,0
s_lshl_b32 s3, s25, 21
M v,176,a,80,a,112
T 24,18,32768
M v,180,a,80,a,116
M v,184,a,80,a,120
T 26,18,34816
s_add_u32 s3, s3, 983040
M v,188,a,80,a,124
L 5,4,s30,1024
M v,192,a,84,a,96
R 60,20,47104
M v,196,a,84,a,100
s_cmp_eq_u32 s88, 1
s_cselect_b32 s67, 1, 0
s_cselect_b32 s50, 0, s48
M v,200,a,84,a,104
T 28,19,32768
M v,204,a,84,a,108
L 6,4,s30,2048
M v,208,a,84,a,112
T 30,19,34816
s_sub_u32 s51, s49, s50
M v,212,a,84,a,116
M v,216,a,84,a,120
M v,220,a,84,a,124
L 7,4,s30,3072
s_cmp_eq_u32 s88, 1
s_cselect_b32 s51, s48, s51
M v,224,a,88,a,96
M v,228,a,88,a,100
M v,232,a,88,a,104
s_lshr_b32 s34, s51, 2
M v,236,a,88,a,108
buffer_load_dwordx4 a[128:131], v0, s[16:19], 0 offen offset:0
M v,240,a,88,a,112
M v,244,a,88,a,116
s_sub_u32 s34, s34, 1
M v,248,a,88,a,120
M v,252,a,88,a,124
buffer_load_dwordx4 a[132:135], v0, s[16:19], s36 offen offset:0
M a,224,a,92,a,96
s_lshl_b32 s50, s50, 15
M a,228,a,92,a,100
M a,232,a,92,a,104
M a,236,a,92,a,108
s_add_u32 s33, s3, s50
M a,240,a,92,a,112
M a,244,a,92,a,116
M a,248,a,92,a,120
M a,252,a,92,a,124
s_waitcnt vmcnt(18) lgkmcnt(0)
s_barrier
M v,32,a,0,a,32
R 96,22,32768
M v,36,a,0,a,36
T 64,12,49152
M v,40,a,0,a,40
s_add_u32 m0, s29, 32768
M v,44,a,0,a,44
T 66,12,51200
M v,48,a,0,a,48
M v,52,a,0,a,52
R 100,22,34816
s_mov_b32 s31, 4718592
M v,56,a,0,a,56
M v,60,a,0,a,60
T 68,13,49152
M v,64,a,4,a,32
M v,68,a,4,a,36
T 70,13,51200
L 8,8,s31,0
M v,72,a,4,a,40
M v,76,a,4,a,44
R 104,22,36864
M v,80,a,4,a,48
L 9,8,s31,1024
M v,84,a,4,a,52
T 72,14,49152
M v,88,a,4,a,56
M v,92,a,4,a,60
T 74,14,51200
M v,96,a,8,a,32
L 10,8,s31,2048
M v,100,a,8,a,36
R 108,22,38912
M v,104,a,8,a,40
M v,108,a,8,a,44
T 76,15,49152
M v,112,a,8,a,48
L 11,8,s31,3072
M v,116,a,8,a,52
T 78,15,51200
M v,120,a,8,a,56
M v,124,a,8,a,60
R 112,22,40960
s_add_u32 m0, s28, 4096
M v,128,a,12,a,32
T 80,16,49152
M v,132,a,12,a,36
M v,136,a,12,a,40
T 82,16,51200
M v,140,a,12,a,44
s_mov_b32 s30, 66688
M v,144,a,12,a,48
R 116,22,43008
M v,148,a,12,a,52
M v,152,a,12,a,56
T 84,17,49152
M v,156,a,12,a,60
L 4,4,s30,0
M v,160,a,16,a,32
T 86,17,51200
M v,164,a,16,a,36
M v,168,a,16,a,40
R 120,22,45056
L 5,4,s30,1024
M v,172,a,16,a,44
M v,176,a,16,a,48
T 88,18,49152
M v,180,a,16,a,52
M v,184,a,16,a,56
T 90,18,51200
L 6,4,s30,2048
M v,188,a,16,a,60
M v,192,a,20,a,32
R 124,22,47104
M v,196,a,20,a,36
L 7,4,s30,3072
M v,200,a,20,a,40
T 92,19,49152
M v,204,a,20,a,44
M v,208,a,20,a,48
T 94,19,51200
M v,212,a,20,a,52
buffer_load_dwordx4 a[136:139], v0, s[16:19], 0 offen offset:64
M v,216,a,20,a,56
M v,220,a,20,a,60
M v,224,a,24,a,32
M v,228,a,24,a,36
buffer_load_dwordx4 a[140:143], v0, s[16:19], s36 offen offset:64
M v,232,a,24,a,40
M v,236,a,24,a,44
M v,240,a,24,a,48
s_mov_b32 s44, 6291456
M v,244,a,24,a,52
M v,248,a,24,a,56
M v,252,a,24,a,60
M a,224,a,28,a,32
buffer_load_dword v31, v29, s[8:11], s44 offen
M a,228,a,28,a,36
M a,232,a,28,a,40
M a,236,a,28,a,44
M a,240,a,28,a,48
M a,244,a,28,a,52
M a,248,a,28,a,56
M a,252,a,28,a,60
s_waitcnt vmcnt(21) lgkmcnt(0)
s_barrier
M v,32,a,64,a,96
R 32,21,0
M v,36,a,64,a,100
T 0,12,0
M v,40,a,64,a,104
s_add_u32 m0, s29, 49152
v_lshrrev_b32 v25, 5, v1
M v,44,a,64,a,108
T 2,12,2048
M v,48,a,64,a,112
M v,52,a,64,a,116
R 36,21,2048
M v,56,a,64,a,120
s_mov_b32 s31, 4980736
M v,60,a,64,a,124
T 4,13,0
M v,64,a,68,a,96
M v,68,a,68,a,100
T 6,13,2048
v_and_b32 v26, 1, v1
M v,72,a,68,a,104
L 8,8,s31,0
M v,76,a,68,a,108
R 40,21,4096
M v,80,a,68,a,112
M v,84,a,68,a,116
T 8,14,0
M v,88,a,68,a,120
L 9,8,s31,1024
M v,92,a,68,a,124
T 10,14,2048
M v,96,a,72,a,96
M v,100,a,72,a,100
R 44,21,6144
v_and_b32 v27, 31, v1
M v,104,a,72,a,104
L 10,8,s31,2048
M v,108,a,72,a,108
T 12,15,0
M v,112,a,72,a,112
M v,116,a,72,a,116
T 14,15,2048
M v,120,a,72,a,120
L 11,8,s31,3072
M v,124,a,72,a,124
R 48,21,8192
M v,128,a,76,a,96
T 16,16,0
v_lshrrev_b32 v27, 1, v27
M v,132,a,76,a,100
M v,136,a,76,a,104
T 18,16,2048
s_add_u32 m0, s28, 32768
M v,140,a,76,a,108
M v,144,a,76,a,112
R 52,21,10240
M v,148,a,76,a,116
M v,152,a,76,a,120
T 20,17,0
M v,156,a,76,a,124
s_mov_b32 s30, 1280
M v,160,a,80,a,96
T 22,17,2048
s_and_b32 s47, s24, 1
M v,164,a,80,a,100
M v,168,a,80,a,104
R 56,21,12288
M v,172,a,80,a,108
L 4,4,s30,0
M v,176,a,80,a,112
T 24,18,0
M v,180,a,80,a,116
M v,184,a,80,a,120
T 26,18,2048
M v,188,a,80,a,124
L 5,4,s30,1024
s_lshl_b32 s47, s47, 2
M v,192,a,84,a,96
R 60,21,14336
M v,196,a,84,a,100
M v,200,a,84,a,104
T 28,19,0
M v,204,a,84,a,108
L 6,4,s30,2048
M v,208,a,84,a,112
T 30,19,2048
M v,212,a,84,a,116
M v,216,a,84,a,120
M v,220,a,84,a,124
L 7,4,s30,3072
s_lshl_b32 s48, s24, 3
M v,224,a,88,a,96
M v,228,a,88,a,100
M v,232,a,88,a,104
M v,236,a,88,a,108
buffer_load_dwordx4 a[144:147], v0, s[16:19], 0 offen offset:128
M v,240,a,88,a,112
M v,244,a,88,a,116
M v,248,a,88,a,120
s_lshl_b32 s49, s25, 9
M v,252,a,88,a,124
buffer_load_dwordx4 a[148:151], v0, s[16:19], s36 offen offset:128
M a,224,a,92,a,96
M a,228,a,92,a,100
M a,232,a,92,a,104
M a,236,a,92,a,108
M a,240,a,92,a,112
M a,244,a,92,a,116
M a,248,a,92,a,120
M a,252,a,92,a,124
s_waitcnt vmcnt(21) lgkmcnt(0)
s_barrier
M v,32,a,0,a,32
R 96,23,0
M v,36,a,0,a,36
T 64,12,16384
M v,40,a,0,a,40
s_add_u32 m0, s29, 0
v_add_u32 v2, 0, v25
M v,44,a,0,a,44
T 66,12,18432
M v,48,a,0,a,48
M v,52,a,0,a,52
R 100,23,2048
M v,56,a,0,a,56
s_mov_b32 s31, 5242880
M v,60,a,0,a,60
T 68,13,16384
v_and_b32 v3, 3, v2
M v,64,a,4,a,32
M v,68,a,4,a,36
T 70,13,18432
M v,72,a,4,a,40
L 8,8,s31,0
M v,76,a,4,a,44
R 104,23,4096
M v,80,a,4,a,48
v_or_b32 v3, s47, v3
M v,84,a,4,a,52
T 72,14,16384
M v,88,a,4,a,56
L 9,8,s31,1024
M v,92,a,4,a,60
T 74,14,18432
M v,96,a,8,a,32
M v,100,a,8,a,36
R 108,23,6144
v_add_u32 v2, s48, v2
M v,104,a,8,a,40
L 10,8,s31,2048
M v,108,a,8,a,44
T 76,15,16384
M v,112,a,8,a,48
M v,116,a,8,a,52
T 78,15,18432
M v,120,a,8,a,56
L 11,8,s31,3072
v_xor_b32 v3, v3, v27
M v,124,a,8,a,60
R 112,23,8192
M v,128,a,12,a,32
T 80,16,16384
M v,132,a,12,a,36
M v,136,a,12,a,40
T 82,16,18432
s_add_u32 m0, s28, 36864
M v,140,a,12,a,44
v_lshlrev_b32 v3, 1, v3
M v,144,a,12,a,48
R 116,23,10240
M v,148,a,12,a,52
M v,152,a,12,a,56
T 84,17,16384
M v,156,a,12,a,60
s_mov_b32 s30, 66816
M v,160,a,16,a,32
T 86,17,18432
v_or_b32 v3, v3, v26
M v,164,a,16,a,36
M v,168,a,16,a,40
R 120,23,12288
M v,172,a,16,a,44
L 4,4,s30,0
M v,176,a,16,a,48
T 88,18,16384
M v,180,a,16,a,52
v_lshlrev_b32 v3, 4, v3
M v,184,a,16,a,56
T 90,18,18432
M v,188,a,16,a,60
L 5,4,s30,1024
M v,192,a,20,a,32
R 124,23,14336
M v,196,a,20,a,36
M v,200,a,20,a,40
T 92,19,16384
v_lshlrev_b32 v2, 13, v2
M v,204,a,20,a,44
L 6,4,s30,2048
M v,208,a,20,a,48
T 94,19,18432
M v,212,a,20,a,52
M v,216,a,20,a,56
M v,220,a,20,a,60
L 7,4,s30,3072
v_add_u32 v2, v2, v3
M v,224,a,24,a,32
M v,228,a,24,a,36
M v,232,a,24,a,40
M v,236,a,24,a,44
buffer_load_dwordx4 a[152:155], v0, s[16:19], 0 offen offset:192
M v,240,a,24,a,48
v_add_u32 v2, s49, v2
M v,244,a,24,a,52
M v,248,a,24,a,56
M v,252,a,24,a,60
buffer_load_dwordx4 a[156:159], v0, s[16:19], s36 offen offset:192
M a,224,a,28,a,32
M a,228,a,28,a,36
v_mov_b32 v28, v2
M a,232,a,28,a,40
M a,236,a,28,a,44
M a,240,a,28,a,48
M a,244,a,28,a,52
M a,248,a,28,a,56
M a,252,a,28,a,60
s_waitcnt vmcnt(20) lgkmcnt(0)
s_barrier
M v,32,a,64,a,96
R 32,20,0
M v,36,a,64,a,100
T 0,12,32768
M v,40,a,64,a,104
s_add_u32 m0, s29, 16384
v_add_u32 v2, 2, v25
M v,44,a,64,a,108
T 2,12,34816
M v,48,a,64,a,112
M v,52,a,64,a,116
R 36,20,2048
M v,56,a,64,a,120
s_mov_b32 s31, 5505024
M v,60,a,64,a,124
T 4,13,32768
v_and_b32 v3, 3, v2
M v,64,a,68,a,96
M v,68,a,68,a,100
T 6,13,34816
M v,72,a,68,a,104
L 8,8,s31,0
M v,76,a,68,a,108
R 40,20,4096
M v,80,a,68,a,112
v_or_b32 v3, s47, v3
M v,84,a,68,a,116
T 8,14,32768
M v,88,a,68,a,120
L 9,8,s31,1024
M v,92,a,68,a,124
T 10,14,34816
M v,96,a,72,a,96
M v,100,a,72,a,100
R 44,20,6144
v_add_u32 v2, s48, v2
M v,104,a,72,a,104
L 10,8,s31,2048
M v,108,a,72,a,108
T 12,15,32768
M v,112,a,72,a,112
M v,116,a,72,a,116
T 14,15,34816
M v,120,a,72,a,120
L 11,8,s31,3072
v_xor_b32 v3, v3, v27
M v,124,a,72,a,124
R 48,20,8192
M v,128,a,76,a,96
T 16,16,32768
M v,132,a,76,a,100
M v,136,a,76,a,104
T 18,16,34816
s_add_u32 m0, s28, 65536
M v,140,a,76,a,108
v_lshlrev_b32 v3, 1, v3
M v,144,a,76,a,112
R 52,20,10240
M v,148,a,76,a,116
M v,152,a,76,a,120
T 20,17,32768
M v,156,a,76,a,124
s_mov_b32 s30, 1408
M v,160,a,80,a,96
T 22,17,34816
v_or_b32 v3, v3, v26
M v,164,a,80,a,100
M v,168,a,80,a,104
R 56,20,12288
M v,172,a,80,a,108
L 4,4,s30,0
M v,176,a,80,a,112
T 24,18,32768
M v,180,a,80,a,116
v_lshlrev_b32 v3, 4, v3
M v,184,a,80,a,120
T 26,18,34816
M v,188,a,80,a,124
L 5,4,s30,1024
M v,192,a,84,a,96
R 60,20,14336
M v,196,a,84,a,100
M v,200,a,84,a,104
T 28,19,32768
v_lshlrev_b32 v2, 13, v2
M v,204,a,84,a,108
L 6,4,s30,2048
M v,208,a,84,a,112
T 30,19,34816
M v,212,a,84,a,116
M v,216,a,84,a,120
M v,220,a,84,a,124
L 7,4,s30,3072
v_add_u32 v2, v2, v3
M v,224,a,88,a,96
M v,228,a,88,a,100
M v,232,a,88,a,104
M v,236,a,88,a,108
buffer_load_dwordx4 a[160:163], v0, s[16:19], 0 offen offset:256
M v,240,a,88,a,112
v_add_u32 v2, s49, v2
M v,244,a,88,a,116
M v,248,a,88,a,120
M v,252,a,88,a,124
buffer_load_dwordx4 a[164:167], v0, s[16:19], s36 offen offset:256
M a,224,a,92,a,96
M a,228,a,92,a,100
v_subrev_u32 v29, 1024, v2
M a,232,a,92,a,104
M a,236,a,92,a,108
M a,240,a,92,a,112
M a,244,a,92,a,116
M a,248,a,92,a,120
M a,252,a,92,a,124
s_waitcnt vmcnt(20) lgkmcnt(0)
s_barrier
M v,32,a,0,a,32
R 96,22,0
M v,36,a,0,a,36
T 64,12,49152
M v,40,a,0,a,40
s_add_u32 m0, s29, 32768
v_add_u32 v2, 4, v25
M v,44,a,0,a,44
T 66,12,51200
M v,48,a,0,a,48
M v,52,a,0,a,52
R 100,22,2048
M v,56,a,0,a,56
s_mov_b32 s31, 5767168
M v,60,a,0,a,60
T 68,13,49152
v_and_b32 v3, 3, v2
M v,64,a,4,a,32
M v,68,a,4,a,36
T 70,13,51200
M v,72,a,4,a,40
L 8,8,s31,0
M v,76,a,4,a,44
R 104,22,4096
M v,80,a,4,a,48
v_or_b32 v3, s47, v3
M v,84,a,4,a,52
T 72,14,49152
M v,88,a,4,a,56
L 9,8,s31,1024
M v,92,a,4,a,60
T 74,14,51200
M v,96,a,8,a,32
M v,100,a,8,a,36
R 108,22,6144
v_add_u32 v2, s48, v2
M v,104,a,8,a,40
L 10,8,s31,2048
M v,108,a,8,a,44
T 76,15,49152
M v,112,a,8,a,48
M v,116,a,8,a,52
T 78,15,51200
M v,120,a,8,a,56
L 11,8,s31,3072
v_xor_b32 v3, v3, v27
M v,124,a,8,a,60
R 112,22,8192
M v,128,a,12,a,32
T 80,16,49152
M v,132,a,12,a,36
M v,136,a,12,a,40
T 82,16,51200
s_add_u32 m0, s28, 69632
M v,140,a,12,a,44
v_lshlrev_b32 v3, 1, v3
M v,144,a,12,a,48
R 116,22,10240
M v,148,a,12,a,52
M v,152,a,12,a,56
T 84,17,49152
M v,156,a,12,a,60
s_mov_b32 s30, 66944
M v,160,a,16,a,32
T 86,17,51200
v_or_b32 v3, v3, v26
M v,164,a,16,a,36
M v,168,a,16,a,40
R 120,22,12288
M v,172,a,16,a,44
L 4,4,s30,0
M v,176,a,16,a,48
T 88,18,49152
M v,180,a,16,a,52
v_lshlrev_b32 v3, 4, v3
M v,184,a,16,a,56
T 90,18,51200
M v,188,a,16,a,60
L 5,4,s30,1024
M v,192,a,20,a,32
R 124,22,14336
M v,196,a,20,a,36
M v,200,a,20,a,40
T 92,19,49152
v_lshlrev_b32 v2, 13, v2
M v,204,a,20,a,44
L 6,4,s30,2048
M v,208,a,20,a,48
T 94,19,51200
M v,212,a,20,a,52
M v,216,a,20,a,56
M v,220,a,20,a,60
L 7,4,s30,3072
v_add_u32 v2, v2, v3
M v,224,a,24,a,32
M v,228,a,24,a,36
M v,232,a,24,a,40
M v,236,a,24,a,44
buffer_load_dwordx4 a[168:171], v0, s[16:19], 0 offen offset:320
M v,240,a,24,a,48
v_add_u32 v2, s49, v2
M v,244,a,24,a,52
M v,248,a,24,a,56
M v,252,a,24,a,60
buffer_load_dwordx4 a[172:175], v0, s[16:19], s36 offen offset:320
M a,224,a,28,a,32
M a,228,a,28,a,36
v_subrev_u32 v30, 2048, v2
M a,232,a,28,a,40
M a,236,a,28,a,44
M a,240,a,28,a,48
M a,244,a,28,a,52
M a,248,a,28,a,56
M a,252,a,28,a,60
s_waitcnt vmcnt(20) lgkmcnt(0)
s_barrier
M v,32,a,64,a,96
R 32,20,32768
M v,36,a,64,a,100
T 0,12,0
M v,40,a,64,a,104
s_add_u32 m0, s29, 49152
v_add_u32 v2, 6, v25
M v,44,a,64,a,108
T 2,12,2048
M v,48,a,64,a,112
M v,52,a,64,a,116
R 36,20,34816
M v,56,a,64,a,120
s_mov_b32 s31, 6029312
M v,60,a,64,a,124
T 4,13,0
v_and_b32 v3, 3, v2
M v,64,a,68,a,96
M v,68,a,68,a,100
T 6,13,2048
M v,72,a,68,a,104
L 8,8,s31,0
M v,76,a,68,a,108
R 40,20,36864
M v,80,a,68,a,112
v_or_b32 v3, s47, v3
M v,84,a,68,a,116
T 8,14,0
M v,88,a,68,a,120
L 9,8,s31,1024
M v,92,a,68,a,124
T 10,14,2048
M v,96,a,72,a,96
M v,100,a,72,a,100
R 44,20,38912
v_add_u32 v2, s48, v2
M v,104,a,72,a,104
L 10,8,s31,2048
M v,108,a,72,a,108
T 12,15,0
M v,112,a,72,a,112
M v,116,a,72,a,116
T 14,15,2048
M v,120,a,72,a,120
L 11,8,s31,3072
v_xor_b32 v3, v3, v27
M v,124,a,72,a,124
R 48,20,40960
M v,128,a,76,a,96
T 16,16,0
M v,132,a,76,a,100
M v,136,a,76,a,104
T 18,16,2048
s_add_u32 m0, s28, 0
M v,140,a,76,a,108
v_lshlrev_b32 v3, 1, v3
M v,144,a,76,a,112
R 52,20,43008
M v,148,a,76,a,116
M v,152,a,76,a,120
T 20,17,0
M v,156,a,76,a,124
s_mov_b32 s30, 1536
M v,160,a,80,a,96
T 22,17,2048
v_or_b32 v3, v3, v26
M v,164,a,80,a,100
M v,168,a,80,a,104
R 56,20,45056
M v,172,a,80,a,108
L 4,4,s30,0
M v,176,a,80,a,112
T 24,18,0
M v,180,a,80,a,116
v_lshlrev_b32 v3, 4, v3
M v,184,a,80,a,120
T 26,18,2048
M v,188,a,80,a,124
L 5,4,s30,1024
M v,192,a,84,a,96
R 60,20,47104
M v,196,a,84,a,100
M v,200,a,84,a,104
T 28,19,0
v_lshlrev_b32 v2, 13, v2
M v,204,a,84,a,108
L 6,4,s30,2048
M v,208,a,84,a,112
T 30,19,2048
M v,212,a,84,a,116
M v,216,a,84,a,120
M v,220,a,84,a,124
L 7,4,s30,3072
v_add_u32 v2, v2, v3
M v,224,a,88,a,96
M v,228,a,88,a,100
M v,232,a,88,a,104
M v,236,a,88,a,108
buffer_load_dwordx4 a[176:179], v0, s[16:19], 0 offen offset:384
M v,240,a,88,a,112
v_add_u32 v2, s49, v2
M v,244,a,88,a,116
M v,248,a,88,a,120
M v,252,a,88,a,124
buffer_load_dwordx4 a[180:183], v0, s[16:19], s36 offen offset:384
M a,224,a,92,a,96
M a,228,a,92,a,100
v_subrev_u32 v31, 3072, v2
M a,232,a,92,a,104
M a,236,a,92,a,108
M a,240,a,92,a,112
M a,244,a,92,a,116
M a,248,a,92,a,120
M a,252,a,92,a,124
s_waitcnt vmcnt(20) lgkmcnt(0)
s_barrier
M v,32,a,0,a,32
R 96,22,32768
M v,36,a,0,a,36
T 64,12,16384
M v,40,a,0,a,40
s_add_u32 m0, s29, 0
M v,44,a,0,a,44
T 66,12,18432
M v,48,a,0,a,48
M v,52,a,0,a,52
R 100,22,34816
M v,56,a,0,a,56
s_mov_b32 s31, 6291456
M v,60,a,0,a,60
T 68,13,16384
M v,64,a,4,a,32
M v,68,a,4,a,36
T 70,13,18432
M v,72,a,4,a,40
L 8,8,s31,0
M v,76,a,4,a,44
R 104,22,36864
M v,80,a,4,a,48
M v,84,a,4,a,52
T 72,14,16384
M v,88,a,4,a,56
L 9,8,s31,1024
M v,92,a,4,a,60
T 74,14,18432
M v,96,a,8,a,32
M v,100,a,8,a,36
R 108,22,38912
M v,104,a,8,a,40
L 10,8,s31,2048
M v,108,a,8,a,44
T 76,15,16384
M v,112,a,8,a,48
M v,116,a,8,a,52
T 78,15,18432
M v,120,a,8,a,56
L 11,8,s31,3072
M v,124,a,8,a,60
R 112,22,40960
M v,128,a,12,a,32
T 80,16,16384
M v,132,a,12,a,36
M v,136,a,12,a,40
T 82,16,18432
s_add_u32 m0, s28, 4096
M v,140,a,12,a,44
M v,144,a,12,a,48
R 116,22,43008
M v,148,a,12,a,52
M v,152,a,12,a,56
T 84,17,16384
M v,156,a,12,a,60
s_mov_b32 s30, 67072
M v,160,a,16,a,32
T 86,17,18432
M v,164,a,16,a,36
M v,168,a,16,a,40
R 120,22,45056
M v,172,a,16,a,44
L 4,4,s30,0
M v,176,a,16,a,48
T 88,18,16384
M v,180,a,16,a,52
M v,184,a,16,a,56
T 90,18,18432
M v,188,a,16,a,60
L 5,4,s30,1024
M v,192,a,20,a,32
R 124,22,47104
M v,196,a,20,a,36
M v,200,a,20,a,40
T 92,19,16384
M v,204,a,20,a,44
L 6,4,s30,2048
M v,208,a,20,a,48
T 94,19,18432
M v,212,a,20,a,52
M v,216,a,20,a,56
M v,220,a,20,a,60
L 7,4,s30,3072
M v,224,a,24,a,32
M v,228,a,24,a,36
M v,232,a,24,a,40
M v,236,a,24,a,44
buffer_load_dwordx4 a[184:187], v0, s[16:19], 0 offen offset:448
M v,240,a,24,a,48
M v,244,a,24,a,52
M v,248,a,24,a,56
M v,252,a,24,a,60
buffer_load_dwordx4 a[188:191], v0, s[16:19], s36 offen offset:448
M a,224,a,28,a,32
M a,228,a,28,a,36
M a,232,a,28,a,40
M a,236,a,28,a,44
M a,240,a,28,a,48
M a,244,a,28,a,52
M a,248,a,28,a,56
M a,252,a,28,a,60
s_waitcnt vmcnt(20) lgkmcnt(0)
s_barrier
M v,32,a,64,a,96
R 32,21,0
M v,36,a,64,a,100
T 0,12,32768
M v,40,a,64,a,104
s_add_u32 m0, s29, 16384
M v,44,a,64,a,108
T 2,12,34816
M v,48,a,64,a,112
M v,52,a,64,a,116
R 36,21,2048
M v,56,a,64,a,120
s_mov_b32 s31, 6553600
M v,60,a,64,a,124
T 4,13,32768
M v,64,a,68,a,96
M v,68,a,68,a,100
T 6,13,34816
M v,72,a,68,a,104
L 8,8,s31,0
M v,76,a,68,a,108
R 40,21,4096
M v,80,a,68,a,112
M v,84,a,68,a,116
T 8,14,32768
M v,88,a,68,a,120
L 9,8,s31,1024
M v,92,a,68,a,124
T 10,14,34816
M v,96,a,72,a,96
M v,100,a,72,a,100
R 44,21,6144
M v,104,a,72,a,104
L 10,8,s31,2048
M v,108,a,72,a,108
T 12,15,32768
M v,112,a,72,a,112
M v,116,a,72,a,116
T 14,15,34816
M v,120,a,72,a,120
L 11,8,s31,3072
M v,124,a,72,a,124
R 48,21,8192
M v,128,a,76,a,96
T 16,16,32768
M v,132,a,76,a,100
M v,136,a,76,a,104
T 18,16,34816
s_add_u32 m0, s28, 32768
M v,140,a,76,a,108
M v,144,a,76,a,112
R 52,21,10240
M v,148,a,76,a,116
M v,152,a,76,a,120
T 20,17,32768
M v,156,a,76,a,124
s_mov_b32 s30, 1664
M v,160,a,80,a,96
T 22,17,34816
M v,164,a,80,a,100
M v,168,a,80,a,104
R 56,21,12288
M v,172,a,80,a,108
L 4,4,s30,0
M v,176,a,80,a,112
T 24,18,32768
M v,180,a,80,a,116
M v,184,a,80,a,120
T 26,18,34816
M v,188,a,80,a,124
L 5,4,s30,1024
M v,192,a,84,a,96
R 60,21,14336
M v,196,a,84,a,100
M v,200,a,84,a,104
T 28,19,32768
M v,204,a,84,a,108
L 6,4,s30,2048
M v,208,a,84,a,112
T 30,19,34816
M v,212,a,84,a,116
M v,216,a,84,a,120
M v,220,a,84,a,124
L 7,4,s30,3072
M v,224,a,88,a,96
M v,228,a,88,a,100
M v,232,a,88,a,104
M v,236,a,88,a,108
buffer_load_dwordx4 a[192:195], v0, s[16:19], 0 offen offset:512
M v,240,a,88,a,112
M v,244,a,88,a,116
M v,248,a,88,a,120
M v,252,a,88,a,124
buffer_load_dwordx4 a[196:199], v0, s[16:19], s36 offen offset:512
M a,224,a,92,a,96
M a,228,a,92,a,100
M a,232,a,92,a,104
M a,236,a,92,a,108
M a,240,a,92,a,112
M a,244,a,92,a,116
M a,248,a,92,a,120
M a,252,a,92,a,124
s_waitcnt vmcnt(20) lgkmcnt(0)
s_barrier
M v,32,a,0,a,32
R 96,23,0
M v,36,a,0,a,36
T 64,12,49152
M v,40,a,0,a,40
s_add_u32 m0, s29, 32768
M v,44,a,0,a,44
T 66,12,51200
M v,48,a,0,a,48
M v,52,a,0,a,52
R 100,23,2048
M v,56,a,0,a,56
s_mov_b32 s31, 6815744
M v,60,a,0,a,60
T 68,13,49152
M v,64,a,4,a,32
M v,68,a,4,a,36
T 70,13,51200
M v,72,a,4,a,40
L 8,8,s31,0
M v,76,a,4,a,44
R 104,23,4096
M v,80,a,4,a,48
M v,84,a,4,a,52
T 72,14,49152
M v,88,a,4,a,56
L 9,8,s31,1024
M v,92,a,4,a,60
T 74,14,51200
M v,96,a,8,a,32
M v,100,a,8,a,36
R 108,23,6144
M v,104,a,8,a,40
L 10,8,s31,2048
M v,108,a,8,a,44
T 76,15,49152
M v,112,a,8,a,48
M v,116,a,8,a,52
T 78,15,51200
M v,120,a,8,a,56
L 11,8,s31,3072
M v,124,a,8,a,60
R 112,23,8192
M v,128,a,12,a,32
T 80,16,49152
M v,132,a,12,a,36
M v,136,a,12,a,40
T 82,16,51200
s_add_u32 m0, s28, 36864
M v,140,a,12,a,44
M v,144,a,12,a,48
R 116,23,10240
M v,148,a,12,a,52
M v,152,a,12,a,56
T 84,17,49152
M v,156,a,12,a,60
s_mov_b32 s30, 67200
M v,160,a,16,a,32
T 86,17,51200
M v,164,a,16,a,36
M v,168,a,16,a,40
R 120,23,12288
M v,172,a,16,a,44
L 4,4,s30,0
M v,176,a,16,a,48
T 88,18,49152
M v,180,a,16,a,52
M v,184,a,16,a,56
T 90,18,51200
M v,188,a,16,a,60
L 5,4,s30,1024
M v,192,a,20,a,32
R 124,23,14336
M v,196,a,20,a,36
M v,200,a,20,a,40
T 92,19,49152
M v,204,a,20,a,44
L 6,4,s30,2048
M v,208,a,20,a,48
T 94,19,51200
M v,212,a,20,a,52
M v,216,a,20,a,56
M v,220,a,20,a,60
L 7,4,s30,3072
M v,224,a,24,a,32
M v,228,a,24,a,36
M v,232,a,24,a,40
M v,236,a,24,a,44
buffer_load_dwordx4 a[200:203], v0, s[16:19], 0 offen offset:576
M v,240,a,24,a,48
M v,244,a,24,a,52
M v,248,a,24,a,56
M v,252,a,24,a,60
buffer_load_dwordx4 a[204:207], v0, s[16:19], s36 offen offset:576
M a,224,a,28,a,32
M a,228,a,28,a,36
M a,232,a,28,a,40
M a,236,a,28,a,44
M a,240,a,28,a,48
M a,244,a,28,a,52
M a,248,a,28,a,56
M a,252,a,28,a,60
s_waitcnt vmcnt(20) lgkmcnt(0)
s_barrier
M v,32,a,64,a,96
R 32,20,0
M v,36,a,64,a,100
T 0,12,0
M v,40,a,64,a,104
s_add_u32 m0, s29, 49152
M v,44,a,64,a,108
T 2,12,2048
M v,48,a,64,a,112
M v,52,a,64,a,116
R 36,20,2048
M v,56,a,64,a,120
s_mov_b32 s31, 7077888
M v,60,a,64,a,124
T 4,13,0
M v,64,a,68,a,96
M v,68,a,68,a,100
T 6,13,2048
M v,72,a,68,a,104
L 8,8,s31,0
M v,76,a,68,a,108
R 40,20,4096
M v,80,a,68,a,112
M v,84,a,68,a,116
T 8,14,0
M v,88,a,68,a,120
L 9,8,s31,1024
M v,92,a,68,a,124
T 10,14,2048
M v,96,a,72,a,96
M v,100,a,72,a,100
R 44,20,6144
M v,104,a,72,a,104
L 10,8,s31,2048
M v,108,a,72,a,108
T 12,15,0
M v,112,a,72,a,112
M v,116,a,72,a,116
T 14,15,2048
M v,120,a,72,a,120
L 11,8,s31,3072
M v,124,a,72,a,124
R 48,20,8192
M v,128,a,76,a,96
T 16,16,0
M v,132,a,76,a,100
M v,136,a,76,a,104
T 18,16,2048
s_add_u32 m0, s28, 65536
M v,140,a,76,a,108
M v,144,a,76,a,112
R 52,20,10240
M v,148,a,76,a,116
M v,152,a,76,a,120
T 20,17,0
M v,156,a,76,a,124
s_mov_b32 s30, 1792
M v,160,a,80,a,96
T 22,17,2048
M v,164,a,80,a,100
M v,168,a,80,a,104
R 56,20,12288
M v,172,a,80,a,108
L 4,4,s30,0
M v,176,a,80,a,112
T 24,18,0
M v,180,a,80,a,116
M v,184,a,80,a,120
T 26,18,2048
M v,188,a,80,a,124
L 5,4,s30,1024
M v,192,a,84,a,96
R 60,20,14336
M v,196,a,84,a,100
M v,200,a,84,a,104
T 28,19,0
M v,204,a,84,a,108
L 6,4,s30,2048
M v,208,a,84,a,112
T 30,19,2048
M v,212,a,84,a,116
M v,216,a,84,a,120
M v,220,a,84,a,124
L 7,4,s30,3072
M v,224,a,88,a,96
M v,228,a,88,a,100
M v,232,a,88,a,104
M v,236,a,88,a,108
buffer_load_dwordx4 a[208:211], v0, s[16:19], 0 offen offset:640
M v,240,a,88,a,112
M v,244,a,88,a,116
M v,248,a,88,a,120
M v,252,a,88,a,124
buffer_load_dwordx4 a[212:215], v0, s[16:19], s36 offen offset:640
M a,224,a,92,a,96
M a,228,a,92,a,100
M a,232,a,92,a,104
M a,236,a,92,a,108
M a,240,a,92,a,112
M a,244,a,92,a,116
M a,248,a,92,a,120
M a,252,a,92,a,124
s_waitcnt vmcnt(20) lgkmcnt(0)
s_barrier
M v,32,a,0,a,32
R 96,22,0
M v,36,a,0,a,36
T 64,12,16384
M v,40,a,0,a,40
s_add_u32 m0, s29, 0
M v,44,a,0,a,44
T 66,12,18432
M v,48,a,0,a,48
M v,52,a,0,a,52
R 100,22,2048
M v,56,a,0,a,56
s_mov_b32 s31, 7340032
M v,60,a,0,a,60
T 68,13,16384
M v,64,a,4,a,32
M v,68,a,4,a,36
T 70,13,18432
M v,72,a,4,a,40
L 8,8,s31,0
M v,76,a,4,a,44
R 104,22,4096
M v,80,a,4,a,48
M v,84,a,4,a,52
T 72,14,16384
M v,88,a,4,a,56
L 9,8,s31,1024
M v,92,a,4,a,60
T 74,14,18432
M v,96,a,8,a,32
M v,100,a,8,a,36
R 108,22,6144
M v,104,a,8,a,40
L 10,8,s31,2048
M v,108,a,8,a,44
T 76,15,16384
M v,112,a,8,a,48
M v,116,a,8,a,52
T 78,15,18432
M v,120,a,8,a,56
L 11,8,s31,3072
M v,124,a,8,a,60
R 112,22,8192
M v,128,a,12,a,32
T 80,16,16384
M v,132,a,12,a,36
M v,136,a,12,a,40
T 82,16,18432
s_add_u32 m0, s28, 69632
M v,140,a,12,a,44
M v,144,a,12,a,48
R 116,22,10240
M v,148,a,12,a,52
M v,152,a,12,a,56
T 84,17,16384
M v,156,a,12,a,60
s_mov_b32 s30, 67328
M v,160,a,16,a,32
T 86,17,18432
M v,164,a,16,a,36
M v,168,a,16,a,40
R 120,22,12288
M v,172,a,16,a,44
L 4,4,s30,0
M v,176,a,16,a,48
T 88,18,16384
M v,180,a,16,a,52
M v,184,a,16,a,56
T 90,18,18432
M v,188,a,16,a,60
L 5,4,s30,1024
M v,192,a,20,a,32
R 124,22,14336
M v,196,a,20,a,36
M v,200,a,20,a,40
T 92,19,16384
M v,204,a,20,a,44
L 6,4,s30,2048
M v,208,a,20,a,48
T 94,19,18432
M v,212,a,20,a,52
M v,216,a,20,a,56
M v,220,a,20,a,60
L 7,4,s30,3072
M v,224,a,24,a,32
M v,228,a,24,a,36
M v,232,a,24,a,40
M v,236,a,24,a,44
buffer_load_dwordx4 a[216:219], v0, s[16:19], 0 offen offset:704
M v,240,a,24,a,48
M v,244,a,24,a,52
M v,248,a,24,a,56
M v,252,a,24,a,60
buffer_load_dwordx4 a[220:223], v0, s[16:19], s36 offen offset:704
M a,224,a,28,a,32
M a,228,a,28,a,36
M a,232,a,28,a,40
M a,236,a,28,a,44
M a,240,a,28,a,48
M a,244,a,28,a,52
M a,248,a,28,a,56
M a,252,a,28,a,60
s_waitcnt vmcnt(20) lgkmcnt(0)
s_barrier
M v,32,a,64,a,96
R 32,20,32768
M v,36,a,64,a,100
T 0,12,32768
M v,40,a,64,a,104
s_add_u32 m0, s29, 16384
M v,44,a,64,a,108
T 2,12,34816
M v,48,a,64,a,112
M v,52,a,64,a,116
R 36,20,34816
M v,56,a,64,a,120
s_mov_b32 s31, 7602176
M v,60,a,64,a,124
T 4,13,32768
M v,64,a,68,a,96
M v,68,a,68,a,100
T 6,13,34816
M v,72,a,68,a,104
M v,76,a,68,a,108
R 40,20,36864
L 8,8,s31,0
M v,80,a,68,a,112
M v,84,a,68,a,116
T 8,14,32768
M v,88,a,68,a,120
M v,92,a,68,a,124
T 10,14,34816
M v,96,a,72,a,96
L 9,8,s31,1024
M v,100,a,72,a,100
R 44,20,38912
M v,104,a,72,a,104
M v,108,a,72,a,108
T 12,15,32768
M v,112,a,72,a,112
M v,116,a,72,a,116
T 14,15,34816
L 10,8,s31,2048
M v,120,a,72,a,120
M v,124,a,72,a,124
R 48,20,40960
M v,128,a,76,a,96
T 16,16,32768
M v,132,a,76,a,100
M v,136,a,76,a,104
T 18,16,34816
L 11,8,s31,3072
M v,140,a,76,a,108
M v,144,a,76,a,112
R 52,20,43008
M v,148,a,76,a,116
M v,152,a,76,a,120
T 20,17,32768
M v,156,a,76,a,124
s_add_u32 m0, s28, 0
M v,160,a,80,a,96
T 22,17,34816
M v,164,a,80,a,100
M v,168,a,80,a,104
R 56,20,45056
M v,172,a,80,a,108
s_mov_b32 s30, 1920
M v,176,a,80,a,112
T 24,18,32768
M v,180,a,80,a,116
M v,184,a,80,a,120
T 26,18,34816
M v,188,a,80,a,124
M v,192,a,84,a,96
R 60,20,47104
L 4,4,s30,0
M v,196,a,84,a,100
M v,200,a,84,a,104
T 28,19,32768
M v,204,a,84,a,108
M v,208,a,84,a,112
T 30,19,34816
M v,212,a,84,a,116
L 5,4,s30,1024
M v,216,a,84,a,120
M v,220,a,84,a,124
M v,224,a,88,a,96
M v,228,a,88,a,100
M v,232,a,88,a,104
L 6,4,s30,2048
M v,236,a,88,a,108
M v,240,a,88,a,112
M v,244,a,88,a,116
M v,248,a,88,a,120
M v,252,a,88,a,124
L 7,4,s30,3072
M a,224,a,92,a,96
M a,228,a,92,a,100
M a,232,a,92,a,104
M a,236,a,92,a,108
M a,240,a,92,a,112
M a,244,a,92,a,116
M a,248,a,92,a,120
M a,252,a,92,a,124
s_waitcnt vmcnt(18) lgkmcnt(0)
s_barrier
M v,32,a,0,a,32
R 96,22,32768
M v,36,a,0,a,36
T 64,12,49152
M v,40,a,0,a,40
s_add_u32 m0, s29, 32768
M v,44,a,0,a,44
T 66,12,51200
M v,48,a,0,a,48
M v,52,a,0,a,52
R 100,22,34816
M v,56,a,0,a,56
s_mov_b32 s31, 7864320
M v,60,a,0,a,60
T 68,13,49152
M v,64,a,4,a,32
M v,68,a,4,a,36
T 70,13,51200
M v,72,a,4,a,40
M v,76,a,4,a,44
R 104,22,36864
L 8,8,s31,0
M v,80,a,4,a,48
M v,84,a,4,a,52
T 72,14,49152
M v,88,a,4,a,56
M v,92,a,4,a,60
T 74,14,51200
M v,96,a,8,a,32
L 9,8,s31,1024
M v,100,a,8,a,36
R 108,22,38912
M v,104,a,8,a,40
M v,108,a,8,a,44
T 76,15,49152
M v,112,a,8,a,48
M v,116,a,8,a,52
T 78,15,51200
L 10,8,s31,2048
M v,120,a,8,a,56
M v,124,a,8,a,60
R 112,22,40960
M v,128,a,12,a,32
T 80,16,49152
M v,132,a,12,a,36
M v,136,a,12,a,40
T 82,16,51200
L 11,8,s31,3072
M v,140,a,12,a,44
M v,144,a,12,a,48
R 116,22,43008
M v,148,a,12,a,52
M v,152,a,12,a,56
T 84,17,49152
M v,156,a,12,a,60
s_add_u32 m0, s28, 4096
M v,160,a,16,a,32
T 86,17,51200
M v,164,a,16,a,36
M v,168,a,16,a,40
R 120,22,45056
M v,172,a,16,a,44
s_mov_b32 s30, 67456
M v,176,a,16,a,48
T 88,18,49152
M v,180,a,16,a,52
M v,184,a,16,a,56
T 90,18,51200
M v,188,a,16,a,60
M v,192,a,20,a,32
R 124,22,47104
L 4,4,s30,0
M v,196,a,20,a,36
M v,200,a,20,a,40
T 92,19,49152
M v,204,a,20,a,44
M v,208,a,20,a,48
T 94,19,51200
M v,212,a,20,a,52
L 5,4,s30,1024
M v,216,a,20,a,56
M v,220,a,20,a,60
M v,224,a,24,a,32
M v,228,a,24,a,36
M v,232,a,24,a,40
L 6,4,s30,2048
M v,236,a,24,a,44
M v,240,a,24,a,48
M v,244,a,24,a,52
M v,248,a,24,a,56
M v,252,a,24,a,60
L 7,4,s30,3072
M a,224,a,28,a,32
M a,228,a,28,a,36
M a,232,a,28,a,40
M a,236,a,28,a,44
M a,240,a,28,a,48
M a,244,a,28,a,52
M a,248,a,28,a,56
M a,252,a,28,a,60
s_waitcnt vmcnt(16) lgkmcnt(0)
s_barrier
M v,32,a,64,a,96
R 32,21,0
M v,36,a,64,a,100
T 0,12,0
M v,40,a,64,a,104
s_add_u32 m0, s29, 49152
M v,44,a,64,a,108
T 2,12,2048
M v,48,a,64,a,112
M v,52,a,64,a,116
R 36,21,2048
M v,56,a,64,a,120
s_mov_b32 s31, 8126464
M v,60,a,64,a,124
T 4,13,0
M v,64,a,68,a,96
M v,68,a,68,a,100
T 6,13,2048
M v,72,a,68,a,104
M v,76,a,68,a,108
R 40,21,4096
L 8,8,s31,0
M v,80,a,68,a,112
M v,84,a,68,a,116
T 8,14,0
M v,88,a,68,a,120
M v,92,a,68,a,124
T 10,14,2048
M v,96,a,72,a,96
L 9,8,s31,1024
M v,100,a,72,a,100
R 44,21,6144
M v,104,a,72,a,104
M v,108,a,72,a,108
T 12,15,0
M v,112,a,72,a,112
M v,116,a,72,a,116
T 14,15,2048
L 10,8,s31,2048
M v,120,a,72,a,120
M v,124,a,72,a,124
R 48,21,8192
M v,128,a,76,a,96
T 16,16,0
M v,132,a,76,a,100
M v,136,a,76,a,104
T 18,16,2048
L 11,8,s31,3072
M v,140,a,76,a,108
M v,144,a,76,a,112
R 52,21,10240
M v,148,a,76,a,116
M v,152,a,76,a,120
T 20,17,0
M v,156,a,76,a,124
s_add_u32 m0, s32, 32768
M v,160,a,80,a,96
T 22,17,2048
M v,164,a,80,a,100
M v,168,a,80,a,104
R 56,21,12288
M v,172,a,80,a,108
s_mov_b32 s35, 524288
M v,176,a,80,a,112
T 24,18,0
M v,180,a,80,a,116
M v,184,a,80,a,120
T 26,18,2048
M v,188,a,80,a,124
M v,192,a,84,a,96
R 60,21,14336
L 28,68,s35,0
M v,196,a,84,a,100
M v,200,a,84,a,104
T 28,19,0
M v,204,a,84,a,108
M v,208,a,84,a,112
T 30,19,2048
M v,212,a,84,a,116
L 29,68,s35,1024
M v,216,a,84,a,120
M v,220,a,84,a,124
M v,224,a,88,a,96
M v,228,a,88,a,100
M v,232,a,88,a,104
L 30,68,s35,2048
M v,236,a,88,a,108
M v,240,a,88,a,112
M v,244,a,88,a,116
M v,248,a,88,a,120
M v,252,a,88,a,124
L 31,68,s35,3072
M a,224,a,92,a,96
M a,228,a,92,a,100
M a,232,a,92,a,104
M a,236,a,92,a,108
M a,240,a,92,a,112
M a,244,a,92,a,116
M a,248,a,92,a,120
M a,252,a,92,a,124
s_waitcnt vmcnt(16) lgkmcnt(0)
s_barrier
M v,32,a,0,a,32
R 96,23,0
M v,36,a,0,a,36
T 64,12,16384
M v,40,a,0,a,40
s_add_u32 m0, s32, 49152
M v,44,a,0,a,44
T 66,12,18432
M v,48,a,0,a,48
M v,52,a,0,a,52
R 100,23,2048
M v,56,a,0,a,56
M v,60,a,0,a,60
T 68,13,16384
M v,64,a,4,a,32
M v,68,a,4,a,36
T 70,13,18432
M v,72,a,4,a,40
M v,76,a,4,a,44
R 104,23,4096
s_mov_b32 s35, 786432
M v,80,a,4,a,48
M v,84,a,4,a,52
T 72,14,16384
M v,88,a,4,a,56
M v,92,a,4,a,60
T 74,14,18432
M v,96,a,8,a,32
M v,100,a,8,a,36
R 108,23,6144
M v,104,a,8,a,40
M v,108,a,8,a,44
T 76,15,16384
M v,112,a,8,a,48
M v,116,a,8,a,52
T 78,15,18432
L 28,68,s35,0
M v,120,a,8,a,56
M v,124,a,8,a,60
R 112,23,8192
M v,128,a,12,a,32
T 80,16,16384
M v,132,a,12,a,36
M v,136,a,12,a,40
T 82,16,18432
M v,140,a,12,a,44
M v,144,a,12,a,48
R 116,23,10240
M v,148,a,12,a,52
M v,152,a,12,a,56
T 84,17,16384
M v,156,a,12,a,60
L 29,68,s35,1024
M v,160,a,16,a,32
T 86,17,18432
M v,164,a,16,a,36
M v,168,a,16,a,40
R 120,23,12288
M v,172,a,16,a,44
M v,176,a,16,a,48
T 88,18,16384
M v,180,a,16,a,52
M v,184,a,16,a,56
T 90,18,18432
M v,188,a,16,a,60
M v,192,a,20,a,32
R 124,23,14336
L 30,68,s35,2048
M v,196,a,20,a,36
M v,200,a,20,a,40
T 92,19,16384
M v,204,a,20,a,44
M v,208,a,20,a,48
T 94,19,18432
M v,212,a,20,a,52
M v,216,a,20,a,56
M v,220,a,20,a,60
M v,224,a,24,a,32
M v,228,a,24,a,36
M v,232,a,24,a,40
L 31,68,s35,3072
M v,236,a,24,a,44
M v,240,a,24,a,48
M v,244,a,24,a,52
M v,248,a,24,a,56
M v,252,a,24,a,60
M a,224,a,28,a,32
M a,228,a,28,a,36
M a,232,a,28,a,40
M a,236,a,28,a,44
M a,240,a,28,a,48
M a,244,a,28,a,52
M a,248,a,28,a,56
M a,252,a,28,a,60
s_waitcnt vmcnt(12) lgkmcnt(0)
s_barrier
M v,32,a,64,a,96
R 32,20,0
M v,36,a,64,a,100
T 0,12,32768
M v,40,a,64,a,104
s_add_u32 m0, s32, 65536
M v,44,a,64,a,108
T 2,12,34816
M v,48,a,64,a,112
M v,52,a,64,a,116
R 36,20,2048
M v,56,a,64,a,120
M v,60,a,64,a,124
T 4,13,32768
M v,64,a,68,a,96
M v,68,a,68,a,100
T 6,13,34816
M v,72,a,68,a,104
M v,76,a,68,a,108
R 40,20,4096
s_mov_b32 s35, 1048576
M v,80,a,68,a,112
M v,84,a,68,a,116
T 8,14,32768
M v,88,a,68,a,120
M v,92,a,68,a,124
T 10,14,34816
M v,96,a,72,a,96
M v,100,a,72,a,100
R 44,20,6144
M v,104,a,72,a,104
M v,108,a,72,a,108
T 12,15,32768
M v,112,a,72,a,112
M v,116,a,72,a,116
T 14,15,34816
L 28,68,s35,0
M v,120,a,72,a,120
M v,124,a,72,a,124
R 48,20,8192
M v,128,a,76,a,96
T 16,16,32768
M v,132,a,76,a,100
M v,136,a,76,a,104
T 18,16,34816
M v,140,a,76,a,108
M v,144,a,76,a,112
R 52,20,10240
M v,148,a,76,a,116
M v,152,a,76,a,120
T 20,17,32768
M v,156,a,76,a,124
L 29,68,s35,1024
M v,160,a,80,a,96
T 22,17,34816
M v,164,a,80,a,100
M v,168,a,80,a,104
R 56,20,12288
M v,172,a,80,a,108
M v,176,a,80,a,112
T 24,18,32768
M v,180,a,80,a,116
M v,184,a,80,a,120
T 26,18,34816
M v,188,a,80,a,124
M v,192,a,84,a,96
R 60,20,14336
L 30,68,s35,2048
M v,196,a,84,a,100
M v,200,a,84,a,104
T 28,19,32768
M v,204,a,84,a,108
M v,208,a,84,a,112
T 30,19,34816
M v,212,a,84,a,116
M v,216,a,84,a,120
M v,220,a,84,a,124
M v,224,a,88,a,96
M v,228,a,88,a,100
M v,232,a,88,a,104
L 31,68,s35,3072
M v,236,a,88,a,108
M v,240,a,88,a,112
M v,244,a,88,a,116
M v,248,a,88,a,120
M v,252,a,88,a,124
M a,224,a,92,a,96
M a,228,a,92,a,100
M a,232,a,92,a,104
M a,236,a,92,a,108
M a,240,a,92,a,112
M a,244,a,92,a,116
M a,248,a,92,a,120
M a,252,a,92,a,124
s_waitcnt vmcnt(8) lgkmcnt(0)
s_barrier
M v,32,a,0,a,32
R 96,22,0
M v,36,a,0,a,36
T 64,12,49152
M v,40,a,0,a,40
s_add_u32 m0, s32, 81920
M v,44,a,0,a,44
T 66,12,51200
M v,48,a,0,a,48
M v,52,a,0,a,52
R 100,22,2048
M v,56,a,0,a,56
M v,60,a,0,a,60
T 68,13,49152
M v,64,a,4,a,32
M v,68,a,4,a,36
T 70,13,51200
M v,72,a,4,a,40
M v,76,a,4,a,44
R 104,22,4096
s_mov_b32 s35, 1310720
M v,80,a,4,a,48
M v,84,a,4,a,52
T 72,14,49152
M v,88,a,4,a,56
M v,92,a,4,a,60
T 74,14,51200
M v,96,a,8,a,32
M v,100,a,8,a,36
R 108,22,6144
M v,104,a,8,a,40
M v,108,a,8,a,44
T 76,15,49152
M v,112,a,8,a,48
M v,116,a,8,a,52
T 78,15,51200
L 28,68,s35,0
M v,120,a,8,a,56
M v,124,a,8,a,60
R 112,22,8192
M v,128,a,12,a,32
T 80,16,49152
M v,132,a,12,a,36
M v,136,a,12,a,40
T 82,16,51200
M v,140,a,12,a,44
M v,144,a,12,a,48
R 116,22,10240
M v,148,a,12,a,52
M v,152,a,12,a,56
T 84,17,49152
M v,156,a,12,a,60
L 29,68,s35,1024
M v,160,a,16,a,32
T 86,17,51200
M v,164,a,16,a,36
M v,168,a,16,a,40
R 120,22,12288
M v,172,a,16,a,44
M v,176,a,16,a,48
T 88,18,49152
M v,180,a,16,a,52
M v,184,a,16,a,56
T 90,18,51200
M v,188,a,16,a,60
M v,192,a,20,a,32
R 124,22,14336
L 30,68,s35,2048
M v,196,a,20,a,36
M v,200,a,20,a,40
T 92,19,49152
M v,204,a,20,a,44
M v,208,a,20,a,48
T 94,19,51200
M v,212,a,20,a,52
M v,216,a,20,a,56
M v,220,a,20,a,60
M v,224,a,24,a,32
M v,228,a,24,a,36
M v,232,a,24,a,40
L 31,68,s35,3072
M v,236,a,24,a,44
M v,240,a,24,a,48
M v,244,a,24,a,52
M v,248,a,24,a,56
M v,252,a,24,a,60
M a,224,a,28,a,32
M a,228,a,28,a,36
M a,232,a,28,a,40
M a,236,a,28,a,44
M a,240,a,28,a,48
M a,244,a,28,a,52
M a,248,a,28,a,56
M a,252,a,28,a,60
s_waitcnt vmcnt(8) lgkmcnt(0)
s_barrier
M v,32,a,64,a,96
s_and_b32 s47, s2, 7
s_lshl_b32 s47, s47, 2
M v,36,a,64,a,100
buffer_load_dword v2, off, s[84:87], s47 sc1
s_mov_b32 m0, 131072
M v,40,a,64,a,104
s_nop 0
buffer_load_dwordx4 v24, s[20:23], 0 offen lds
M v,44,a,64,a,108
s_add_u32 m0, s32, 0
s_mov_b32 s35, 0
M v,48,a,64,a,112
L 28,68,s35,0
M v,52,a,64,a,116
L 29,68,s35,1024
L 30,68,s35,2048
M v,56,a,64,a,120
L 31,68,s35,3072
s_add_u32 m0, s32, 16384
M v,60,a,64,a,124
s_mov_b32 s35, 262144
L 28,68,s35,0
M v,64,a,68,a,96
L 29,68,s35,1024
L 30,68,s35,2048
M v,68,a,68,a,100
L 31,68,s35,3072
M v,72,a,68,a,104
M v,76,a,68,a,108
M v,80,a,68,a,112
M v,84,a,68,a,116
v_cvt_pk_bf16_f32 v32, v32, v33
v_cvt_pk_bf16_f32 v33, v34, v35
M v,88,a,68,a,120
v_cvt_pk_bf16_f32 v34, v64, v65
v_cvt_pk_bf16_f32 v35, v66, v67
M v,92,a,68,a,124
v_cvt_pk_bf16_f32 v36, v36, v37
v_cvt_pk_bf16_f32 v37, v38, v39
M v,96,a,72,a,96
v_cvt_pk_bf16_f32 v38, v68, v69
v_cvt_pk_bf16_f32 v39, v70, v71
M v,100,a,72,a,100
v_cvt_pk_bf16_f32 v40, v40, v41
v_cvt_pk_bf16_f32 v41, v42, v43
M v,104,a,72,a,104
v_cvt_pk_bf16_f32 v42, v72, v73
v_cvt_pk_bf16_f32 v43, v74, v75
M v,108,a,72,a,108
v_cvt_pk_bf16_f32 v44, v44, v45
v_cvt_pk_bf16_f32 v45, v46, v47
M v,112,a,72,a,112
v_cvt_pk_bf16_f32 v46, v76, v77
v_cvt_pk_bf16_f32 v47, v78, v79
M v,116,a,72,a,116
v_cvt_pk_bf16_f32 v48, v48, v49
v_cvt_pk_bf16_f32 v49, v50, v51
M v,120,a,72,a,120
v_cvt_pk_bf16_f32 v50, v80, v81
v_cvt_pk_bf16_f32 v51, v82, v83
M v,124,a,72,a,124
v_cvt_pk_bf16_f32 v52, v52, v53
v_cvt_pk_bf16_f32 v53, v54, v55
M v,128,a,76,a,96
v_cvt_pk_bf16_f32 v54, v84, v85
v_cvt_pk_bf16_f32 v55, v86, v87
M v,132,a,76,a,100
v_cvt_pk_bf16_f32 v56, v56, v57
v_cvt_pk_bf16_f32 v57, v58, v59
M v,136,a,76,a,104
v_cvt_pk_bf16_f32 v58, v88, v89
v_cvt_pk_bf16_f32 v59, v90, v91
M v,140,a,76,a,108
v_cvt_pk_bf16_f32 v60, v60, v61
v_cvt_pk_bf16_f32 v61, v62, v63
M v,144,a,76,a,112
v_cvt_pk_bf16_f32 v62, v92, v93
v_cvt_pk_bf16_f32 v63, v94, v95
M v,148,a,76,a,116
v_cvt_pk_bf16_f32 v64, v96, v97
v_cvt_pk_bf16_f32 v65, v98, v99
M v,152,a,76,a,120
v_cvt_pk_bf16_f32 v66, v128, v129
v_cvt_pk_bf16_f32 v67, v130, v131
M v,156,a,76,a,124
v_cvt_pk_bf16_f32 v68, v100, v101
v_cvt_pk_bf16_f32 v69, v102, v103
M v,160,a,80,a,96
v_cvt_pk_bf16_f32 v70, v132, v133
v_cvt_pk_bf16_f32 v71, v134, v135
M v,164,a,80,a,100
v_cvt_pk_bf16_f32 v72, v104, v105
v_cvt_pk_bf16_f32 v73, v106, v107
M v,168,a,80,a,104
v_cvt_pk_bf16_f32 v74, v136, v137
v_cvt_pk_bf16_f32 v75, v138, v139
M v,172,a,80,a,108
v_cvt_pk_bf16_f32 v76, v108, v109
v_cvt_pk_bf16_f32 v77, v110, v111
M v,176,a,80,a,112
v_cvt_pk_bf16_f32 v78, v140, v141
v_cvt_pk_bf16_f32 v79, v142, v143
M v,180,a,80,a,116
v_cvt_pk_bf16_f32 v80, v112, v113
v_cvt_pk_bf16_f32 v81, v114, v115
M v,184,a,80,a,120
v_cvt_pk_bf16_f32 v82, v144, v145
v_cvt_pk_bf16_f32 v83, v146, v147
M v,188,a,80,a,124
v_cvt_pk_bf16_f32 v84, v116, v117
v_cvt_pk_bf16_f32 v85, v118, v119
M v,192,a,84,a,96
v_cvt_pk_bf16_f32 v86, v148, v149
v_cvt_pk_bf16_f32 v87, v150, v151
M v,196,a,84,a,100
v_cvt_pk_bf16_f32 v120, v120, v121
v_cvt_pk_bf16_f32 v121, v122, v123
M v,200,a,84,a,104
v_cvt_pk_bf16_f32 v122, v152, v153
v_cvt_pk_bf16_f32 v123, v154, v155
M v,204,a,84,a,108
v_cvt_pk_bf16_f32 v116, v124, v125
v_cvt_pk_bf16_f32 v117, v126, v127
M v,208,a,84,a,112
v_cvt_pk_bf16_f32 v118, v156, v157
v_cvt_pk_bf16_f32 v119, v158, v159
M v,212,a,84,a,116
v_cvt_pk_bf16_f32 v160, v160, v161
v_cvt_pk_bf16_f32 v161, v162, v163
M v,216,a,84,a,120
v_cvt_pk_bf16_f32 v162, v192, v193
v_cvt_pk_bf16_f32 v163, v194, v195
M v,220,a,84,a,124
v_accvgpr_write_b32 a0, v160
v_accvgpr_write_b32 a1, v161
M v,224,a,88,a,96
v_accvgpr_write_b32 a2, v162
v_accvgpr_write_b32 a3, v163
M v,228,a,88,a,100
v_cvt_pk_bf16_f32 v164, v164, v165
v_cvt_pk_bf16_f32 v165, v166, v167
M v,232,a,88,a,104
v_cvt_pk_bf16_f32 v166, v196, v197
v_cvt_pk_bf16_f32 v167, v198, v199
M v,236,a,88,a,108
v_accvgpr_write_b32 a4, v164
v_accvgpr_write_b32 a5, v165
M v,240,a,88,a,112
v_accvgpr_write_b32 a6, v166
v_accvgpr_write_b32 a7, v167
M v,244,a,88,a,116
v_cvt_pk_bf16_f32 v168, v168, v169
v_cvt_pk_bf16_f32 v169, v170, v171
M v,248,a,88,a,120
v_cvt_pk_bf16_f32 v170, v200, v201
v_cvt_pk_bf16_f32 v171, v202, v203
M v,252,a,88,a,124
v_accvgpr_write_b32 a8, v168
v_accvgpr_write_b32 a9, v169
M a,224,a,92,a,96
v_accvgpr_write_b32 a10, v170
v_accvgpr_write_b32 a11, v171
M a,228,a,92,a,100
v_cvt_pk_bf16_f32 v172, v172, v173
v_cvt_pk_bf16_f32 v173, v174, v175
M a,232,a,92,a,104
v_cvt_pk_bf16_f32 v174, v204, v205
v_cvt_pk_bf16_f32 v175, v206, v207
M a,236,a,92,a,108
v_accvgpr_write_b32 a12, v172
v_accvgpr_write_b32 a13, v173
M a,240,a,92,a,112
v_accvgpr_write_b32 a14, v174
v_accvgpr_write_b32 a15, v175
M a,244,a,92,a,116
v_cvt_pk_bf16_f32 v176, v176, v177
v_cvt_pk_bf16_f32 v177, v178, v179
M a,248,a,92,a,120
v_cvt_pk_bf16_f32 v178, v208, v209
v_cvt_pk_bf16_f32 v179, v210, v211
M a,252,a,92,a,124
v_accvgpr_write_b32 a16, v176
v_accvgpr_write_b32 a17, v177
s_nop 7
v_accvgpr_write_b32 a18, v178
v_accvgpr_write_b32 a19, v179
v_cvt_pk_bf16_f32 v180, v180, v181
v_cvt_pk_bf16_f32 v181, v182, v183
v_cvt_pk_bf16_f32 v182, v212, v213
v_cvt_pk_bf16_f32 v183, v214, v215
v_accvgpr_write_b32 a20, v180
v_accvgpr_write_b32 a21, v181
v_accvgpr_write_b32 a22, v182
v_accvgpr_write_b32 a23, v183
v_cvt_pk_bf16_f32 v184, v184, v185
v_cvt_pk_bf16_f32 v185, v186, v187
v_cvt_pk_bf16_f32 v186, v216, v217
v_cvt_pk_bf16_f32 v187, v218, v219
v_accvgpr_write_b32 a24, v184
v_accvgpr_write_b32 a25, v185
v_accvgpr_write_b32 a26, v186
v_accvgpr_write_b32 a27, v187
v_cvt_pk_bf16_f32 v188, v188, v189
v_cvt_pk_bf16_f32 v189, v190, v191
v_cvt_pk_bf16_f32 v190, v220, v221
v_cvt_pk_bf16_f32 v191, v222, v223
v_accvgpr_write_b32 a28, v188
v_accvgpr_write_b32 a29, v189
v_accvgpr_write_b32 a30, v190
v_accvgpr_write_b32 a31, v191
v_accvgpr_read_b32 v160, a224
v_accvgpr_read_b32 v161, a225
v_accvgpr_read_b32 v162, a226
v_accvgpr_read_b32 v163, a227
v_cvt_pk_bf16_f32 v224, v224, v225
v_cvt_pk_bf16_f32 v225, v226, v227
v_cvt_pk_bf16_f32 v226, v160, v161
v_cvt_pk_bf16_f32 v227, v162, v163
v_accvgpr_write_b32 a32, v224
v_accvgpr_write_b32 a33, v225
v_accvgpr_write_b32 a34, v226
v_accvgpr_write_b32 a35, v227
v_accvgpr_read_b32 v164, a228
v_accvgpr_read_b32 v165, a229
v_accvgpr_read_b32 v166, a230
v_accvgpr_read_b32 v167, a231
v_cvt_pk_bf16_f32 v228, v228, v229
v_cvt_pk_bf16_f32 v229, v230, v231
v_cvt_pk_bf16_f32 v230, v164, v165
v_cvt_pk_bf16_f32 v231, v166, v167
v_accvgpr_write_b32 a36, v228
v_accvgpr_write_b32 a37, v229
v_accvgpr_write_b32 a38, v230
v_accvgpr_write_b32 a39, v231
v_accvgpr_read_b32 v160, a232
v_accvgpr_read_b32 v161, a233
v_accvgpr_read_b32 v162, a234
v_accvgpr_read_b32 v163, a235
v_cvt_pk_bf16_f32 v232, v232, v233
v_cvt_pk_bf16_f32 v233, v234, v235
v_cvt_pk_bf16_f32 v234, v160, v161
v_cvt_pk_bf16_f32 v235, v162, v163
v_accvgpr_write_b32 a40, v232
v_accvgpr_write_b32 a41, v233
v_accvgpr_write_b32 a42, v234
v_accvgpr_write_b32 a43, v235
v_accvgpr_read_b32 v164, a236
v_accvgpr_read_b32 v165, a237
v_accvgpr_read_b32 v166, a238
v_accvgpr_read_b32 v167, a239
v_cvt_pk_bf16_f32 v236, v236, v237
v_cvt_pk_bf16_f32 v237, v238, v239
v_cvt_pk_bf16_f32 v238, v164, v165
v_cvt_pk_bf16_f32 v239, v166, v167
v_accvgpr_write_b32 a44, v236
v_accvgpr_write_b32 a45, v237
v_accvgpr_write_b32 a46, v238
v_accvgpr_write_b32 a47, v239
v_accvgpr_read_b32 v160, a240
v_accvgpr_read_b32 v161, a241
v_accvgpr_read_b32 v162, a242
v_accvgpr_read_b32 v163, a243
v_cvt_pk_bf16_f32 v240, v240, v241
v_cvt_pk_bf16_f32 v241, v242, v243
v_cvt_pk_bf16_f32 v242, v160, v161
v_cvt_pk_bf16_f32 v243, v162, v163
v_accvgpr_write_b32 a48, v240
v_accvgpr_write_b32 a49, v241
v_accvgpr_write_b32 a50, v242
v_accvgpr_write_b32 a51, v243
v_accvgpr_read_b32 v164, a244
v_accvgpr_read_b32 v165, a245
v_accvgpr_read_b32 v166, a246
v_accvgpr_read_b32 v167, a247
v_cvt_pk_bf16_f32 v244, v244, v245
v_cvt_pk_bf16_f32 v245, v246, v247
v_cvt_pk_bf16_f32 v246, v164, v165
v_cvt_pk_bf16_f32 v247, v166, v167
v_accvgpr_write_b32 a52, v244
v_accvgpr_write_b32 a53, v245
v_accvgpr_write_b32 a54, v246
v_accvgpr_write_b32 a55, v247
v_accvgpr_read_b32 v160, a248
v_accvgpr_read_b32 v161, a249
v_accvgpr_read_b32 v162, a250
v_accvgpr_read_b32 v163, a251
v_cvt_pk_bf16_f32 v248, v248, v249
v_cvt_pk_bf16_f32 v249, v250, v251
v_cvt_pk_bf16_f32 v250, v160, v161
v_cvt_pk_bf16_f32 v251, v162, v163
v_accvgpr_write_b32 a56, v248
v_accvgpr_write_b32 a57, v249
v_accvgpr_write_b32 a58, v250
v_accvgpr_write_b32 a59, v251
v_accvgpr_read_b32 v164, a252
v_accvgpr_read_b32 v165, a253
v_accvgpr_read_b32 v166, a254
v_accvgpr_read_b32 v167, a255
v_cvt_pk_bf16_f32 v252, v252, v253
v_cvt_pk_bf16_f32 v253, v254, v255
v_cvt_pk_bf16_f32 v254, v164, v165
v_cvt_pk_bf16_f32 v255, v166, v167
v_accvgpr_write_b32 a60, v252
v_accvgpr_write_b32 a61, v253
v_accvgpr_write_b32 a62, v254
v_accvgpr_write_b32 a63, v255
s_branch MG_in
K1_V:
R 0,20,0
T 32,12,0
T 34,12,2048
R 4,20,2048
T 36,13,0
T 38,13,2048
R 8,20,4096
T 40,14,0
T 42,14,2048
R 12,20,6144
T 44,15,0
T 46,15,2048
R 16,20,8192
T 48,16,0
T 50,16,2048
R 20,20,10240
T 52,17,0
T 54,17,2048
R 24,20,12288
T 56,18,0
T 58,18,2048
R 28,20,14336
T 60,19,0
T 62,19,2048
s_waitcnt lgkmcnt(0)
Z v,32,a,0,a,32
R 64,22,0
Z v,36,a,0,a,36
T 96,12,16384
Z v,40,a,0,a,40
s_add_u32 m0, s29, 0
s_lshl_b32 s47, s24, 12
Z v,44,a,0,a,44
T 98,12,18432
s_lshl_b32 s48, s2, 14
Z v,48,a,0,a,48
Z v,52,a,0,a,52
R 68,22,2048
s_add_u32 s47, s47, s48
Z v,56,a,0,a,56
s_mov_b32 s31, 1048576
v_lshlrev_b32 v25, 6, v1
Z v,60,a,0,a,60
T 100,13,16384
Z v,64,a,4,a,32
v_add_u32 v25, s47, v25
Z v,68,a,4,a,36
T 102,13,18432
Z v,72,a,4,a,40
v_subrev_u32 v26, 524288, v25
Z v,76,a,4,a,44
R 72,22,4096
L 8,8,s31,0
Z v,80,a,4,a,48
v_subrev_u32 v27, 1835008, v25
Z v,84,a,4,a,52
T 104,14,16384
v_subrev_u32 v28, 2588672, v25
Z v,88,a,4,a,56
v_lshrrev_b32 v29, 5, v1
Z v,92,a,4,a,60
T 106,14,18432
Z v,96,a,8,a,32
L 9,8,s31,1024
v_lshlrev_b32 v29, 5, v29
Z v,100,a,8,a,36
R 76,22,6144
Z v,104,a,8,a,40
v_lshrrev_b32 v30, 3, v1
Z v,108,a,8,a,44
T 108,15,16384
v_and_b32 v2, 3, v30
Z v,112,a,8,a,48
Z v,116,a,8,a,52
T 110,15,18432
L 10,8,s31,2048
Z v,120,a,8,a,56
v_add_u32 v29, v29, v2
Z v,124,a,8,a,60
R 80,22,8192
s_lshl_b32 s47, s24, 6
Z v,128,a,12,a,32
T 112,16,16384
s_lshl_b32 s48, s27, 2
Z v,132,a,12,a,36
Z v,136,a,12,a,40
T 114,16,18432
L 11,8,s31,3072
Z v,140,a,12,a,44
s_add_u32 s47, s47, s48
v_add_u32 v29, s47, v29
Z v,144,a,12,a,48
R 84,22,10240
Z v,148,a,12,a,52
v_lshlrev_b32 v29, 13, v29
Z v,152,a,12,a,56
T 116,17,16384
Z v,156,a,12,a,60
s_add_u32 m0, s28, 69632
v_and_b32 v3, 7, v1
Z v,160,a,16,a,32
T 118,17,18432
v_lshlrev_b32 v3, 6, v3
Z v,164,a,16,a,36
Z v,168,a,16,a,40
R 88,22,12288
s_lshl_b32 s48, s25, 9
Z v,172,a,16,a,44
s_mov_b32 s30, 65792
Z v,176,a,16,a,48
T 120,18,16384
v_add_u32 v29, s48, v29
Z v,180,a,16,a,52
v_add_u32 v29, v29, v3
Z v,184,a,16,a,56
T 122,18,18432
Z v,188,a,16,a,60
v_and_b32 v30, 1, v30
Z v,192,a,20,a,32
R 92,22,14336
L 4,4,s30,0
Z v,196,a,20,a,36
s_lshl_b32 s47, s27, 8
Z v,200,a,20,a,40
T 124,19,16384
s_lshl_b32 s48, s25, 4
Z v,204,a,20,a,44
Z v,208,a,20,a,48
T 126,19,18432
s_add_u32 s47, s47, s48
Z v,212,a,20,a,52
L 5,4,s30,1024
s_lshl_b32 s48, s26, 3
Z v,216,a,20,a,56
Z v,220,a,20,a,60
s_add_u32 s47, s47, s48
Z v,224,a,24,a,32
Z v,228,a,24,a,36
s_lshl_b32 s48, s24, 1
Z v,232,a,24,a,40
L 6,4,s30,2048
s_add_u32 s47, s47, s48
Z v,236,a,24,a,44
Z v,240,a,24,a,48
v_add_u32 v30, s47, v30
Z v,244,a,24,a,52
v_lshlrev_b32 v30, 11, v30
Z v,248,a,24,a,56
Z v,252,a,24,a,60
L 7,4,s30,3072
v_add_u32 v30, v30, v3
Z a,224,a,28,a,32
Z a,228,a,28,a,36
v_lshrrev_b32 v2, 4, v1
Z a,232,a,28,a,40
v_lshlrev_b32 v2, 9, v2
Z a,236,a,28,a,44
Z a,240,a,28,a,48
v_add_u32 v30, v30, v2
Z a,244,a,28,a,52
Z a,248,a,28,a,56
Z a,252,a,28,a,60
s_waitcnt vmcnt(16) lgkmcnt(0)
s_barrier
M v,32,a,64,a,96
R 0,20,32768
M v,36,a,64,a,100
T 32,12,32768
M v,40,a,64,a,104
s_add_u32 m0, s29, 16384
M v,44,a,64,a,108
T 34,12,34816
M v,48,a,64,a,112
M v,52,a,64,a,116
R 4,20,34816
s_mov_b32 s31, 1310720
M v,56,a,64,a,120
M v,60,a,64,a,124
T 36,13,32768
M v,64,a,68,a,96
M v,68,a,68,a,100
T 38,13,34816
L 8,8,s31,0
M v,72,a,68,a,104
M v,76,a,68,a,108
R 8,20,36864
M v,80,a,68,a,112
M v,84,a,68,a,116
T 40,14,32768
L 9,8,s31,1024
M v,88,a,68,a,120
M v,92,a,68,a,124
T 42,14,34816
M v,96,a,72,a,96
M v,100,a,72,a,100
R 12,20,38912
L 10,8,s31,2048
M v,104,a,72,a,104
M v,108,a,72,a,108
T 44,15,32768
M v,112,a,72,a,112
M v,116,a,72,a,116
T 46,15,34816
L 11,8,s31,3072
M v,120,a,72,a,120
M v,124,a,72,a,124
R 16,20,40960
M v,128,a,76,a,96
T 48,16,32768
M v,132,a,76,a,100
s_add_u32 m0, s28, 0
M v,136,a,76,a,104
T 50,16,34816
M v,140,a,76,a,108
M v,144,a,76,a,112
R 20,20,43008
M v,148,a,76,a,116
s_mov_b32 s30, 384
M v,152,a,76,a,120
T 52,17,32768
M v,156,a,76,a,124
M v,160,a,80,a,96
T 54,17,34816
L 4,4,s30,0
M v,164,a,80,a,100
M v,168,a,80,a,104
R 24,20,45056
M v,172,a,80,a,108
M v,176,a,80,a,112
T 56,18,32768
L 5,4,s30,1024
M v,180,a,80,a,116
M v,184,a,80,a,120
T 58,18,34816
M v,188,a,80,a,124
M v,192,a,84,a,96
R 28,20,47104
L 6,4,s30,2048
M v,196,a,84,a,100
M v,200,a,84,a,104
T 60,19,32768
M v,204,a,84,a,108
M v,208,a,84,a,112
T 62,19,34816
L 7,4,s30,3072
M v,212,a,84,a,116
M v,216,a,84,a,120
M v,220,a,84,a,124
M v,224,a,88,a,96
buffer_load_dword v31, v30, s[4:7], 0 offen
M v,228,a,88,a,100
M v,232,a,88,a,104
M v,236,a,88,a,108
M v,240,a,88,a,112
s_mov_b32 s44, 0
M v,244,a,88,a,116
M v,248,a,88,a,120
M v,252,a,88,a,124
M a,224,a,92,a,96
buffer_load_dword v31, v29, s[8:11], s44 offen
M a,228,a,92,a,100
M a,232,a,92,a,104
M a,236,a,92,a,108
M a,240,a,92,a,112
M a,244,a,92,a,116
M a,248,a,92,a,120
M a,252,a,92,a,124
s_waitcnt vmcnt(18) lgkmcnt(0)
s_barrier
M v,32,a,0,a,32
R 64,22,32768
M v,36,a,0,a,36
T 96,12,49152
M v,40,a,0,a,40
s_add_u32 m0, s29, 32768
M v,44,a,0,a,44
T 98,12,51200
M v,48,a,0,a,48
M v,52,a,0,a,52
R 68,22,34816
s_mov_b32 s31, 1572864
M v,56,a,0,a,56
M v,60,a,0,a,60
T 100,13,49152
M v,64,a,4,a,32
M v,68,a,4,a,36
T 102,13,51200
L 8,8,s31,0
M v,72,a,4,a,40
M v,76,a,4,a,44
R 72,22,36864
M v,80,a,4,a,48
M v,84,a,4,a,52
T 104,14,49152
L 9,8,s31,1024
M v,88,a,4,a,56
M v,92,a,4,a,60
T 106,14,51200
M v,96,a,8,a,32
M v,100,a,8,a,36
R 76,22,38912
L 10,8,s31,2048
M v,104,a,8,a,40
M v,108,a,8,a,44
T 108,15,49152
M v,112,a,8,a,48
M v,116,a,8,a,52
T 110,15,51200
L 11,8,s31,3072
M v,120,a,8,a,56
M v,124,a,8,a,60
R 80,22,40960
M v,128,a,12,a,32
T 112,16,49152
M v,132,a,12,a,36
s_add_u32 m0, s28, 4096
M v,136,a,12,a,40
T 114,16,51200
M v,140,a,12,a,44
M v,144,a,12,a,48
R 84,22,43008
M v,148,a,12,a,52
s_mov_b32 s30, 65920
M v,152,a,12,a,56
T 116,17,49152
M v,156,a,12,a,60
M v,160,a,16,a,32
T 118,17,51200
L 4,4,s30,0
M v,164,a,16,a,36
M v,168,a,16,a,40
R 88,22,45056
M v,172,a,16,a,44
M v,176,a,16,a,48
T 120,18,49152
L 5,4,s30,1024
M v,180,a,16,a,52
M v,184,a,16,a,56
T 122,18,51200
M v,188,a,16,a,60
M v,192,a,20,a,32
R 92,22,47104
L 6,4,s30,2048
M v,196,a,20,a,36
M v,200,a,20,a,40
T 124,19,49152
M v,204,a,20,a,44
M v,208,a,20,a,48
T 126,19,51200
L 7,4,s30,3072
M v,212,a,20,a,52
M v,216,a,20,a,56
M v,220,a,20,a,60
M v,224,a,24,a,32
s_mov_b32 s44, 2097152
M v,228,a,24,a,36
M v,232,a,24,a,40
M v,236,a,24,a,44
M v,240,a,24,a,48
buffer_load_dword v31, v29, s[8:11], s44 offen
M v,244,a,24,a,52
M v,248,a,24,a,56
M v,252,a,24,a,60
M a,224,a,28,a,32
buffer_load_dword v31, v25, s[16:19], 0 offen
M a,228,a,28,a,36
M a,232,a,28,a,40
M a,236,a,28,a,44
M a,240,a,28,a,48
M a,244,a,28,a,52
M a,248,a,28,a,56
M a,252,a,28,a,60
s_waitcnt vmcnt(20) lgkmcnt(0)
s_barrier
M v,32,a,64,a,96
R 0,21,0
M v,36,a,64,a,100
T 32,12,0
M v,40,a,64,a,104
s_add_u32 m0, s29, 49152
M v,44,a,64,a,108
T 34,12,2048
M v,48,a,64,a,112
M v,52,a,64,a,116
R 4,21,2048
M v,56,a,64,a,120
s_mov_b32 s31, 1835008
M v,60,a,64,a,124
T 36,13,0
M v,64,a,68,a,96
M v,68,a,68,a,100
T 38,13,2048
M v,72,a,68,a,104
L 8,8,s31,0
M v,76,a,68,a,108
R 8,21,4096
M v,80,a,68,a,112
M v,84,a,68,a,116
T 40,14,0
M v,88,a,68,a,120
M v,92,a,68,a,124
T 42,14,2048
L 9,8,s31,1024
M v,96,a,72,a,96
M v,100,a,72,a,100
R 12,21,6144
M v,104,a,72,a,104
M v,108,a,72,a,108
T 44,15,0
L 10,8,s31,2048
M v,112,a,72,a,112
M v,116,a,72,a,116
T 46,15,2048
M v,120,a,72,a,120
M v,124,a,72,a,124
R 16,21,8192
M v,128,a,76,a,96
T 48,16,0
L 11,8,s31,3072
M v,132,a,76,a,100
M v,136,a,76,a,104
T 50,16,2048
M v,140,a,76,a,108
M v,144,a,76,a,112
R 20,21,10240
s_add_u32 m0, s28, 32768
M v,148,a,76,a,116
M v,152,a,76,a,120
T 52,17,0
M v,156,a,76,a,124
M v,160,a,80,a,96
T 54,17,2048
M v,164,a,80,a,100
s_mov_b32 s30, 512
M v,168,a,80,a,104
R 24,21,12288
M v,172,a,80,a,108
M v,176,a,80,a,112
T 56,18,0
M v,180,a,80,a,116
L 4,4,s30,0
M v,184,a,80,a,120
T 58,18,2048
M v,188,a,80,a,124
M v,192,a,84,a,96
R 28,21,14336
M v,196,a,84,a,100
M v,200,a,84,a,104
T 60,19,0
L 5,4,s30,1024
M v,204,a,84,a,108
M v,208,a,84,a,112
T 62,19,2048
M v,212,a,84,a,116
M v,216,a,84,a,120
L 6,4,s30,2048
M v,220,a,84,a,124
M v,224,a,88,a,96
M v,228,a,88,a,100
M v,232,a,88,a,104
M v,236,a,88,a,108
L 7,4,s30,3072
M v,240,a,88,a,112
M v,244,a,88,a,116
M v,248,a,88,a,120
M v,252,a,88,a,124
buffer_load_dword v31, v25, s[68:71], 0 offen
M a,224,a,92,a,96
M a,228,a,92,a,100
M a,232,a,92,a,104
M a,236,a,92,a,108
M a,240,a,92,a,112
M a,244,a,92,a,116
M a,248,a,92,a,120
M a,252,a,92,a,124
s_waitcnt vmcnt(19) lgkmcnt(0)
s_barrier
M v,32,a,0,a,32
R 64,23,0
M v,36,a,0,a,36
T 96,12,16384
M v,40,a,0,a,40
s_add_u32 m0, s29, 0
M v,44,a,0,a,44
T 98,12,18432
M v,48,a,0,a,48
M v,52,a,0,a,52
R 68,23,2048
M v,56,a,0,a,56
s_mov_b32 s31, 2097152
M v,60,a,0,a,60
T 100,13,16384
M v,64,a,4,a,32
M v,68,a,4,a,36
T 102,13,18432
M v,72,a,4,a,40
L 8,8,s31,0
M v,76,a,4,a,44
R 72,23,4096
M v,80,a,4,a,48
M v,84,a,4,a,52
T 104,14,16384
M v,88,a,4,a,56
M v,92,a,4,a,60
T 106,14,18432
L 9,8,s31,1024
M v,96,a,8,a,32
M v,100,a,8,a,36
R 76,23,6144
M v,104,a,8,a,40
M v,108,a,8,a,44
T 108,15,16384
L 10,8,s31,2048
M v,112,a,8,a,48
M v,116,a,8,a,52
T 110,15,18432
M v,120,a,8,a,56
M v,124,a,8,a,60
R 80,23,8192
M v,128,a,12,a,32
T 112,16,16384
L 11,8,s31,3072
M v,132,a,12,a,36
M v,136,a,12,a,40
T 114,16,18432
M v,140,a,12,a,44
M v,144,a,12,a,48
R 84,23,10240
s_add_u32 m0, s28, 36864
M v,148,a,12,a,52
M v,152,a,12,a,56
T 116,17,16384
M v,156,a,12,a,60
M v,160,a,16,a,32
T 118,17,18432
M v,164,a,16,a,36
s_mov_b32 s30, 66048
M v,168,a,16,a,40
R 88,23,12288
M v,172,a,16,a,44
M v,176,a,16,a,48
T 120,18,16384
M v,180,a,16,a,52
L 4,4,s30,0
M v,184,a,16,a,56
T 122,18,18432
M v,188,a,16,a,60
M v,192,a,20,a,32
R 92,23,14336
M v,196,a,20,a,36
M v,200,a,20,a,40
T 124,19,16384
L 5,4,s30,1024
M v,204,a,20,a,44
M v,208,a,20,a,48
T 126,19,18432
M v,212,a,20,a,52
M v,216,a,20,a,56
L 6,4,s30,2048
M v,220,a,20,a,60
M v,224,a,24,a,32
M v,228,a,24,a,36
M v,232,a,24,a,40
M v,236,a,24,a,44
L 7,4,s30,3072
M v,240,a,24,a,48
M v,244,a,24,a,52
M v,248,a,24,a,56
M v,252,a,24,a,60
buffer_load_dword v31, v27, s[72:75], 0 offen
M a,224,a,28,a,32
M a,228,a,28,a,36
M a,232,a,28,a,40
M a,236,a,28,a,44
M a,240,a,28,a,48
M a,244,a,28,a,52
M a,248,a,28,a,56
M a,252,a,28,a,60
s_waitcnt vmcnt(18) lgkmcnt(0)
s_barrier
M v,32,a,64,a,96
R 0,20,0
M v,36,a,64,a,100
T 32,12,32768
M v,40,a,64,a,104
s_add_u32 m0, s29, 16384
M v,44,a,64,a,108
T 34,12,34816
M v,48,a,64,a,112
M v,52,a,64,a,116
R 4,20,2048
M v,56,a,64,a,120
s_mov_b32 s31, 2359296
M v,60,a,64,a,124
T 36,13,32768
M v,64,a,68,a,96
M v,68,a,68,a,100
T 38,13,34816
M v,72,a,68,a,104
L 8,8,s31,0
M v,76,a,68,a,108
R 8,20,4096
M v,80,a,68,a,112
M v,84,a,68,a,116
T 40,14,32768
M v,88,a,68,a,120
M v,92,a,68,a,124
T 42,14,34816
L 9,8,s31,1024
M v,96,a,72,a,96
M v,100,a,72,a,100
R 12,20,6144
M v,104,a,72,a,104
M v,108,a,72,a,108
T 44,15,32768
L 10,8,s31,2048
M v,112,a,72,a,112
M v,116,a,72,a,116
T 46,15,34816
M v,120,a,72,a,120
M v,124,a,72,a,124
R 16,20,8192
M v,128,a,76,a,96
T 48,16,32768
L 11,8,s31,3072
M v,132,a,76,a,100
M v,136,a,76,a,104
T 50,16,34816
M v,140,a,76,a,108
M v,144,a,76,a,112
R 20,20,10240
s_add_u32 m0, s28, 65536
M v,148,a,76,a,116
M v,152,a,76,a,120
T 52,17,32768
M v,156,a,76,a,124
M v,160,a,80,a,96
T 54,17,34816
M v,164,a,80,a,100
s_mov_b32 s30, 640
M v,168,a,80,a,104
R 24,20,12288
M v,172,a,80,a,108
M v,176,a,80,a,112
T 56,18,32768
M v,180,a,80,a,116
L 4,4,s30,0
M v,184,a,80,a,120
T 58,18,34816
M v,188,a,80,a,124
M v,192,a,84,a,96
R 28,20,14336
M v,196,a,84,a,100
M v,200,a,84,a,104
T 60,19,32768
L 5,4,s30,1024
M v,204,a,84,a,108
M v,208,a,84,a,112
T 62,19,34816
M v,212,a,84,a,116
M v,216,a,84,a,120
L 6,4,s30,2048
M v,220,a,84,a,124
M v,224,a,88,a,96
M v,228,a,88,a,100
M v,232,a,88,a,104
M v,236,a,88,a,108
L 7,4,s30,3072
M v,240,a,88,a,112
M v,244,a,88,a,116
M v,248,a,88,a,120
M v,252,a,88,a,124
buffer_load_dword v31, v26, s[76:79], 0 offen
M a,224,a,92,a,96
M a,228,a,92,a,100
M a,232,a,92,a,104
M a,236,a,92,a,108
M a,240,a,92,a,112
M a,244,a,92,a,116
M a,248,a,92,a,120
M a,252,a,92,a,124
s_waitcnt vmcnt(18) lgkmcnt(0)
s_barrier
M v,32,a,0,a,32
R 64,22,0
M v,36,a,0,a,36
T 96,12,49152
M v,40,a,0,a,40
s_add_u32 m0, s29, 32768
M v,44,a,0,a,44
T 98,12,51200
M v,48,a,0,a,48
M v,52,a,0,a,52
R 68,22,2048
M v,56,a,0,a,56
s_mov_b32 s31, 2621440
M v,60,a,0,a,60
T 100,13,49152
M v,64,a,4,a,32
M v,68,a,4,a,36
T 102,13,51200
M v,72,a,4,a,40
L 8,8,s31,0
M v,76,a,4,a,44
R 72,22,4096
M v,80,a,4,a,48
M v,84,a,4,a,52
T 104,14,49152
M v,88,a,4,a,56
M v,92,a,4,a,60
T 106,14,51200
L 9,8,s31,1024
M v,96,a,8,a,32
M v,100,a,8,a,36
R 76,22,6144
M v,104,a,8,a,40
M v,108,a,8,a,44
T 108,15,49152
L 10,8,s31,2048
M v,112,a,8,a,48
M v,116,a,8,a,52
T 110,15,51200
M v,120,a,8,a,56
M v,124,a,8,a,60
R 80,22,8192
M v,128,a,12,a,32
T 112,16,49152
L 11,8,s31,3072
M v,132,a,12,a,36
M v,136,a,12,a,40
T 114,16,51200
M v,140,a,12,a,44
M v,144,a,12,a,48
R 84,22,10240
s_add_u32 m0, s28, 69632
M v,148,a,12,a,52
M v,152,a,12,a,56
T 116,17,49152
M v,156,a,12,a,60
M v,160,a,16,a,32
T 118,17,51200
M v,164,a,16,a,36
s_mov_b32 s30, 66176
M v,168,a,16,a,40
R 88,22,12288
M v,172,a,16,a,44
M v,176,a,16,a,48
T 120,18,49152
M v,180,a,16,a,52
L 4,4,s30,0
M v,184,a,16,a,56
T 122,18,51200
M v,188,a,16,a,60
M v,192,a,20,a,32
R 92,22,14336
M v,196,a,20,a,36
M v,200,a,20,a,40
T 124,19,49152
L 5,4,s30,1024
M v,204,a,20,a,44
M v,208,a,20,a,48
T 126,19,51200
M v,212,a,20,a,52
M v,216,a,20,a,56
L 6,4,s30,2048
M v,220,a,20,a,60
M v,224,a,24,a,32
M v,228,a,24,a,36
M v,232,a,24,a,40
M v,236,a,24,a,44
L 7,4,s30,3072
M v,240,a,24,a,48
M v,244,a,24,a,52
M v,248,a,24,a,56
M v,252,a,24,a,60
buffer_load_dword v31, v28, s[80:83], 0 offen
M a,224,a,28,a,32
M a,228,a,28,a,36
M a,232,a,28,a,40
M a,236,a,28,a,44
M a,240,a,28,a,48
M a,244,a,28,a,52
M a,248,a,28,a,56
M a,252,a,28,a,60
s_waitcnt vmcnt(18) lgkmcnt(0)
s_barrier
M v,32,a,64,a,96
R 0,20,32768
M v,36,a,64,a,100
T 32,12,0
M v,40,a,64,a,104
s_add_u32 m0, s29, 49152
M v,44,a,64,a,108
T 34,12,2048
M v,48,a,64,a,112
M v,52,a,64,a,116
R 4,20,34816
M v,56,a,64,a,120
s_mov_b32 s31, 2883584
M v,60,a,64,a,124
T 36,13,0
M v,64,a,68,a,96
M v,68,a,68,a,100
T 38,13,2048
M v,72,a,68,a,104
M v,76,a,68,a,108
R 8,20,36864
L 8,8,s31,0
M v,80,a,68,a,112
M v,84,a,68,a,116
T 40,14,0
M v,88,a,68,a,120
M v,92,a,68,a,124
T 42,14,2048
M v,96,a,72,a,96
L 9,8,s31,1024
M v,100,a,72,a,100
R 12,20,38912
M v,104,a,72,a,104
M v,108,a,72,a,108
T 44,15,0
M v,112,a,72,a,112
M v,116,a,72,a,116
T 46,15,2048
L 10,8,s31,2048
M v,120,a,72,a,120
M v,124,a,72,a,124
R 16,20,40960
M v,128,a,76,a,96
T 48,16,0
M v,132,a,76,a,100
M v,136,a,76,a,104
T 50,16,2048
L 11,8,s31,3072
M v,140,a,76,a,108
M v,144,a,76,a,112
R 20,20,43008
M v,148,a,76,a,116
M v,152,a,76,a,120
T 52,17,0
M v,156,a,76,a,124
s_add_u32 m0, s28, 0
M v,160,a,80,a,96
T 54,17,2048
M v,164,a,80,a,100
M v,168,a,80,a,104
R 24,20,45056
M v,172,a,80,a,108
s_mov_b32 s30, 768
M v,176,a,80,a,112
T 56,18,0
M v,180,a,80,a,116
M v,184,a,80,a,120
T 58,18,2048
M v,188,a,80,a,124
M v,192,a,84,a,96
R 28,20,47104
L 4,4,s30,0
M v,196,a,84,a,100
M v,200,a,84,a,104
T 60,19,0
M v,204,a,84,a,108
M v,208,a,84,a,112
T 62,19,2048
M v,212,a,84,a,116
L 5,4,s30,1024
M v,216,a,84,a,120
M v,220,a,84,a,124
M v,224,a,88,a,96
M v,228,a,88,a,100
M v,232,a,88,a,104
L 6,4,s30,2048
M v,236,a,88,a,108
M v,240,a,88,a,112
M v,244,a,88,a,116
M v,248,a,88,a,120
M v,252,a,88,a,124
L 7,4,s30,3072
M a,224,a,92,a,96
M a,228,a,92,a,100
M a,232,a,92,a,104
M a,236,a,92,a,108
M a,240,a,92,a,112
M a,244,a,92,a,116
M a,248,a,92,a,120
M a,252,a,92,a,124
s_waitcnt vmcnt(17) lgkmcnt(0)
s_barrier
M v,32,a,0,a,32
R 64,22,32768
M v,36,a,0,a,36
T 96,12,16384
M v,40,a,0,a,40
s_add_u32 m0, s29, 0
M v,44,a,0,a,44
T 98,12,18432
M v,48,a,0,a,48
M v,52,a,0,a,52
R 68,22,34816
M v,56,a,0,a,56
s_mov_b32 s31, 3145728
M v,60,a,0,a,60
T 100,13,16384
M v,64,a,4,a,32
M v,68,a,4,a,36
T 102,13,18432
M v,72,a,4,a,40
L 8,8,s31,0
M v,76,a,4,a,44
R 72,22,36864
M v,80,a,4,a,48
M v,84,a,4,a,52
T 104,14,16384
M v,88,a,4,a,56
L 9,8,s31,1024
M v,92,a,4,a,60
T 106,14,18432
M v,96,a,8,a,32
M v,100,a,8,a,36
R 76,22,38912
M v,104,a,8,a,40
L 10,8,s31,2048
M v,108,a,8,a,44
T 108,15,16384
M v,112,a,8,a,48
M v,116,a,8,a,52
T 110,15,18432
M v,120,a,8,a,56
L 11,8,s31,3072
M v,124,a,8,a,60
R 80,22,40960
M v,128,a,12,a,32
T 112,16,16384
M v,132,a,12,a,36
M v,136,a,12,a,40
T 114,16,18432
s_add_u32 m0, s28, 4096
M v,140,a,12,a,44
M v,144,a,12,a,48
R 84,22,43008
M v,148,a,12,a,52
M v,152,a,12,a,56
T 116,17,16384
M v,156,a,12,a,60
s_mov_b32 s30, 66304
M v,160,a,16,a,32
T 118,17,18432
M v,164,a,16,a,36
M v,168,a,16,a,40
R 88,22,45056
M v,172,a,16,a,44
L 4,4,s30,0
M v,176,a,16,a,48
T 120,18,16384
M v,180,a,16,a,52
M v,184,a,16,a,56
T 122,18,18432
M v,188,a,16,a,60
L 5,4,s30,1024
M v,192,a,20,a,32
R 92,22,47104
M v,196,a,20,a,36
M v,200,a,20,a,40
T 124,19,16384
M v,204,a,20,a,44
L 6,4,s30,2048
M v,208,a,20,a,48
T 126,19,18432
M v,212,a,20,a,52
M v,216,a,20,a,56
M v,220,a,20,a,60
L 7,4,s30,3072
M v,224,a,24,a,32
M v,228,a,24,a,36
M v,232,a,24,a,40
M v,236,a,24,a,44
s_mov_b32 s44, 4194304
M v,240,a,24,a,48
M v,244,a,24,a,52
M v,248,a,24,a,56
M v,252,a,24,a,60
buffer_load_dword v31, v29, s[8:11], s44 offen
M a,224,a,28,a,32
M a,228,a,28,a,36
M a,232,a,28,a,40
M a,236,a,28,a,44
M a,240,a,28,a,48
M a,244,a,28,a,52
M a,248,a,28,a,56
M a,252,a,28,a,60
s_waitcnt vmcnt(17) lgkmcnt(0)
s_barrier
M v,32,a,64,a,96
R 0,21,0
M v,36,a,64,a,100
T 32,12,32768
M v,40,a,64,a,104
s_add_u32 m0, s29, 16384
M v,44,a,64,a,108
T 34,12,34816
M v,48,a,64,a,112
M v,52,a,64,a,116
R 4,21,2048
M v,56,a,64,a,120
s_mov_b32 s31, 3407872
M v,60,a,64,a,124
T 36,13,32768
M v,64,a,68,a,96
M v,68,a,68,a,100
T 38,13,34816
M v,72,a,68,a,104
M v,76,a,68,a,108
R 8,21,4096
L 8,8,s31,0
M v,80,a,68,a,112
M v,84,a,68,a,116
T 40,14,32768
M v,88,a,68,a,120
M v,92,a,68,a,124
T 42,14,34816
M v,96,a,72,a,96
L 9,8,s31,1024
M v,100,a,72,a,100
R 12,21,6144
M v,104,a,72,a,104
M v,108,a,72,a,108
T 44,15,32768
M v,112,a,72,a,112
M v,116,a,72,a,116
T 46,15,34816
L 10,8,s31,2048
M v,120,a,72,a,120
M v,124,a,72,a,124
R 16,21,8192
M v,128,a,76,a,96
T 48,16,32768
M v,132,a,76,a,100
M v,136,a,76,a,104
T 50,16,34816
L 11,8,s31,3072
M v,140,a,76,a,108
M v,144,a,76,a,112
R 20,21,10240
M v,148,a,76,a,116
M v,152,a,76,a,120
T 52,17,32768
M v,156,a,76,a,124
s_add_u32 m0, s28, 32768
M v,160,a,80,a,96
T 54,17,34816
M v,164,a,80,a,100
M v,168,a,80,a,104
R 24,21,12288
M v,172,a,80,a,108
s_mov_b32 s30, 896
M v,176,a,80,a,112
T 56,18,32768
M v,180,a,80,a,116
M v,184,a,80,a,120
T 58,18,34816
M v,188,a,80,a,124
M v,192,a,84,a,96
R 28,21,14336
L 4,4,s30,0
M v,196,a,84,a,100
M v,200,a,84,a,104
T 60,19,32768
M v,204,a,84,a,108
M v,208,a,84,a,112
T 62,19,34816
M v,212,a,84,a,116
L 5,4,s30,1024
M v,216,a,84,a,120
M v,220,a,84,a,124
M v,224,a,88,a,96
M v,228,a,88,a,100
M v,232,a,88,a,104
L 6,4,s30,2048
M v,236,a,88,a,108
M v,240,a,88,a,112
M v,244,a,88,a,116
M v,248,a,88,a,120
M v,252,a,88,a,124
L 7,4,s30,3072
M a,224,a,92,a,96
M a,228,a,92,a,100
M a,232,a,92,a,104
M a,236,a,92,a,108
M a,240,a,92,a,112
M a,244,a,92,a,116
M a,248,a,92,a,120
M a,252,a,92,a,124
s_waitcnt vmcnt(17) lgkmcnt(0)
s_barrier
M v,32,a,0,a,32
R 64,23,0
M v,36,a,0,a,36
T 96,12,49152
M v,40,a,0,a,40
s_add_u32 m0, s29, 32768
s_lshl_b32 s40, s25, 21
M v,44,a,0,a,44
T 98,12,51200
M v,48,a,0,a,48
M v,52,a,0,a,52
R 68,23,2048
M v,56,a,0,a,56
s_mov_b32 s31, 3670016
s_lshl_b32 s41, s27, 18
M v,60,a,0,a,60
T 100,13,49152
M v,64,a,4,a,32
M v,68,a,4,a,36
T 102,13,51200
M v,72,a,4,a,40
M v,76,a,4,a,44
R 72,23,4096
L 8,8,s31,0
M v,80,a,4,a,48
s_add_u32 s40, s40, s41
M v,84,a,4,a,52
T 104,14,49152
M v,88,a,4,a,56
M v,92,a,4,a,60
T 106,14,51200
s_add_u32 s40, s40, 1064960
M v,96,a,8,a,32
L 9,8,s31,1024
M v,100,a,8,a,36
R 76,23,6144
M v,104,a,8,a,40
M v,108,a,8,a,44
T 108,15,49152
M v,112,a,8,a,48
s_and_b32 s41, s24, 1
M v,116,a,8,a,52
T 110,15,51200
L 10,8,s31,2048
M v,120,a,8,a,56
M v,124,a,8,a,60
R 80,23,8192
M v,128,a,12,a,32
T 112,16,49152
M v,132,a,12,a,36
s_lshl_b32 s41, s41, 17
M v,136,a,12,a,40
T 114,16,51200
L 11,8,s31,3072
M v,140,a,12,a,44
M v,144,a,12,a,48
R 84,23,10240
M v,148,a,12,a,52
s_add_u32 s40, s40, s41
M v,152,a,12,a,56
T 116,17,49152
M v,156,a,12,a,60
s_add_u32 m0, s28, 36864
M v,160,a,16,a,32
T 118,17,51200
M v,164,a,16,a,36
M v,168,a,16,a,40
R 88,23,12288
s_lshr_b32 s41, s24, 1
M v,172,a,16,a,44
s_mov_b32 s30, 66432
M v,176,a,16,a,48
T 120,18,49152
M v,180,a,16,a,52
M v,184,a,16,a,56
T 122,18,51200
s_lshl_b32 s41, s41, 13
M v,188,a,16,a,60
M v,192,a,20,a,32
R 92,23,14336
L 4,4,s30,0
M v,196,a,20,a,36
M v,200,a,20,a,40
T 124,19,49152
M v,204,a,20,a,44
s_add_u32 s40, s40, s41
M v,208,a,20,a,48
T 126,19,51200
M v,212,a,20,a,52
L 5,4,s30,1024
M v,216,a,20,a,56
M v,220,a,20,a,60
M v,224,a,24,a,32
s_mov_b32 s41, 1024
M v,228,a,24,a,36
M v,232,a,24,a,40
L 6,4,s30,2048
M v,236,a,24,a,44
M v,240,a,24,a,48
s_mov_b32 s42, 1024
M v,244,a,24,a,52
M v,248,a,24,a,56
M v,252,a,24,a,60
L 7,4,s30,3072
M a,224,a,28,a,32
M a,228,a,28,a,36
s_mov_b32 s43, 25600
M a,232,a,28,a,40
M a,236,a,28,a,44
M a,240,a,28,a,48
M a,244,a,28,a,52
M a,248,a,28,a,56
M a,252,a,28,a,60
s_waitcnt vmcnt(16) lgkmcnt(0)
s_barrier
M v,32,a,64,a,96
R 0,20,0
M v,36,a,64,a,100
T 32,12,0
M v,40,a,64,a,104
s_add_u32 m0, s29, 49152
s_and_b32 s47, s2, 7
M v,44,a,64,a,108
T 34,12,2048
M v,48,a,64,a,112
M v,52,a,64,a,116
R 4,20,2048
s_lshr_b32 s48, s2, 3
M v,56,a,64,a,120
s_mov_b32 s31, 3932160
M v,60,a,64,a,124
T 36,13,0
M v,64,a,68,a,96
M v,68,a,68,a,100
T 38,13,2048
s_and_b32 s25, s48, 1
M v,72,a,68,a,104
M v,76,a,68,a,108
R 8,20,4096
L 8,8,s31,0
M v,80,a,68,a,112
s_lshl_b32 s47, s47, 1
M v,84,a,68,a,116
T 40,14,0
M v,88,a,68,a,120
M v,92,a,68,a,124
T 42,14,2048
M v,96,a,72,a,96
L 9,8,s31,1024
s_add_u32 s25, s25, s47
M v,100,a,72,a,100
R 12,20,6144
M v,104,a,72,a,104
M v,108,a,72,a,108
T 44,15,0
s_lshr_b32 s26, s48, 1
M v,112,a,72,a,112
M v,116,a,72,a,116
T 46,15,2048
L 10,8,s31,2048
M v,120,a,72,a,120
M v,124,a,72,a,124
R 16,20,8192
s_lshl_b32 s27, s26, 7
M v,128,a,76,a,96
T 48,16,0
M v,132,a,76,a,100
M v,136,a,76,a,104
T 50,16,2048
L 11,8,s31,3072
M v,140,a,76,a,108
s_lshl_b32 s32, s24, 12
M v,144,a,76,a,112
R 20,20,10240
M v,148,a,76,a,116
M v,152,a,76,a,120
T 52,17,0
s_mov_b32 s36, 14336
M v,156,a,76,a,124
s_add_u32 m0, s28, 65536
M v,160,a,80,a,96
T 54,17,2048
M v,164,a,80,a,100
s_lshl_b32 s47, s24, 5
M v,168,a,80,a,104
R 24,20,12288
M v,172,a,80,a,108
s_mov_b32 s30, 1024
M v,176,a,80,a,112
T 56,18,0
M v,180,a,80,a,116
s_add_u32 s47, s47, s27
M v,184,a,80,a,120
T 58,18,2048
M v,188,a,80,a,124
M v,192,a,84,a,96
R 28,20,14336
L 4,4,s30,0
M v,196,a,84,a,100
v_lshrrev_b32 v2, 4, v1
M v,200,a,84,a,104
T 60,19,0
M v,204,a,84,a,108
M v,208,a,84,a,112
T 62,19,2048
v_and_b32 v3, 15, v1
M v,212,a,84,a,116
L 5,4,s30,1024
M v,216,a,84,a,120
M v,220,a,84,a,124
v_add_u32 v3, s47, v3
M v,224,a,88,a,96
M v,228,a,88,a,100
M v,232,a,88,a,104
L 6,4,s30,2048
M v,236,a,88,a,108
v_mul_u32_u24 v0, 896, v3
M v,240,a,88,a,112
M v,244,a,88,a,116
M v,248,a,88,a,120
v_lshlrev_b32 v2, 4, v2
M v,252,a,88,a,124
L 7,4,s30,3072
M a,224,a,92,a,96
M a,228,a,92,a,100
M a,232,a,92,a,104
v_add_u32 v0, v0, v2
M a,236,a,92,a,108
M a,240,a,92,a,112
M a,244,a,92,a,116
M a,248,a,92,a,120
M a,252,a,92,a,124
s_waitcnt vmcnt(16) lgkmcnt(0)
s_barrier
M v,32,a,0,a,32
R 64,22,0
M v,36,a,0,a,36
T 96,12,16384
M v,40,a,0,a,40
s_add_u32 m0, s29, 0
s_and_b32 s47, s2, 7
M v,44,a,0,a,44
T 98,12,18432
M v,48,a,0,a,48
M v,52,a,0,a,52
R 68,22,2048
M v,56,a,0,a,56
s_mov_b32 s31, 4194304
M v,60,a,0,a,60
T 100,13,16384
s_lshr_b32 s48, s2, 3
M v,64,a,4,a,32
M v,68,a,4,a,36
T 102,13,18432
M v,72,a,4,a,40
M v,76,a,4,a,44
R 72,22,4096
L 8,8,s31,0
M v,80,a,4,a,48
s_lshl_b32 s47, s47, 7
M v,84,a,4,a,52
T 104,14,16384
M v,88,a,4,a,56
M v,92,a,4,a,60
T 106,14,18432
M v,96,a,8,a,32
L 9,8,s31,1024
M v,100,a,8,a,36
R 76,22,6144
s_add_u32 s91, s47, 35651584
M v,104,a,8,a,40
M v,108,a,8,a,44
T 108,15,16384
M v,112,a,8,a,48
M v,116,a,8,a,52
T 110,15,18432
L 10,8,s31,2048
M v,120,a,8,a,56
s_lshl_b32 s48, s48, 2
M v,124,a,8,a,60
R 80,22,8192
M v,128,a,12,a,32
T 112,16,16384
M v,132,a,12,a,36
M v,136,a,12,a,40
T 114,16,18432
L 11,8,s31,3072
M v,140,a,12,a,44
s_add_u32 s48, s48, s91
M v,144,a,12,a,48
R 84,22,10240
M v,148,a,12,a,52
M v,152,a,12,a,56
T 116,17,16384
M v,156,a,12,a,60
s_add_u32 m0, s28, 69632
M v,160,a,16,a,32
T 118,17,18432
s_cmp_eq_u32 s24, 0
s_cselect_b32 s89, s48, 0
M v,164,a,16,a,36
M v,168,a,16,a,40
R 88,22,12288
M v,172,a,16,a,44
s_mov_b32 s30, 66560
M v,176,a,16,a,48
T 120,18,16384
M v,180,a,16,a,52
s_mov_b32 s37, 0x53800000
M v,184,a,16,a,56
T 122,18,18432
M v,188,a,16,a,60
M v,192,a,20,a,32
R 92,22,14336
L 4,4,s30,0
M v,196,a,20,a,36
M v,200,a,20,a,40
T 124,19,16384
s_mul_i32 s38, s25, 229376
M v,204,a,20,a,44
M v,208,a,20,a,48
T 126,19,18432
M v,212,a,20,a,52
L 5,4,s30,1024
M v,216,a,20,a,56
M v,220,a,20,a,60
s_mul_i32 s39, s25, 100352
M v,224,a,24,a,32
M v,228,a,24,a,36
M v,232,a,24,a,40
L 6,4,s30,2048
M v,236,a,24,a,44
M v,240,a,24,a,48
s_mov_b32 s64, 0x3db8aa3b
M v,244,a,24,a,52
M v,248,a,24,a,56
M v,252,a,24,a,60
L 7,4,s30,3072
M a,224,a,28,a,32
M a,228,a,28,a,36
s_mov_b32 s65, 0x3db8aa3b
M a,232,a,28,a,40
M a,236,a,28,a,44
M a,240,a,28,a,48
M a,244,a,28,a,52
M a,248,a,28,a,56
M a,252,a,28,a,60
s_waitcnt vmcnt(16) lgkmcnt(0)
s_barrier
M v,32,a,64,a,96
R 0,20,32768
M v,36,a,64,a,100
T 32,12,32768
M v,40,a,64,a,104
s_add_u32 m0, s29, 16384
s_mov_b32 s88, 0
M v,44,a,64,a,108
T 34,12,34816
M v,48,a,64,a,112
M v,52,a,64,a,116
R 4,20,34816
s_cmp_le_u32 s26, 6
s_cselect_b32 s88, 1, s88
M v,56,a,64,a,120
s_mov_b32 s31, 4456448
M v,60,a,64,a,124
T 36,13,32768
M v,64,a,68,a,96
s_cmp_ge_u32 s26, 9
s_cselect_b32 s88, 2, s88
M v,68,a,68,a,100
T 38,13,34816
M v,72,a,68,a,104
L 8,8,s31,0
M v,76,a,68,a,108
R 8,20,36864
s_sub_u32 s47, 15, s26
M v,80,a,68,a,112
M v,84,a,68,a,116
T 40,14,32768
M v,88,a,68,a,120
L 9,8,s31,1024
s_min_u32 s47, s47, s26
M v,92,a,68,a,124
T 42,14,34816
M v,96,a,72,a,96
M v,100,a,72,a,100
R 12,20,38912
s_lshl_b32 s48, s47, 2
M v,104,a,72,a,104
L 10,8,s31,2048
M v,108,a,72,a,108
T 44,15,32768
M v,112,a,72,a,112
s_sub_i32 s48, 28, s48
M v,116,a,72,a,116
T 46,15,34816
M v,120,a,72,a,120
L 11,8,s31,3072
M v,124,a,72,a,124
R 16,20,40960
s_max_i32 s48, s48, 4
M v,128,a,76,a,96
T 48,16,32768
M v,132,a,76,a,100
M v,136,a,76,a,104
T 50,16,34816
s_add_u32 m0, s28, 0
M v,140,a,76,a,108
s_cmp_eq_u32 s88, 0
s_cselect_b32 s48, 0, s48
M v,144,a,76,a,112
R 20,20,43008
M v,148,a,76,a,116
s_add_u32 s49, s26, 1
M v,152,a,76,a,120
T 52,17,32768
M v,156,a,76,a,124
s_mov_b32 s30, 1152
M v,160,a,80,a,96
T 54,17,34816
s_lshl_b32 s49, s49, 2
M v,164,a,80,a,100
M v,168,a,80,a,104
R 24,20,45056
M v,172,a,80,a,108
L 4,4,s30,0
s_lshl_b32 s3, s25, 21
M v,176,a,80,a,112
T 56,18,32768
M v,180,a,80,a,116
M v,184,a,80,a,120
T 58,18,34816
s_add_u32 s3, s3, 983040
M v,188,a,80,a,124
L 5,4,s30,1024
M v,192,a,84,a,96
R 28,20,47104
M v,196,a,84,a,100
s_cmp_eq_u32 s88, 1
s_cselect_b32 s67, 1, 0
s_cselect_b32 s50, 0, s48
M v,200,a,84,a,104
T 60,19,32768
M v,204,a,84,a,108
L 6,4,s30,2048
M v,208,a,84,a,112
T 62,19,34816
s_sub_u32 s51, s49, s50
M v,212,a,84,a,116
M v,216,a,84,a,120
M v,220,a,84,a,124
L 7,4,s30,3072
s_cmp_eq_u32 s88, 1
s_cselect_b32 s51, s48, s51
M v,224,a,88,a,96
M v,228,a,88,a,100
M v,232,a,88,a,104
s_lshr_b32 s34, s51, 2
M v,236,a,88,a,108
buffer_load_dwordx4 a[128:131], v0, s[16:19], 0 offen offset:0
M v,240,a,88,a,112
M v,244,a,88,a,116
s_sub_u32 s34, s34, 1
M v,248,a,88,a,120
M v,252,a,88,a,124
buffer_load_dwordx4 a[132:135], v0, s[16:19], s36 offen offset:0
M a,224,a,92,a,96
s_lshl_b32 s50, s50, 15
M a,228,a,92,a,100
M a,232,a,92,a,104
M a,236,a,92,a,108
s_add_u32 s33, s3, s50
M a,240,a,92,a,112
M a,244,a,92,a,116
M a,248,a,92,a,120
M a,252,a,92,a,124
s_waitcnt vmcnt(18) lgkmcnt(0)
s_barrier
M v,32,a,0,a,32
R 64,22,32768
M v,36,a,0,a,36
T 96,12,49152
M v,40,a,0,a,40
s_add_u32 m0, s29, 32768
M v,44,a,0,a,44
T 98,12,51200
M v,48,a,0,a,48
M v,52,a,0,a,52
R 68,22,34816
s_mov_b32 s31, 4718592
M v,56,a,0,a,56
M v,60,a,0,a,60
T 100,13,49152
M v,64,a,4,a,32
M v,68,a,4,a,36
T 102,13,51200
L 8,8,s31,0
M v,72,a,4,a,40
M v,76,a,4,a,44
R 72,22,36864
M v,80,a,4,a,48
L 9,8,s31,1024
M v,84,a,4,a,52
T 104,14,49152
M v,88,a,4,a,56
M v,92,a,4,a,60
T 106,14,51200
M v,96,a,8,a,32
L 10,8,s31,2048
M v,100,a,8,a,36
R 76,22,38912
M v,104,a,8,a,40
M v,108,a,8,a,44
T 108,15,49152
M v,112,a,8,a,48
L 11,8,s31,3072
M v,116,a,8,a,52
T 110,15,51200
M v,120,a,8,a,56
M v,124,a,8,a,60
R 80,22,40960
s_add_u32 m0, s28, 4096
M v,128,a,12,a,32
T 112,16,49152
M v,132,a,12,a,36
M v,136,a,12,a,40
T 114,16,51200
M v,140,a,12,a,44
s_mov_b32 s30, 66688
M v,144,a,12,a,48
R 84,22,43008
M v,148,a,12,a,52
M v,152,a,12,a,56
T 116,17,49152
M v,156,a,12,a,60
L 4,4,s30,0
M v,160,a,16,a,32
T 118,17,51200
M v,164,a,16,a,36
M v,168,a,16,a,40
R 88,22,45056
L 5,4,s30,1024
M v,172,a,16,a,44
M v,176,a,16,a,48
T 120,18,49152
M v,180,a,16,a,52
M v,184,a,16,a,56
T 122,18,51200
L 6,4,s30,2048
M v,188,a,16,a,60
M v,192,a,20,a,32
R 92,22,47104
M v,196,a,20,a,36
L 7,4,s30,3072
M v,200,a,20,a,40
T 124,19,49152
M v,204,a,20,a,44
M v,208,a,20,a,48
T 126,19,51200
M v,212,a,20,a,52
buffer_load_dwordx4 a[136:139], v0, s[16:19], 0 offen offset:64
M v,216,a,20,a,56
M v,220,a,20,a,60
M v,224,a,24,a,32
M v,228,a,24,a,36
buffer_load_dwordx4 a[140:143], v0, s[16:19], s36 offen offset:64
M v,232,a,24,a,40
M v,236,a,24,a,44
M v,240,a,24,a,48
s_mov_b32 s44, 6291456
M v,244,a,24,a,52
M v,248,a,24,a,56
M v,252,a,24,a,60
M a,224,a,28,a,32
buffer_load_dword v31, v29, s[8:11], s44 offen
M a,228,a,28,a,36
M a,232,a,28,a,40
M a,236,a,28,a,44
M a,240,a,28,a,48
M a,244,a,28,a,52
M a,248,a,28,a,56
M a,252,a,28,a,60
s_waitcnt vmcnt(21) lgkmcnt(0)
s_barrier
M v,32,a,64,a,96
R 0,21,0
M v,36,a,64,a,100
T 32,12,0
M v,40,a,64,a,104
s_add_u32 m0, s29, 49152
v_lshrrev_b32 v25, 5, v1
M v,44,a,64,a,108
T 34,12,2048
M v,48,a,64,a,112
M v,52,a,64,a,116
R 4,21,2048
M v,56,a,64,a,120
s_mov_b32 s31, 4980736
M v,60,a,64,a,124
T 36,13,0
M v,64,a,68,a,96
M v,68,a,68,a,100
T 38,13,2048
v_and_b32 v26, 1, v1
M v,72,a,68,a,104
L 8,8,s31,0
M v,76,a,68,a,108
R 8,21,4096
M v,80,a,68,a,112
M v,84,a,68,a,116
T 40,14,0
M v,88,a,68,a,120
L 9,8,s31,1024
M v,92,a,68,a,124
T 42,14,2048
M v,96,a,72,a,96
M v,100,a,72,a,100
R 12,21,6144
v_and_b32 v27, 31, v1
M v,104,a,72,a,104
L 10,8,s31,2048
M v,108,a,72,a,108
T 44,15,0
M v,112,a,72,a,112
M v,116,a,72,a,116
T 46,15,2048
M v,120,a,72,a,120
L 11,8,s31,3072
M v,124,a,72,a,124
R 16,21,8192
M v,128,a,76,a,96
T 48,16,0
v_lshrrev_b32 v27, 1, v27
M v,132,a,76,a,100
M v,136,a,76,a,104
T 50,16,2048
s_add_u32 m0, s28, 32768
M v,140,a,76,a,108
M v,144,a,76,a,112
R 20,21,10240
M v,148,a,76,a,116
M v,152,a,76,a,120
T 52,17,0
M v,156,a,76,a,124
s_mov_b32 s30, 1280
M v,160,a,80,a,96
T 54,17,2048
s_and_b32 s47, s24, 1
M v,164,a,80,a,100
M v,168,a,80,a,104
R 24,21,12288
M v,172,a,80,a,108
L 4,4,s30,0
M v,176,a,80,a,112
T 56,18,0
M v,180,a,80,a,116
M v,184,a,80,a,120
T 58,18,2048
M v,188,a,80,a,124
L 5,4,s30,1024
s_lshl_b32 s47, s47, 2
M v,192,a,84,a,96
R 28,21,14336
M v,196,a,84,a,100
M v,200,a,84,a,104
T 60,19,0
M v,204,a,84,a,108
L 6,4,s30,2048
M v,208,a,84,a,112
T 62,19,2048
M v,212,a,84,a,116
M v,216,a,84,a,120
M v,220,a,84,a,124
L 7,4,s30,3072
s_lshl_b32 s48, s24, 3
M v,224,a,88,a,96
M v,228,a,88,a,100
M v,232,a,88,a,104
M v,236,a,88,a,108
buffer_load_dwordx4 a[144:147], v0, s[16:19], 0 offen offset:128
M v,240,a,88,a,112
M v,244,a,88,a,116
M v,248,a,88,a,120
s_lshl_b32 s49, s25, 9
M v,252,a,88,a,124
buffer_load_dwordx4 a[148:151], v0, s[16:19], s36 offen offset:128
M a,224,a,92,a,96
M a,228,a,92,a,100
M a,232,a,92,a,104
M a,236,a,92,a,108
M a,240,a,92,a,112
M a,244,a,92,a,116
M a,248,a,92,a,120
M a,252,a,92,a,124
s_waitcnt vmcnt(21) lgkmcnt(0)
s_barrier
M v,32,a,0,a,32
R 64,23,0
M v,36,a,0,a,36
T 96,12,16384
M v,40,a,0,a,40
s_add_u32 m0, s29, 0
v_add_u32 v2, 0, v25
M v,44,a,0,a,44
T 98,12,18432
M v,48,a,0,a,48
M v,52,a,0,a,52
R 68,23,2048
M v,56,a,0,a,56
s_mov_b32 s31, 5242880
M v,60,a,0,a,60
T 100,13,16384
v_and_b32 v3, 3, v2
M v,64,a,4,a,32
M v,68,a,4,a,36
T 102,13,18432
M v,72,a,4,a,40
L 8,8,s31,0
M v,76,a,4,a,44
R 72,23,4096
M v,80,a,4,a,48
v_or_b32 v3, s47, v3
M v,84,a,4,a,52
T 104,14,16384
M v,88,a,4,a,56
L 9,8,s31,1024
M v,92,a,4,a,60
T 106,14,18432
M v,96,a,8,a,32
M v,100,a,8,a,36
R 76,23,6144
v_add_u32 v2, s48, v2
M v,104,a,8,a,40
L 10,8,s31,2048
M v,108,a,8,a,44
T 108,15,16384
M v,112,a,8,a,48
M v,116,a,8,a,52
T 110,15,18432
M v,120,a,8,a,56
L 11,8,s31,3072
v_xor_b32 v3, v3, v27
M v,124,a,8,a,60
R 80,23,8192
M v,128,a,12,a,32
T 112,16,16384
M v,132,a,12,a,36
M v,136,a,12,a,40
T 114,16,18432
s_add_u32 m0, s28, 36864
M v,140,a,12,a,44
v_lshlrev_b32 v3, 1, v3
M v,144,a,12,a,48
R 84,23,10240
M v,148,a,12,a,52
M v,152,a,12,a,56
T 116,17,16384
M v,156,a,12,a,60
s_mov_b32 s30, 66816
M v,160,a,16,a,32
T 118,17,18432
v_or_b32 v3, v3, v26
M v,164,a,16,a,36
M v,168,a,16,a,40
R 88,23,12288
M v,172,a,16,a,44
L 4,4,s30,0
M v,176,a,16,a,48
T 120,18,16384
M v,180,a,16,a,52
v_lshlrev_b32 v3, 4, v3
M v,184,a,16,a,56
T 122,18,18432
M v,188,a,16,a,60
L 5,4,s30,1024
M v,192,a,20,a,32
R 92,23,14336
M v,196,a,20,a,36
M v,200,a,20,a,40
T 124,19,16384
v_lshlrev_b32 v2, 13, v2
M v,204,a,20,a,44
L 6,4,s30,2048
M v,208,a,20,a,48
T 126,19,18432
M v,212,a,20,a,52
M v,216,a,20,a,56
M v,220,a,20,a,60
L 7,4,s30,3072
v_add_u32 v2, v2, v3
M v,224,a,24,a,32
M v,228,a,24,a,36
M v,232,a,24,a,40
M v,236,a,24,a,44
buffer_load_dwordx4 a[152:155], v0, s[16:19], 0 offen offset:192
M v,240,a,24,a,48
v_add_u32 v2, s49, v2
M v,244,a,24,a,52
M v,248,a,24,a,56
M v,252,a,24,a,60
buffer_load_dwordx4 a[156:159], v0, s[16:19], s36 offen offset:192
M a,224,a,28,a,32
M a,228,a,28,a,36
v_mov_b32 v28, v2
M a,232,a,28,a,40
M a,236,a,28,a,44
M a,240,a,28,a,48
M a,244,a,28,a,52
M a,248,a,28,a,56
M a,252,a,28,a,60
s_waitcnt vmcnt(20) lgkmcnt(0)
s_barrier
M v,32,a,64,a,96
R 0,20,0
M v,36,a,64,a,100
T 32,12,32768
M v,40,a,64,a,104
s_add_u32 m0, s29, 16384
v_add_u32 v2, 2, v25
M v,44,a,64,a,108
T 34,12,34816
M v,48,a,64,a,112
M v,52,a,64,a,116
R 4,20,2048
M v,56,a,64,a,120
s_mov_b32 s31, 5505024
M v,60,a,64,a,124
T 36,13,32768
v_and_b32 v3, 3, v2
M v,64,a,68,a,96
M v,68,a,68,a,100
T 38,13,34816
M v,72,a,68,a,104
L 8,8,s31,0
M v,76,a,68,a,108
R 8,20,4096
M v,80,a,68,a,112
v_or_b32 v3, s47, v3
M v,84,a,68,a,116
T 40,14,32768
M v,88,a,68,a,120
L 9,8,s31,1024
M v,92,a,68,a,124
T 42,14,34816
M v,96,a,72,a,96
M v,100,a,72,a,100
R 12,20,6144
v_add_u32 v2, s48, v2
M v,104,a,72,a,104
L 10,8,s31,2048
M v,108,a,72,a,108
T 44,15,32768
M v,112,a,72,a,112
M v,116,a,72,a,116
T 46,15,34816
M v,120,a,72,a,120
L 11,8,s31,3072
v_xor_b32 v3, v3, v27
M v,124,a,72,a,124
R 16,20,8192
M v,128,a,76,a,96
T 48,16,32768
M v,132,a,76,a,100
M v,136,a,76,a,104
T 50,16,34816
s_add_u32 m0, s28, 65536
M v,140,a,76,a,108
v_lshlrev_b32 v3, 1, v3
M v,144,a,76,a,112
R 20,20,10240
M v,148,a,76,a,116
M v,152,a,76,a,120
T 52,17,32768
M v,156,a,76,a,124
s_mov_b32 s30, 1408
M v,160,a,80,a,96
T 54,17,34816
v_or_b32 v3, v3, v26
M v,164,a,80,a,100
M v,168,a,80,a,104
R 24,20,12288
M v,172,a,80,a,108
L 4,4,s30,0
M v,176,a,80,a,112
T 56,18,32768
M v,180,a,80,a,116
v_lshlrev_b32 v3, 4, v3
M v,184,a,80,a,120
T 58,18,34816
M v,188,a,80,a,124
L 5,4,s30,1024
M v,192,a,84,a,96
R 28,20,14336
M v,196,a,84,a,100
M v,200,a,84,a,104
T 60,19,32768
v_lshlrev_b32 v2, 13, v2
M v,204,a,84,a,108
L 6,4,s30,2048
M v,208,a,84,a,112
T 62,19,34816
M v,212,a,84,a,116
M v,216,a,84,a,120
M v,220,a,84,a,124
L 7,4,s30,3072
v_add_u32 v2, v2, v3
M v,224,a,88,a,96
M v,228,a,88,a,100
M v,232,a,88,a,104
M v,236,a,88,a,108
buffer_load_dwordx4 a[160:163], v0, s[16:19], 0 offen offset:256
M v,240,a,88,a,112
v_add_u32 v2, s49, v2
M v,244,a,88,a,116
M v,248,a,88,a,120
M v,252,a,88,a,124
buffer_load_dwordx4 a[164:167], v0, s[16:19], s36 offen offset:256
M a,224,a,92,a,96
M a,228,a,92,a,100
v_subrev_u32 v29, 1024, v2
M a,232,a,92,a,104
M a,236,a,92,a,108
M a,240,a,92,a,112
M a,244,a,92,a,116
M a,248,a,92,a,120
M a,252,a,92,a,124
s_waitcnt vmcnt(20) lgkmcnt(0)
s_barrier
M v,32,a,0,a,32
R 64,22,0
M v,36,a,0,a,36
T 96,12,49152
M v,40,a,0,a,40
s_add_u32 m0, s29, 32768
v_add_u32 v2, 4, v25
M v,44,a,0,a,44
T 98,12,51200
M v,48,a,0,a,48
M v,52,a,0,a,52
R 68,22,2048
M v,56,a,0,a,56
s_mov_b32 s31, 5767168
M v,60,a,0,a,60
T 100,13,49152
v_and_b32 v3, 3, v2
M v,64,a,4,a,32
M v,68,a,4,a,36
T 102,13,51200
M v,72,a,4,a,40
L 8,8,s31,0
M v,76,a,4,a,44
R 72,22,4096
M v,80,a,4,a,48
v_or_b32 v3, s47, v3
M v,84,a,4,a,52
T 104,14,49152
M v,88,a,4,a,56
L 9,8,s31,1024
M v,92,a,4,a,60
T 106,14,51200
M v,96,a,8,a,32
M v,100,a,8,a,36
R 76,22,6144
v_add_u32 v2, s48, v2
M v,104,a,8,a,40
L 10,8,s31,2048
M v,108,a,8,a,44
T 108,15,49152
M v,112,a,8,a,48
M v,116,a,8,a,52
T 110,15,51200
M v,120,a,8,a,56
L 11,8,s31,3072
v_xor_b32 v3, v3, v27
M v,124,a,8,a,60
R 80,22,8192
M v,128,a,12,a,32
T 112,16,49152
M v,132,a,12,a,36
M v,136,a,12,a,40
T 114,16,51200
s_add_u32 m0, s28, 69632
M v,140,a,12,a,44
v_lshlrev_b32 v3, 1, v3
M v,144,a,12,a,48
R 84,22,10240
M v,148,a,12,a,52
M v,152,a,12,a,56
T 116,17,49152
M v,156,a,12,a,60
s_mov_b32 s30, 66944
M v,160,a,16,a,32
T 118,17,51200
v_or_b32 v3, v3, v26
M v,164,a,16,a,36
M v,168,a,16,a,40
R 88,22,12288
M v,172,a,16,a,44
L 4,4,s30,0
M v,176,a,16,a,48
T 120,18,49152
M v,180,a,16,a,52
v_lshlrev_b32 v3, 4, v3
M v,184,a,16,a,56
T 122,18,51200
M v,188,a,16,a,60
L 5,4,s30,1024
M v,192,a,20,a,32
R 92,22,14336
M v,196,a,20,a,36
M v,200,a,20,a,40
T 124,19,49152
v_lshlrev_b32 v2, 13, v2
M v,204,a,20,a,44
L 6,4,s30,2048
M v,208,a,20,a,48
T 126,19,51200
M v,212,a,20,a,52
M v,216,a,20,a,56
M v,220,a,20,a,60
L 7,4,s30,3072
v_add_u32 v2, v2, v3
M v,224,a,24,a,32
M v,228,a,24,a,36
M v,232,a,24,a,40
M v,236,a,24,a,44
buffer_load_dwordx4 a[168:171], v0, s[16:19], 0 offen offset:320
M v,240,a,24,a,48
v_add_u32 v2, s49, v2
M v,244,a,24,a,52
M v,248,a,24,a,56
M v,252,a,24,a,60
buffer_load_dwordx4 a[172:175], v0, s[16:19], s36 offen offset:320
M a,224,a,28,a,32
M a,228,a,28,a,36
v_subrev_u32 v30, 2048, v2
M a,232,a,28,a,40
M a,236,a,28,a,44
M a,240,a,28,a,48
M a,244,a,28,a,52
M a,248,a,28,a,56
M a,252,a,28,a,60
s_waitcnt vmcnt(20) lgkmcnt(0)
s_barrier
M v,32,a,64,a,96
R 0,20,32768
M v,36,a,64,a,100
T 32,12,0
M v,40,a,64,a,104
s_add_u32 m0, s29, 49152
v_add_u32 v2, 6, v25
M v,44,a,64,a,108
T 34,12,2048
M v,48,a,64,a,112
M v,52,a,64,a,116
R 4,20,34816
M v,56,a,64,a,120
s_mov_b32 s31, 6029312
M v,60,a,64,a,124
T 36,13,0
v_and_b32 v3, 3, v2
M v,64,a,68,a,96
M v,68,a,68,a,100
T 38,13,2048
M v,72,a,68,a,104
L 8,8,s31,0
M v,76,a,68,a,108
R 8,20,36864
M v,80,a,68,a,112
v_or_b32 v3, s47, v3
M v,84,a,68,a,116
T 40,14,0
M v,88,a,68,a,120
L 9,8,s31,1024
M v,92,a,68,a,124
T 42,14,2048
M v,96,a,72,a,96
M v,100,a,72,a,100
R 12,20,38912
v_add_u32 v2, s48, v2
M v,104,a,72,a,104
L 10,8,s31,2048
M v,108,a,72,a,108
T 44,15,0
M v,112,a,72,a,112
M v,116,a,72,a,116
T 46,15,2048
M v,120,a,72,a,120
L 11,8,s31,3072
v_xor_b32 v3, v3, v27
M v,124,a,72,a,124
R 16,20,40960
M v,128,a,76,a,96
T 48,16,0
M v,132,a,76,a,100
M v,136,a,76,a,104
T 50,16,2048
s_add_u32 m0, s28, 0
M v,140,a,76,a,108
v_lshlrev_b32 v3, 1, v3
M v,144,a,76,a,112
R 20,20,43008
M v,148,a,76,a,116
M v,152,a,76,a,120
T 52,17,0
M v,156,a,76,a,124
s_mov_b32 s30, 1536
M v,160,a,80,a,96
T 54,17,2048
v_or_b32 v3, v3, v26
M v,164,a,80,a,100
M v,168,a,80,a,104
R 24,20,45056
M v,172,a,80,a,108
L 4,4,s30,0
M v,176,a,80,a,112
T 56,18,0
M v,180,a,80,a,116
v_lshlrev_b32 v3, 4, v3
M v,184,a,80,a,120
T 58,18,2048
M v,188,a,80,a,124
L 5,4,s30,1024
M v,192,a,84,a,96
R 28,20,47104
M v,196,a,84,a,100
M v,200,a,84,a,104
T 60,19,0
v_lshlrev_b32 v2, 13, v2
M v,204,a,84,a,108
L 6,4,s30,2048
M v,208,a,84,a,112
T 62,19,2048
M v,212,a,84,a,116
M v,216,a,84,a,120
M v,220,a,84,a,124
L 7,4,s30,3072
v_add_u32 v2, v2, v3
M v,224,a,88,a,96
M v,228,a,88,a,100
M v,232,a,88,a,104
M v,236,a,88,a,108
buffer_load_dwordx4 a[176:179], v0, s[16:19], 0 offen offset:384
M v,240,a,88,a,112
v_add_u32 v2, s49, v2
M v,244,a,88,a,116
M v,248,a,88,a,120
M v,252,a,88,a,124
buffer_load_dwordx4 a[180:183], v0, s[16:19], s36 offen offset:384
M a,224,a,92,a,96
M a,228,a,92,a,100
v_subrev_u32 v31, 3072, v2
M a,232,a,92,a,104
M a,236,a,92,a,108
M a,240,a,92,a,112
M a,244,a,92,a,116
M a,248,a,92,a,120
M a,252,a,92,a,124
s_waitcnt vmcnt(20) lgkmcnt(0)
s_barrier
M v,32,a,0,a,32
R 64,22,32768
M v,36,a,0,a,36
T 96,12,16384
M v,40,a,0,a,40
s_add_u32 m0, s29, 0
M v,44,a,0,a,44
T 98,12,18432
M v,48,a,0,a,48
M v,52,a,0,a,52
R 68,22,34816
M v,56,a,0,a,56
s_mov_b32 s31, 6291456
M v,60,a,0,a,60
T 100,13,16384
M v,64,a,4,a,32
M v,68,a,4,a,36
T 102,13,18432
M v,72,a,4,a,40
L 8,8,s31,0
M v,76,a,4,a,44
R 72,22,36864
M v,80,a,4,a,48
M v,84,a,4,a,52
T 104,14,16384
M v,88,a,4,a,56
L 9,8,s31,1024
M v,92,a,4,a,60
T 106,14,18432
M v,96,a,8,a,32
M v,100,a,8,a,36
R 76,22,38912
M v,104,a,8,a,40
L 10,8,s31,2048
M v,108,a,8,a,44
T 108,15,16384
M v,112,a,8,a,48
M v,116,a,8,a,52
T 110,15,18432
M v,120,a,8,a,56
L 11,8,s31,3072
M v,124,a,8,a,60
R 80,22,40960
M v,128,a,12,a,32
T 112,16,16384
M v,132,a,12,a,36
M v,136,a,12,a,40
T 114,16,18432
s_add_u32 m0, s28, 4096
M v,140,a,12,a,44
M v,144,a,12,a,48
R 84,22,43008
M v,148,a,12,a,52
M v,152,a,12,a,56
T 116,17,16384
M v,156,a,12,a,60
s_mov_b32 s30, 67072
M v,160,a,16,a,32
T 118,17,18432
M v,164,a,16,a,36
M v,168,a,16,a,40
R 88,22,45056
M v,172,a,16,a,44
L 4,4,s30,0
M v,176,a,16,a,48
T 120,18,16384
M v,180,a,16,a,52
M v,184,a,16,a,56
T 122,18,18432
M v,188,a,16,a,60
L 5,4,s30,1024
M v,192,a,20,a,32
R 92,22,47104
M v,196,a,20,a,36
M v,200,a,20,a,40
T 124,19,16384
M v,204,a,20,a,44
L 6,4,s30,2048
M v,208,a,20,a,48
T 126,19,18432
M v,212,a,20,a,52
M v,216,a,20,a,56
M v,220,a,20,a,60
L 7,4,s30,3072
M v,224,a,24,a,32
M v,228,a,24,a,36
M v,232,a,24,a,40
M v,236,a,24,a,44
buffer_load_dwordx4 a[184:187], v0, s[16:19], 0 offen offset:448
M v,240,a,24,a,48
M v,244,a,24,a,52
M v,248,a,24,a,56
M v,252,a,24,a,60
buffer_load_dwordx4 a[188:191], v0, s[16:19], s36 offen offset:448
M a,224,a,28,a,32
M a,228,a,28,a,36
M a,232,a,28,a,40
M a,236,a,28,a,44
M a,240,a,28,a,48
M a,244,a,28,a,52
M a,248,a,28,a,56
M a,252,a,28,a,60
s_waitcnt vmcnt(20) lgkmcnt(0)
s_barrier
M v,32,a,64,a,96
R 0,21,0
M v,36,a,64,a,100
T 32,12,32768
M v,40,a,64,a,104
s_add_u32 m0, s29, 16384
M v,44,a,64,a,108
T 34,12,34816
M v,48,a,64,a,112
M v,52,a,64,a,116
R 4,21,2048
M v,56,a,64,a,120
s_mov_b32 s31, 6553600
M v,60,a,64,a,124
T 36,13,32768
M v,64,a,68,a,96
M v,68,a,68,a,100
T 38,13,34816
M v,72,a,68,a,104
L 8,8,s31,0
M v,76,a,68,a,108
R 8,21,4096
M v,80,a,68,a,112
M v,84,a,68,a,116
T 40,14,32768
M v,88,a,68,a,120
L 9,8,s31,1024
M v,92,a,68,a,124
T 42,14,34816
M v,96,a,72,a,96
M v,100,a,72,a,100
R 12,21,6144
M v,104,a,72,a,104
L 10,8,s31,2048
M v,108,a,72,a,108
T 44,15,32768
M v,112,a,72,a,112
M v,116,a,72,a,116
T 46,15,34816
M v,120,a,72,a,120
L 11,8,s31,3072
M v,124,a,72,a,124
R 16,21,8192
M v,128,a,76,a,96
T 48,16,32768
M v,132,a,76,a,100
M v,136,a,76,a,104
T 50,16,34816
s_add_u32 m0, s28, 32768
M v,140,a,76,a,108
M v,144,a,76,a,112
R 20,21,10240
M v,148,a,76,a,116
M v,152,a,76,a,120
T 52,17,32768
M v,156,a,76,a,124
s_mov_b32 s30, 1664
M v,160,a,80,a,96
T 54,17,34816
M v,164,a,80,a,100
M v,168,a,80,a,104
R 24,21,12288
M v,172,a,80,a,108
L 4,4,s30,0
M v,176,a,80,a,112
T 56,18,32768
M v,180,a,80,a,116
M v,184,a,80,a,120
T 58,18,34816
M v,188,a,80,a,124
L 5,4,s30,1024
M v,192,a,84,a,96
R 28,21,14336
M v,196,a,84,a,100
M v,200,a,84,a,104
T 60,19,32768
M v,204,a,84,a,108
L 6,4,s30,2048
M v,208,a,84,a,112
T 62,19,34816
M v,212,a,84,a,116
M v,216,a,84,a,120
M v,220,a,84,a,124
L 7,4,s30,3072
M v,224,a,88,a,96
M v,228,a,88,a,100
M v,232,a,88,a,104
M v,236,a,88,a,108
buffer_load_dwordx4 a[192:195], v0, s[16:19], 0 offen offset:512
M v,240,a,88,a,112
M v,244,a,88,a,116
M v,248,a,88,a,120
M v,252,a,88,a,124
buffer_load_dwordx4 a[196:199], v0, s[16:19], s36 offen offset:512
M a,224,a,92,a,96
M a,228,a,92,a,100
M a,232,a,92,a,104
M a,236,a,92,a,108
M a,240,a,92,a,112
M a,244,a,92,a,116
M a,248,a,92,a,120
M a,252,a,92,a,124
s_waitcnt vmcnt(20) lgkmcnt(0)
s_barrier
M v,32,a,0,a,32
R 64,23,0
M v,36,a,0,a,36
T 96,12,49152
M v,40,a,0,a,40
s_add_u32 m0, s29, 32768
M v,44,a,0,a,44
T 98,12,51200
M v,48,a,0,a,48
M v,52,a,0,a,52
R 68,23,2048
M v,56,a,0,a,56
s_mov_b32 s31, 6815744
M v,60,a,0,a,60
T 100,13,49152
M v,64,a,4,a,32
M v,68,a,4,a,36
T 102,13,51200
M v,72,a,4,a,40
L 8,8,s31,0
M v,76,a,4,a,44
R 72,23,4096
M v,80,a,4,a,48
M v,84,a,4,a,52
T 104,14,49152
M v,88,a,4,a,56
L 9,8,s31,1024
M v,92,a,4,a,60
T 106,14,51200
M v,96,a,8,a,32
M v,100,a,8,a,36
R 76,23,6144
M v,104,a,8,a,40
L 10,8,s31,2048
M v,108,a,8,a,44
T 108,15,49152
M v,112,a,8,a,48
M v,116,a,8,a,52
T 110,15,51200
M v,120,a,8,a,56
L 11,8,s31,3072
M v,124,a,8,a,60
R 80,23,8192
M v,128,a,12,a,32
T 112,16,49152
M v,132,a,12,a,36
M v,136,a,12,a,40
T 114,16,51200
s_add_u32 m0, s28, 36864
M v,140,a,12,a,44
M v,144,a,12,a,48
R 84,23,10240
M v,148,a,12,a,52
M v,152,a,12,a,56
T 116,17,49152
M v,156,a,12,a,60
s_mov_b32 s30, 67200
M v,160,a,16,a,32
T 118,17,51200
M v,164,a,16,a,36
M v,168,a,16,a,40
R 88,23,12288
M v,172,a,16,a,44
L 4,4,s30,0
M v,176,a,16,a,48
T 120,18,49152
M v,180,a,16,a,52
M v,184,a,16,a,56
T 122,18,51200
M v,188,a,16,a,60
L 5,4,s30,1024
M v,192,a,20,a,32
R 92,23,14336
M v,196,a,20,a,36
M v,200,a,20,a,40
T 124,19,49152
M v,204,a,20,a,44
L 6,4,s30,2048
M v,208,a,20,a,48
T 126,19,51200
M v,212,a,20,a,52
M v,216,a,20,a,56
M v,220,a,20,a,60
L 7,4,s30,3072
M v,224,a,24,a,32
M v,228,a,24,a,36
M v,232,a,24,a,40
M v,236,a,24,a,44
buffer_load_dwordx4 a[200:203], v0, s[16:19], 0 offen offset:576
M v,240,a,24,a,48
M v,244,a,24,a,52
M v,248,a,24,a,56
M v,252,a,24,a,60
buffer_load_dwordx4 a[204:207], v0, s[16:19], s36 offen offset:576
M a,224,a,28,a,32
M a,228,a,28,a,36
M a,232,a,28,a,40
M a,236,a,28,a,44
M a,240,a,28,a,48
M a,244,a,28,a,52
M a,248,a,28,a,56
M a,252,a,28,a,60
s_waitcnt vmcnt(20) lgkmcnt(0)
s_barrier
M v,32,a,64,a,96
R 0,20,0
M v,36,a,64,a,100
T 32,12,0
M v,40,a,64,a,104
s_add_u32 m0, s29, 49152
M v,44,a,64,a,108
T 34,12,2048
M v,48,a,64,a,112
M v,52,a,64,a,116
R 4,20,2048
M v,56,a,64,a,120
s_mov_b32 s31, 7077888
M v,60,a,64,a,124
T 36,13,0
M v,64,a,68,a,96
M v,68,a,68,a,100
T 38,13,2048
M v,72,a,68,a,104
L 8,8,s31,0
M v,76,a,68,a,108
R 8,20,4096
M v,80,a,68,a,112
M v,84,a,68,a,116
T 40,14,0
M v,88,a,68,a,120
L 9,8,s31,1024
M v,92,a,68,a,124
T 42,14,2048
M v,96,a,72,a,96
M v,100,a,72,a,100
R 12,20,6144
M v,104,a,72,a,104
L 10,8,s31,2048
M v,108,a,72,a,108
T 44,15,0
M v,112,a,72,a,112
M v,116,a,72,a,116
T 46,15,2048
M v,120,a,72,a,120
L 11,8,s31,3072
M v,124,a,72,a,124
R 16,20,8192
M v,128,a,76,a,96
T 48,16,0
M v,132,a,76,a,100
M v,136,a,76,a,104
T 50,16,2048
s_add_u32 m0, s28, 65536
M v,140,a,76,a,108
M v,144,a,76,a,112
R 20,20,10240
M v,148,a,76,a,116
M v,152,a,76,a,120
T 52,17,0
M v,156,a,76,a,124
s_mov_b32 s30, 1792
M v,160,a,80,a,96
T 54,17,2048
M v,164,a,80,a,100
M v,168,a,80,a,104
R 24,20,12288
M v,172,a,80,a,108
L 4,4,s30,0
M v,176,a,80,a,112
T 56,18,0
M v,180,a,80,a,116
M v,184,a,80,a,120
T 58,18,2048
M v,188,a,80,a,124
L 5,4,s30,1024
M v,192,a,84,a,96
R 28,20,14336
M v,196,a,84,a,100
M v,200,a,84,a,104
T 60,19,0
M v,204,a,84,a,108
L 6,4,s30,2048
M v,208,a,84,a,112
T 62,19,2048
M v,212,a,84,a,116
M v,216,a,84,a,120
M v,220,a,84,a,124
L 7,4,s30,3072
M v,224,a,88,a,96
M v,228,a,88,a,100
M v,232,a,88,a,104
M v,236,a,88,a,108
buffer_load_dwordx4 a[208:211], v0, s[16:19], 0 offen offset:640
M v,240,a,88,a,112
M v,244,a,88,a,116
M v,248,a,88,a,120
M v,252,a,88,a,124
buffer_load_dwordx4 a[212:215], v0, s[16:19], s36 offen offset:640
M a,224,a,92,a,96
M a,228,a,92,a,100
M a,232,a,92,a,104
M a,236,a,92,a,108
M a,240,a,92,a,112
M a,244,a,92,a,116
M a,248,a,92,a,120
M a,252,a,92,a,124
s_waitcnt vmcnt(20) lgkmcnt(0)
s_barrier
M v,32,a,0,a,32
R 64,22,0
M v,36,a,0,a,36
T 96,12,16384
M v,40,a,0,a,40
s_add_u32 m0, s29, 0
M v,44,a,0,a,44
T 98,12,18432
M v,48,a,0,a,48
M v,52,a,0,a,52
R 68,22,2048
M v,56,a,0,a,56
s_mov_b32 s31, 7340032
M v,60,a,0,a,60
T 100,13,16384
M v,64,a,4,a,32
M v,68,a,4,a,36
T 102,13,18432
M v,72,a,4,a,40
L 8,8,s31,0
M v,76,a,4,a,44
R 72,22,4096
M v,80,a,4,a,48
M v,84,a,4,a,52
T 104,14,16384
M v,88,a,4,a,56
L 9,8,s31,1024
M v,92,a,4,a,60
T 106,14,18432
M v,96,a,8,a,32
M v,100,a,8,a,36
R 76,22,6144
M v,104,a,8,a,40
L 10,8,s31,2048
M v,108,a,8,a,44
T 108,15,16384
M v,112,a,8,a,48
M v,116,a,8,a,52
T 110,15,18432
M v,120,a,8,a,56
L 11,8,s31,3072
M v,124,a,8,a,60
R 80,22,8192
M v,128,a,12,a,32
T 112,16,16384
M v,132,a,12,a,36
M v,136,a,12,a,40
T 114,16,18432
s_add_u32 m0, s28, 69632
M v,140,a,12,a,44
M v,144,a,12,a,48
R 84,22,10240
M v,148,a,12,a,52
M v,152,a,12,a,56
T 116,17,16384
M v,156,a,12,a,60
s_mov_b32 s30, 67328
M v,160,a,16,a,32
T 118,17,18432
M v,164,a,16,a,36
M v,168,a,16,a,40
R 88,22,12288
M v,172,a,16,a,44
L 4,4,s30,0
M v,176,a,16,a,48
T 120,18,16384
M v,180,a,16,a,52
M v,184,a,16,a,56
T 122,18,18432
M v,188,a,16,a,60
L 5,4,s30,1024
M v,192,a,20,a,32
R 92,22,14336
M v,196,a,20,a,36
M v,200,a,20,a,40
T 124,19,16384
M v,204,a,20,a,44
L 6,4,s30,2048
M v,208,a,20,a,48
T 126,19,18432
M v,212,a,20,a,52
M v,216,a,20,a,56
M v,220,a,20,a,60
L 7,4,s30,3072
M v,224,a,24,a,32
M v,228,a,24,a,36
M v,232,a,24,a,40
M v,236,a,24,a,44
buffer_load_dwordx4 a[216:219], v0, s[16:19], 0 offen offset:704
M v,240,a,24,a,48
M v,244,a,24,a,52
M v,248,a,24,a,56
M v,252,a,24,a,60
buffer_load_dwordx4 a[220:223], v0, s[16:19], s36 offen offset:704
M a,224,a,28,a,32
M a,228,a,28,a,36
M a,232,a,28,a,40
M a,236,a,28,a,44
M a,240,a,28,a,48
M a,244,a,28,a,52
M a,248,a,28,a,56
M a,252,a,28,a,60
s_waitcnt vmcnt(20) lgkmcnt(0)
s_barrier
M v,32,a,64,a,96
R 0,20,32768
M v,36,a,64,a,100
T 32,12,32768
M v,40,a,64,a,104
s_add_u32 m0, s29, 16384
M v,44,a,64,a,108
T 34,12,34816
M v,48,a,64,a,112
M v,52,a,64,a,116
R 4,20,34816
M v,56,a,64,a,120
s_mov_b32 s31, 7602176
M v,60,a,64,a,124
T 36,13,32768
M v,64,a,68,a,96
M v,68,a,68,a,100
T 38,13,34816
M v,72,a,68,a,104
M v,76,a,68,a,108
R 8,20,36864
L 8,8,s31,0
M v,80,a,68,a,112
M v,84,a,68,a,116
T 40,14,32768
M v,88,a,68,a,120
M v,92,a,68,a,124
T 42,14,34816
M v,96,a,72,a,96
L 9,8,s31,1024
M v,100,a,72,a,100
R 12,20,38912
M v,104,a,72,a,104
M v,108,a,72,a,108
T 44,15,32768
M v,112,a,72,a,112
M v,116,a,72,a,116
T 46,15,34816
L 10,8,s31,2048
M v,120,a,72,a,120
M v,124,a,72,a,124
R 16,20,40960
M v,128,a,76,a,96
T 48,16,32768
M v,132,a,76,a,100
M v,136,a,76,a,104
T 50,16,34816
L 11,8,s31,3072
M v,140,a,76,a,108
M v,144,a,76,a,112
R 20,20,43008
M v,148,a,76,a,116
M v,152,a,76,a,120
T 52,17,32768
M v,156,a,76,a,124
s_add_u32 m0, s28, 0
M v,160,a,80,a,96
T 54,17,34816
M v,164,a,80,a,100
M v,168,a,80,a,104
R 24,20,45056
M v,172,a,80,a,108
s_mov_b32 s30, 1920
M v,176,a,80,a,112
T 56,18,32768
M v,180,a,80,a,116
M v,184,a,80,a,120
T 58,18,34816
M v,188,a,80,a,124
M v,192,a,84,a,96
R 28,20,47104
L 4,4,s30,0
M v,196,a,84,a,100
M v,200,a,84,a,104
T 60,19,32768
M v,204,a,84,a,108
M v,208,a,84,a,112
T 62,19,34816
M v,212,a,84,a,116
L 5,4,s30,1024
M v,216,a,84,a,120
M v,220,a,84,a,124
M v,224,a,88,a,96
M v,228,a,88,a,100
M v,232,a,88,a,104
L 6,4,s30,2048
M v,236,a,88,a,108
M v,240,a,88,a,112
M v,244,a,88,a,116
M v,248,a,88,a,120
M v,252,a,88,a,124
L 7,4,s30,3072
M a,224,a,92,a,96
M a,228,a,92,a,100
M a,232,a,92,a,104
M a,236,a,92,a,108
M a,240,a,92,a,112
M a,244,a,92,a,116
M a,248,a,92,a,120
M a,252,a,92,a,124
s_waitcnt vmcnt(18) lgkmcnt(0)
s_barrier
M v,32,a,0,a,32
R 64,22,32768
M v,36,a,0,a,36
T 96,12,49152
M v,40,a,0,a,40
s_add_u32 m0, s29, 32768
M v,44,a,0,a,44
T 98,12,51200
M v,48,a,0,a,48
M v,52,a,0,a,52
R 68,22,34816
M v,56,a,0,a,56
s_mov_b32 s31, 7864320
M v,60,a,0,a,60
T 100,13,49152
M v,64,a,4,a,32
M v,68,a,4,a,36
T 102,13,51200
M v,72,a,4,a,40
M v,76,a,4,a,44
R 72,22,36864
L 8,8,s31,0
M v,80,a,4,a,48
M v,84,a,4,a,52
T 104,14,49152
M v,88,a,4,a,56
M v,92,a,4,a,60
T 106,14,51200
M v,96,a,8,a,32
L 9,8,s31,1024
M v,100,a,8,a,36
R 76,22,38912
M v,104,a,8,a,40
M v,108,a,8,a,44
T 108,15,49152
M v,112,a,8,a,48
M v,116,a,8,a,52
T 110,15,51200
L 10,8,s31,2048
M v,120,a,8,a,56
M v,124,a,8,a,60
R 80,22,40960
M v,128,a,12,a,32
T 112,16,49152
M v,132,a,12,a,36
M v,136,a,12,a,40
T 114,16,51200
L 11,8,s31,3072
M v,140,a,12,a,44
M v,144,a,12,a,48
R 84,22,43008
M v,148,a,12,a,52
M v,152,a,12,a,56
T 116,17,49152
M v,156,a,12,a,60
s_add_u32 m0, s28, 4096
M v,160,a,16,a,32
T 118,17,51200
M v,164,a,16,a,36
M v,168,a,16,a,40
R 88,22,45056
M v,172,a,16,a,44
s_mov_b32 s30, 67456
M v,176,a,16,a,48
T 120,18,49152
M v,180,a,16,a,52
M v,184,a,16,a,56
T 122,18,51200
M v,188,a,16,a,60
M v,192,a,20,a,32
R 92,22,47104
L 4,4,s30,0
M v,196,a,20,a,36
M v,200,a,20,a,40
T 124,19,49152
M v,204,a,20,a,44
M v,208,a,20,a,48
T 126,19,51200
M v,212,a,20,a,52
L 5,4,s30,1024
M v,216,a,20,a,56
M v,220,a,20,a,60
M v,224,a,24,a,32
M v,228,a,24,a,36
M v,232,a,24,a,40
L 6,4,s30,2048
M v,236,a,24,a,44
M v,240,a,24,a,48
M v,244,a,24,a,52
M v,248,a,24,a,56
M v,252,a,24,a,60
L 7,4,s30,3072
M a,224,a,28,a,32
M a,228,a,28,a,36
M a,232,a,28,a,40
M a,236,a,28,a,44
M a,240,a,28,a,48
M a,244,a,28,a,52
M a,248,a,28,a,56
M a,252,a,28,a,60
s_waitcnt vmcnt(16) lgkmcnt(0)
s_barrier
M v,32,a,64,a,96
R 0,21,0
M v,36,a,64,a,100
T 32,12,0
M v,40,a,64,a,104
s_add_u32 m0, s29, 49152
M v,44,a,64,a,108
T 34,12,2048
M v,48,a,64,a,112
M v,52,a,64,a,116
R 4,21,2048
M v,56,a,64,a,120
s_mov_b32 s31, 8126464
M v,60,a,64,a,124
T 36,13,0
M v,64,a,68,a,96
M v,68,a,68,a,100
T 38,13,2048
M v,72,a,68,a,104
M v,76,a,68,a,108
R 8,21,4096
L 8,8,s31,0
M v,80,a,68,a,112
M v,84,a,68,a,116
T 40,14,0
M v,88,a,68,a,120
M v,92,a,68,a,124
T 42,14,2048
M v,96,a,72,a,96
L 9,8,s31,1024
M v,100,a,72,a,100
R 12,21,6144
M v,104,a,72,a,104
M v,108,a,72,a,108
T 44,15,0
M v,112,a,72,a,112
M v,116,a,72,a,116
T 46,15,2048
L 10,8,s31,2048
M v,120,a,72,a,120
M v,124,a,72,a,124
R 16,21,8192
M v,128,a,76,a,96
T 48,16,0
M v,132,a,76,a,100
M v,136,a,76,a,104
T 50,16,2048
L 11,8,s31,3072
M v,140,a,76,a,108
M v,144,a,76,a,112
R 20,21,10240
M v,148,a,76,a,116
M v,152,a,76,a,120
T 52,17,0
M v,156,a,76,a,124
s_add_u32 m0, s32, 32768
M v,160,a,80,a,96
T 54,17,2048
M v,164,a,80,a,100
M v,168,a,80,a,104
R 24,21,12288
M v,172,a,80,a,108
s_mov_b32 s35, 524288
M v,176,a,80,a,112
T 56,18,0
M v,180,a,80,a,116
M v,184,a,80,a,120
T 58,18,2048
M v,188,a,80,a,124
M v,192,a,84,a,96
R 28,21,14336
L 28,68,s35,0
M v,196,a,84,a,100
M v,200,a,84,a,104
T 60,19,0
M v,204,a,84,a,108
M v,208,a,84,a,112
T 62,19,2048
M v,212,a,84,a,116
L 29,68,s35,1024
M v,216,a,84,a,120
M v,220,a,84,a,124
M v,224,a,88,a,96
M v,228,a,88,a,100
M v,232,a,88,a,104
L 30,68,s35,2048
M v,236,a,88,a,108
M v,240,a,88,a,112
M v,244,a,88,a,116
M v,248,a,88,a,120
M v,252,a,88,a,124
L 31,68,s35,3072
M a,224,a,92,a,96
M a,228,a,92,a,100
M a,232,a,92,a,104
M a,236,a,92,a,108
M a,240,a,92,a,112
M a,244,a,92,a,116
M a,248,a,92,a,120
M a,252,a,92,a,124
s_waitcnt vmcnt(16) lgkmcnt(0)
s_barrier
M v,32,a,0,a,32
R 64,23,0
M v,36,a,0,a,36
T 96,12,16384
M v,40,a,0,a,40
s_add_u32 m0, s32, 49152
M v,44,a,0,a,44
T 98,12,18432
M v,48,a,0,a,48
M v,52,a,0,a,52
R 68,23,2048
M v,56,a,0,a,56
M v,60,a,0,a,60
T 100,13,16384
M v,64,a,4,a,32
M v,68,a,4,a,36
T 102,13,18432
M v,72,a,4,a,40
M v,76,a,4,a,44
R 72,23,4096
s_mov_b32 s35, 786432
M v,80,a,4,a,48
M v,84,a,4,a,52
T 104,14,16384
M v,88,a,4,a,56
M v,92,a,4,a,60
T 106,14,18432
M v,96,a,8,a,32
M v,100,a,8,a,36
R 76,23,6144
M v,104,a,8,a,40
M v,108,a,8,a,44
T 108,15,16384
M v,112,a,8,a,48
M v,116,a,8,a,52
T 110,15,18432
L 28,68,s35,0
M v,120,a,8,a,56
M v,124,a,8,a,60
R 80,23,8192
M v,128,a,12,a,32
T 112,16,16384
M v,132,a,12,a,36
M v,136,a,12,a,40
T 114,16,18432
M v,140,a,12,a,44
M v,144,a,12,a,48
R 84,23,10240
M v,148,a,12,a,52
M v,152,a,12,a,56
T 116,17,16384
M v,156,a,12,a,60
L 29,68,s35,1024
M v,160,a,16,a,32
T 118,17,18432
M v,164,a,16,a,36
M v,168,a,16,a,40
R 88,23,12288
M v,172,a,16,a,44
M v,176,a,16,a,48
T 120,18,16384
M v,180,a,16,a,52
M v,184,a,16,a,56
T 122,18,18432
M v,188,a,16,a,60
M v,192,a,20,a,32
R 92,23,14336
L 30,68,s35,2048
M v,196,a,20,a,36
M v,200,a,20,a,40
T 124,19,16384
M v,204,a,20,a,44
M v,208,a,20,a,48
T 126,19,18432
M v,212,a,20,a,52
M v,216,a,20,a,56
M v,220,a,20,a,60
M v,224,a,24,a,32
M v,228,a,24,a,36
M v,232,a,24,a,40
L 31,68,s35,3072
M v,236,a,24,a,44
M v,240,a,24,a,48
M v,244,a,24,a,52
M v,248,a,24,a,56
M v,252,a,24,a,60
M a,224,a,28,a,32
M a,228,a,28,a,36
M a,232,a,28,a,40
M a,236,a,28,a,44
M a,240,a,28,a,48
M a,244,a,28,a,52
M a,248,a,28,a,56
M a,252,a,28,a,60
s_waitcnt vmcnt(12) lgkmcnt(0)
s_barrier
M v,32,a,64,a,96
R 0,20,0
M v,36,a,64,a,100
T 32,12,32768
M v,40,a,64,a,104
s_add_u32 m0, s32, 65536
M v,44,a,64,a,108
T 34,12,34816
M v,48,a,64,a,112
M v,52,a,64,a,116
R 4,20,2048
M v,56,a,64,a,120
M v,60,a,64,a,124
T 36,13,32768
M v,64,a,68,a,96
M v,68,a,68,a,100
T 38,13,34816
M v,72,a,68,a,104
M v,76,a,68,a,108
R 8,20,4096
s_mov_b32 s35, 1048576
M v,80,a,68,a,112
M v,84,a,68,a,116
T 40,14,32768
M v,88,a,68,a,120
M v,92,a,68,a,124
T 42,14,34816
M v,96,a,72,a,96
M v,100,a,72,a,100
R 12,20,6144
M v,104,a,72,a,104
M v,108,a,72,a,108
T 44,15,32768
M v,112,a,72,a,112
M v,116,a,72,a,116
T 46,15,34816
L 28,68,s35,0
M v,120,a,72,a,120
M v,124,a,72,a,124
R 16,20,8192
M v,128,a,76,a,96
T 48,16,32768
M v,132,a,76,a,100
M v,136,a,76,a,104
T 50,16,34816
M v,140,a,76,a,108
M v,144,a,76,a,112
R 20,20,10240
M v,148,a,76,a,116
M v,152,a,76,a,120
T 52,17,32768
M v,156,a,76,a,124
L 29,68,s35,1024
M v,160,a,80,a,96
T 54,17,34816
M v,164,a,80,a,100
M v,168,a,80,a,104
R 24,20,12288
M v,172,a,80,a,108
M v,176,a,80,a,112
T 56,18,32768
M v,180,a,80,a,116
M v,184,a,80,a,120
T 58,18,34816
M v,188,a,80,a,124
M v,192,a,84,a,96
R 28,20,14336
L 30,68,s35,2048
M v,196,a,84,a,100
M v,200,a,84,a,104
T 60,19,32768
M v,204,a,84,a,108
M v,208,a,84,a,112
T 62,19,34816
M v,212,a,84,a,116
M v,216,a,84,a,120
M v,220,a,84,a,124
M v,224,a,88,a,96
M v,228,a,88,a,100
M v,232,a,88,a,104
L 31,68,s35,3072
M v,236,a,88,a,108
M v,240,a,88,a,112
M v,244,a,88,a,116
M v,248,a,88,a,120
M v,252,a,88,a,124
M a,224,a,92,a,96
M a,228,a,92,a,100
M a,232,a,92,a,104
M a,236,a,92,a,108
M a,240,a,92,a,112
M a,244,a,92,a,116
M a,248,a,92,a,120
M a,252,a,92,a,124
s_waitcnt vmcnt(8) lgkmcnt(0)
s_barrier
M v,32,a,0,a,32
R 64,22,0
M v,36,a,0,a,36
T 96,12,49152
M v,40,a,0,a,40
s_add_u32 m0, s32, 81920
M v,44,a,0,a,44
T 98,12,51200
M v,48,a,0,a,48
M v,52,a,0,a,52
R 68,22,2048
M v,56,a,0,a,56
M v,60,a,0,a,60
T 100,13,49152
M v,64,a,4,a,32
M v,68,a,4,a,36
T 102,13,51200
M v,72,a,4,a,40
M v,76,a,4,a,44
R 72,22,4096
s_mov_b32 s35, 1310720
M v,80,a,4,a,48
M v,84,a,4,a,52
T 104,14,49152
M v,88,a,4,a,56
M v,92,a,4,a,60
T 106,14,51200
M v,96,a,8,a,32
M v,100,a,8,a,36
R 76,22,6144
M v,104,a,8,a,40
M v,108,a,8,a,44
T 108,15,49152
M v,112,a,8,a,48
M v,116,a,8,a,52
T 110,15,51200
L 28,68,s35,0
M v,120,a,8,a,56
M v,124,a,8,a,60
R 80,22,8192
M v,128,a,12,a,32
T 112,16,49152
M v,132,a,12,a,36
M v,136,a,12,a,40
T 114,16,51200
M v,140,a,12,a,44
M v,144,a,12,a,48
R 84,22,10240
M v,148,a,12,a,52
M v,152,a,12,a,56
T 116,17,49152
M v,156,a,12,a,60
L 29,68,s35,1024
M v,160,a,16,a,32
T 118,17,51200
M v,164,a,16,a,36
M v,168,a,16,a,40
R 88,22,12288
M v,172,a,16,a,44
M v,176,a,16,a,48
T 120,18,49152
M v,180,a,16,a,52
M v,184,a,16,a,56
T 122,18,51200
M v,188,a,16,a,60
M v,192,a,20,a,32
R 92,22,14336
L 30,68,s35,2048
M v,196,a,20,a,36
M v,200,a,20,a,40
T 124,19,49152
M v,204,a,20,a,44
M v,208,a,20,a,48
T 126,19,51200
M v,212,a,20,a,52
M v,216,a,20,a,56
M v,220,a,20,a,60
M v,224,a,24,a,32
M v,228,a,24,a,36
M v,232,a,24,a,40
L 31,68,s35,3072
M v,236,a,24,a,44
M v,240,a,24,a,48
M v,244,a,24,a,52
M v,248,a,24,a,56
M v,252,a,24,a,60
M a,224,a,28,a,32
M a,228,a,28,a,36
M a,232,a,28,a,40
M a,236,a,28,a,44
M a,240,a,28,a,48
M a,244,a,28,a,52
M a,248,a,28,a,56
M a,252,a,28,a,60
s_waitcnt vmcnt(8) lgkmcnt(0)
s_barrier
M v,32,a,64,a,96
s_and_b32 s47, s2, 7
s_lshl_b32 s47, s47, 2
M v,36,a,64,a,100
buffer_load_dword v2, off, s[84:87], s47 sc1
s_mov_b32 m0, 131072
M v,40,a,64,a,104
s_nop 0
buffer_load_dwordx4 v24, s[20:23], 0 offen lds
M v,44,a,64,a,108
s_add_u32 m0, s32, 0
s_mov_b32 s35, 0
M v,48,a,64,a,112
L 28,68,s35,0
M v,52,a,64,a,116
L 29,68,s35,1024
L 30,68,s35,2048
M v,56,a,64,a,120
L 31,68,s35,3072
s_add_u32 m0, s32, 16384
M v,60,a,64,a,124
s_mov_b32 s35, 262144
L 28,68,s35,0
M v,64,a,68,a,96
L 29,68,s35,1024
L 30,68,s35,2048
M v,68,a,68,a,100
L 31,68,s35,3072
M v,72,a,68,a,104
M v,76,a,68,a,108
M v,80,a,68,a,112
M v,84,a,68,a,116
v_cvt_pk_bf16_f32 v32, v32, v33
v_cvt_pk_bf16_f32 v33, v34, v35
M v,88,a,68,a,120
v_cvt_pk_bf16_f32 v34, v64, v65
v_cvt_pk_bf16_f32 v35, v66, v67
M v,92,a,68,a,124
v_cvt_pk_bf16_f32 v36, v36, v37
v_cvt_pk_bf16_f32 v37, v38, v39
M v,96,a,72,a,96
v_cvt_pk_bf16_f32 v38, v68, v69
v_cvt_pk_bf16_f32 v39, v70, v71
M v,100,a,72,a,100
v_cvt_pk_bf16_f32 v40, v40, v41
v_cvt_pk_bf16_f32 v41, v42, v43
M v,104,a,72,a,104
v_cvt_pk_bf16_f32 v42, v72, v73
v_cvt_pk_bf16_f32 v43, v74, v75
M v,108,a,72,a,108
v_cvt_pk_bf16_f32 v44, v44, v45
v_cvt_pk_bf16_f32 v45, v46, v47
M v,112,a,72,a,112
v_cvt_pk_bf16_f32 v46, v76, v77
v_cvt_pk_bf16_f32 v47, v78, v79
M v,116,a,72,a,116
v_cvt_pk_bf16_f32 v48, v48, v49
v_cvt_pk_bf16_f32 v49, v50, v51
M v,120,a,72,a,120
v_cvt_pk_bf16_f32 v50, v80, v81
v_cvt_pk_bf16_f32 v51, v82, v83
M v,124,a,72,a,124
v_cvt_pk_bf16_f32 v52, v52, v53
v_cvt_pk_bf16_f32 v53, v54, v55
M v,128,a,76,a,96
v_cvt_pk_bf16_f32 v54, v84, v85
v_cvt_pk_bf16_f32 v55, v86, v87
M v,132,a,76,a,100
v_cvt_pk_bf16_f32 v56, v56, v57
v_cvt_pk_bf16_f32 v57, v58, v59
M v,136,a,76,a,104
v_cvt_pk_bf16_f32 v58, v88, v89
v_cvt_pk_bf16_f32 v59, v90, v91
M v,140,a,76,a,108
v_cvt_pk_bf16_f32 v60, v60, v61
v_cvt_pk_bf16_f32 v61, v62, v63
M v,144,a,76,a,112
v_cvt_pk_bf16_f32 v62, v92, v93
v_cvt_pk_bf16_f32 v63, v94, v95
M v,148,a,76,a,116
v_cvt_pk_bf16_f32 v64, v96, v97
v_cvt_pk_bf16_f32 v65, v98, v99
M v,152,a,76,a,120
v_cvt_pk_bf16_f32 v66, v128, v129
v_cvt_pk_bf16_f32 v67, v130, v131
M v,156,a,76,a,124
v_cvt_pk_bf16_f32 v68, v100, v101
v_cvt_pk_bf16_f32 v69, v102, v103
M v,160,a,80,a,96
v_cvt_pk_bf16_f32 v70, v132, v133
v_cvt_pk_bf16_f32 v71, v134, v135
M v,164,a,80,a,100
v_cvt_pk_bf16_f32 v72, v104, v105
v_cvt_pk_bf16_f32 v73, v106, v107
M v,168,a,80,a,104
v_cvt_pk_bf16_f32 v74, v136, v137
v_cvt_pk_bf16_f32 v75, v138, v139
M v,172,a,80,a,108
v_cvt_pk_bf16_f32 v76, v108, v109
v_cvt_pk_bf16_f32 v77, v110, v111
M v,176,a,80,a,112
v_cvt_pk_bf16_f32 v78, v140, v141
v_cvt_pk_bf16_f32 v79, v142, v143
M v,180,a,80,a,116
v_cvt_pk_bf16_f32 v80, v112, v113
v_cvt_pk_bf16_f32 v81, v114, v115
M v,184,a,80,a,120
v_cvt_pk_bf16_f32 v82, v144, v145
v_cvt_pk_bf16_f32 v83, v146, v147
M v,188,a,80,a,124
v_cvt_pk_bf16_f32 v84, v116, v117
v_cvt_pk_bf16_f32 v85, v118, v119
M v,192,a,84,a,96
v_cvt_pk_bf16_f32 v86, v148, v149
v_cvt_pk_bf16_f32 v87, v150, v151
M v,196,a,84,a,100
v_cvt_pk_bf16_f32 v120, v120, v121
v_cvt_pk_bf16_f32 v121, v122, v123
M v,200,a,84,a,104
v_cvt_pk_bf16_f32 v122, v152, v153
v_cvt_pk_bf16_f32 v123, v154, v155
M v,204,a,84,a,108
v_cvt_pk_bf16_f32 v116, v124, v125
v_cvt_pk_bf16_f32 v117, v126, v127
M v,208,a,84,a,112
v_cvt_pk_bf16_f32 v118, v156, v157
v_cvt_pk_bf16_f32 v119, v158, v159
M v,212,a,84,a,116
v_cvt_pk_bf16_f32 v160, v160, v161
v_cvt_pk_bf16_f32 v161, v162, v163
M v,216,a,84,a,120
v_cvt_pk_bf16_f32 v162, v192, v193
v_cvt_pk_bf16_f32 v163, v194, v195
M v,220,a,84,a,124
v_accvgpr_write_b32 a0, v160
v_accvgpr_write_b32 a1, v161
M v,224,a,88,a,96
v_accvgpr_write_b32 a2, v162
v_accvgpr_write_b32 a3, v163
M v,228,a,88,a,100
v_cvt_pk_bf16_f32 v164, v164, v165
v_cvt_pk_bf16_f32 v165, v166, v167
M v,232,a,88,a,104
v_cvt_pk_bf16_f32 v166, v196, v197
v_cvt_pk_bf16_f32 v167, v198, v199
M v,236,a,88,a,108
v_accvgpr_write_b32 a4, v164
v_accvgpr_write_b32 a5, v165
M v,240,a,88,a,112
v_accvgpr_write_b32 a6, v166
v_accvgpr_write_b32 a7, v167
M v,244,a,88,a,116
v_cvt_pk_bf16_f32 v168, v168, v169
v_cvt_pk_bf16_f32 v169, v170, v171
M v,248,a,88,a,120
v_cvt_pk_bf16_f32 v170, v200, v201
v_cvt_pk_bf16_f32 v171, v202, v203
M v,252,a,88,a,124
v_accvgpr_write_b32 a8, v168
v_accvgpr_write_b32 a9, v169
M a,224,a,92,a,96
v_accvgpr_write_b32 a10, v170
v_accvgpr_write_b32 a11, v171
M a,228,a,92,a,100
v_cvt_pk_bf16_f32 v172, v172, v173
v_cvt_pk_bf16_f32 v173, v174, v175
M a,232,a,92,a,104
v_cvt_pk_bf16_f32 v174, v204, v205
v_cvt_pk_bf16_f32 v175, v206, v207
M a,236,a,92,a,108
v_accvgpr_write_b32 a12, v172
v_accvgpr_write_b32 a13, v173
M a,240,a,92,a,112
v_accvgpr_write_b32 a14, v174
v_accvgpr_write_b32 a15, v175
M a,244,a,92,a,116
v_cvt_pk_bf16_f32 v176, v176, v177
v_cvt_pk_bf16_f32 v177, v178, v179
M a,248,a,92,a,120
v_cvt_pk_bf16_f32 v178, v208, v209
v_cvt_pk_bf16_f32 v179, v210, v211
M a,252,a,92,a,124
v_accvgpr_write_b32 a16, v176
v_accvgpr_write_b32 a17, v177
s_nop 7
v_accvgpr_write_b32 a18, v178
v_accvgpr_write_b32 a19, v179
v_cvt_pk_bf16_f32 v180, v180, v181
v_cvt_pk_bf16_f32 v181, v182, v183
v_cvt_pk_bf16_f32 v182, v212, v213
v_cvt_pk_bf16_f32 v183, v214, v215
v_accvgpr_write_b32 a20, v180
v_accvgpr_write_b32 a21, v181
v_accvgpr_write_b32 a22, v182
v_accvgpr_write_b32 a23, v183
v_cvt_pk_bf16_f32 v184, v184, v185
v_cvt_pk_bf16_f32 v185, v186, v187
v_cvt_pk_bf16_f32 v186, v216, v217
v_cvt_pk_bf16_f32 v187, v218, v219
v_accvgpr_write_b32 a24, v184
v_accvgpr_write_b32 a25, v185
v_accvgpr_write_b32 a26, v186
v_accvgpr_write_b32 a27, v187
v_cvt_pk_bf16_f32 v188, v188, v189
v_cvt_pk_bf16_f32 v189, v190, v191
v_cvt_pk_bf16_f32 v190, v220, v221
v_cvt_pk_bf16_f32 v191, v222, v223
v_accvgpr_write_b32 a28, v188
v_accvgpr_write_b32 a29, v189
v_accvgpr_write_b32 a30, v190
v_accvgpr_write_b32 a31, v191
v_accvgpr_read_b32 v160, a224
v_accvgpr_read_b32 v161, a225
v_accvgpr_read_b32 v162, a226
v_accvgpr_read_b32 v163, a227
v_cvt_pk_bf16_f32 v224, v224, v225
v_cvt_pk_bf16_f32 v225, v226, v227
v_cvt_pk_bf16_f32 v226, v160, v161
v_cvt_pk_bf16_f32 v227, v162, v163
v_accvgpr_write_b32 a32, v224
v_accvgpr_write_b32 a33, v225
v_accvgpr_write_b32 a34, v226
v_accvgpr_write_b32 a35, v227
v_accvgpr_read_b32 v164, a228
v_accvgpr_read_b32 v165, a229
v_accvgpr_read_b32 v166, a230
v_accvgpr_read_b32 v167, a231
v_cvt_pk_bf16_f32 v228, v228, v229
v_cvt_pk_bf16_f32 v229, v230, v231
v_cvt_pk_bf16_f32 v230, v164, v165
v_cvt_pk_bf16_f32 v231, v166, v167
v_accvgpr_write_b32 a36, v228
v_accvgpr_write_b32 a37, v229
v_accvgpr_write_b32 a38, v230
v_accvgpr_write_b32 a39, v231
v_accvgpr_read_b32 v160, a232
v_accvgpr_read_b32 v161, a233
v_accvgpr_read_b32 v162, a234
v_accvgpr_read_b32 v163, a235
v_cvt_pk_bf16_f32 v232, v232, v233
v_cvt_pk_bf16_f32 v233, v234, v235
v_cvt_pk_bf16_f32 v234, v160, v161
v_cvt_pk_bf16_f32 v235, v162, v163
v_accvgpr_write_b32 a40, v232
v_accvgpr_write_b32 a41, v233
v_accvgpr_write_b32 a42, v234
v_accvgpr_write_b32 a43, v235
v_accvgpr_read_b32 v164, a236
v_accvgpr_read_b32 v165, a237
v_accvgpr_read_b32 v166, a238
v_accvgpr_read_b32 v167, a239
v_cvt_pk_bf16_f32 v236, v236, v237
v_cvt_pk_bf16_f32 v237, v238, v239
v_cvt_pk_bf16_f32 v238, v164, v165
v_cvt_pk_bf16_f32 v239, v166, v167
v_accvgpr_write_b32 a44, v236
v_accvgpr_write_b32 a45, v237
v_accvgpr_write_b32 a46, v238
v_accvgpr_write_b32 a47, v239
v_accvgpr_read_b32 v160, a240
v_accvgpr_read_b32 v161, a241
v_accvgpr_read_b32 v162, a242
v_accvgpr_read_b32 v163, a243
v_cvt_pk_bf16_f32 v240, v240, v241
v_cvt_pk_bf16_f32 v241, v242, v243
v_cvt_pk_bf16_f32 v242, v160, v161
v_cvt_pk_bf16_f32 v243, v162, v163
v_accvgpr_write_b32 a48, v240
v_accvgpr_write_b32 a49, v241
v_accvgpr_write_b32 a50, v242
v_accvgpr_write_b32 a51, v243
v_accvgpr_read_b32 v164, a244
v_accvgpr_read_b32 v165, a245
v_accvgpr_read_b32 v166, a246
v_accvgpr_read_b32 v167, a247
v_cvt_pk_bf16_f32 v244, v244, v245
v_cvt_pk_bf16_f32 v245, v246, v247
v_cvt_pk_bf16_f32 v246, v164, v165
v_cvt_pk_bf16_f32 v247, v166, v167
v_accvgpr_write_b32 a52, v244
v_accvgpr_write_b32 a53, v245
v_accvgpr_write_b32 a54, v246
v_accvgpr_write_b32 a55, v247
v_accvgpr_read_b32 v160, a248
v_accvgpr_read_b32 v161, a249
v_accvgpr_read_b32 v162, a250
v_accvgpr_read_b32 v163, a251
v_cvt_pk_bf16_f32 v248, v248, v249
v_cvt_pk_bf16_f32 v249, v250, v251
v_cvt_pk_bf16_f32 v250, v160, v161
v_cvt_pk_bf16_f32 v251, v162, v163
v_accvgpr_write_b32 a56, v248
v_accvgpr_write_b32 a57, v249
v_accvgpr_write_b32 a58, v250
v_accvgpr_write_b32 a59, v251
v_accvgpr_read_b32 v164, a252
v_accvgpr_read_b32 v165, a253
v_accvgpr_read_b32 v166, a254
v_accvgpr_read_b32 v167, a255
v_cvt_pk_bf16_f32 v252, v252, v253
v_cvt_pk_bf16_f32 v253, v254, v255
v_cvt_pk_bf16_f32 v254, v164, v165
v_cvt_pk_bf16_f32 v255, v166, v167
v_accvgpr_write_b32 a60, v252
v_accvgpr_write_b32 a61, v253
v_accvgpr_write_b32 a62, v254
v_accvgpr_write_b32 a63, v255
MG_in:
v_mov_b32 v104, v28
v_mov_b32 v105, v29
v_mov_b32 v106, v30
v_mov_b32 v107, v31
s_lshr_b32 s47, s24, 1
s_lshl_b32 s47, s47, 8
s_add_u32 s47, s47, 98304
v_subrev_u32 v88, s47, v12
v_subrev_u32 v89, s47, v13
v_subrev_u32 v90, s47, v14
v_subrev_u32 v91, s47, v15
v_subrev_u32 v92, s47, v16
v_subrev_u32 v93, s47, v17
v_subrev_u32 v94, s47, v18
v_subrev_u32 v95, s47, v19
v_add_u32 v96, 0x10000, v88
v_add_u32 v97, 0x10000, v89
v_add_u32 v98, 0x10000, v90
v_add_u32 v99, 0x10000, v91
v_add_u32 v100, 0x10000, v92
v_add_u32 v101, 0x10000, v93
v_add_u32 v102, 0x10000, v94
v_add_u32 v103, 0x10000, v95
v_lshlrev_b32 v7, 4, v1
s_cmp_eq_u32 s88, 2
s_cselect_b32 s47, 0, 0x7ff00000
v_add_u32 v126, s47, v7
s_waitcnt vmcnt(0)
v_readfirstlane_b32 s66, v2
s_cmp_lg_u32 s66, 0
s_cbranch_scc1 NON_ok
s_mov_b32 s59, 0
s_and_b32 s47, s2, 7
s_lshl_b32 s47, s47, 2
NON_l:
s_sleep 1
buffer_load_dword v2, off, s[84:87], s47 sc1
s_waitcnt vmcnt(0)
v_readfirstlane_b32 s66, v2
s_add_u32 s59, s59, 1
s_cmp_ge_u32 s59, 0x8000
s_cbranch_scc1 NON_ok
s_cmp_eq_u32 s66, 0
s_cbranch_scc1 NON_l
NON_ok:
s_barrier
T 64,88,0
T 66,88,2048
T 68,89,0
T 70,89,2048
T 72,90,0
T 74,90,2048
T 76,91,0
T 78,91,2048
T 80,92,0
T 82,92,2048
T 84,93,0
T 86,93,2048
s_waitcnt lgkmcnt(0)
Z v,128,a,64,a,128
T 88,94,0
T 90,94,2048
Z v,132,a,64,a,132
T 92,95,0
T 94,95,2048
Z v,136,a,68,a,128
s_add_u32 m0, s32, 98304
s_mov_b32 s35, 1572864
Z v,140,a,68,a,132
T 96,88,256
T 98,88,2304
Z v,144,a,72,a,128
T 100,89,256
T 102,89,2304
Z v,148,a,72,a,132
L 104,68,s35,0
L 105,68,s35,1024
Z v,152,a,76,a,128
T 104,90,256
T 106,90,2304
Z v,156,a,76,a,132
T 108,91,256
T 110,91,2304
Z v,160,a,80,a,128
L 106,68,s35,2048
v_lshrrev_b32 v13, 4, v1
Z v,164,a,80,a,132
T 112,92,256
T 114,92,2304
Z v,168,a,84,a,128
L 107,68,s35,3072
s_add_u32 m0, s32, 114688
Z v,172,a,84,a,132
T 116,93,256
T 118,93,2304
s_waitcnt lgkmcnt(6)
Z v,176,a,88,a,128
T 120,94,256
T 122,94,2304
Z v,180,a,88,a,132
s_mov_b32 s35, 1835008
L 104,68,s35,0
Z v,184,a,92,a,128
T 124,95,256
T 126,95,2304
Z v,188,a,92,a,132
T 64,88,16384
T 66,88,18432
Z v,192,a,96,a,128
L 105,68,s35,1024
v_and_b32 v14, 15, v1
Z v,196,a,96,a,132
T 68,89,16384
T 70,89,18432
Z v,200,a,100,a,128
T 72,90,16384
T 74,90,18432
Z v,204,a,100,a,132
L 106,68,s35,2048
L 107,68,s35,3072
Z v,208,a,104,a,128
T 76,91,16384
T 78,91,18432
Z v,212,a,104,a,132
buffer_load_dwordx4 a[224:227], v0, s[16:19], 0 offen offset:768
buffer_load_dwordx4 a[228:231], v0, s[16:19], s36 offen offset:768
s_waitcnt lgkmcnt(6)
Z v,216,a,108,a,128
T 80,92,16384
T 82,92,18432
Z v,220,a,108,a,132
T 84,93,16384
T 86,93,18432
Z v,224,a,112,a,128
buffer_load_dwordx4 a[232:235], v0, s[16:19], 0 offen offset:832
v_lshrrev_b32 v16, 2, v14
Z v,228,a,112,a,132
T 88,94,16384
T 90,94,18432
Z v,232,a,116,a,128
T 92,95,16384
T 94,95,18432
Z v,236,a,116,a,132
buffer_load_dwordx4 a[236:239], v0, s[16:19], s36 offen offset:832
buffer_store_dwordx4 v[32:35], v7, s[12:15], s40 offen sc1
Z v,240,a,120,a,128
T 96,88,16640
T 98,88,18688
Z v,244,a,120,a,132
T 100,89,16640
T 102,89,18688
Z v,248,a,124,a,128
s_add_u32 s40, s40, s41
buffer_store_dwordx4 v[36:39], v7, s[12:15], s40 offen sc1
Z v,252,a,124,a,132
T 104,90,16640
T 106,90,18688
M v,128,a,64,a,136
s_add_u32 s40, s40, s42
v_and_b32 v17, 3, v14
M v,132,a,64,a,140
T 108,91,16640
T 110,91,18688
s_waitcnt lgkmcnt(6)
M v,136,a,68,a,136
T 112,92,16640
T 114,92,18688
M v,140,a,68,a,140
buffer_store_dwordx4 v[40:43], v7, s[12:15], s40 offen sc1
s_add_u32 s40, s40, s41
M v,144,a,72,a,136
T 116,93,16640
T 118,93,18688
M v,148,a,72,a,140
T 120,94,16640
T 122,94,18688
M v,152,a,76,a,136
buffer_store_dwordx4 v[44:47], v7, s[12:15], s40 offen sc1
s_add_u32 s40, s40, s42
M v,156,a,76,a,140
T 124,95,16640
T 126,95,18688
M v,160,a,80,a,136
buffer_store_dwordx4 v[48:51], v7, s[12:15], s40 offen sc1
v_lshlrev_b32 v19, 3, v17
M v,164,a,80,a,140
s_add_u32 s40, s40, s41
v_mov_b32 v3, v7
M v,168,a,84,a,136
buffer_store_dwordx4 v[52:55], v7, s[12:15], s40 offen sc1
v_add_u32 v4, 0x10000, v7
M v,172,a,84,a,140
v_add_u32 v6, s32, v7
v_add_u32 v5, 0x10000, v6
M v,176,a,88,a,136
s_add_u32 s40, s40, s42
v_add_u32 v6, 0x4000, v6
M v,180,a,88,a,140
v_lshlrev_b32 v16, 2, v13
v_sub_u32 v10, v14, v16
M v,184,a,92,a,136
s_lshl_b32 s52, s24, 5
v_add_u32 v10, s52, v10
M v,188,a,92,a,140
v_mov_b32 v12, 0xff800000
v_lshlrev_b32 v124, 4, v13
M v,192,a,96,a,136
s_waitcnt vmcnt(63) lgkmcnt(0)
s_barrier
M v,196,a,96,a,140
T 64,88,32768
T 66,88,34816
M v,200,a,100,a,136
T 68,89,32768
T 70,89,34816
M v,204,a,100,a,140
T 72,90,32768
T 74,90,34816
M v,208,a,104,a,136
T 76,91,32768
T 78,91,34816
M v,212,a,104,a,140
T 80,92,32768
T 82,92,34816
M v,216,a,108,a,136
T 84,93,32768
T 86,93,34816
M v,220,a,108,a,140
v_add_u32 v124, 131072, v124
v_and_b32 v125, 31, v1
M v,224,a,112,a,136
v_lshlrev_b32 v125, 2, v125
v_lshrrev_b32 v16, 5, v1
M v,228,a,112,a,140
v_and_b32 v17, 1, v1
v_and_b32 v18, 31, v1
M v,232,a,116,a,136
v_lshrrev_b32 v18, 1, v18
v_and_b32 v19, 7, v18
M v,236,a,116,a,140
v_lshrrev_b32 v20, 4, v1
v_and_b32 v20, 1, v20
M v,240,a,120,a,136
s_and_b32 s52, s24, 1
s_lshl_b32 s52, s52, 2
M v,244,a,120,a,140
M v,248,a,124,a,136
M v,252,a,124,a,140
s_waitcnt lgkmcnt(0)
M v,128,a,64,a,144
T 88,94,32768
T 90,94,34816
M v,132,a,64,a,148
T 92,95,32768
T 94,95,34816
M v,136,a,68,a,144
s_add_u32 m0, s32, 0
s_mov_b32 s35, 2097152
M v,140,a,68,a,148
T 96,88,33024
T 98,88,35072
M v,144,a,72,a,144
T 100,89,33024
T 102,89,35072
M v,148,a,72,a,148
L 104,68,s35,0
s_lshl_b32 s53, s24, 3
M v,152,a,76,a,144
T 104,90,33024
T 106,90,35072
M v,156,a,76,a,148
T 108,91,33024
T 110,91,35072
M v,160,a,80,a,144
L 105,68,s35,1024
L 106,68,s35,2048
M v,164,a,80,a,148
T 112,92,33024
T 114,92,35072
M v,168,a,84,a,144
L 107,68,s35,3072
s_mul_i32 s54, s25, 224
M v,172,a,84,a,148
T 116,93,33024
T 118,93,35072
s_waitcnt lgkmcnt(6)
M v,176,a,88,a,144
T 120,94,33024
T 122,94,35072
M v,180,a,88,a,148
s_add_u32 m0, s32, 16384
v_add_u32 v21, 0, v16
M v,184,a,92,a,144
T 124,95,33024
T 126,95,35072
M v,188,a,92,a,148
T 64,88,49152
T 66,88,51200
M v,192,a,96,a,144
s_mov_b32 s35, 2359296
L 104,68,s35,0
M v,196,a,96,a,148
T 68,89,49152
T 70,89,51200
M v,200,a,100,a,144
T 72,90,49152
T 74,90,51200
M v,204,a,100,a,148
L 105,68,s35,1024
L 106,68,s35,2048
M v,208,a,104,a,144
T 76,91,49152
T 78,91,51200
M v,212,a,104,a,148
L 107,68,s35,3072
v_and_b32 v22, 3, v21
s_waitcnt lgkmcnt(6)
M v,216,a,108,a,144
T 80,92,49152
T 82,92,51200
M v,220,a,108,a,148
T 84,93,49152
T 86,93,51200
M v,224,a,112,a,144
buffer_store_dwordx4 v[56:59], v7, s[12:15], s40 offen sc1
v_or_b32 v22, s52, v22
M v,228,a,112,a,148
T 88,94,49152
T 90,94,51200
M v,232,a,116,a,144
T 92,95,49152
T 94,95,51200
M v,236,a,116,a,148
s_add_u32 s40, s40, s41
buffer_store_dwordx4 v[60:63], v7, s[12:15], s40 offen sc1
M v,240,a,120,a,144
T 96,88,49408
T 98,88,51456
M v,244,a,120,a,148
T 100,89,49408
T 102,89,51456
M v,248,a,124,a,144
s_add_u32 s40, s40, s43
v_add_u32 v21, s53, v21
M v,252,a,124,a,148
T 104,90,49408
T 106,90,51456
M v,128,a,64,a,152
buffer_store_dwordx4 v[64:67], v7, s[12:15], s40 offen sc1
s_add_u32 s40, s40, s41
M v,132,a,64,a,156
T 108,91,49408
T 110,91,51456
s_waitcnt lgkmcnt(6)
M v,136,a,68,a,152
T 112,92,49408
T 114,92,51456
M v,140,a,68,a,156
buffer_store_dwordx4 v[68:71], v7, s[12:15], s40 offen sc1
v_xor_b32 v23, v22, v19
M v,144,a,72,a,152
T 116,93,49408
T 118,93,51456
M v,148,a,72,a,156
T 120,94,49408
T 122,94,51456
M v,152,a,76,a,152
s_add_u32 s40, s40, s42
buffer_store_dwordx4 v[72:75], v7, s[12:15], s40 offen sc1
M v,156,a,76,a,156
T 124,95,49408
T 126,95,51456
M v,160,a,80,a,152
s_add_u32 s40, s40, s41
v_lshlrev_b32 v23, 1, v23
M v,164,a,80,a,156
v_or_b32 v23, v23, v17
v_lshlrev_b32 v23, 4, v23
M v,168,a,84,a,152
buffer_store_dwordx4 v[76:79], v7, s[12:15], s40 offen sc1
v_lshlrev_b32 v24, 5, v20
M v,172,a,84,a,156
v_add_u32 v24, v24, v21
v_mul_u32_u24 v24, 3584, v24
M v,176,a,88,a,152
s_add_u32 s40, s40, s42
v_add_u32 v24, v24, v23
M v,180,a,88,a,156
v_add_u32 v24, s54, v24
v_mov_b32 v108, v24
M v,184,a,92,a,152
v_add_u32 v21, 2, v16
v_and_b32 v22, 3, v21
M v,188,a,92,a,156
v_or_b32 v22, s52, v22
v_add_u32 v21, s53, v21
M v,192,a,96,a,152
s_waitcnt vmcnt(63) lgkmcnt(0)
s_barrier
M v,196,a,96,a,156
T 64,96,0
T 66,96,2048
M v,200,a,100,a,152
T 68,97,0
T 70,97,2048
M v,204,a,100,a,156
T 72,98,0
T 74,98,2048
M v,208,a,104,a,152
T 76,99,0
T 78,99,2048
M v,212,a,104,a,156
T 80,100,0
T 82,100,2048
M v,216,a,108,a,152
T 84,101,0
T 86,101,2048
M v,220,a,108,a,156
v_xor_b32 v23, v22, v19
v_lshlrev_b32 v23, 1, v23
M v,224,a,112,a,152
v_or_b32 v23, v23, v17
v_lshlrev_b32 v23, 4, v23
M v,228,a,112,a,156
v_lshlrev_b32 v24, 5, v20
v_add_u32 v24, v24, v21
M v,232,a,116,a,152
v_mul_u32_u24 v24, 3584, v24
v_add_u32 v24, v24, v23
M v,236,a,116,a,156
v_add_u32 v24, s54, v24
M v,240,a,120,a,152
M v,244,a,120,a,156
M v,248,a,124,a,152
M v,252,a,124,a,156
s_waitcnt lgkmcnt(0)
M v,128,a,64,a,160
T 88,102,0
T 90,102,2048
M v,132,a,64,a,164
T 92,103,0
T 94,103,2048
M v,136,a,68,a,160
s_add_u32 m0, s32, 32768
v_subrev_u32 v109, 1024, v24
M v,140,a,68,a,164
T 96,96,256
T 98,96,2304
M v,144,a,72,a,160
T 100,97,256
T 102,97,2304
M v,148,a,72,a,164
s_mov_b32 s35, 2621440
L 104,68,s35,0
M v,152,a,76,a,160
T 104,98,256
T 106,98,2304
M v,156,a,76,a,164
T 108,99,256
T 110,99,2304
M v,160,a,80,a,160
L 105,68,s35,1024
v_add_u32 v21, 4, v16
M v,164,a,80,a,164
T 112,100,256
T 114,100,2304
M v,168,a,84,a,160
L 106,68,s35,2048
v_and_b32 v22, 3, v21
M v,172,a,84,a,164
T 116,101,256
T 118,101,2304
s_waitcnt lgkmcnt(6)
M v,176,a,88,a,160
T 120,102,256
T 122,102,2304
M v,180,a,88,a,164
L 107,68,s35,3072
s_add_u32 m0, s32, 49152
M v,184,a,92,a,160
T 124,103,256
T 126,103,2304
M v,188,a,92,a,164
T 64,96,16384
T 66,96,18432
M v,192,a,96,a,160
s_mov_b32 s35, 2883584
v_or_b32 v22, s52, v22
M v,196,a,96,a,164
T 68,97,16384
T 70,97,18432
M v,200,a,100,a,160
T 72,98,16384
T 74,98,18432
M v,204,a,100,a,164
L 104,68,s35,0
L 105,68,s35,1024
M v,208,a,104,a,160
T 76,99,16384
T 78,99,18432
M v,212,a,104,a,164
L 106,68,s35,2048
v_add_u32 v21, s53, v21
s_waitcnt lgkmcnt(6)
M v,216,a,108,a,160
T 80,100,16384
T 82,100,18432
M v,220,a,108,a,164
T 84,101,16384
T 86,101,18432
M v,224,a,112,a,160
L 107,68,s35,3072
v_xor_b32 v23, v22, v19
M v,228,a,112,a,164
T 88,102,16384
T 90,102,18432
M v,232,a,116,a,160
T 92,103,16384
T 94,103,18432
M v,236,a,116,a,164
buffer_store_dwordx4 v[80:83], v7, s[12:15], s40 offen sc1
s_add_u32 s40, s40, s41
M v,240,a,120,a,160
T 96,96,16640
T 98,96,18688
M v,244,a,120,a,164
T 100,97,16640
T 102,97,18688
M v,248,a,124,a,160
buffer_store_dwordx4 v[84:87], v7, s[12:15], s40 offen sc1
v_lshlrev_b32 v23, 1, v23
M v,252,a,124,a,164
T 104,98,16640
T 106,98,18688
M v,128,a,64,a,168
s_add_u32 s40, s40, s42
v_or_b32 v23, v23, v17
M v,132,a,64,a,172
T 108,99,16640
T 110,99,18688
s_waitcnt lgkmcnt(6)
M v,136,a,68,a,168
T 112,100,16640
T 114,100,18688
M v,140,a,68,a,172
buffer_store_dwordx4 v[120:123], v7, s[12:15], s40 offen sc1
s_add_u32 s40, s40, s41
M v,144,a,72,a,168
T 116,101,16640
T 118,101,18688
M v,148,a,72,a,172
T 120,102,16640
T 122,102,18688
M v,152,a,76,a,168
buffer_store_dwordx4 v[116:119], v7, s[12:15], s40 offen sc1
v_lshlrev_b32 v23, 4, v23
M v,156,a,76,a,172
T 124,103,16640
T 126,103,18688
M v,160,a,80,a,168
s_add_u32 s40, s40, s43
v_lshlrev_b32 v24, 5, v20
M v,164,a,80,a,172
buffer_store_dwordx4 a[0:3], v7, s[12:15], s40 offen sc1
v_add_u32 v24, v24, v21
M v,168,a,84,a,168
v_mul_u32_u24 v24, 3584, v24
v_add_u32 v24, v24, v23
M v,172,a,84,a,172
s_add_u32 s40, s40, s41
v_add_u32 v24, s54, v24
M v,176,a,88,a,168
v_subrev_u32 v110, 2048, v24
v_add_u32 v21, 6, v16
M v,180,a,88,a,172
v_and_b32 v22, 3, v21
v_or_b32 v22, s52, v22
M v,184,a,92,a,168
v_add_u32 v21, s53, v21
v_xor_b32 v23, v22, v19
M v,188,a,92,a,172
v_lshlrev_b32 v23, 1, v23
v_or_b32 v23, v23, v17
M v,192,a,96,a,168
s_waitcnt vmcnt(37) lgkmcnt(0)
s_barrier
M v,196,a,96,a,172
T 64,96,32768
T 66,96,34816
M v,200,a,100,a,168
T 68,97,32768
T 70,97,34816
M v,204,a,100,a,172
T 72,98,32768
T 74,98,34816
M v,208,a,104,a,168
T 76,99,32768
T 78,99,34816
M v,212,a,104,a,172
T 80,100,32768
T 82,100,34816
M v,216,a,108,a,168
T 84,101,32768
T 86,101,34816
M v,220,a,108,a,172
v_lshlrev_b32 v23, 4, v23
v_lshlrev_b32 v24, 5, v20
M v,224,a,112,a,168
v_add_u32 v24, v24, v21
v_mul_u32_u24 v24, 3584, v24
M v,228,a,112,a,172
v_add_u32 v24, v24, v23
v_add_u32 v24, s54, v24
M v,232,a,116,a,168
M v,236,a,116,a,172
v_subrev_u32 v111, 3072, v24
M v,240,a,120,a,168
M v,244,a,120,a,172
M v,248,a,124,a,168
M v,252,a,124,a,172
s_waitcnt lgkmcnt(0)
M v,128,a,64,a,176
T 88,102,32768
T 90,102,34816
M v,132,a,64,a,180
T 92,103,32768
T 94,103,34816
M v,136,a,68,a,176
s_add_u32 m0, s32, 65536
M v,140,a,68,a,180
T 96,96,33024
T 98,96,35072
M v,144,a,72,a,176
T 100,97,33024
T 102,97,35072
M v,148,a,72,a,180
s_mov_b32 s35, 3145728
L 104,68,s35,0
M v,152,a,76,a,176
T 104,98,33024
T 106,98,35072
M v,156,a,76,a,180
T 108,99,33024
T 110,99,35072
M v,160,a,80,a,176
L 105,68,s35,1024
M v,164,a,80,a,180
T 112,100,33024
T 114,100,35072
M v,168,a,84,a,176
L 106,68,s35,2048
M v,172,a,84,a,180
T 116,101,33024
T 118,101,35072
s_waitcnt lgkmcnt(6)
M v,176,a,88,a,176
T 120,102,33024
T 122,102,35072
M v,180,a,88,a,180
L 107,68,s35,3072
s_add_u32 m0, s32, 81920
M v,184,a,92,a,176
T 124,103,33024
T 126,103,35072
M v,188,a,92,a,180
T 64,96,49152
T 66,96,51200
M v,192,a,96,a,176
s_mov_b32 s35, 3407872
M v,196,a,96,a,180
T 68,97,49152
T 70,97,51200
M v,200,a,100,a,176
T 72,98,49152
T 74,98,51200
M v,204,a,100,a,180
L 104,68,s35,0
L 105,68,s35,1024
M v,208,a,104,a,176
T 76,99,49152
T 78,99,51200
M v,212,a,104,a,180
L 106,68,s35,2048
s_waitcnt lgkmcnt(6)
M v,216,a,108,a,176
T 80,100,49152
T 82,100,51200
M v,220,a,108,a,180
T 84,101,49152
T 86,101,51200
M v,224,a,112,a,176
L 107,68,s35,3072
M v,228,a,112,a,180
T 88,102,49152
T 90,102,51200
M v,232,a,116,a,176
T 92,103,49152
T 94,103,51200
M v,236,a,116,a,180
buffer_store_dwordx4 a[4:7], v7, s[12:15], s40 offen sc1
s_add_u32 s40, s40, s42
M v,240,a,120,a,176
T 96,96,49408
T 98,96,51456
M v,244,a,120,a,180
T 100,97,49408
T 102,97,51456
M v,248,a,124,a,176
buffer_store_dwordx4 a[8:11], v7, s[12:15], s40 offen sc1
M v,252,a,124,a,180
T 104,98,49408
T 106,98,51456
M v,128,a,64,a,184
s_add_u32 s40, s40, s41
M v,132,a,64,a,188
T 108,99,49408
T 110,99,51456
s_waitcnt lgkmcnt(6)
M v,136,a,68,a,184
T 112,100,49408
T 114,100,51456
M v,140,a,68,a,188
buffer_store_dwordx4 a[12:15], v7, s[12:15], s40 offen sc1
s_add_u32 s40, s40, s42
M v,144,a,72,a,184
T 116,101,49408
T 118,101,51456
M v,148,a,72,a,188
T 120,102,49408
T 122,102,51456
M v,152,a,76,a,184
buffer_store_dwordx4 a[16:19], v7, s[12:15], s40 offen sc1
M v,156,a,76,a,188
T 124,103,49408
T 126,103,51456
M v,160,a,80,a,184
s_add_u32 s40, s40, s41
M v,164,a,80,a,188
buffer_store_dwordx4 a[20:23], v7, s[12:15], s40 offen sc1
M v,168,a,84,a,184
M v,172,a,84,a,188
s_add_u32 s40, s40, s42
M v,176,a,88,a,184
M v,180,a,88,a,188
M v,184,a,92,a,184
M v,188,a,92,a,188
M v,192,a,96,a,184
s_waitcnt vmcnt(32) lgkmcnt(0)
s_barrier
M v,196,a,96,a,188
T 64,88,0
T 66,88,2048
M v,200,a,100,a,184
T 68,89,0
T 70,89,2048
M v,204,a,100,a,188
T 72,90,0
T 74,90,2048
M v,208,a,104,a,184
T 76,91,0
T 78,91,2048
M v,212,a,104,a,188
T 80,92,0
T 82,92,2048
M v,216,a,108,a,184
T 84,93,0
T 86,93,2048
M v,220,a,108,a,188
M v,224,a,112,a,184
M v,228,a,112,a,188
M v,232,a,116,a,184
M v,236,a,116,a,188
M v,240,a,120,a,184
M v,244,a,120,a,188
M v,248,a,124,a,184
M v,252,a,124,a,188
s_waitcnt lgkmcnt(0)
M v,128,a,64,a,192
T 88,94,0
T 90,94,2048
M v,132,a,64,a,196
T 92,95,0
T 94,95,2048
M v,136,a,68,a,192
s_add_u32 m0, s32, 98304
v_lshrrev_b32 v16, 2, v14
M v,140,a,68,a,196
T 96,88,256
T 98,88,2304
M v,144,a,72,a,192
T 100,89,256
T 102,89,2304
M v,148,a,72,a,196
s_mov_b32 s35, 0
L 108,72,s35,0
M v,152,a,76,a,192
T 104,90,256
T 106,90,2304
M v,156,a,76,a,196
T 108,91,256
T 110,91,2304
M v,160,a,80,a,192
L 109,72,s35,1024
v_and_b32 v17, 3, v14
M v,164,a,80,a,196
T 112,92,256
T 114,92,2304
M v,168,a,84,a,192
L 110,72,s35,2048
v_lshlrev_b32 v19, 3, v17
M v,172,a,84,a,196
T 116,93,256
T 118,93,2304
s_waitcnt lgkmcnt(6)
M v,176,a,88,a,192
T 120,94,256
T 122,94,2304
M v,180,a,88,a,196
L 111,72,s35,3072
s_add_u32 m0, s32, 114688
M v,184,a,92,a,192
T 124,95,256
T 126,95,2304
M v,188,a,92,a,196
T 64,88,16384
T 66,88,18432
M v,192,a,96,a,192
s_mov_b32 s35, 229376
v_lshlrev_b32 v18, 2, v13
M v,196,a,96,a,196
T 68,89,16384
T 70,89,18432
M v,200,a,100,a,192
T 72,90,16384
T 74,90,18432
M v,204,a,100,a,196
L 108,72,s35,0
L 109,72,s35,1024
M v,208,a,104,a,192
T 76,91,16384
T 78,91,18432
M v,212,a,104,a,196
L 110,72,s35,2048
v_add_u32 v18, v18, v16
s_waitcnt lgkmcnt(6)
M v,216,a,108,a,192
T 80,92,16384
T 82,92,18432
M v,220,a,108,a,196
T 84,93,16384
T 86,93,18432
M v,224,a,112,a,192
L 111,72,s35,3072
v_lshrrev_b32 v20, 1, v18
M v,228,a,112,a,196
T 88,94,16384
T 90,94,18432
M v,232,a,116,a,192
T 92,95,16384
T 94,95,18432
M v,236,a,116,a,196
buffer_store_dwordx4 a[24:27], v7, s[12:15], s40 offen sc1
s_add_u32 s40, s40, s41
M v,240,a,120,a,192
T 96,88,16640
T 98,88,18688
M v,244,a,120,a,196
T 100,89,16640
T 102,89,18688
M v,248,a,124,a,192
buffer_store_dwordx4 a[28:31], v7, s[12:15], s40 offen sc1
v_and_b32 v20, 3, v20
M v,252,a,124,a,196
T 104,90,16640
T 106,90,18688
M v,128,a,64,a,200
s_add_u32 s40, s40, s43
v_lshlrev_b32 v18, 7, v18
M v,132,a,64,a,204
T 108,91,16640
T 110,91,18688
s_waitcnt lgkmcnt(6)
M v,136,a,68,a,200
T 112,92,16640
T 114,92,18688
M v,140,a,68,a,204
buffer_store_dwordx4 a[32:35], v7, s[12:15], s40 offen sc1
s_add_u32 s40, s40, s41
M v,144,a,72,a,200
T 116,93,16640
T 118,93,18688
M v,148,a,72,a,204
T 120,94,16640
T 122,94,18688
M v,152,a,76,a,200
buffer_store_dwordx4 a[36:39], v7, s[12:15], s40 offen sc1
v_add_u32 v18, v18, v19
M v,156,a,76,a,204
T 124,95,16640
T 126,95,18688
M v,160,a,80,a,200
s_add_u32 s40, s40, s42
v_xor_b32 v21, 0, v20
M v,164,a,80,a,204
buffer_store_dwordx4 a[40:43], v7, s[12:15], s40 offen sc1
v_lshlrev_b32 v21, 5, v21
M v,168,a,84,a,200
v_add_u32 v116, v18, v21
v_add_u32 v120, 0x10000, v116
M v,172,a,84,a,204
s_add_u32 s40, s40, s41
v_xor_b32 v21, 1, v20
M v,176,a,88,a,200
v_lshlrev_b32 v21, 5, v21
v_add_u32 v117, v18, v21
M v,180,a,88,a,204
M v,184,a,92,a,200
M v,188,a,92,a,204
v_add_u32 v121, 0x10000, v117
M v,192,a,96,a,200
s_waitcnt vmcnt(31) lgkmcnt(0)
s_barrier
M v,196,a,96,a,204
T 64,88,32768
T 66,88,34816
M v,200,a,100,a,200
T 68,89,32768
T 70,89,34816
M v,204,a,100,a,204
T 72,90,32768
T 74,90,34816
M v,208,a,104,a,200
T 76,91,32768
T 78,91,34816
M v,212,a,104,a,204
T 80,92,32768
T 82,92,34816
M v,216,a,108,a,200
T 84,93,32768
T 86,93,34816
M v,220,a,108,a,204
v_xor_b32 v21, 2, v20
v_lshlrev_b32 v21, 5, v21
M v,224,a,112,a,200
v_add_u32 v118, v18, v21
M v,228,a,112,a,204
M v,232,a,116,a,200
M v,236,a,116,a,204
v_add_u32 v122, 0x10000, v118
M v,240,a,120,a,200
M v,244,a,120,a,204
M v,248,a,124,a,200
M v,252,a,124,a,204
s_waitcnt lgkmcnt(0)
M v,128,a,64,a,208
T 88,94,32768
T 90,94,34816
M v,132,a,64,a,212
T 92,95,32768
T 94,95,34816
M v,136,a,68,a,208
s_add_u32 m0, s32, 0
v_xor_b32 v21, 3, v20
M v,140,a,68,a,212
T 96,88,33024
T 98,88,35072
M v,144,a,72,a,208
T 100,89,33024
T 102,89,35072
M v,148,a,72,a,212
s_mov_b32 s35, 458752
L 108,72,s35,0
M v,152,a,76,a,208
T 104,90,33024
T 106,90,35072
M v,156,a,76,a,212
T 108,91,33024
T 110,91,35072
M v,160,a,80,a,208
L 109,72,s35,1024
v_lshlrev_b32 v21, 5, v21
M v,164,a,80,a,212
T 112,92,33024
T 114,92,35072
M v,168,a,84,a,208
L 110,72,s35,2048
v_add_u32 v119, v18, v21
M v,172,a,84,a,212
T 116,93,33024
T 118,93,35072
s_waitcnt lgkmcnt(6)
M v,176,a,88,a,208
T 120,94,33024
T 122,94,35072
M v,180,a,88,a,212
L 111,72,s35,3072
s_add_u32 m0, s32, 16384
M v,184,a,92,a,208
T 124,95,33024
T 126,95,35072
M v,188,a,92,a,212
T 64,88,49152
T 66,88,51200
M v,192,a,96,a,208
s_mov_b32 s35, 688128
v_add_u32 v123, 0x10000, v119
M v,196,a,96,a,212
T 68,89,49152
T 70,89,51200
M v,200,a,100,a,208
T 72,90,49152
T 74,90,51200
M v,204,a,100,a,212
L 108,72,s35,0
L 109,72,s35,1024
M v,208,a,104,a,208
T 76,91,49152
T 78,91,51200
M v,212,a,104,a,212
L 110,72,s35,2048
v_and_b32 v17, 1, v1
s_waitcnt lgkmcnt(6)
M v,216,a,108,a,208
T 80,92,49152
T 82,92,51200
M v,220,a,108,a,212
T 84,93,49152
T 86,93,51200
M v,224,a,112,a,208
L 111,72,s35,3072
v_lshrrev_b32 v16, 3, v1
M v,228,a,112,a,212
T 88,94,49152
T 90,94,51200
M v,232,a,116,a,208
T 92,95,49152
T 94,95,51200
M v,236,a,116,a,212
buffer_store_dwordx4 a[44:47], v7, s[12:15], s40 offen sc1
s_add_u32 s40, s40, s42
M v,240,a,120,a,208
T 96,88,49408
T 98,88,51456
M v,244,a,120,a,212
T 100,89,49408
T 102,89,51456
M v,248,a,124,a,208
buffer_store_dwordx4 a[48:51], v7, s[12:15], s40 offen sc1
v_and_b32 v18, 7, v1
M v,252,a,124,a,212
T 104,90,49408
T 106,90,51456
M v,128,a,64,a,216
s_add_u32 s40, s40, s41
v_lshrrev_b32 v18, 1, v18
M v,132,a,64,a,220
T 108,91,49408
T 110,91,51456
s_waitcnt lgkmcnt(6)
M v,136,a,68,a,216
T 112,92,49408
T 114,92,51456
M v,140,a,68,a,220
buffer_store_dwordx4 a[52:55], v7, s[12:15], s40 offen sc1
s_add_u32 s40, s40, s42
M v,144,a,72,a,216
T 116,93,49408
T 118,93,51456
M v,148,a,72,a,220
T 120,94,49408
T 122,94,51456
M v,152,a,76,a,216
buffer_store_dwordx4 a[56:59], v7, s[12:15], s40 offen sc1
v_lshrrev_b32 v19, 4, v1
M v,156,a,76,a,220
T 124,95,49408
T 126,95,51456
M v,160,a,80,a,216
s_add_u32 s40, s40, s41
v_xor_b32 v18, v18, v19
M v,164,a,80,a,220
buffer_store_dwordx4 a[60:63], v7, s[12:15], s40 offen sc1
v_lshlrev_b32 v18, 1, v18
M v,168,a,84,a,216
v_or_b32 v18, v18, v17
v_lshlrev_b32 v18, 4, v18
M v,172,a,84,a,220
s_add_u32 s40, s40, s43
s_lshl_b32 s52, s24, 5
M v,176,a,88,a,216
v_add_u32 v16, s52, v16
v_mul_u32_u24 v16, 896, v16
M v,180,a,88,a,220
M v,184,a,92,a,216
M v,188,a,92,a,220
v_add_u32 v16, v16, v18
M v,192,a,96,a,216
s_waitcnt vmcnt(31) lgkmcnt(0)
s_barrier
M v,196,a,96,a,220
T 64,96,0
T 66,96,2048
M v,200,a,100,a,216
T 68,97,0
T 70,97,2048
M v,204,a,100,a,220
T 72,98,0
T 74,98,2048
M v,208,a,104,a,216
T 76,99,0
T 78,99,2048
M v,212,a,104,a,220
T 80,100,0
T 82,100,2048
M v,216,a,108,a,216
T 84,101,0
T 86,101,2048
M v,220,a,108,a,220
v_add_u32 v112, 0, v16
v_add_u32 v113, 6144, v16
M v,224,a,112,a,216
v_add_u32 v114, 12288, v16
M v,228,a,112,a,220
M v,232,a,116,a,216
M v,236,a,116,a,220
v_add_u32 v115, 18432, v16
M v,240,a,120,a,216
M v,244,a,120,a,220
M v,248,a,124,a,216
M v,252,a,124,a,220
s_waitcnt lgkmcnt(0)
M v,128,a,64,a,224
T 88,102,0
T 90,102,2048
M v,132,a,64,a,228
T 92,103,0
T 94,103,2048
M v,136,a,68,a,224
s_add_u32 m0, s32, 32768
M v,140,a,68,a,228
T 96,96,256
T 98,96,2304
M v,144,a,72,a,224
T 100,97,256
T 102,97,2304
M v,148,a,72,a,228
s_mov_b32 s35, 917504
M v,152,a,76,a,224
T 104,98,256
T 106,98,2304
M v,156,a,76,a,228
T 108,99,256
T 110,99,2304
M v,160,a,80,a,224
L 108,72,s35,0
M v,164,a,80,a,228
T 112,100,256
T 114,100,2304
M v,168,a,84,a,224
M v,172,a,84,a,228
T 116,101,256
T 118,101,2304
s_waitcnt lgkmcnt(6)
M v,176,a,88,a,224
T 120,102,256
T 122,102,2304
M v,180,a,88,a,228
L 109,72,s35,1024
M v,184,a,92,a,224
T 124,103,256
T 126,103,2304
M v,188,a,92,a,228
T 64,96,16384
T 66,96,18432
M v,192,a,96,a,224
L 110,72,s35,2048
M v,196,a,96,a,228
T 68,97,16384
T 70,97,18432
M v,200,a,100,a,224
T 72,98,16384
T 74,98,18432
M v,204,a,100,a,228
L 111,72,s35,3072
M v,208,a,104,a,224
T 76,99,16384
T 78,99,18432
M v,212,a,104,a,228
s_waitcnt lgkmcnt(6)
M v,216,a,108,a,224
T 80,100,16384
T 82,100,18432
M v,220,a,108,a,228
T 84,101,16384
T 86,101,18432
M v,224,a,112,a,224
s_add_u32 m0, s32, 49152
M v,228,a,112,a,228
T 88,102,16384
T 90,102,18432
M v,232,a,116,a,224
T 92,103,16384
T 94,103,18432
M v,236,a,116,a,228
s_mov_b32 s35, 1146880
M v,240,a,120,a,224
T 96,96,16640
T 98,96,18688
M v,244,a,120,a,228
T 100,97,16640
T 102,97,18688
M v,248,a,124,a,224
M v,252,a,124,a,228
T 104,98,16640
T 106,98,18688
M v,128,a,64,a,232
L 108,72,s35,0
M v,132,a,64,a,236
T 108,99,16640
T 110,99,18688
s_waitcnt lgkmcnt(6)
M v,136,a,68,a,232
T 112,100,16640
T 114,100,18688
M v,140,a,68,a,236
L 109,72,s35,1024
M v,144,a,72,a,232
T 116,101,16640
T 118,101,18688
M v,148,a,72,a,236
T 120,102,16640
T 122,102,18688
M v,152,a,76,a,232
L 110,72,s35,2048
M v,156,a,76,a,236
T 124,103,16640
T 126,103,18688
M v,160,a,80,a,232
M v,164,a,80,a,236
M v,168,a,84,a,232
L 111,72,s35,3072
M v,172,a,84,a,236
M v,176,a,88,a,232
M v,180,a,88,a,236
M v,184,a,92,a,232
M v,188,a,92,a,236
M v,192,a,96,a,232
s_waitcnt vmcnt(8) lgkmcnt(0)
s_barrier
s_cmp_eq_u32 s89, 0
s_cbranch_scc1 PS_kv
s_mov_b64 exec, 1
v_mov_b32 v127, s66
buffer_store_dword v127, off, s[12:15], s89 sc1
s_mov_b64 exec, -1
s_mov_b32 s89, 0
PS_kv:
M v,196,a,96,a,236
T 64,96,32768
T 66,96,34816
M v,200,a,100,a,232
T 68,97,32768
T 70,97,34816
M v,204,a,100,a,236
T 72,98,32768
T 74,98,34816
M v,208,a,104,a,232
T 76,99,32768
T 78,99,34816
M v,212,a,104,a,236
T 80,100,32768
T 82,100,34816
M v,216,a,108,a,232
T 84,101,32768
T 86,101,34816
M v,220,a,108,a,236
M v,224,a,112,a,232
M v,228,a,112,a,236
M v,232,a,116,a,232
M v,236,a,116,a,236
M v,240,a,120,a,232
M v,244,a,120,a,236
M v,248,a,124,a,232
M v,252,a,124,a,236
s_waitcnt lgkmcnt(0)
Z v,16,a,64,a,128
T 88,102,32768
T 90,102,34816
Z v,20,a,64,a,132
R 92,124,0
s_add_u32 m0, s32, 81920
Z v,24,a,68,a,128
Z v,28,a,68,a,132
T 96,96,33024
T 98,96,35072
Z v,32,a,72,a,128
T 100,97,33024
T 102,97,35072
Z v,36,a,72,a,132
v_mul_f32 v128, s64, v128
v_mul_f32 v129, s64, v129
Z v,40,a,76,a,128
T 104,98,33024
T 106,98,35072
Z v,44,a,76,a,132
T 108,99,33024
T 110,99,35072
Z v,48,a,80,a,128
s_mov_b32 s35, 1376256
v_mul_f32 v130, s64, v130
Z v,52,a,80,a,132
T 112,100,33024
T 114,100,35072
Z v,56,a,84,a,128
v_mul_f32 v131, s64, v131
v_mul_f32 v136, s64, v136
Z v,60,a,84,a,132
T 116,101,33024
T 118,101,35072
s_waitcnt lgkmcnt(6)
Z v,64,a,88,a,128
T 120,102,33024
T 122,102,35072
Z v,68,a,88,a,132
v_mul_f32 v137, s64, v137
v_mul_f32 v138, s64, v138
Z v,72,a,92,a,128
R 124,124,64
v_mul_f32 v139, s64, v139
Z v,76,a,92,a,132
T 64,96,49152
T 66,96,51200
M v,16,a,96,a,136
L 108,72,s35,0
v_cvt_pk_bf16_f32 v128, v128, v129
M v,20,a,96,a,140
T 68,97,49152
T 70,97,51200
M v,24,a,100,a,136
T 72,98,49152
T 74,98,51200
M v,28,a,100,a,140
v_cvt_pk_bf16_f32 v129, v130, v131
v_cvt_pk_bf16_f32 v130, v136, v137
M v,32,a,104,a,136
T 76,99,49152
T 78,99,51200
M v,36,a,104,a,140
v_cvt_pk_bf16_f32 v131, v138, v139
v_accvgpr_write_b32 a0, v128
s_waitcnt lgkmcnt(6)
M v,40,a,108,a,136
T 80,100,49152
T 82,100,51200
M v,44,a,108,a,140
T 84,101,49152
T 86,101,51200
M v,48,a,112,a,136
L 109,72,s35,1024
v_accvgpr_write_b32 a1, v129
M v,52,a,112,a,140
T 88,102,49152
T 90,102,51200
M v,56,a,116,a,136
R 92,124,128
v_accvgpr_write_b32 a2, v130
M v,60,a,116,a,140
v_accvgpr_write_b32 a3, v131
v_mul_f32 v132, s64, v132
M v,64,a,120,a,136
T 96,96,49408
T 98,96,51456
M v,68,a,120,a,140
T 100,97,49408
T 102,97,51456
M v,72,a,124,a,136
v_mul_f32 v133, s64, v133
v_mul_f32 v134, s64, v134
M v,76,a,124,a,140
T 104,98,49408
T 106,98,51456
M v,16,a,64,a,144
L 110,72,s35,2048
v_mul_f32 v135, s64, v135
M v,20,a,64,a,148
T 108,99,49408
T 110,99,51456
s_waitcnt lgkmcnt(6)
M v,24,a,68,a,144
T 112,100,49408
T 114,100,51456
M v,28,a,68,a,148
v_mul_f32 v140, s64, v140
v_mul_f32 v141, s64, v141
M v,32,a,72,a,144
T 116,101,49408
T 118,101,51456
M v,36,a,72,a,148
T 120,102,49408
T 122,102,51456
M v,40,a,76,a,144
L 111,72,s35,3072
v_mul_f32 v142, s64, v142
M v,44,a,76,a,148
R 124,124,192
v_mul_f32 v143, s64, v143
M v,48,a,80,a,144
v_cvt_pk_bf16_f32 v132, v132, v133
v_cvt_pk_bf16_f32 v133, v134, v135
M v,52,a,80,a,148
v_cvt_pk_bf16_f32 v134, v140, v141
v_cvt_pk_bf16_f32 v135, v142, v143
M v,56,a,84,a,144
v_accvgpr_write_b32 a4, v132
v_accvgpr_write_b32 a5, v133
M v,60,a,84,a,148
v_accvgpr_write_b32 a6, v134
v_accvgpr_write_b32 a7, v135
M v,64,a,88,a,144
v_mul_f32 v144, s64, v144
v_mul_f32 v145, s64, v145
M v,68,a,88,a,148
v_mul_f32 v146, s64, v146
v_mul_f32 v147, s64, v147
M v,72,a,92,a,144
v_mul_f32 v152, s64, v152
v_mul_f32 v153, s64, v153
M v,76,a,92,a,148
v_mul_f32 v154, s64, v154
v_mul_f32 v155, s64, v155
M v,16,a,96,a,152
s_waitcnt vmcnt(17) lgkmcnt(0)
s_barrier
M v,20,a,96,a,156
T 64,88,0
T 66,88,2048
M v,24,a,100,a,152
T 68,89,0
T 70,89,2048
M v,28,a,100,a,156
T 72,90,0
T 74,90,2048
M v,32,a,104,a,152
T 76,91,0
T 78,91,2048
M v,36,a,104,a,156
T 80,92,0
T 82,92,2048
M v,40,a,108,a,152
T 84,93,0
T 86,93,2048
M v,44,a,108,a,156
v_cvt_pk_bf16_f32 v144, v144, v145
v_cvt_pk_bf16_f32 v145, v146, v147
M v,48,a,112,a,152
v_cvt_pk_bf16_f32 v146, v152, v153
v_cvt_pk_bf16_f32 v147, v154, v155
M v,52,a,112,a,156
v_accvgpr_write_b32 a8, v144
v_accvgpr_write_b32 a9, v145
M v,56,a,116,a,152
v_accvgpr_write_b32 a10, v146
v_accvgpr_write_b32 a11, v147
M v,60,a,116,a,156
v_mul_f32 v148, s64, v148
v_mul_f32 v149, s64, v149
M v,64,a,120,a,152
v_mul_f32 v150, s64, v150
v_mul_f32 v151, s64, v151
M v,68,a,120,a,156
v_mul_f32 v156, s64, v156
v_mul_f32 v157, s64, v157
M v,72,a,124,a,152
v_mul_f32 v158, s64, v158
v_mul_f32 v159, s64, v159
M v,76,a,124,a,156
v_cvt_pk_bf16_f32 v148, v148, v149
v_cvt_pk_bf16_f32 v149, v150, v151
v_cvt_pk_bf16_f32 v150, v156, v157
v_cvt_pk_bf16_f32 v151, v158, v159
v_accvgpr_write_b32 a12, v148
v_accvgpr_write_b32 a13, v149
v_accvgpr_write_b32 a14, v150
v_accvgpr_write_b32 a15, v151
v_mul_f32 v160, s64, v160
v_mul_f32 v161, s64, v161
v_mul_f32 v162, s64, v162
v_mul_f32 v163, s64, v163
v_mul_f32 v168, s64, v168
v_mul_f32 v169, s64, v169
v_mul_f32 v170, s64, v170
v_mul_f32 v171, s64, v171
v_cvt_pk_bf16_f32 v160, v160, v161
v_cvt_pk_bf16_f32 v161, v162, v163
v_cvt_pk_bf16_f32 v162, v168, v169
v_cvt_pk_bf16_f32 v163, v170, v171
v_accvgpr_write_b32 a16, v160
v_accvgpr_write_b32 a17, v161
v_accvgpr_write_b32 a18, v162
v_accvgpr_write_b32 a19, v163
v_mul_f32 v164, s64, v164
v_mul_f32 v165, s64, v165
v_mul_f32 v166, s64, v166
v_mul_f32 v167, s64, v167
v_mul_f32 v172, s64, v172
v_mul_f32 v173, s64, v173
v_mul_f32 v174, s64, v174
v_mul_f32 v175, s64, v175
v_cvt_pk_bf16_f32 v164, v164, v165
v_cvt_pk_bf16_f32 v165, v166, v167
v_cvt_pk_bf16_f32 v166, v172, v173
v_cvt_pk_bf16_f32 v167, v174, v175
v_accvgpr_write_b32 a20, v164
v_accvgpr_write_b32 a21, v165
v_accvgpr_write_b32 a22, v166
v_accvgpr_write_b32 a23, v167
s_lshl_b32 s57, s25, 4
s_add_u32 s57, s57, s26
s_lshl_b32 s57, s57, 16
s_lshl_b32 s56, s24, 14
s_add_u32 s57, s57, s56
s_add_u32 s57, s57, 83886080
s_waitcnt lgkmcnt(0)
M v,16,a,64,a,160
T 88,94,0
T 90,94,2048
M v,20,a,64,a,164
R 92,124,256
buffer_load_dword v2, v125, s[12:15], s91 offen sc1
M v,24,a,68,a,160
v_mul_f32 v176, s64, v176
v_mul_f32 v177, s64, v177
M v,28,a,68,a,164
T 96,88,256
T 98,88,2304
M v,32,a,72,a,160
T 100,89,256
T 102,89,2304
M v,36,a,72,a,164
v_mul_f32 v178, s64, v178
v_mul_f32 v179, s64, v179
M v,40,a,76,a,160
T 104,90,256
T 106,90,2304
M v,44,a,76,a,164
T 108,91,256
T 110,91,2304
M v,48,a,80,a,160
s_add_u32 s58, s57, 0
v_mul_f32 v184, s64, v184
M v,52,a,80,a,164
T 112,92,256
T 114,92,2304
M v,56,a,84,a,160
v_mul_f32 v185, s64, v185
v_mul_f32 v186, s64, v186
M v,60,a,84,a,164
T 116,93,256
T 118,93,2304
s_waitcnt lgkmcnt(6)
M v,64,a,88,a,160
T 120,94,256
T 122,94,2304
M v,68,a,88,a,164
buffer_store_dwordx4 a[0:3], v126, s[12:15], s58 offen offset:0 sc1
v_mul_f32 v187, s64, v187
M v,72,a,92,a,160
R 124,124,320
v_cvt_pk_bf16_f32 v176, v176, v177
M v,76,a,92,a,164
T 64,88,16384
T 66,88,18432
M v,16,a,96,a,168
buffer_store_dwordx4 a[4:7], v126, s[12:15], s58 offen offset:1024 sc1
v_cvt_pk_bf16_f32 v177, v178, v179
M v,20,a,96,a,172
T 68,89,16384
T 70,89,18432
M v,24,a,100,a,168
T 72,90,16384
T 74,90,18432
M v,28,a,100,a,172
v_cvt_pk_bf16_f32 v178, v184, v185
v_cvt_pk_bf16_f32 v179, v186, v187
M v,32,a,104,a,168
T 76,91,16384
T 78,91,18432
M v,36,a,104,a,172
buffer_store_dwordx4 a[8:11], v126, s[12:15], s58 offen offset:2048 sc1
v_accvgpr_write_b32 a24, v176
s_waitcnt lgkmcnt(6)
M v,40,a,108,a,168
T 80,92,16384
T 82,92,18432
M v,44,a,108,a,172
T 84,93,16384
T 86,93,18432
M v,48,a,112,a,168
v_accvgpr_write_b32 a25, v177
v_accvgpr_write_b32 a26, v178
M v,52,a,112,a,172
T 88,94,16384
T 90,94,18432
M v,56,a,116,a,168
R 92,124,384
buffer_store_dwordx4 a[12:15], v126, s[12:15], s58 offen offset:3072 sc1
M v,60,a,116,a,172
v_accvgpr_write_b32 a27, v179
v_mul_f32 v180, s64, v180
M v,64,a,120,a,168
T 96,88,16640
T 98,88,18688
M v,68,a,120,a,172
T 100,89,16640
T 102,89,18688
M v,72,a,124,a,168
v_mul_f32 v181, s64, v181
v_mul_f32 v182, s64, v182
M v,76,a,124,a,172
T 104,90,16640
T 106,90,18688
M v,16,a,64,a,176
s_add_u32 s58, s57, 4096
v_mul_f32 v183, s64, v183
M v,20,a,64,a,180
T 108,91,16640
T 110,91,18688
s_waitcnt lgkmcnt(6)
M v,24,a,68,a,176
T 112,92,16640
T 114,92,18688
M v,28,a,68,a,180
v_mul_f32 v188, s64, v188
v_mul_f32 v189, s64, v189
M v,32,a,72,a,176
T 116,93,16640
T 118,93,18688
M v,36,a,72,a,180
T 120,94,16640
T 122,94,18688
M v,40,a,76,a,176
buffer_store_dwordx4 a[16:19], v126, s[12:15], s58 offen offset:0 sc1
v_mul_f32 v190, s64, v190
M v,44,a,76,a,180
R 124,124,448
v_mul_f32 v191, s64, v191
M v,48,a,80,a,176
v_cvt_pk_bf16_f32 v180, v180, v181
v_cvt_pk_bf16_f32 v181, v182, v183
M v,52,a,80,a,180
buffer_store_dwordx4 a[20:23], v126, s[12:15], s58 offen offset:1024 sc1
v_cvt_pk_bf16_f32 v182, v188, v189
M v,56,a,84,a,176
v_cvt_pk_bf16_f32 v183, v190, v191
v_accvgpr_write_b32 a28, v180
M v,60,a,84,a,180
v_accvgpr_write_b32 a29, v181
v_accvgpr_write_b32 a30, v182
M v,64,a,88,a,176
v_accvgpr_write_b32 a31, v183
v_mul_f32 v192, s64, v192
M v,68,a,88,a,180
v_mul_f32 v193, s64, v193
v_mul_f32 v194, s64, v194
M v,72,a,92,a,176
v_mul_f32 v195, s64, v195
v_mul_f32 v200, s64, v200
M v,76,a,92,a,180
v_mul_f32 v201, s64, v201
v_mul_f32 v202, s64, v202
M v,16,a,96,a,184
s_waitcnt vmcnt(6) lgkmcnt(0)
s_barrier
M v,20,a,96,a,188
T 64,88,32768
T 66,88,34816
M v,24,a,100,a,184
T 68,89,32768
T 70,89,34816
M v,28,a,100,a,188
T 72,90,32768
T 74,90,34816
M v,32,a,104,a,184
T 76,91,32768
T 78,91,34816
M v,36,a,104,a,188
T 80,92,32768
T 82,92,34816
M v,40,a,108,a,184
T 84,93,32768
T 86,93,34816
M v,44,a,108,a,188
v_mul_f32 v203, s64, v203
v_cvt_pk_bf16_f32 v192, v192, v193
M v,48,a,112,a,184
v_cvt_pk_bf16_f32 v193, v194, v195
v_cvt_pk_bf16_f32 v194, v200, v201
M v,52,a,112,a,188
v_cvt_pk_bf16_f32 v195, v202, v203
v_accvgpr_write_b32 a32, v192
M v,56,a,116,a,184
v_accvgpr_write_b32 a33, v193
v_accvgpr_write_b32 a34, v194
M v,60,a,116,a,188
v_accvgpr_write_b32 a35, v195
v_mul_f32 v196, s64, v196
M v,64,a,120,a,184
v_mul_f32 v197, s64, v197
v_mul_f32 v198, s64, v198
M v,68,a,120,a,188
v_mul_f32 v199, s64, v199
v_mul_f32 v204, s64, v204
M v,72,a,124,a,184
v_mul_f32 v205, s64, v205
v_mul_f32 v206, s64, v206
M v,76,a,124,a,188
v_mul_f32 v207, s64, v207
v_cvt_pk_bf16_f32 v196, v196, v197
v_cvt_pk_bf16_f32 v197, v198, v199
v_cvt_pk_bf16_f32 v198, v204, v205
v_cvt_pk_bf16_f32 v199, v206, v207
v_accvgpr_write_b32 a36, v196
v_accvgpr_write_b32 a37, v197
v_accvgpr_write_b32 a38, v198
v_accvgpr_write_b32 a39, v199
v_mul_f32 v208, s64, v208
v_mul_f32 v209, s64, v209
v_mul_f32 v210, s64, v210
v_mul_f32 v211, s64, v211
v_mul_f32 v216, s64, v216
v_mul_f32 v217, s64, v217
v_mul_f32 v218, s64, v218
v_mul_f32 v219, s64, v219
v_cvt_pk_bf16_f32 v208, v208, v209
v_cvt_pk_bf16_f32 v209, v210, v211
v_cvt_pk_bf16_f32 v210, v216, v217
v_cvt_pk_bf16_f32 v211, v218, v219
v_accvgpr_write_b32 a40, v208
v_accvgpr_write_b32 a41, v209
v_accvgpr_write_b32 a42, v210
v_accvgpr_write_b32 a43, v211
v_cmp_ne_u32 vcc, s66, v2
s_nop 1
s_cbranch_vccnz SP_kv
SPB_kv:
s_waitcnt lgkmcnt(0)
M v,16,a,64,a,192
T 88,94,32768
T 90,94,34816
M v,20,a,64,a,196
R 92,124,512
s_add_u32 m0, s32, 65536
M v,24,a,68,a,192
v_mul_f32 v212, s64, v212
v_mul_f32 v213, s64, v213
M v,28,a,68,a,196
T 96,88,33024
T 98,88,35072
M v,32,a,72,a,192
T 100,89,33024
T 102,89,35072
M v,36,a,72,a,196
C 5,12,s33,0
C 5,12,s33,1024
M v,40,a,76,a,192
T 104,90,33024
T 106,90,35072
M v,44,a,76,a,196
T 108,91,33024
T 110,91,35072
M v,48,a,80,a,192
C 5,12,s33,2048
v_mul_f32 v214, s64, v214
M v,52,a,80,a,196
T 112,92,33024
T 114,92,35072
M v,56,a,84,a,192
C 5,12,s33,3072
v_mul_f32 v215, s64, v215
M v,60,a,84,a,196
T 116,93,33024
T 118,93,35072
s_waitcnt lgkmcnt(6)
M v,64,a,88,a,192
T 120,94,33024
T 122,94,35072
M v,68,a,88,a,196
s_add_u32 s33, s33, 0x8000
v_mul_f32 v220, s64, v220
M v,72,a,92,a,192
R 124,124,576
v_mul_f32 v221, s64, v221
M v,76,a,92,a,196
T 64,88,49152
T 66,88,51200
M v,16,a,96,a,200
s_add_u32 m0, s32, 98304
v_mul_f32 v222, s64, v222
M v,20,a,96,a,204
T 68,89,49152
T 70,89,51200
M v,24,a,100,a,200
T 72,90,49152
T 74,90,51200
M v,28,a,100,a,204
C 5,12,s33,0
C 5,12,s33,1024
M v,32,a,104,a,200
T 76,91,49152
T 78,91,51200
M v,36,a,104,a,204
v_mul_f32 v223, s64, v223
v_cvt_pk_bf16_f32 v212, v212, v213
s_waitcnt lgkmcnt(6)
M v,40,a,108,a,200
T 80,92,49152
T 82,92,51200
M v,44,a,108,a,204
T 84,93,49152
T 86,93,51200
M v,48,a,112,a,200
C 5,12,s33,2048
C 5,12,s33,3072
M v,52,a,112,a,204
T 88,94,49152
T 90,94,51200
M v,56,a,116,a,200
R 92,124,640
v_cvt_pk_bf16_f32 v213, v214, v215
M v,60,a,116,a,204
s_add_u32 s33, s33, 0x8000
v_cvt_pk_bf16_f32 v214, v220, v221
M v,64,a,120,a,200
T 96,88,49408
T 98,88,51456
M v,68,a,120,a,204
T 100,89,49408
T 102,89,51456
M v,72,a,124,a,200
s_add_u32 s58, s57, 4096
v_cvt_pk_bf16_f32 v215, v222, v223
M v,76,a,124,a,204
T 104,90,49408
T 106,90,51456
M v,16,a,64,a,208
buffer_store_dwordx4 a[24:27], v126, s[12:15], s58 offen offset:2048 sc1
v_accvgpr_write_b32 a44, v212
M v,20,a,64,a,212
T 108,91,49408
T 110,91,51456
s_waitcnt lgkmcnt(6)
M v,24,a,68,a,208
T 112,92,49408
T 114,92,51456
M v,28,a,68,a,212
buffer_store_dwordx4 a[28:31], v126, s[12:15], s58 offen offset:3072 sc1
v_accvgpr_write_b32 a45, v213
M v,32,a,72,a,208
T 116,93,49408
T 118,93,51456
M v,36,a,72,a,212
T 120,94,49408
T 122,94,51456
M v,40,a,76,a,208
s_add_u32 s58, s57, 8192
buffer_store_dwordx4 a[32:35], v126, s[12:15], s58 offen offset:0 sc1
M v,44,a,76,a,212
R 124,124,704
v_accvgpr_write_b32 a46, v214
M v,48,a,80,a,208
v_accvgpr_write_b32 a47, v215
v_mul_f32 v224, s64, v224
M v,52,a,80,a,212
buffer_store_dwordx4 a[36:39], v126, s[12:15], s58 offen offset:1024 sc1
v_mul_f32 v225, s64, v225
M v,56,a,84,a,208
v_mul_f32 v226, s64, v226
v_mul_f32 v227, s64, v227
M v,60,a,84,a,212
buffer_store_dwordx4 a[40:43], v126, s[12:15], s58 offen offset:2048 sc1
v_mul_f32 v232, s64, v232
M v,64,a,88,a,208
v_mul_f32 v233, s64, v233
v_mul_f32 v234, s64, v234
M v,68,a,88,a,212
v_mul_f32 v235, s64, v235
v_cvt_pk_bf16_f32 v224, v224, v225
M v,72,a,92,a,208
v_cvt_pk_bf16_f32 v225, v226, v227
v_cvt_pk_bf16_f32 v226, v232, v233
M v,76,a,92,a,212
v_cvt_pk_bf16_f32 v227, v234, v235
v_accvgpr_write_b32 a48, v224
M v,16,a,96,a,216
s_waitcnt vmcnt(20) lgkmcnt(0)
s_barrier
M v,20,a,96,a,220
T 64,96,16384
T 66,96,18432
M v,24,a,100,a,216
T 68,97,16384
T 70,97,18432
M v,28,a,100,a,220
T 72,98,16384
T 74,98,18432
M v,32,a,104,a,216
T 76,99,16384
T 78,99,18432
M v,36,a,104,a,220
T 80,100,16384
T 82,100,18432
M v,40,a,108,a,216
T 84,101,16384
T 86,101,18432
M v,44,a,108,a,220
v_accvgpr_write_b32 a49, v225
v_accvgpr_write_b32 a50, v226
M v,48,a,112,a,216
v_accvgpr_write_b32 a51, v227
v_mul_f32 v228, s64, v228
M v,52,a,112,a,220
v_mul_f32 v229, s64, v229
v_mul_f32 v230, s64, v230
M v,56,a,116,a,216
v_mul_f32 v231, s64, v231
v_mul_f32 v236, s64, v236
M v,60,a,116,a,220
v_mul_f32 v237, s64, v237
v_mul_f32 v238, s64, v238
M v,64,a,120,a,216
v_mul_f32 v239, s64, v239
v_cvt_pk_bf16_f32 v228, v228, v229
M v,68,a,120,a,220
v_cvt_pk_bf16_f32 v229, v230, v231
v_cvt_pk_bf16_f32 v230, v236, v237
M v,72,a,124,a,216
v_cvt_pk_bf16_f32 v231, v238, v239
v_accvgpr_write_b32 a52, v228
M v,76,a,124,a,220
v_accvgpr_write_b32 a53, v229
v_accvgpr_write_b32 a54, v230
v_accvgpr_write_b32 a55, v231
v_mul_f32 v240, s64, v240
v_mul_f32 v241, s64, v241
v_mul_f32 v242, s64, v242
v_mul_f32 v243, s64, v243
v_mul_f32 v248, s64, v248
v_mul_f32 v249, s64, v249
v_mul_f32 v250, s64, v250
v_mul_f32 v251, s64, v251
v_cvt_pk_bf16_f32 v240, v240, v241
v_cvt_pk_bf16_f32 v241, v242, v243
v_cvt_pk_bf16_f32 v242, v248, v249
v_cvt_pk_bf16_f32 v243, v250, v251
v_accvgpr_write_b32 a56, v240
v_accvgpr_write_b32 a57, v241
v_accvgpr_write_b32 a58, v242
v_accvgpr_write_b32 a59, v243
v_mul_f32 v244, s64, v244
v_mul_f32 v245, s64, v245
v_mul_f32 v246, s64, v246
v_mul_f32 v247, s64, v247
v_mul_f32 v252, s64, v252
v_mul_f32 v253, s64, v253
v_mul_f32 v254, s64, v254
v_mul_f32 v255, s64, v255
v_cvt_pk_bf16_f32 v244, v244, v245
v_cvt_pk_bf16_f32 v245, v246, v247
v_cvt_pk_bf16_f32 v246, v252, v253
v_cvt_pk_bf16_f32 v247, v254, v255
v_accvgpr_write_b32 a60, v244
v_accvgpr_write_b32 a61, v245
v_accvgpr_write_b32 a62, v246
v_accvgpr_write_b32 a63, v247
s_waitcnt lgkmcnt(0)
M v,16,a,64,a,224
T 88,102,16384
T 90,102,18432
M v,20,a,64,a,228
R 92,124,768
s_add_u32 s58, s57, 8192
M v,24,a,68,a,224
T 96,96,16640
T 98,96,18688
M v,28,a,68,a,228
buffer_store_dwordx4 a[44:47], v126, s[12:15], s58 offen offset:3072 sc1
s_add_u32 s58, s57, 12288
M v,32,a,72,a,224
T 100,97,16640
T 102,97,18688
M v,36,a,72,a,228
T 104,98,16640
T 106,98,18688
M v,40,a,76,a,224
buffer_store_dwordx4 a[48:51], v126, s[12:15], s58 offen offset:0 sc1
buffer_store_dwordx4 a[52:55], v126, s[12:15], s58 offen offset:1024 sc1
M v,44,a,76,a,228
T 108,99,16640
T 110,99,18688
M v,48,a,80,a,224
T 112,100,16640
T 114,100,18688
M v,52,a,80,a,228
T 116,101,16640
T 118,101,18688
M v,56,a,84,a,224
buffer_store_dwordx4 a[56:59], v126, s[12:15], s58 offen offset:2048 sc1
buffer_store_dwordx4 a[60:63], v126, s[12:15], s58 offen offset:3072 sc1
M v,60,a,84,a,228
T 120,102,16640
T 122,102,18688
s_waitcnt lgkmcnt(8)
M v,64,a,88,a,224
R 124,124,832
s_add_u32 m0, s32, 0
M v,68,a,88,a,228
C 5,12,s33,0
C 5,12,s33,1024
M v,72,a,92,a,224
C 5,12,s33,2048
C 5,12,s33,3072
M v,76,a,92,a,228
s_add_u32 m0, s32, 16384
s_nop 0
C 6,12,s33,0
M v,16,a,96,a,232
C 6,12,s33,1024
C 6,12,s33,2048
M v,20,a,96,a,236
C 6,12,s33,3072
M v,24,a,100,a,232
s_add_u32 s33, s33, 0x8000
M v,28,a,100,a,236
M v,32,a,104,a,232
M v,36,a,104,a,236
s_waitcnt vmcnt(22) lgkmcnt(0)
s_barrier
M v,40,a,108,a,232
R 64,4,0
R 68,4,1024
M v,44,a,108,a,236
R 72,4,2048
R 76,4,3072
M v,48,a,112,a,232
R 80,4,4096
R 84,4,5120
M v,52,a,112,a,236
R 88,4,6144
R 92,4,7168
M v,56,a,116,a,232
M v,60,a,116,a,236
M v,64,a,120,a,232
M v,68,a,120,a,236
M v,72,a,124,a,232
M v,76,a,124,a,236
s_nop 7
s_cmp_eq_u32 s88, 1
s_cbranch_scc0 MG_sp1
v_accvgpr_write_b32 a192, v128
v_accvgpr_write_b32 a193, v129
v_accvgpr_write_b32 a194, v130
v_accvgpr_write_b32 a195, v131
v_accvgpr_write_b32 a196, v132
v_accvgpr_write_b32 a197, v133
v_accvgpr_write_b32 a198, v134
v_accvgpr_write_b32 a199, v135
v_accvgpr_write_b32 a200, v144
v_accvgpr_write_b32 a201, v145
v_accvgpr_write_b32 a202, v146
v_accvgpr_write_b32 a203, v147
v_accvgpr_write_b32 a204, v148
v_accvgpr_write_b32 a205, v149
v_accvgpr_write_b32 a206, v150
v_accvgpr_write_b32 a207, v151
v_accvgpr_write_b32 a208, v160
v_accvgpr_write_b32 a209, v161
v_accvgpr_write_b32 a210, v162
v_accvgpr_write_b32 a211, v163
v_accvgpr_write_b32 a212, v164
v_accvgpr_write_b32 a213, v165
v_accvgpr_write_b32 a214, v166
v_accvgpr_write_b32 a215, v167
v_accvgpr_write_b32 a216, v176
v_accvgpr_write_b32 a217, v177
v_accvgpr_write_b32 a218, v178
v_accvgpr_write_b32 a219, v179
v_accvgpr_write_b32 a220, v180
v_accvgpr_write_b32 a221, v181
v_accvgpr_write_b32 a222, v182
v_accvgpr_write_b32 a223, v183
v_accvgpr_write_b32 a224, v192
v_accvgpr_write_b32 a225, v193
v_accvgpr_write_b32 a226, v194
v_accvgpr_write_b32 a227, v195
v_accvgpr_write_b32 a228, v196
v_accvgpr_write_b32 a229, v197
v_accvgpr_write_b32 a230, v198
v_accvgpr_write_b32 a231, v199
v_accvgpr_write_b32 a232, v208
v_accvgpr_write_b32 a233, v209
v_accvgpr_write_b32 a234, v210
v_accvgpr_write_b32 a235, v211
v_accvgpr_write_b32 a236, v212
v_accvgpr_write_b32 a237, v213
v_accvgpr_write_b32 a238, v214
v_accvgpr_write_b32 a239, v215
v_accvgpr_write_b32 a240, v224
v_accvgpr_write_b32 a241, v225
v_accvgpr_write_b32 a242, v226
v_accvgpr_write_b32 a243, v227
v_accvgpr_write_b32 a244, v228
v_accvgpr_write_b32 a245, v229
v_accvgpr_write_b32 a246, v230
v_accvgpr_write_b32 a247, v231
v_accvgpr_write_b32 a248, v240
v_accvgpr_write_b32 a249, v241
v_accvgpr_write_b32 a250, v242
v_accvgpr_write_b32 a251, v243
v_accvgpr_write_b32 a252, v244
v_accvgpr_write_b32 a253, v245
v_accvgpr_write_b32 a254, v246
v_accvgpr_write_b32 a255, v247
s_sub_u32 s35, 15, s26
s_min_u32 s35, s35, s26
s_lshl_b32 s91, s25, 3
s_add_u32 s91, s91, s35
s_lshl_b32 s91, s91, 7
s_add_u32 s91, s91, 35655680
SP_q:
s_mov_b32 s59, 0
SP_q_l:
buffer_load_dword v92, off, s[12:15], s91 sc1
s_waitcnt vmcnt(0)
v_cmp_ne_u32 vcc, s66, v92
s_add_u32 s59, s59, 1
s_cmp_ge_u32 s59, 0x8000
s_cbranch_scc1 SP_q_x
s_nop 1
s_cbranch_vccz SP_q_x
s_sleep 1
s_branch SP_q_l
SP_q_x:
s_sub_u32 s35, 15, s26
s_lshl_b32 s57, s25, 4
s_add_u32 s57, s57, s35
s_lshl_b32 s57, s57, 16
s_lshl_b32 s56, s24, 14
s_add_u32 s57, s57, s56
s_add_u32 s57, s57, 83886080
buffer_load_dwordx4 a[0:3], v7, s[12:15], s57 offen offset:0 sc1
buffer_load_dwordx4 a[4:7], v7, s[12:15], s57 offen offset:1024 sc1
buffer_load_dwordx4 a[8:11], v7, s[12:15], s57 offen offset:2048 sc1
buffer_load_dwordx4 a[12:15], v7, s[12:15], s57 offen offset:3072 sc1
s_add_u32 s57, s57, 4096
buffer_load_dwordx4 a[16:19], v7, s[12:15], s57 offen offset:0 sc1
buffer_load_dwordx4 a[20:23], v7, s[12:15], s57 offen offset:1024 sc1
buffer_load_dwordx4 a[24:27], v7, s[12:15], s57 offen offset:2048 sc1
buffer_load_dwordx4 a[28:31], v7, s[12:15], s57 offen offset:3072 sc1
s_add_u32 s57, s57, 4096
buffer_load_dwordx4 a[32:35], v7, s[12:15], s57 offen offset:0 sc1
buffer_load_dwordx4 a[36:39], v7, s[12:15], s57 offen offset:1024 sc1
buffer_load_dwordx4 a[40:43], v7, s[12:15], s57 offen offset:2048 sc1
buffer_load_dwordx4 a[44:47], v7, s[12:15], s57 offen offset:3072 sc1
s_add_u32 s57, s57, 4096
buffer_load_dwordx4 a[48:51], v7, s[12:15], s57 offen offset:0 sc1
buffer_load_dwordx4 a[52:55], v7, s[12:15], s57 offen offset:1024 sc1
buffer_load_dwordx4 a[56:59], v7, s[12:15], s57 offen offset:2048 sc1
buffer_load_dwordx4 a[60:63], v7, s[12:15], s57 offen offset:3072 sc1
s_waitcnt vmcnt(0)
MG_sp1:
s_sub_u32 s35, 15, s26
s_min_u32 s35, s35, s26
s_lshl_b32 s36, s25, 3
s_add_u32 s36, s36, s35
s_lshl_b32 s36, s36, 7
s_add_u32 s36, s36, 35655680
s_cmp_eq_u32 s88, 2
s_cselect_b32 s36, s36, 0
s_cmp_eq_u32 s24, 0
s_cselect_b32 s89, s36, 0
s_mov_b32 s90, 0
s_waitcnt lgkmcnt(0)
Z v,240,a,64,a,0
R 96,4,8192
Z v,244,a,64,a,4
R 100,4,9216
s_add_u32 m0, s32, 32768
M v,240,a,68,a,8
R 104,4,10240
C 5,12,s33,0
M v,244,a,68,a,12
R 108,4,11264
C 5,12,s33,1024
M v,240,a,72,a,16
R 112,4,12288
C 5,12,s33,2048
M v,244,a,72,a,20
R 116,4,13312
C 5,12,s33,3072
M v,240,a,76,a,24
R 120,4,14336
s_add_u32 m0, s32, 49152
M v,244,a,76,a,28
R 124,4,15360
v_mul_f32 v13, 0xbfb8aa3b, v72
M v,240,a,80,a,32
C 6,12,s33,0
v_mul_f32 v14, 0xbfb8aa3b, v76
M v,244,a,80,a,36
C 6,12,s33,1024
M v,240,a,84,a,40
C 6,12,s33,2048
M v,244,a,84,a,44
C 6,12,s33,3072
M v,240,a,88,a,48
s_add_u32 s33, s33, 0x8000
M v,244,a,88,a,52
v_exp_f32 v13, v13
M v,240,a,92,a,56
v_exp_f32 v14, v14
M v,244,a,92,a,60
s_nop 0
v_add_f32 v13, 1.0, v13
s_waitcnt lgkmcnt(0)
Z v,248,a,96,a,0
s_waitcnt vmcnt(16) lgkmcnt(0)
s_barrier
s_cmp_eq_u32 s89, 0
s_cbranch_scc1 PS_sp1
s_mov_b64 exec, 1
v_mov_b32 v127, s66
buffer_store_dword v127, off, s[12:15], s89 sc1
s_mov_b64 exec, -1
s_mov_b32 s89, 0
PS_sp1:
Z v,252,a,96,a,4
R 64,4,32768
R 68,4,33792
M v,248,a,100,a,8
R 72,4,34816
R 76,4,35840
M v,252,a,100,a,12
R 80,4,36864
R 84,4,37888
M v,248,a,104,a,16
R 88,4,38912
R 92,4,39936
M v,252,a,104,a,20
v_add_f32 v14, 1.0, v14
M v,248,a,108,a,24
v_rcp_f32 v8, v13
M v,252,a,108,a,28
v_rcp_f32 v9, v14
M v,248,a,112,a,32
s_nop 0
v_sub_f32 v14, 1.0, v8
M v,252,a,112,a,36
v_sub_f32 v74, 1.0, v9
v_mul_f32 v16, v14, v16
M v,248,a,116,a,40
v_mul_f32 v17, v14, v17
v_mul_f32 v18, v14, v18
M v,252,a,116,a,44
v_mul_f32 v19, v14, v19
v_cvt_pk_bf16_f32 v16, v16, v17
M v,248,a,120,a,48
v_cvt_pk_bf16_f32 v17, v18, v19
v_pk_max_i16 v16, v16, 0
M v,252,a,120,a,52
v_pk_max_i16 v17, v17, 0
v_accvgpr_write_b32 a128, v16
M v,248,a,124,a,56
v_accvgpr_write_b32 a129, v17
v_mul_f32 v24, v14, v24
M v,252,a,124,a,60
v_mul_f32 v25, v14, v25
v_mul_f32 v26, v14, v26
v_mul_f32 v27, v14, v27
v_cvt_pk_bf16_f32 v24, v24, v25
v_cvt_pk_bf16_f32 v25, v26, v27
v_pk_max_i16 v24, v24, 0
v_pk_max_i16 v25, v25, 0
v_accvgpr_write_b32 a130, v24
v_accvgpr_write_b32 a131, v25
v_mul_f32 v20, v74, v20
v_mul_f32 v21, v74, v21
v_mul_f32 v22, v74, v22
v_mul_f32 v23, v74, v23
v_cvt_pk_bf16_f32 v20, v20, v21
v_cvt_pk_bf16_f32 v21, v22, v23
v_pk_max_i16 v20, v20, 0
v_pk_max_i16 v21, v21, 0
v_accvgpr_write_b32 a132, v20
v_accvgpr_write_b32 a133, v21
v_mul_f32 v28, v74, v28
v_mul_f32 v29, v74, v29
v_mul_f32 v30, v74, v30
v_mul_f32 v31, v74, v31
v_cvt_pk_bf16_f32 v28, v28, v29
v_cvt_pk_bf16_f32 v29, v30, v31
v_pk_max_i16 v28, v28, 0
v_pk_max_i16 v29, v29, 0
v_accvgpr_write_b32 a134, v28
v_accvgpr_write_b32 a135, v29
v_mul_f32 v32, v14, v32
v_mul_f32 v33, v14, v33
v_mul_f32 v34, v14, v34
v_mul_f32 v35, v14, v35
v_cvt_pk_bf16_f32 v32, v32, v33
v_cvt_pk_bf16_f32 v33, v34, v35
v_pk_max_i16 v32, v32, 0
v_pk_max_i16 v33, v33, 0
v_accvgpr_write_b32 a136, v32
v_accvgpr_write_b32 a137, v33
v_mul_f32 v40, v14, v40
v_mul_f32 v41, v14, v41
v_mul_f32 v42, v14, v42
v_mul_f32 v43, v14, v43
v_cvt_pk_bf16_f32 v40, v40, v41
v_cvt_pk_bf16_f32 v41, v42, v43
v_pk_max_i16 v40, v40, 0
v_pk_max_i16 v41, v41, 0
v_accvgpr_write_b32 a138, v40
v_accvgpr_write_b32 a139, v41
v_mul_f32 v36, v74, v36
v_mul_f32 v37, v74, v37
v_mul_f32 v38, v74, v38
v_mul_f32 v39, v74, v39
v_cvt_pk_bf16_f32 v36, v36, v37
v_cvt_pk_bf16_f32 v37, v38, v39
v_pk_max_i16 v36, v36, 0
v_pk_max_i16 v37, v37, 0
v_accvgpr_write_b32 a140, v36
v_accvgpr_write_b32 a141, v37
v_mul_f32 v44, v74, v44
v_mul_f32 v45, v74, v45
v_mul_f32 v46, v74, v46
v_mul_f32 v47, v74, v47
v_cvt_pk_bf16_f32 v44, v44, v45
v_cvt_pk_bf16_f32 v45, v46, v47
v_pk_max_i16 v44, v44, 0
v_pk_max_i16 v45, v45, 0
v_accvgpr_write_b32 a142, v44
v_accvgpr_write_b32 a143, v45
v_mul_f32 v48, v14, v48
v_mul_f32 v49, v14, v49
v_mul_f32 v50, v14, v50
v_mul_f32 v51, v14, v51
v_cvt_pk_bf16_f32 v48, v48, v49
v_cvt_pk_bf16_f32 v49, v50, v51
v_pk_max_i16 v48, v48, 0
v_pk_max_i16 v49, v49, 0
v_accvgpr_write_b32 a144, v48
v_accvgpr_write_b32 a145, v49
v_mul_f32 v56, v14, v56
v_mul_f32 v57, v14, v57
v_mul_f32 v58, v14, v58
v_mul_f32 v59, v14, v59
v_cvt_pk_bf16_f32 v56, v56, v57
v_cvt_pk_bf16_f32 v57, v58, v59
v_pk_max_i16 v56, v56, 0
v_pk_max_i16 v57, v57, 0
v_accvgpr_write_b32 a146, v56
v_accvgpr_write_b32 a147, v57
v_mul_f32 v52, v74, v52
v_mul_f32 v53, v74, v53
v_mul_f32 v54, v74, v54
v_mul_f32 v55, v74, v55
v_cvt_pk_bf16_f32 v52, v52, v53
v_cvt_pk_bf16_f32 v53, v54, v55
v_pk_max_i16 v52, v52, 0
v_pk_max_i16 v53, v53, 0
v_accvgpr_write_b32 a148, v52
v_accvgpr_write_b32 a149, v53
v_mul_f32 v60, v74, v60
v_mul_f32 v61, v74, v61
v_mul_f32 v62, v74, v62
v_mul_f32 v63, v74, v63
v_cvt_pk_bf16_f32 v60, v60, v61
v_cvt_pk_bf16_f32 v61, v62, v63
v_pk_max_i16 v60, v60, 0
v_pk_max_i16 v61, v61, 0
v_accvgpr_write_b32 a150, v60
v_accvgpr_write_b32 a151, v61
v_mul_f32 v64, v14, v64
v_mul_f32 v65, v14, v65
v_mul_f32 v66, v14, v66
v_mul_f32 v67, v14, v67
v_cvt_pk_bf16_f32 v64, v64, v65
v_cvt_pk_bf16_f32 v65, v66, v67
v_pk_max_i16 v64, v64, 0
v_pk_max_i16 v65, v65, 0
v_accvgpr_write_b32 a152, v64
v_accvgpr_write_b32 a153, v65
v_accvgpr_write_b32 a154, 0
v_accvgpr_write_b32 a155, 0
v_mul_f32 v68, v74, v68
v_mul_f32 v69, v74, v69
v_mul_f32 v70, v74, v70
v_mul_f32 v71, v74, v71
v_cvt_pk_bf16_f32 v68, v68, v69
v_cvt_pk_bf16_f32 v69, v70, v71
v_pk_max_i16 v68, v68, 0
v_pk_max_i16 v69, v69, 0
v_accvgpr_write_b32 a156, v68
v_accvgpr_write_b32 a157, v69
v_accvgpr_write_b32 a158, 0
v_accvgpr_write_b32 a159, 0
s_nop 7
s_or_b32 s35, s34, s67
s_cmp_lg_u32 s35, 0
s_cbranch_scc1 NM_1
v_mov_b32 v11, v10
s_nop 0
v_cmp_le_i32_e64 s[40:41], -16, v11
v_cmp_le_i32_e64 s[42:43], -15, v11
v_cmp_le_i32_e64 s[44:45], -14, v11
v_cmp_le_i32_e64 s[46:47], -13, v11
v_cmp_le_i32_e64 s[48:49], 0, v11
v_cmp_le_i32_e64 s[50:51], 1, v11
v_cmp_le_i32_e64 s[52:53], 2, v11
v_cmp_le_i32_e64 s[54:55], 3, v11
v_cmp_le_i32_e64 s[56:57], 16, v11
v_cmp_le_i32_e64 s[58:59], 17, v11
v_cmp_le_i32_e64 s[60:61], 18, v11
v_cmp_le_i32_e64 s[62:63], 19, v11
v_cndmask_b32_e64 v240, v12, v240, s[48:49]
v_cndmask_b32_e64 v241, v12, v241, s[50:51]
v_cndmask_b32_e64 v242, v12, v242, s[52:53]
v_cndmask_b32_e64 v243, v12, v243, s[54:55]
v_cndmask_b32_e64 v248, v12, v248, s[56:57]
v_cndmask_b32_e64 v249, v12, v249, s[58:59]
v_cndmask_b32_e64 v250, v12, v250, s[60:61]
v_cndmask_b32_e64 v251, v12, v251, s[62:63]
v_cndmask_b32_e64 v244, v12, v244, s[40:41]
v_cndmask_b32_e64 v245, v12, v245, s[42:43]
v_cndmask_b32_e64 v246, v12, v246, s[44:45]
v_cndmask_b32_e64 v247, v12, v247, s[46:47]
v_cndmask_b32_e64 v252, v12, v252, s[48:49]
v_cndmask_b32_e64 v253, v12, v253, s[50:51]
v_cndmask_b32_e64 v254, v12, v254, s[52:53]
v_cndmask_b32_e64 v255, v12, v255, s[54:55]
NM_1:
v_max3_f32 v13, v240, v241, v242
v_max3_f32 v14, v243, v248, v249
v_max3_f32 v13, v13, v250, v251
v_max_f32 v13, v13, v14
v_mov_b32 v14, v13
s_nop 1
v_permlane32_swap_b32 v13, v14
s_nop 1
v_max_f32 v13, v13, v14
v_mov_b32 v14, v13
s_nop 1
v_permlane16_swap_b32 v13, v14
s_nop 1
v_max_f32 v13, v13, v14
v_sub_f32 v72, 0, v13
v_sub_f32 v73, 0, v13
v_sub_f32 v74, 0, v13
v_sub_f32 v75, 0, v13
v_sub_f32 v16, v240, v13
v_sub_f32 v17, v241, v13
v_sub_f32 v18, v242, v13
v_sub_f32 v19, v243, v13
v_sub_f32 v24, v248, v13
v_sub_f32 v25, v249, v13
v_sub_f32 v26, v250, v13
v_sub_f32 v27, v251, v13
v_max3_f32 v13, v244, v245, v246
v_max3_f32 v14, v247, v252, v253
v_max3_f32 v13, v13, v254, v255
v_max_f32 v13, v13, v14
v_mov_b32 v14, v13
s_nop 1
v_permlane32_swap_b32 v13, v14
s_nop 1
v_max_f32 v13, v13, v14
v_mov_b32 v14, v13
s_nop 1
v_permlane16_swap_b32 v13, v14
s_nop 1
v_max_f32 v13, v13, v14
v_sub_f32 v76, 0, v13
v_sub_f32 v77, 0, v13
v_sub_f32 v78, 0, v13
v_sub_f32 v79, 0, v13
v_sub_f32 v20, v244, v13
v_sub_f32 v21, v245, v13
v_sub_f32 v22, v246, v13
v_sub_f32 v23, v247, v13
v_sub_f32 v28, v252, v13
v_sub_f32 v29, v253, v13
v_sub_f32 v30, v254, v13
v_sub_f32 v31, v255, v13
v_mov_b32 v84, 0
v_mov_b32 v85, 0
v_mov_b32 v86, 0
v_mov_b32 v87, 0
MG_a0:
s_cmp_eq_u32 s34, 0
s_cbranch_scc1 K2_n4
s_waitcnt lgkmcnt(0)
v_mfma_f32_16x16x32_bf16 v[32:35], a[64:67], a[0:3], v[72:75]
R 96,4,40960
v_mfma_f32_16x16x32_bf16 v[36:39], a[64:67], a[4:7], v[76:79]
R 100,4,41984
s_add_u32 m0, s32, 65536
M v,32,a,68,a,8
R 104,4,43008
C 5,12,s33,0
M v,36,a,68,a,12
R 108,4,44032
C 5,12,s33,1024
M v,32,a,72,a,16
R 112,4,45056
C 5,12,s33,2048
M v,36,a,72,a,20
R 116,4,46080
C 5,12,s33,3072
M v,32,a,76,a,24
R 120,4,47104
s_add_u32 m0, s32, 81920
M v,36,a,76,a,28
R 124,4,48128
M v,32,a,80,a,32
C 6,12,s33,0
M v,36,a,80,a,36
C 6,12,s33,1024
M v,32,a,84,a,40
C 6,12,s33,2048
M v,36,a,84,a,44
C 6,12,s33,3072
M v,32,a,88,a,48
s_add_u32 s33, s33, 0x8000
M v,36,a,88,a,52
v_exp_f32 v64, v16
M v,32,a,92,a,56
v_exp_f32 v65, v17
M v,36,a,92,a,60
v_exp_f32 v66, v18
s_waitcnt lgkmcnt(0)
v_mfma_f32_16x16x32_bf16 v[40:43], a[96:99], a[0:3], v[72:75]
s_waitcnt vmcnt(16) lgkmcnt(0)
s_barrier
s_cmp_eq_u32 s89, 0
s_cbranch_scc1 PS_a0
s_mov_b64 exec, 1
v_mov_b32 v127, s66
buffer_store_dword v127, off, s[12:15], s89 sc1
s_mov_b64 exec, -1
s_mov_b32 s89, 0
PS_a0:
v_mfma_f32_16x16x32_bf16 v[44:47], a[96:99], a[4:7], v[76:79]
R 64,3,0
R 68,3,1024
M v,40,a,100,a,8
R 72,3,2048
R 76,3,3072
M v,44,a,100,a,12
R 80,3,4096
R 84,3,5120
M v,40,a,104,a,16
R 88,3,6144
R 92,3,7168
M v,44,a,104,a,20
v_add_f32 v80, v84, v64
v_add_f32 v81, v85, v65
M v,40,a,108,a,24
v_cvt_pk_bf16_f32 v48, v64, v65
M v,44,a,108,a,28
v_exp_f32 v67, v19
M v,40,a,112,a,32
v_exp_f32 v68, v24
M v,44,a,112,a,36
v_add_f32 v80, v80, v66
v_add_f32 v81, v81, v67
M v,40,a,116,a,40
v_cvt_pk_bf16_f32 v49, v66, v67
M v,44,a,116,a,44
v_exp_f32 v69, v25
M v,40,a,120,a,48
v_exp_f32 v70, v26
M v,44,a,120,a,52
v_add_f32 v80, v80, v68
v_add_f32 v81, v81, v69
M v,40,a,124,a,56
v_cvt_pk_bf16_f32 v50, v68, v69
M v,44,a,124,a,60
v_exp_f32 v71, v27
s_nop 0
v_add_f32 v80, v80, v70
v_add_f32 v81, v81, v71
v_cvt_pk_bf16_f32 v51, v70, v71
v_exp_f32 v64, v20
v_exp_f32 v65, v21
v_exp_f32 v66, v22
v_add_f32 v82, v86, v64
v_add_f32 v83, v87, v65
v_cvt_pk_bf16_f32 v52, v64, v65
v_exp_f32 v67, v23
v_exp_f32 v68, v28
v_add_f32 v82, v82, v66
v_add_f32 v83, v83, v67
v_cvt_pk_bf16_f32 v53, v66, v67
v_exp_f32 v69, v29
v_exp_f32 v70, v30
v_add_f32 v82, v82, v68
v_add_f32 v83, v83, v69
v_cvt_pk_bf16_f32 v54, v68, v69
v_exp_f32 v71, v31
s_nop 0
v_add_f32 v82, v82, v70
v_add_f32 v83, v83, v71
v_cvt_pk_bf16_f32 v55, v70, v71
v_max3_f32 v14, v80, v81, v82
v_max_f32 v14, v14, v83
v_cmp_lt_f32 vcc, s37, v14
v_mov_b64 v[128:129], 0
v_mov_b64 v[130:131], 0
v_mov_b64 v[132:133], 0
v_mov_b64 v[134:135], 0
v_mov_b64 v[136:137], 0
v_mov_b64 v[138:139], 0
v_mov_b64 v[140:141], 0
v_mov_b64 v[142:143], 0
v_mov_b64 v[144:145], 0
v_mov_b64 v[146:147], 0
v_mov_b64 v[148:149], 0
v_mov_b64 v[150:151], 0
v_mov_b64 v[152:153], 0
v_mov_b64 v[154:155], 0
v_mov_b64 v[156:157], 0
v_mov_b64 v[158:159], 0
v_mov_b64 v[160:161], 0
v_mov_b64 v[162:163], 0
v_mov_b64 v[164:165], 0
v_mov_b64 v[166:167], 0
v_mov_b64 v[168:169], 0
v_mov_b64 v[170:171], 0
v_mov_b64 v[172:173], 0
v_mov_b64 v[174:175], 0
v_mov_b64 v[176:177], 0
v_mov_b64 v[178:179], 0
v_mov_b64 v[180:181], 0
v_mov_b64 v[182:183], 0
v_mov_b64 v[184:185], 0
v_mov_b64 v[186:187], 0
v_mov_b64 v[188:189], 0
v_mov_b64 v[190:191], 0
v_mov_b64 v[192:193], 0
v_mov_b64 v[194:195], 0
v_mov_b64 v[196:197], 0
v_mov_b64 v[198:199], 0
v_mov_b64 v[200:201], 0
v_mov_b64 v[202:203], 0
v_mov_b64 v[204:205], 0
v_mov_b64 v[206:207], 0
v_mov_b64 v[208:209], 0
v_mov_b64 v[210:211], 0
v_mov_b64 v[212:213], 0
v_mov_b64 v[214:215], 0
v_mov_b64 v[216:217], 0
v_mov_b64 v[218:219], 0
v_mov_b64 v[220:221], 0
v_mov_b64 v[222:223], 0
v_mov_b64 v[224:225], 0
v_mov_b64 v[226:227], 0
v_mov_b64 v[228:229], 0
v_mov_b64 v[230:231], 0
v_mov_b64 v[232:233], 0
v_mov_b64 v[234:235], 0
v_mov_b64 v[236:237], 0
v_mov_b64 v[238:239], 0
v_mov_b64 v[240:241], 0
v_mov_b64 v[242:243], 0
v_mov_b64 v[244:245], 0
v_mov_b64 v[246:247], 0
v_mov_b64 v[248:249], 0
v_mov_b64 v[250:251], 0
v_mov_b64 v[252:253], 0
v_mov_b64 v[254:255], 0
s_nop 0
s_cbranch_vccnz RARE_a0s
BACK_a0s:
s_branch K2_an1
.p2align 6
K2_loop:
s_waitcnt lgkmcnt(0)
v_mfma_f32_16x16x32_bf16 v[32:35], a[64:67], a[0:3], v[72:75]
R 96,4,40960
v_mfma_f32_16x16x32_bf16 v[36:39], a[64:67], a[4:7], v[76:79]
R 100,4,41984
s_add_u32 m0, s32, 65536
M v,32,a,68,a,8
v_exp_f32 v64, v16
M v,36,a,68,a,12
R 104,4,43008
M v,32,a,72,a,16
v_exp_f32 v65, v17
M v,36,a,72,a,20
R 108,4,44032
C 5,12,s33,0
M v,32,a,76,a,24
R 112,4,45056
M v,36,a,76,a,28
v_exp_f32 v66, v18
M v,32,a,80,a,32
R 116,4,46080
v_add_f32 v80, v84, v64
M v,36,a,80,a,36
C 5,12,s33,1024
v_add_f32 v81, v85, v65
M v,32,a,84,a,40
R 120,4,47104
v_cvt_pk_bf16_f32 v48, v64, v65
M v,36,a,84,a,44
R 124,4,48128
M v,32,a,88,a,48
v_exp_f32 v67, v19
M v,36,a,88,a,52
R 64,4,49152
C 5,12,s33,2048
M v,32,a,92,a,56
v_exp_f32 v68, v24
M v,36,a,92,a,60
R 68,4,50176
v_add_f32 v80, v80, v66
s_waitcnt lgkmcnt(3)
v_mfma_f32_16x16x32_bf16 v[40:43], a[96:99], a[0:3], v[72:75]
v_add_f32 v81, v81, v67
v_cvt_pk_bf16_f32 v49, v66, v67
v_mfma_f32_16x16x32_bf16 v[44:47], a[96:99], a[4:7], v[76:79]
R 72,4,51200
C 5,12,s33,3072
M v,40,a,100,a,8
R 76,4,52224
M v,44,a,100,a,12
v_exp_f32 v69, v25
M v,40,a,104,a,16
R 80,4,53248
M v,44,a,104,a,20
s_add_u32 m0, s32, 81920
M v,40,a,108,a,24
R 84,4,54272
M v,44,a,108,a,28
R 88,4,55296
M v,40,a,112,a,32
v_exp_f32 v70, v26
M v,44,a,112,a,36
R 92,4,56320
C 6,12,s33,0
M v,40,a,116,a,40
v_add_f32 v80, v80, v68
v_add_f32 v81, v81, v69
M v,44,a,116,a,44
R 96,4,57344
v_cvt_pk_bf16_f32 v50, v68, v69
M v,40,a,120,a,48
v_exp_f32 v71, v27
M v,44,a,120,a,52
R 100,4,58368
C 6,12,s33,1024
s_waitcnt lgkmcnt(3)
M v,40,a,124,a,56
R 104,4,59392
s_nop 0
M v,44,a,124,a,60
v_add_f32 v80, v80, v70
v_add_f32 v81, v81, v71
M v,128,a,64,v,56
R 108,4,60416
v_cvt_pk_bf16_f32 v51, v70, v71
M v,132,a,64,v,60
C 6,12,s33,2048
M v,136,a,68,v,56
R 112,4,61440
M v,140,a,68,v,60
R 116,4,62464
M v,144,a,72,v,56
v_exp_f32 v64, v20
M v,148,a,72,v,60
R 120,4,63488
C 6,12,s33,3072
M v,152,a,76,v,56
v_exp_f32 v65, v21
M v,156,a,76,v,60
R 124,4,64512
M v,160,a,80,v,56
v_exp_f32 v66, v22
M v,164,a,80,v,60
s_add_u32 s33, s33, 0x8000
v_add_f32 v82, v86, v64
M v,168,a,84,v,56
v_add_f32 v83, v87, v65
v_cvt_pk_bf16_f32 v52, v64, v65
M v,172,a,84,v,60
v_exp_f32 v67, v23
M v,176,a,88,v,56
v_exp_f32 v68, v28
M v,180,a,88,v,60
v_add_f32 v82, v82, v66
v_add_f32 v83, v83, v67
s_waitcnt lgkmcnt(0)
M v,184,a,92,v,56
v_cvt_pk_bf16_f32 v53, v66, v67
M v,188,a,92,v,60
v_exp_f32 v69, v29
M v,192,a,96,v,56
s_waitcnt vmcnt(16) lgkmcnt(0)
s_barrier
M v,196,a,96,v,60
R 64,3,0
R 68,3,1024
M v,200,a,100,v,56
R 72,3,2048
R 76,3,3072
M v,204,a,100,v,60
R 80,3,4096
R 84,3,5120
M v,208,a,104,v,56
R 88,3,6144
R 92,3,7168
M v,212,a,104,v,60
v_exp_f32 v70, v30
M v,216,a,108,v,56
v_add_f32 v82, v82, v68
v_add_f32 v83, v83, v69
M v,220,a,108,v,60
v_cvt_pk_bf16_f32 v54, v68, v69
M v,224,a,112,v,56
v_exp_f32 v71, v31
M v,228,a,112,v,60
s_nop 0
v_add_f32 v82, v82, v70
M v,232,a,116,v,56
v_add_f32 v83, v83, v71
v_cvt_pk_bf16_f32 v55, v70, v71
M v,236,a,116,v,60
v_max3_f32 v14, v80, v81, v82
v_max_f32 v14, v14, v83
M v,240,a,120,v,56
v_cmp_lt_f32 vcc, s37, v14
M v,244,a,120,v,60
M v,248,a,124,v,56
M v,252,a,124,v,60
s_nop 0
s_cbranch_vccnz RARE_an0
BACK_an0:
K2_an1:
s_waitcnt lgkmcnt(0)
v_mfma_f32_16x16x32_bf16 v[16:19], a[64:67], a[0:3], v[72:75]
R 96,3,8192
v_mfma_f32_16x16x32_bf16 v[20:23], a[64:67], a[4:7], v[76:79]
R 100,3,9216
s_add_u32 m0, s32, 98304
M v,16,a,68,a,8
v_exp_f32 v64, v32
M v,20,a,68,a,12
R 104,3,10240
M v,16,a,72,a,16
v_exp_f32 v65, v33
M v,20,a,72,a,20
R 108,3,11264
C 5,12,s33,0
M v,16,a,76,a,24
R 112,3,12288
M v,20,a,76,a,28
v_exp_f32 v66, v34
M v,16,a,80,a,32
R 116,3,13312
v_add_f32 v84, v80, v64
M v,20,a,80,a,36
C 5,12,s33,1024
v_add_f32 v85, v81, v65
M v,16,a,84,a,40
R 120,3,14336
v_cvt_pk_bf16_f32 v56, v64, v65
M v,20,a,84,a,44
R 124,3,15360
M v,16,a,88,a,48
v_exp_f32 v67, v35
M v,20,a,88,a,52
R 64,3,16384
C 5,12,s33,2048
M v,16,a,92,a,56
v_exp_f32 v68, v40
M v,20,a,92,a,60
R 68,3,17408
v_add_f32 v84, v84, v66
s_waitcnt lgkmcnt(3)
v_mfma_f32_16x16x32_bf16 v[24:27], a[96:99], a[0:3], v[72:75]
v_add_f32 v85, v85, v67
v_cvt_pk_bf16_f32 v57, v66, v67
v_mfma_f32_16x16x32_bf16 v[28:31], a[96:99], a[4:7], v[76:79]
R 72,3,18432
C 5,12,s33,3072
M v,24,a,100,a,8
R 76,3,19456
M v,28,a,100,a,12
v_exp_f32 v69, v41
M v,24,a,104,a,16
R 80,3,20480
M v,28,a,104,a,20
s_add_u32 m0, s32, 114688
M v,24,a,108,a,24
R 84,3,21504
M v,28,a,108,a,28
R 88,3,22528
M v,24,a,112,a,32
v_exp_f32 v70, v42
M v,28,a,112,a,36
R 92,3,23552
C 6,12,s33,0
M v,24,a,116,a,40
v_add_f32 v84, v84, v68
v_add_f32 v85, v85, v69
M v,28,a,116,a,44
R 96,3,24576
v_cvt_pk_bf16_f32 v58, v68, v69
M v,24,a,120,a,48
v_exp_f32 v71, v43
M v,28,a,120,a,52
R 100,3,25600
C 6,12,s33,1024
s_waitcnt lgkmcnt(3)
M v,24,a,124,a,56
R 104,3,26624
s_nop 0
M v,28,a,124,a,60
v_add_f32 v84, v84, v70
v_add_f32 v85, v85, v71
M v,128,a,64,v,48
R 108,3,27648
v_cvt_pk_bf16_f32 v59, v70, v71
M v,132,a,64,v,52
C 6,12,s33,2048
M v,136,a,68,v,48
R 112,3,28672
M v,140,a,68,v,52
R 116,3,29696
M v,144,a,72,v,48
v_exp_f32 v64, v36
M v,148,a,72,v,52
R 120,3,30720
C 6,12,s33,3072
M v,152,a,76,v,48
v_exp_f32 v65, v37
M v,156,a,76,v,52
R 124,3,31744
M v,160,a,80,v,48
v_exp_f32 v66, v38
M v,164,a,80,v,52
s_add_u32 s33, s33, 0x8000
v_add_f32 v86, v82, v64
M v,168,a,84,v,48
v_add_f32 v87, v83, v65
v_cvt_pk_bf16_f32 v60, v64, v65
M v,172,a,84,v,52
v_exp_f32 v67, v39
M v,176,a,88,v,48
v_exp_f32 v68, v44
M v,180,a,88,v,52
v_add_f32 v86, v86, v66
v_add_f32 v87, v87, v67
s_waitcnt lgkmcnt(0)
M v,184,a,92,v,48
v_cvt_pk_bf16_f32 v61, v66, v67
M v,188,a,92,v,52
v_exp_f32 v69, v45
M v,192,a,96,v,48
s_waitcnt vmcnt(16) lgkmcnt(0)
s_barrier
s_cmp_eq_u32 s90, 0
s_cbranch_scc1 PS_an1
s_mov_b64 exec, 1
v_mov_b32 v127, s66
buffer_store_dword v127, off, s[12:15], s90 sc1
s_mov_b64 exec, -1
s_mov_b32 s90, 0
PS_an1:
M v,196,a,96,v,52
R 64,3,32768
R 68,3,33792
M v,200,a,100,v,48
R 72,3,34816
R 76,3,35840
M v,204,a,100,v,52
R 80,3,36864
R 84,3,37888
M v,208,a,104,v,48
R 88,3,38912
R 92,3,39936
M v,212,a,104,v,52
v_exp_f32 v70, v46
M v,216,a,108,v,48
v_add_f32 v86, v86, v68
v_add_f32 v87, v87, v69
M v,220,a,108,v,52
v_cvt_pk_bf16_f32 v62, v68, v69
M v,224,a,112,v,48
v_exp_f32 v71, v47
M v,228,a,112,v,52
s_nop 0
v_add_f32 v86, v86, v70
M v,232,a,116,v,48
v_add_f32 v87, v87, v71
v_cvt_pk_bf16_f32 v63, v70, v71
M v,236,a,116,v,52
v_max3_f32 v14, v84, v85, v86
v_max_f32 v14, v14, v87
M v,240,a,120,v,48
v_cmp_lt_f32 vcc, s37, v14
M v,244,a,120,v,52
M v,248,a,124,v,48
M v,252,a,124,v,52
s_nop 0
s_cbranch_vccnz RARE_an1
BACK_an1:
s_waitcnt lgkmcnt(0)
v_mfma_f32_16x16x32_bf16 v[32:35], a[64:67], a[0:3], v[72:75]
R 96,3,40960
v_mfma_f32_16x16x32_bf16 v[36:39], a[64:67], a[4:7], v[76:79]
R 100,3,41984
s_add_u32 m0, s32, 0
M v,32,a,68,a,8
v_exp_f32 v64, v16
M v,36,a,68,a,12
R 104,3,43008
M v,32,a,72,a,16
v_exp_f32 v65, v17
M v,36,a,72,a,20
R 108,3,44032
C 5,12,s33,0
M v,32,a,76,a,24
R 112,3,45056
M v,36,a,76,a,28
v_exp_f32 v66, v18
M v,32,a,80,a,32
R 116,3,46080
v_add_f32 v80, v84, v64
M v,36,a,80,a,36
C 5,12,s33,1024
v_add_f32 v81, v85, v65
M v,32,a,84,a,40
R 120,3,47104
v_cvt_pk_bf16_f32 v48, v64, v65
M v,36,a,84,a,44
R 124,3,48128
M v,32,a,88,a,48
v_exp_f32 v67, v19
M v,36,a,88,a,52
R 64,3,49152
C 5,12,s33,2048
M v,32,a,92,a,56
v_exp_f32 v68, v24
M v,36,a,92,a,60
R 68,3,50176
v_add_f32 v80, v80, v66
s_waitcnt lgkmcnt(3)
v_mfma_f32_16x16x32_bf16 v[40:43], a[96:99], a[0:3], v[72:75]
v_add_f32 v81, v81, v67
v_cvt_pk_bf16_f32 v49, v66, v67
v_mfma_f32_16x16x32_bf16 v[44:47], a[96:99], a[4:7], v[76:79]
R 72,3,51200
C 5,12,s33,3072
M v,40,a,100,a,8
R 76,3,52224
M v,44,a,100,a,12
v_exp_f32 v69, v25
M v,40,a,104,a,16
R 80,3,53248
M v,44,a,104,a,20
s_add_u32 m0, s32, 16384
M v,40,a,108,a,24
R 84,3,54272
M v,44,a,108,a,28
R 88,3,55296
M v,40,a,112,a,32
v_exp_f32 v70, v26
M v,44,a,112,a,36
R 92,3,56320
C 6,12,s33,0
M v,40,a,116,a,40
v_add_f32 v80, v80, v68
v_add_f32 v81, v81, v69
M v,44,a,116,a,44
R 96,3,57344
v_cvt_pk_bf16_f32 v50, v68, v69
M v,40,a,120,a,48
v_exp_f32 v71, v27
M v,44,a,120,a,52
R 100,3,58368
C 6,12,s33,1024
s_waitcnt lgkmcnt(3)
M v,40,a,124,a,56
R 104,3,59392
s_nop 0
M v,44,a,124,a,60
v_add_f32 v80, v80, v70
v_add_f32 v81, v81, v71
M v,128,a,64,v,56
R 108,3,60416
v_cvt_pk_bf16_f32 v51, v70, v71
M v,132,a,64,v,60
C 6,12,s33,2048
M v,136,a,68,v,56
R 112,3,61440
M v,140,a,68,v,60
R 116,3,62464
M v,144,a,72,v,56
v_exp_f32 v64, v20
M v,148,a,72,v,60
R 120,3,63488
C 6,12,s33,3072
M v,152,a,76,v,56
v_exp_f32 v65, v21
M v,156,a,76,v,60
R 124,3,64512
M v,160,a,80,v,56
v_exp_f32 v66, v22
M v,164,a,80,v,60
s_add_u32 s33, s33, 0x8000
v_add_f32 v82, v86, v64
M v,168,a,84,v,56
v_add_f32 v83, v87, v65
v_cvt_pk_bf16_f32 v52, v64, v65
M v,172,a,84,v,60
v_exp_f32 v67, v23
M v,176,a,88,v,56
v_exp_f32 v68, v28
M v,180,a,88,v,60
v_add_f32 v82, v82, v66
v_add_f32 v83, v83, v67
s_waitcnt lgkmcnt(0)
M v,184,a,92,v,56
v_cvt_pk_bf16_f32 v53, v66, v67
M v,188,a,92,v,60
v_exp_f32 v69, v29
M v,192,a,96,v,56
s_waitcnt vmcnt(16) lgkmcnt(0)
s_barrier
M v,196,a,96,v,60
R 64,4,0
R 68,4,1024
M v,200,a,100,v,56
R 72,4,2048
R 76,4,3072
M v,204,a,100,v,60
R 80,4,4096
R 84,4,5120
M v,208,a,104,v,56
R 88,4,6144
R 92,4,7168
M v,212,a,104,v,60
v_exp_f32 v70, v30
M v,216,a,108,v,56
v_add_f32 v82, v82, v68
v_add_f32 v83, v83, v69
M v,220,a,108,v,60
v_cvt_pk_bf16_f32 v54, v68, v69
M v,224,a,112,v,56
v_exp_f32 v71, v31
M v,228,a,112,v,60
s_nop 0
v_add_f32 v82, v82, v70
M v,232,a,116,v,56
v_add_f32 v83, v83, v71
v_cvt_pk_bf16_f32 v55, v70, v71
M v,236,a,116,v,60
v_max3_f32 v14, v80, v81, v82
v_max_f32 v14, v14, v83
M v,240,a,120,v,56
v_cmp_lt_f32 vcc, s37, v14
M v,244,a,120,v,60
M v,248,a,124,v,56
M v,252,a,124,v,60
s_nop 0
s_cbranch_vccnz RARE_an2
BACK_an2:
s_waitcnt lgkmcnt(0)
v_mfma_f32_16x16x32_bf16 v[16:19], a[64:67], a[0:3], v[72:75]
R 96,4,8192
v_mfma_f32_16x16x32_bf16 v[20:23], a[64:67], a[4:7], v[76:79]
R 100,4,9216
s_add_u32 m0, s32, 32768
M v,16,a,68,a,8
v_exp_f32 v64, v32
M v,20,a,68,a,12
R 104,4,10240
M v,16,a,72,a,16
v_exp_f32 v65, v33
M v,20,a,72,a,20
R 108,4,11264
C 5,12,s33,0
M v,16,a,76,a,24
R 112,4,12288
M v,20,a,76,a,28
v_exp_f32 v66, v34
M v,16,a,80,a,32
R 116,4,13312
v_add_f32 v84, v80, v64
M v,20,a,80,a,36
C 5,12,s33,1024
v_add_f32 v85, v81, v65
M v,16,a,84,a,40
R 120,4,14336
v_cvt_pk_bf16_f32 v56, v64, v65
M v,20,a,84,a,44
R 124,4,15360
M v,16,a,88,a,48
v_exp_f32 v67, v35
M v,20,a,88,a,52
R 64,4,16384
C 5,12,s33,2048
M v,16,a,92,a,56
v_exp_f32 v68, v40
M v,20,a,92,a,60
R 68,4,17408
v_add_f32 v84, v84, v66
s_waitcnt lgkmcnt(3)
v_mfma_f32_16x16x32_bf16 v[24:27], a[96:99], a[0:3], v[72:75]
v_add_f32 v85, v85, v67
v_cvt_pk_bf16_f32 v57, v66, v67
v_mfma_f32_16x16x32_bf16 v[28:31], a[96:99], a[4:7], v[76:79]
R 72,4,18432
C 5,12,s33,3072
M v,24,a,100,a,8
R 76,4,19456
M v,28,a,100,a,12
v_exp_f32 v69, v41
M v,24,a,104,a,16
R 80,4,20480
M v,28,a,104,a,20
s_add_u32 m0, s32, 49152
M v,24,a,108,a,24
R 84,4,21504
M v,28,a,108,a,28
R 88,4,22528
M v,24,a,112,a,32
v_exp_f32 v70, v42
M v,28,a,112,a,36
R 92,4,23552
C 6,12,s33,0
M v,24,a,116,a,40
v_add_f32 v84, v84, v68
v_add_f32 v85, v85, v69
M v,28,a,116,a,44
R 96,4,24576
v_cvt_pk_bf16_f32 v58, v68, v69
M v,24,a,120,a,48
v_exp_f32 v71, v43
M v,28,a,120,a,52
R 100,4,25600
C 6,12,s33,1024
s_waitcnt lgkmcnt(3)
M v,24,a,124,a,56
R 104,4,26624
s_nop 0
M v,28,a,124,a,60
v_add_f32 v84, v84, v70
v_add_f32 v85, v85, v71
M v,128,a,64,v,48
R 108,4,27648
v_cvt_pk_bf16_f32 v59, v70, v71
M v,132,a,64,v,52
C 6,12,s33,2048
M v,136,a,68,v,48
R 112,4,28672
M v,140,a,68,v,52
R 116,4,29696
M v,144,a,72,v,48
v_exp_f32 v64, v36
M v,148,a,72,v,52
R 120,4,30720
C 6,12,s33,3072
M v,152,a,76,v,48
v_exp_f32 v65, v37
M v,156,a,76,v,52
R 124,4,31744
M v,160,a,80,v,48
v_exp_f32 v66, v38
M v,164,a,80,v,52
s_add_u32 s33, s33, 0x8000
v_add_f32 v86, v82, v64
M v,168,a,84,v,48
v_add_f32 v87, v83, v65
v_cvt_pk_bf16_f32 v60, v64, v65
M v,172,a,84,v,52
v_exp_f32 v67, v39
M v,176,a,88,v,48
v_exp_f32 v68, v44
M v,180,a,88,v,52
v_add_f32 v86, v86, v66
v_add_f32 v87, v87, v67
s_waitcnt lgkmcnt(0)
M v,184,a,92,v,48
v_cvt_pk_bf16_f32 v61, v66, v67
M v,188,a,92,v,52
v_exp_f32 v69, v45
M v,192,a,96,v,48
s_waitcnt vmcnt(16) lgkmcnt(0)
s_barrier
M v,196,a,96,v,52
R 64,4,32768
R 68,4,33792
M v,200,a,100,v,48
R 72,4,34816
R 76,4,35840
M v,204,a,100,v,52
R 80,4,36864
R 84,4,37888
M v,208,a,104,v,48
R 88,4,38912
R 92,4,39936
M v,212,a,104,v,52
v_exp_f32 v70, v46
M v,216,a,108,v,48
v_add_f32 v86, v86, v68
v_add_f32 v87, v87, v69
M v,220,a,108,v,52
v_cvt_pk_bf16_f32 v62, v68, v69
M v,224,a,112,v,48
v_exp_f32 v71, v47
M v,228,a,112,v,52
s_nop 0
v_add_f32 v86, v86, v70
M v,232,a,116,v,48
v_add_f32 v87, v87, v71
v_cvt_pk_bf16_f32 v63, v70, v71
M v,236,a,116,v,52
v_max3_f32 v14, v84, v85, v86
v_max_f32 v14, v14, v87
M v,240,a,120,v,48
v_cmp_lt_f32 vcc, s37, v14
M v,244,a,120,v,52
M v,248,a,124,v,48
M v,252,a,124,v,52
s_nop 0
s_cbranch_vccnz RARE_an3
BACK_an3:
s_sub_u32 s34, s34, 1
s_cmp_lg_u32 s34, 0
s_cbranch_scc1 K2_loop
s_cmp_lg_u32 s67, 0
s_cbranch_scc1 MG_help
s_cmp_eq_u32 s88, 2
s_cbranch_scc1 MG_giver
s_waitcnt lgkmcnt(0)
v_mfma_f32_16x16x32_bf16 v[32:35], a[64:67], a[0:3], v[72:75]
R 96,4,40960
v_subrev_u32 v11, 0, v10
v_mfma_f32_16x16x32_bf16 v[36:39], a[64:67], a[4:7], v[76:79]
R 100,4,41984
s_add_u32 m0, s32, 81920
M v,32,a,68,a,8
v_cmp_le_i32_e64 s[40:41], -16, v11
v_cmp_le_i32_e64 s[42:43], -15, v11
M v,36,a,68,a,12
R 104,4,43008
v_cmp_le_i32_e64 s[44:45], -14, v11
M v,32,a,72,a,16
v_cmp_le_i32_e64 s[46:47], -13, v11
v_cmp_le_i32_e64 s[48:49], 0, v11
M v,36,a,72,a,20
R 108,4,44032
v_cmp_le_i32_e64 s[50:51], 1, v11
M v,32,a,76,a,24
R 112,4,45056
v_cmp_le_i32_e64 s[52:53], 2, v11
M v,36,a,76,a,28
v_cmp_le_i32_e64 s[54:55], 3, v11
v_cmp_le_i32_e64 s[56:57], 16, v11
M v,32,a,80,a,32
R 116,4,46080
C 6,12,s33,0
M v,36,a,80,a,36
v_cmp_le_i32_e64 s[58:59], 17, v11
v_cmp_le_i32_e64 s[60:61], 18, v11
M v,32,a,84,a,40
R 120,4,47104
v_cmp_le_i32_e64 s[62:63], 19, v11
M v,36,a,84,a,44
R 124,4,48128
v_cndmask_b32_e64 v16, v12, v16, s[48:49]
M v,32,a,88,a,48
v_cndmask_b32_e64 v17, v12, v17, s[50:51]
v_cndmask_b32_e64 v18, v12, v18, s[52:53]
M v,36,a,88,a,52
R 64,4,49152
v_cndmask_b32_e64 v19, v12, v19, s[54:55]
M v,32,a,92,a,56
v_cndmask_b32_e64 v24, v12, v24, s[56:57]
M v,36,a,92,a,60
R 68,4,50176
v_cndmask_b32_e64 v25, v12, v25, s[58:59]
s_waitcnt lgkmcnt(3)
v_mfma_f32_16x16x32_bf16 v[40:43], a[96:99], a[0:3], v[72:75]
C 6,12,s33,1024
v_cndmask_b32_e64 v26, v12, v26, s[60:61]
v_mfma_f32_16x16x32_bf16 v[44:47], a[96:99], a[4:7], v[76:79]
R 72,4,51200
v_cndmask_b32_e64 v27, v12, v27, s[62:63]
M v,40,a,100,a,8
R 76,4,52224
v_cndmask_b32_e64 v20, v12, v20, s[40:41]
M v,44,a,100,a,12
v_cndmask_b32_e64 v21, v12, v21, s[42:43]
v_cndmask_b32_e64 v22, v12, v22, s[44:45]
M v,40,a,104,a,16
R 80,4,53248
v_cndmask_b32_e64 v23, v12, v23, s[46:47]
M v,44,a,104,a,20
v_cndmask_b32_e64 v28, v12, v28, s[48:49]
v_cndmask_b32_e64 v29, v12, v29, s[50:51]
M v,40,a,108,a,24
R 84,4,54272
v_cndmask_b32_e64 v30, v12, v30, s[52:53]
M v,44,a,108,a,28
R 88,4,55296
C 6,12,s33,2048
M v,40,a,112,a,32
v_cndmask_b32_e64 v31, v12, v31, s[54:55]
M v,44,a,112,a,36
R 92,4,56320
M v,40,a,116,a,40
v_exp_f32 v64, v16
M v,44,a,116,a,44
R 96,4,57344
M v,40,a,120,a,48
v_exp_f32 v65, v17
M v,44,a,120,a,52
R 100,4,58368
s_waitcnt lgkmcnt(3)
M v,40,a,124,a,56
R 104,4,59392
M v,44,a,124,a,60
C 6,12,s33,3072
M v,128,a,64,v,56
R 108,4,60416
M v,132,a,64,v,60
v_exp_f32 v66, v18
M v,136,a,68,v,56
R 112,4,61440
v_add_f32 v80, v84, v64
M v,140,a,68,v,60
R 116,4,62464
v_add_f32 v81, v85, v65
M v,144,a,72,v,56
v_cvt_pk_bf16_f32 v48, v64, v65
M v,148,a,72,v,60
R 120,4,63488
M v,152,a,76,v,56
s_add_u32 s33, s33, 0x8000
M v,156,a,76,v,60
R 124,4,64512
M v,160,a,80,v,56
v_exp_f32 v67, v19
M v,164,a,80,v,60
v_exp_f32 v68, v24
M v,168,a,84,v,56
v_add_f32 v80, v80, v66
v_add_f32 v81, v81, v67
M v,172,a,84,v,60
v_cvt_pk_bf16_f32 v49, v66, v67
M v,176,a,88,v,56
v_exp_f32 v69, v25
M v,180,a,88,v,60
v_exp_f32 v70, v26
s_waitcnt lgkmcnt(0)
M v,184,a,92,v,56
v_add_f32 v80, v80, v68
v_add_f32 v81, v81, v69
M v,188,a,92,v,60
v_cvt_pk_bf16_f32 v50, v68, v69
M v,192,a,96,v,56
s_waitcnt vmcnt(12) lgkmcnt(0)
s_barrier
M v,196,a,96,v,60
R 64,3,0
R 68,3,1024
M v,200,a,100,v,56
R 72,3,2048
R 76,3,3072
M v,204,a,100,v,60
R 80,3,4096
R 84,3,5120
M v,208,a,104,v,56
R 88,3,6144
R 92,3,7168
M v,212,a,104,v,60
v_exp_f32 v71, v27
M v,216,a,108,v,56
s_nop 0
v_add_f32 v80, v80, v70
M v,220,a,108,v,60
v_add_f32 v81, v81, v71
v_cvt_pk_bf16_f32 v51, v70, v71
M v,224,a,112,v,56
v_exp_f32 v64, v20
M v,228,a,112,v,60
v_exp_f32 v65, v21
M v,232,a,116,v,56
v_exp_f32 v66, v22
M v,236,a,116,v,60
v_add_f32 v82, v86, v64
v_add_f32 v83, v87, v65
M v,240,a,120,v,56
v_cvt_pk_bf16_f32 v52, v64, v65
M v,244,a,120,v,60
v_exp_f32 v67, v23
M v,248,a,124,v,56
v_exp_f32 v68, v28
M v,252,a,124,v,60
v_add_f32 v82, v82, v66
v_add_f32 v83, v83, v67
v_cvt_pk_bf16_f32 v53, v66, v67
v_exp_f32 v69, v29
v_exp_f32 v70, v30
v_add_f32 v82, v82, v68
v_add_f32 v83, v83, v69
v_cvt_pk_bf16_f32 v54, v68, v69
v_exp_f32 v71, v31
s_nop 0
v_add_f32 v82, v82, v70
v_add_f32 v83, v83, v71
v_cvt_pk_bf16_f32 v55, v70, v71
v_max3_f32 v14, v80, v81, v82
v_max_f32 v14, v14, v83
v_cmp_lt_f32 vcc, s37, v14
s_nop 0
s_cbranch_vccnz RARE_am0
BACK_am0:
K2_am1:
s_waitcnt lgkmcnt(0)
v_mfma_f32_16x16x32_bf16 v[16:19], a[64:67], a[0:3], v[72:75]
R 96,3,8192
v_subrev_u32 v11, 32, v10
v_mfma_f32_16x16x32_bf16 v[20:23], a[64:67], a[4:7], v[76:79]
R 100,3,9216
s_add_u32 m0, s32, 98304
M v,16,a,68,a,8
v_cmp_le_i32_e64 s[40:41], -16, v11
v_cmp_le_i32_e64 s[42:43], -15, v11
M v,20,a,68,a,12
R 104,3,10240
v_cmp_le_i32_e64 s[44:45], -14, v11
M v,16,a,72,a,16
s_add_u32 s35, s39, 0
v_cmp_le_i32_e64 s[46:47], -13, v11
M v,20,a,72,a,20
R 108,3,11264
v_cmp_le_i32_e64 s[48:49], 0, v11
M v,16,a,76,a,24
R 112,3,12288
v_cmp_le_i32_e64 s[50:51], 1, v11
M v,20,a,76,a,28
v_cmp_le_i32_e64 s[52:53], 2, v11
v_cmp_le_i32_e64 s[54:55], 3, v11
M v,16,a,80,a,32
R 116,3,13312
L 112,80,s35,0
M v,20,a,80,a,36
v_cmp_le_i32_e64 s[56:57], 16, v11
v_cmp_le_i32_e64 s[58:59], 17, v11
M v,16,a,84,a,40
R 120,3,14336
v_cmp_le_i32_e64 s[60:61], 18, v11
M v,20,a,84,a,44
R 124,3,15360
v_cmp_le_i32_e64 s[62:63], 19, v11
M v,16,a,88,a,48
L 113,80,s35,1024
v_cndmask_b32_e64 v32, v12, v32, s[48:49]
M v,20,a,88,a,52
R 64,3,16384
v_cndmask_b32_e64 v33, v12, v33, s[50:51]
M v,16,a,92,a,56
v_cndmask_b32_e64 v34, v12, v34, s[52:53]
v_cndmask_b32_e64 v35, v12, v35, s[54:55]
M v,20,a,92,a,60
R 68,3,17408
v_cndmask_b32_e64 v40, v12, v40, s[56:57]
s_waitcnt lgkmcnt(3)
v_mfma_f32_16x16x32_bf16 v[24:27], a[96:99], a[0:3], v[72:75]
L 114,80,s35,2048
v_cndmask_b32_e64 v41, v12, v41, s[58:59]
v_mfma_f32_16x16x32_bf16 v[28:31], a[96:99], a[4:7], v[76:79]
R 72,3,18432
v_cndmask_b32_e64 v42, v12, v42, s[60:61]
M v,24,a,100,a,8
R 76,3,19456
v_cndmask_b32_e64 v43, v12, v43, s[62:63]
M v,28,a,100,a,12
L 115,80,s35,3072
v_cndmask_b32_e64 v36, v12, v36, s[40:41]
M v,24,a,104,a,16
R 80,3,20480
v_cndmask_b32_e64 v37, v12, v37, s[42:43]
M v,28,a,104,a,20
v_cndmask_b32_e64 v38, v12, v38, s[44:45]
v_cndmask_b32_e64 v39, v12, v39, s[46:47]
M v,24,a,108,a,24
R 84,3,21504
v_cndmask_b32_e64 v44, v12, v44, s[48:49]
M v,28,a,108,a,28
R 88,3,22528
s_add_u32 m0, s32, 114688
M v,24,a,112,a,32
v_cndmask_b32_e64 v45, v12, v45, s[50:51]
v_cndmask_b32_e64 v46, v12, v46, s[52:53]
M v,28,a,112,a,36
R 92,3,23552
v_cndmask_b32_e64 v47, v12, v47, s[54:55]
M v,24,a,116,a,40
v_exp_f32 v64, v32
M v,28,a,116,a,44
R 96,3,24576
C 6,12,s33,0
M v,24,a,120,a,48
v_exp_f32 v65, v33
M v,28,a,120,a,52
R 100,3,25600
s_waitcnt lgkmcnt(3)
M v,24,a,124,a,56
R 104,3,26624
M v,28,a,124,a,60
C 6,12,s33,1024
M v,128,a,64,v,48
R 108,3,27648
M v,132,a,64,v,52
v_exp_f32 v66, v34
M v,136,a,68,v,48
R 112,3,28672
C 6,12,s33,2048
M v,140,a,68,v,52
R 116,3,29696
v_add_f32 v84, v80, v64
M v,144,a,72,v,48
v_add_f32 v85, v81, v65
v_cvt_pk_bf16_f32 v56, v64, v65
M v,148,a,72,v,52
R 120,3,30720
M v,152,a,76,v,48
C 6,12,s33,3072
M v,156,a,76,v,52
R 124,3,31744
M v,160,a,80,v,48
v_exp_f32 v67, v35
M v,164,a,80,v,52
v_exp_f32 v68, v40
M v,168,a,84,v,48
s_add_u32 s33, s33, 0x8000
v_add_f32 v84, v84, v66
M v,172,a,84,v,52
v_add_f32 v85, v85, v67
v_cvt_pk_bf16_f32 v57, v66, v67
M v,176,a,88,v,48
v_exp_f32 v69, v41
M v,180,a,88,v,52
v_exp_f32 v70, v42
s_waitcnt lgkmcnt(0)
M v,184,a,92,v,48
v_add_f32 v84, v84, v68
v_add_f32 v85, v85, v69
M v,188,a,92,v,52
v_cvt_pk_bf16_f32 v58, v68, v69
M v,192,a,96,v,48
s_waitcnt vmcnt(12) lgkmcnt(0)
s_barrier
s_cmp_eq_u32 s90, 0
s_cbranch_scc1 PS_am1
s_mov_b64 exec, 1
v_mov_b32 v127, s66
buffer_store_dword v127, off, s[12:15], s90 sc1
s_mov_b64 exec, -1
s_mov_b32 s90, 0
PS_am1:
M v,196,a,96,v,52
R 64,3,32768
R 68,3,33792
M v,200,a,100,v,48
R 72,3,34816
R 76,3,35840
M v,204,a,100,v,52
R 80,3,36864
R 84,3,37888
M v,208,a,104,v,48
R 88,3,38912
R 92,3,39936
M v,212,a,104,v,52
v_exp_f32 v71, v43
M v,216,a,108,v,48
s_nop 0
v_add_f32 v84, v84, v70
M v,220,a,108,v,52
v_add_f32 v85, v85, v71
v_cvt_pk_bf16_f32 v59, v70, v71
M v,224,a,112,v,48
v_exp_f32 v64, v36
M v,228,a,112,v,52
v_exp_f32 v65, v37
M v,232,a,116,v,48
v_exp_f32 v66, v38
M v,236,a,116,v,52
v_add_f32 v86, v82, v64
v_add_f32 v87, v83, v65
M v,240,a,120,v,48
v_cvt_pk_bf16_f32 v60, v64, v65
M v,244,a,120,v,52
v_exp_f32 v67, v39
M v,248,a,124,v,48
v_exp_f32 v68, v44
M v,252,a,124,v,52
v_add_f32 v86, v86, v66
v_add_f32 v87, v87, v67
v_cvt_pk_bf16_f32 v61, v66, v67
v_exp_f32 v69, v45
v_exp_f32 v70, v46
v_add_f32 v86, v86, v68
v_add_f32 v87, v87, v69
v_cvt_pk_bf16_f32 v62, v68, v69
v_exp_f32 v71, v47
s_nop 0
v_add_f32 v86, v86, v70
v_add_f32 v87, v87, v71
v_cvt_pk_bf16_f32 v63, v70, v71
v_max3_f32 v14, v84, v85, v86
v_max_f32 v14, v14, v87
v_cmp_lt_f32 vcc, s37, v14
s_nop 0
s_cbranch_vccnz RARE_am1
BACK_am1:
s_waitcnt lgkmcnt(0)
v_mfma_f32_16x16x32_bf16 v[32:35], a[64:67], a[0:3], v[72:75]
R 96,3,40960
v_subrev_u32 v11, 64, v10
v_mfma_f32_16x16x32_bf16 v[36:39], a[64:67], a[4:7], v[76:79]
R 100,3,41984
s_add_u32 m0, s32, 0
M v,32,a,68,a,8
v_cmp_le_i32_e64 s[40:41], -16, v11
v_cmp_le_i32_e64 s[42:43], -15, v11
M v,36,a,68,a,12
R 104,3,43008
v_cmp_le_i32_e64 s[44:45], -14, v11
M v,32,a,72,a,16
s_add_u32 s35, s38, 0
v_cmp_le_i32_e64 s[46:47], -13, v11
M v,36,a,72,a,20
R 108,3,44032
v_cmp_le_i32_e64 s[48:49], 0, v11
M v,32,a,76,a,24
R 112,3,45056
v_cmp_le_i32_e64 s[50:51], 1, v11
M v,36,a,76,a,28
v_cmp_le_i32_e64 s[52:53], 2, v11
v_cmp_le_i32_e64 s[54:55], 3, v11
M v,32,a,80,a,32
R 116,3,46080
L 112,76,s35,0
M v,36,a,80,a,36
v_cmp_le_i32_e64 s[56:57], 16, v11
v_cmp_le_i32_e64 s[58:59], 17, v11
M v,32,a,84,a,40
R 120,3,47104
v_cmp_le_i32_e64 s[60:61], 18, v11
M v,36,a,84,a,44
R 124,3,48128
v_cmp_le_i32_e64 s[62:63], 19, v11
M v,32,a,88,a,48
L 113,76,s35,1024
v_cndmask_b32_e64 v16, v12, v16, s[48:49]
M v,36,a,88,a,52
R 64,3,49152
v_cndmask_b32_e64 v17, v12, v17, s[50:51]
M v,32,a,92,a,56
v_cndmask_b32_e64 v18, v12, v18, s[52:53]
v_cndmask_b32_e64 v19, v12, v19, s[54:55]
M v,36,a,92,a,60
R 68,3,50176
v_cndmask_b32_e64 v24, v12, v24, s[56:57]
s_waitcnt lgkmcnt(3)
v_mfma_f32_16x16x32_bf16 v[40:43], a[96:99], a[0:3], v[72:75]
L 114,76,s35,2048
v_cndmask_b32_e64 v25, v12, v25, s[58:59]
v_mfma_f32_16x16x32_bf16 v[44:47], a[96:99], a[4:7], v[76:79]
R 72,3,51200
v_cndmask_b32_e64 v26, v12, v26, s[60:61]
M v,40,a,100,a,8
R 76,3,52224
v_cndmask_b32_e64 v27, v12, v27, s[62:63]
M v,44,a,100,a,12
L 115,76,s35,3072
v_cndmask_b32_e64 v20, v12, v20, s[40:41]
M v,40,a,104,a,16
R 80,3,53248
v_cndmask_b32_e64 v21, v12, v21, s[42:43]
M v,44,a,104,a,20
v_cndmask_b32_e64 v22, v12, v22, s[44:45]
v_cndmask_b32_e64 v23, v12, v23, s[46:47]
M v,40,a,108,a,24
R 84,3,54272
v_cndmask_b32_e64 v28, v12, v28, s[48:49]
M v,44,a,108,a,28
R 88,3,55296
s_add_u32 m0, s32, 16384
M v,40,a,112,a,32
v_cndmask_b32_e64 v29, v12, v29, s[50:51]
v_cndmask_b32_e64 v30, v12, v30, s[52:53]
M v,44,a,112,a,36
R 92,3,56320
v_cndmask_b32_e64 v31, v12, v31, s[54:55]
M v,40,a,116,a,40
v_exp_f32 v64, v16
M v,44,a,116,a,44
R 96,3,57344
s_add_u32 s35, s38, 114688
M v,40,a,120,a,48
v_exp_f32 v65, v17
M v,44,a,120,a,52
R 100,3,58368
s_waitcnt lgkmcnt(3)
M v,40,a,124,a,56
R 104,3,59392
M v,44,a,124,a,60
L 112,76,s35,0
M v,128,a,64,v,56
R 108,3,60416
M v,132,a,64,v,60
v_exp_f32 v66, v18
M v,136,a,68,v,56
R 112,3,61440
L 113,76,s35,1024
M v,140,a,68,v,60
R 116,3,62464
v_add_f32 v80, v84, v64
M v,144,a,72,v,56
v_add_f32 v81, v85, v65
v_cvt_pk_bf16_f32 v48, v64, v65
M v,148,a,72,v,60
R 120,3,63488
M v,152,a,76,v,56
L 114,76,s35,2048
M v,156,a,76,v,60
R 124,3,64512
M v,160,a,80,v,56
v_exp_f32 v67, v19
M v,164,a,80,v,60
v_exp_f32 v68, v24
M v,168,a,84,v,56
L 115,76,s35,3072
v_add_f32 v80, v80, v66
M v,172,a,84,v,60
v_add_f32 v81, v81, v67
v_cvt_pk_bf16_f32 v49, v66, v67
M v,176,a,88,v,56
v_exp_f32 v69, v25
M v,180,a,88,v,60
v_exp_f32 v70, v26
s_waitcnt lgkmcnt(0)
M v,184,a,92,v,56
v_add_f32 v80, v80, v68
v_add_f32 v81, v81, v69
M v,188,a,92,v,60
v_cvt_pk_bf16_f32 v50, v68, v69
M v,192,a,96,v,56
s_waitcnt vmcnt(16) lgkmcnt(0)
s_barrier
M v,196,a,96,v,60
R 64,4,16384
R 68,4,17408
M v,200,a,100,v,56
R 72,4,18432
R 76,4,19456
M v,204,a,100,v,60
R 80,4,20480
R 84,4,21504
M v,208,a,104,v,56
R 88,4,22528
R 92,4,23552
M v,212,a,104,v,60
v_exp_f32 v71, v27
M v,216,a,108,v,56
s_nop 0
v_add_f32 v80, v80, v70
M v,220,a,108,v,60
v_add_f32 v81, v81, v71
v_cvt_pk_bf16_f32 v51, v70, v71
M v,224,a,112,v,56
v_exp_f32 v64, v20
M v,228,a,112,v,60
v_exp_f32 v65, v21
M v,232,a,116,v,56
v_exp_f32 v66, v22
M v,236,a,116,v,60
v_add_f32 v82, v86, v64
v_add_f32 v83, v87, v65
M v,240,a,120,v,56
v_cvt_pk_bf16_f32 v52, v64, v65
M v,244,a,120,v,60
v_exp_f32 v67, v23
M v,248,a,124,v,56
v_exp_f32 v68, v28
M v,252,a,124,v,60
v_add_f32 v82, v82, v66
v_add_f32 v83, v83, v67
v_cvt_pk_bf16_f32 v53, v66, v67
v_exp_f32 v69, v29
v_exp_f32 v70, v30
v_add_f32 v82, v82, v68
v_add_f32 v83, v83, v69
v_cvt_pk_bf16_f32 v54, v68, v69
v_exp_f32 v71, v31
s_nop 0
v_add_f32 v82, v82, v70
v_add_f32 v83, v83, v71
v_cvt_pk_bf16_f32 v55, v70, v71
v_max3_f32 v14, v80, v81, v82
v_max_f32 v14, v14, v83
v_cmp_lt_f32 vcc, s37, v14
s_nop 0
s_cbranch_vccnz RARE_am2
BACK_am2:
s_waitcnt lgkmcnt(0)
M v,128,a,64,v,48
R 96,4,24576
v_subrev_u32 v11, 96, v10
M v,132,a,64,v,52
R 100,4,25600
s_add_u32 m0, s32, 32768
M v,136,a,68,v,48
R 104,4,26624
s_add_u32 s35, s39, 128
M v,140,a,68,v,52
R 108,4,27648
L 112,80,s35,0
M v,144,a,72,v,48
R 112,4,28672
L 113,80,s35,1024
M v,148,a,72,v,52
R 116,4,29696
L 114,80,s35,2048
M v,152,a,76,v,48
R 120,4,30720
L 115,80,s35,3072
M v,156,a,76,v,52
R 124,4,31744
s_add_u32 m0, s32, 49152
M v,160,a,80,v,48
s_add_u32 s35, s38, 128
v_cmp_le_i32_e64 s[40:41], -16, v11
M v,164,a,80,v,52
L 112,76,s35,0
v_cmp_le_i32_e64 s[42:43], -15, v11
M v,168,a,84,v,48
L 113,76,s35,1024
v_cmp_le_i32_e64 s[44:45], -14, v11
M v,172,a,84,v,52
L 114,76,s35,2048
v_cmp_le_i32_e64 s[46:47], -13, v11
M v,176,a,88,v,48
L 115,76,s35,3072
v_cmp_le_i32_e64 s[48:49], 0, v11
M v,180,a,88,v,52
v_cmp_le_i32_e64 s[50:51], 1, v11
v_cmp_le_i32_e64 s[52:53], 2, v11
M v,184,a,92,v,48
v_cmp_le_i32_e64 s[54:55], 3, v11
v_cmp_le_i32_e64 s[56:57], 16, v11
M v,188,a,92,v,52
v_cmp_le_i32_e64 s[58:59], 17, v11
v_cmp_le_i32_e64 s[60:61], 18, v11
s_waitcnt lgkmcnt(0)
M v,192,a,96,v,48
s_waitcnt vmcnt(16) lgkmcnt(0)
s_barrier
M v,196,a,96,v,52
R 64,4,49152
R 68,4,50176
M v,200,a,100,v,48
R 72,4,51200
R 76,4,52224
M v,204,a,100,v,52
R 80,4,53248
R 84,4,54272
M v,208,a,104,v,48
R 88,4,55296
R 92,4,56320
M v,212,a,104,v,52
v_cmp_le_i32_e64 s[62:63], 19, v11
v_cndmask_b32_e64 v32, v12, v32, s[48:49]
M v,216,a,108,v,48
v_cndmask_b32_e64 v33, v12, v33, s[50:51]
v_cndmask_b32_e64 v34, v12, v34, s[52:53]
M v,220,a,108,v,52
v_cndmask_b32_e64 v35, v12, v35, s[54:55]
v_cndmask_b32_e64 v40, v12, v40, s[56:57]
M v,224,a,112,v,48
v_cndmask_b32_e64 v41, v12, v41, s[58:59]
v_cndmask_b32_e64 v42, v12, v42, s[60:61]
M v,228,a,112,v,52
v_cndmask_b32_e64 v43, v12, v43, s[62:63]
v_cndmask_b32_e64 v36, v12, v36, s[40:41]
M v,232,a,116,v,48
v_cndmask_b32_e64 v37, v12, v37, s[42:43]
v_cndmask_b32_e64 v38, v12, v38, s[44:45]
M v,236,a,116,v,52
v_cndmask_b32_e64 v39, v12, v39, s[46:47]
v_cndmask_b32_e64 v44, v12, v44, s[48:49]
M v,240,a,120,v,48
v_cndmask_b32_e64 v45, v12, v45, s[50:51]
v_cndmask_b32_e64 v46, v12, v46, s[52:53]
M v,244,a,120,v,52
v_cndmask_b32_e64 v47, v12, v47, s[54:55]
M v,248,a,124,v,48
v_exp_f32 v64, v32
M v,252,a,124,v,52
v_exp_f32 v65, v33
v_exp_f32 v66, v34
v_add_f32 v84, v80, v64
v_add_f32 v85, v81, v65
v_cvt_pk_bf16_f32 v56, v64, v65
v_exp_f32 v67, v35
v_exp_f32 v68, v40
v_add_f32 v84, v84, v66
v_add_f32 v85, v85, v67
v_cvt_pk_bf16_f32 v57, v66, v67
v_exp_f32 v69, v41
v_exp_f32 v70, v42
v_add_f32 v84, v84, v68
v_add_f32 v85, v85, v69
v_cvt_pk_bf16_f32 v58, v68, v69
v_exp_f32 v71, v43
s_nop 0
v_add_f32 v84, v84, v70
v_add_f32 v85, v85, v71
v_cvt_pk_bf16_f32 v59, v70, v71
v_exp_f32 v64, v36
v_exp_f32 v65, v37
v_exp_f32 v66, v38
v_add_f32 v86, v82, v64
v_add_f32 v87, v83, v65
v_cvt_pk_bf16_f32 v60, v64, v65
v_exp_f32 v67, v39
v_exp_f32 v68, v44
v_add_f32 v86, v86, v66
v_add_f32 v87, v87, v67
v_cvt_pk_bf16_f32 v61, v66, v67
v_exp_f32 v69, v45
v_exp_f32 v70, v46
v_add_f32 v86, v86, v68
v_add_f32 v87, v87, v69
v_cvt_pk_bf16_f32 v62, v68, v69
v_exp_f32 v71, v47
s_nop 0
v_add_f32 v86, v86, v70
v_add_f32 v87, v87, v71
v_cvt_pk_bf16_f32 v63, v70, v71
v_max3_f32 v14, v84, v85, v86
v_max_f32 v14, v14, v87
v_cmp_lt_f32 vcc, s37, v14
s_nop 0
s_cbranch_vccnz RARE_am3
BACK_am3:
s_lshl_b32 s42, s25, 4
s_add_u32 s42, s42, s26
s_lshl_b32 s42, s42, 2
s_add_u32 s42, s42, s24
s_mul_i32 s42, s42, 28672
s_add_u32 s42, s42, 36700160
s_waitcnt lgkmcnt(0)
M v,128,a,64,v,56
R 96,4,57344
v_add_f32 v72, v84, v85
M v,132,a,64,v,60
R 100,4,58368
s_add_u32 m0, s32, 65536
M v,136,a,68,v,56
v_mov_b32 v13, v72
s_nop 1
M v,140,a,68,v,60
R 104,4,59392
v_permlane32_swap_b32 v72, v13
M v,144,a,72,v,56
s_add_u32 s35, s38, 114816
s_nop 1
M v,148,a,72,v,60
R 108,4,60416
v_add_f32 v72, v72, v13
M v,152,a,76,v,56
R 112,4,61440
v_mov_b32 v13, v72
M v,156,a,76,v,60
s_nop 1
v_permlane16_swap_b32 v72, v13
M v,160,a,80,v,56
R 116,4,62464
L 112,76,s35,0
M v,164,a,80,v,60
s_nop 1
v_add_f32 v72, v72, v13
M v,168,a,84,v,56
R 120,4,63488
v_rcp_f32 v72, v72
M v,172,a,84,v,60
R 124,4,64512
s_nop 0
M v,176,a,88,v,56
L 113,76,s35,1024
v_mul_f32 v72, v72, v8
M v,180,a,88,v,60
T 64,120,32768
T 66,120,34816
M v,184,a,92,v,56
v_add_f32 v74, v86, v87
v_mov_b32 v13, v74
M v,188,a,92,v,60
T 68,121,32768
T 70,121,34816
s_waitcnt lgkmcnt(5)
M v,192,a,96,v,56
L 114,76,s35,2048
s_nop 1
M v,196,a,96,v,60
T 72,122,32768
T 74,122,34816
M v,200,a,100,v,56
T 76,123,32768
T 78,123,34816
M v,204,a,100,v,60
L 115,76,s35,3072
v_permlane32_swap_b32 v74, v13
M v,208,a,104,v,56
T 80,120,36864
T 82,120,38912
M v,212,a,104,v,60
s_nop 1
v_add_f32 v74, v74, v13
M v,216,a,108,v,56
T 84,121,36864
T 86,121,38912
M v,220,a,108,v,60
T 88,122,36864
T 90,122,38912
M v,224,a,112,v,56
s_add_u32 m0, s32, 81920
v_mov_b32 v13, v74
M v,228,a,112,v,60
T 92,123,36864
T 94,123,38912
M v,232,a,116,v,56
s_nop 1
v_permlane16_swap_b32 v74, v13
M v,236,a,116,v,60
T 96,120,40960
T 98,120,43008
M v,240,a,120,v,56
s_add_u32 s35, s39, 256
s_nop 1
M v,244,a,120,v,60
T 100,121,40960
T 102,121,43008
s_waitcnt lgkmcnt(6)
M v,248,a,124,v,56
T 104,122,40960
T 106,122,43008
M v,252,a,124,v,60
L 112,80,s35,0
v_add_f32 v74, v74, v13
Z v,16,a,64,a,128
T 108,123,40960
T 110,123,43008
Z v,20,a,64,a,132
v_rcp_f32 v74, v74
s_nop 0
Z v,24,a,68,a,128
T 112,120,45056
T 114,120,47104
Z v,28,a,68,a,132
T 116,121,45056
T 118,121,47104
Z v,32,a,72,a,128
L 113,80,s35,1024
v_mul_f32 v74, v74, v9
Z v,36,a,72,a,132
T 120,122,45056
T 122,122,47104
Z v,40,a,76,a,128
L 114,80,s35,2048
v_mul_f32 v128, v72, v128
Z v,44,a,76,a,132
T 124,123,45056
T 126,123,47104
M v,16,a,80,a,136
v_mul_f32 v129, v72, v129
v_mul_f32 v130, v72, v130
M v,20,a,80,a,140
v_mul_f32 v131, v72, v131
v_mul_f32 v136, v72, v136
M v,24,a,84,a,136
L 115,80,s35,3072
v_mul_f32 v137, v72, v137
M v,28,a,84,a,140
v_mul_f32 v138, v72, v138
v_mul_f32 v139, v72, v139
M v,32,a,88,a,136
v_cvt_pk_bf16_f32 v128, v128, v129
v_cvt_pk_bf16_f32 v129, v130, v131
M v,36,a,88,a,140
v_cvt_pk_bf16_f32 v130, v136, v137
v_cvt_pk_bf16_f32 v131, v138, v139
s_waitcnt lgkmcnt(0)
M v,40,a,92,a,136
v_mul_f32 v132, v74, v132
v_mul_f32 v133, v74, v133
M v,44,a,92,a,140
v_mul_f32 v134, v74, v134
v_mul_f32 v135, v74, v135
M v,16,a,96,a,144
s_waitcnt vmcnt(16) lgkmcnt(0)
s_barrier
M v,20,a,96,a,148
T 64,116,0
T 66,116,2048
M v,24,a,100,a,144
T 68,117,0
T 70,117,2048
M v,28,a,100,a,148
T 72,118,0
T 74,118,2048
M v,32,a,104,a,144
T 76,119,0
T 78,119,2048
M v,36,a,104,a,148
T 80,116,4096
T 82,116,6144
M v,40,a,108,a,144
T 84,117,4096
T 86,117,6144
M v,44,a,108,a,148
v_mul_f32 v140, v74, v140
v_mul_f32 v141, v74, v141
M v,16,a,112,a,152
v_mul_f32 v142, v74, v142
v_mul_f32 v143, v74, v143
M v,20,a,112,a,156
v_cvt_pk_bf16_f32 v132, v132, v133
v_cvt_pk_bf16_f32 v133, v134, v135
M v,24,a,116,a,152
v_cvt_pk_bf16_f32 v134, v140, v141
v_cvt_pk_bf16_f32 v135, v142, v143
M v,28,a,116,a,156
v_mul_f32 v144, v72, v144
v_mul_f32 v145, v72, v145
M v,32,a,120,a,152
v_mul_f32 v146, v72, v146
v_mul_f32 v147, v72, v147
M v,36,a,120,a,156
v_mul_f32 v152, v72, v152
v_mul_f32 v153, v72, v153
M v,40,a,124,a,152
v_mul_f32 v154, v72, v154
v_mul_f32 v155, v72, v155
M v,44,a,124,a,156
v_cvt_pk_bf16_f32 v144, v144, v145
v_cvt_pk_bf16_f32 v145, v146, v147
v_cvt_pk_bf16_f32 v146, v152, v153
v_cvt_pk_bf16_f32 v147, v154, v155
v_mul_f32 v148, v74, v148
v_mul_f32 v149, v74, v149
v_mul_f32 v150, v74, v150
v_mul_f32 v151, v74, v151
v_mul_f32 v156, v74, v156
v_mul_f32 v157, v74, v157
v_mul_f32 v158, v74, v158
v_mul_f32 v159, v74, v159
v_cvt_pk_bf16_f32 v148, v148, v149
v_cvt_pk_bf16_f32 v149, v150, v151
v_cvt_pk_bf16_f32 v150, v156, v157
v_cvt_pk_bf16_f32 v151, v158, v159
v_mul_f32 v160, v72, v160
v_mul_f32 v161, v72, v161
v_mul_f32 v162, v72, v162
v_mul_f32 v163, v72, v163
v_mul_f32 v168, v72, v168
v_mul_f32 v169, v72, v169
v_mul_f32 v170, v72, v170
v_mul_f32 v171, v72, v171
v_cvt_pk_bf16_f32 v160, v160, v161
v_cvt_pk_bf16_f32 v161, v162, v163
v_cvt_pk_bf16_f32 v162, v168, v169
v_cvt_pk_bf16_f32 v163, v170, v171
v_mul_f32 v164, v74, v164
v_mul_f32 v165, v74, v165
v_mul_f32 v166, v74, v166
v_mul_f32 v167, v74, v167
v_mul_f32 v172, v74, v172
v_mul_f32 v173, v74, v173
v_mul_f32 v174, v74, v174
v_mul_f32 v175, v74, v175
v_cvt_pk_bf16_f32 v164, v164, v165
v_cvt_pk_bf16_f32 v165, v166, v167
v_cvt_pk_bf16_f32 v166, v172, v173
v_cvt_pk_bf16_f32 v167, v174, v175
v_mul_f32 v176, v72, v176
v_mul_f32 v177, v72, v177
v_mul_f32 v178, v72, v178
v_mul_f32 v179, v72, v179
v_mul_f32 v184, v72, v184
v_mul_f32 v185, v72, v185
v_mul_f32 v186, v72, v186
v_mul_f32 v187, v72, v187
v_cvt_pk_bf16_f32 v176, v176, v177
v_cvt_pk_bf16_f32 v177, v178, v179
v_cvt_pk_bf16_f32 v178, v184, v185
v_cvt_pk_bf16_f32 v179, v186, v187
v_mul_f32 v180, v74, v180
v_mul_f32 v181, v74, v181
v_mul_f32 v182, v74, v182
v_mul_f32 v183, v74, v183
v_mul_f32 v188, v74, v188
v_mul_f32 v189, v74, v189
v_mul_f32 v190, v74, v190
v_mul_f32 v191, v74, v191
v_cvt_pk_bf16_f32 v180, v180, v181
v_cvt_pk_bf16_f32 v181, v182, v183
v_cvt_pk_bf16_f32 v182, v188, v189
v_cvt_pk_bf16_f32 v183, v190, v191
v_mul_f32 v192, v72, v192
v_mul_f32 v193, v72, v193
v_mul_f32 v194, v72, v194
v_mul_f32 v195, v72, v195
v_mul_f32 v200, v72, v200
v_mul_f32 v201, v72, v201
v_mul_f32 v202, v72, v202
v_mul_f32 v203, v72, v203
v_cvt_pk_bf16_f32 v192, v192, v193
v_cvt_pk_bf16_f32 v193, v194, v195
v_cvt_pk_bf16_f32 v194, v200, v201
v_cvt_pk_bf16_f32 v195, v202, v203
v_mul_f32 v196, v74, v196
v_mul_f32 v197, v74, v197
v_mul_f32 v198, v74, v198
v_mul_f32 v199, v74, v199
v_mul_f32 v204, v74, v204
v_mul_f32 v205, v74, v205
v_mul_f32 v206, v74, v206
v_mul_f32 v207, v74, v207
v_cvt_pk_bf16_f32 v196, v196, v197
v_cvt_pk_bf16_f32 v197, v198, v199
v_cvt_pk_bf16_f32 v198, v204, v205
v_cvt_pk_bf16_f32 v199, v206, v207
v_mul_f32 v208, v72, v208
v_mul_f32 v209, v72, v209
v_mul_f32 v210, v72, v210
v_mul_f32 v211, v72, v211
v_mul_f32 v216, v72, v216
v_mul_f32 v217, v72, v217
v_mul_f32 v218, v72, v218
v_mul_f32 v219, v72, v219
v_cvt_pk_bf16_f32 v208, v208, v209
v_cvt_pk_bf16_f32 v209, v210, v211
v_cvt_pk_bf16_f32 v210, v216, v217
v_cvt_pk_bf16_f32 v211, v218, v219
v_mul_f32 v212, v74, v212
v_mul_f32 v213, v74, v213
v_mul_f32 v214, v74, v214
v_mul_f32 v215, v74, v215
v_mul_f32 v220, v74, v220
v_mul_f32 v221, v74, v221
v_mul_f32 v222, v74, v222
v_mul_f32 v223, v74, v223
v_cvt_pk_bf16_f32 v212, v212, v213
v_cvt_pk_bf16_f32 v213, v214, v215
v_cvt_pk_bf16_f32 v214, v220, v221
v_cvt_pk_bf16_f32 v215, v222, v223
v_mul_f32 v224, v72, v224
v_mul_f32 v225, v72, v225
v_mul_f32 v226, v72, v226
v_mul_f32 v227, v72, v227
v_mul_f32 v232, v72, v232
v_mul_f32 v233, v72, v233
v_mul_f32 v234, v72, v234
v_mul_f32 v235, v72, v235
v_cvt_pk_bf16_f32 v224, v224, v225
v_cvt_pk_bf16_f32 v225, v226, v227
v_cvt_pk_bf16_f32 v226, v232, v233
v_cvt_pk_bf16_f32 v227, v234, v235
v_mul_f32 v228, v74, v228
v_mul_f32 v229, v74, v229
v_mul_f32 v230, v74, v230
v_mul_f32 v231, v74, v231
v_mul_f32 v236, v74, v236
v_mul_f32 v237, v74, v237
v_mul_f32 v238, v74, v238
v_mul_f32 v239, v74, v239
v_cvt_pk_bf16_f32 v228, v228, v229
v_cvt_pk_bf16_f32 v229, v230, v231
v_cvt_pk_bf16_f32 v230, v236, v237
v_cvt_pk_bf16_f32 v231, v238, v239
v_mul_f32 v240, v72, v240
v_mul_f32 v241, v72, v241
v_mul_f32 v242, v72, v242
v_mul_f32 v243, v72, v243
v_mul_f32 v248, v72, v248
v_mul_f32 v249, v72, v249
v_mul_f32 v250, v72, v250
v_mul_f32 v251, v72, v251
v_cvt_pk_bf16_f32 v240, v240, v241
v_cvt_pk_bf16_f32 v241, v242, v243
v_cvt_pk_bf16_f32 v242, v248, v249
v_cvt_pk_bf16_f32 v243, v250, v251
v_mul_f32 v244, v74, v244
v_mul_f32 v245, v74, v245
v_mul_f32 v246, v74, v246
v_mul_f32 v247, v74, v247
v_mul_f32 v252, v74, v252
v_mul_f32 v253, v74, v253
v_mul_f32 v254, v74, v254
v_mul_f32 v255, v74, v255
v_cvt_pk_bf16_f32 v244, v244, v245
v_cvt_pk_bf16_f32 v245, v246, v247
v_cvt_pk_bf16_f32 v246, v252, v253
v_cvt_pk_bf16_f32 v247, v254, v255
MG_out:
s_waitcnt lgkmcnt(0)
M v,16,a,64,v,128
T 88,118,4096
T 90,118,6144
M v,20,a,64,v,132
T 92,119,4096
T 94,119,6144
M v,24,a,68,v,128
s_add_u32 m0, s32, 98304
M v,28,a,68,v,132
T 96,116,8192
T 98,116,10240
M v,32,a,72,v,128
T 100,117,8192
T 102,117,10240
M v,36,a,72,v,132
s_add_u32 s35, s38, 256
M v,40,a,76,v,128
T 104,118,8192
T 106,118,10240
M v,44,a,76,v,132
T 108,119,8192
T 110,119,10240
M v,16,a,80,v,144
L 112,76,s35,0
M v,20,a,80,v,148
T 112,116,12288
T 114,116,14336
M v,24,a,84,v,144
M v,28,a,84,v,148
T 116,117,12288
T 118,117,14336
s_waitcnt lgkmcnt(6)
M v,32,a,88,v,144
T 120,118,12288
T 122,118,14336
M v,36,a,88,v,148
L 113,76,s35,1024
M v,40,a,92,v,144
T 124,119,12288
T 126,119,14336
M v,44,a,92,v,148
T 64,116,16384
T 66,116,18432
M v,16,a,96,v,160
L 114,76,s35,2048
M v,20,a,96,v,164
T 68,117,16384
T 70,117,18432
M v,24,a,100,v,160
T 72,118,16384
T 74,118,18432
M v,28,a,100,v,164
L 115,76,s35,3072
M v,32,a,104,v,160
T 76,119,16384
T 78,119,18432
M v,36,a,104,v,164
s_waitcnt lgkmcnt(6)
M v,40,a,108,v,160
T 80,116,20480
T 82,116,22528
M v,44,a,108,v,164
T 84,117,20480
T 86,117,22528
M v,16,a,112,v,176
s_add_u32 m0, s32, 114688
M v,20,a,112,v,180
T 88,118,20480
T 90,118,22528
M v,24,a,116,v,176
T 92,119,20480
T 94,119,22528
M v,28,a,116,v,180
s_add_u32 s35, s38, 114944
M v,32,a,120,v,176
T 96,116,24576
T 98,116,26624
M v,36,a,120,v,180
T 100,117,24576
T 102,117,26624
M v,40,a,124,v,176
M v,44,a,124,v,180
T 104,118,24576
T 106,118,26624
M v,16,a,64,v,192
L 112,76,s35,0
M v,20,a,64,v,196
T 108,119,24576
T 110,119,26624
s_waitcnt lgkmcnt(6)
M v,24,a,68,v,192
T 112,116,28672
T 114,116,30720
M v,28,a,68,v,196
L 113,76,s35,1024
M v,32,a,72,v,192
T 116,117,28672
T 118,117,30720
M v,36,a,72,v,196
T 120,118,28672
T 122,118,30720
M v,40,a,76,v,192
L 114,76,s35,2048
M v,44,a,76,v,196
T 124,119,28672
T 126,119,30720
M v,16,a,80,v,208
M v,20,a,80,v,212
M v,24,a,84,v,208
L 115,76,s35,3072
M v,28,a,84,v,212
M v,32,a,88,v,208
M v,36,a,88,v,212
M v,40,a,92,v,208
M v,44,a,92,v,212
M v,16,a,96,v,224
s_waitcnt vmcnt(16) lgkmcnt(0)
s_barrier
M v,20,a,96,v,228
T 64,116,32768
T 66,116,34816
M v,24,a,100,v,224
T 68,117,32768
T 70,117,34816
M v,28,a,100,v,228
T 72,118,32768
T 74,118,34816
M v,32,a,104,v,224
T 76,119,32768
T 78,119,34816
M v,36,a,104,v,228
T 80,116,36864
T 82,116,38912
M v,40,a,108,v,224
T 84,117,36864
T 86,117,38912
M v,44,a,108,v,228
M v,16,a,112,v,240
M v,20,a,112,v,244
M v,24,a,116,v,240
M v,28,a,116,v,244
M v,32,a,120,v,240
M v,36,a,120,v,244
M v,40,a,124,v,240
M v,44,a,124,v,244
s_waitcnt lgkmcnt(0)
Z v,48,a,64,a,128
T 88,118,36864
T 90,118,38912
Z v,52,a,64,a,132
T 92,119,36864
T 94,119,38912
Z v,56,a,68,a,128
s_add_u32 m0, s32, 0
s_add_u32 s35, s39, 384
Z v,60,a,68,a,132
T 96,116,40960
T 98,116,43008
Z v,64,a,72,a,128
T 100,117,40960
T 102,117,43008
Z v,68,a,72,a,132
L 112,80,s35,0
L 113,80,s35,1024
Z v,72,a,76,a,128
T 104,118,40960
T 106,118,43008
Z v,76,a,76,a,132
T 108,119,40960
T 110,119,43008
M v,48,a,80,a,136
L 114,80,s35,2048
L 115,80,s35,3072
M v,52,a,80,a,140
T 112,116,45056
T 114,116,47104
M v,56,a,84,a,136
s_add_u32 m0, s32, 16384
s_add_u32 s35, s38, 384
M v,60,a,84,a,140
T 116,117,45056
T 118,117,47104
s_waitcnt lgkmcnt(6)
M v,64,a,88,a,136
T 120,118,45056
T 122,118,47104
M v,68,a,88,a,140
L 112,76,s35,0
L 113,76,s35,1024
M v,72,a,92,a,136
T 124,119,45056
T 126,119,47104
M v,76,a,92,a,140
T 64,116,49152
T 66,116,51200
M v,48,a,96,a,144
L 114,76,s35,2048
L 115,76,s35,3072
M v,52,a,96,a,148
T 68,117,49152
T 70,117,51200
M v,56,a,100,a,144
T 72,118,49152
T 74,118,51200
M v,60,a,100,a,148
s_add_u32 s35, s42, 0
v_cvt_pk_bf16_f32 v16, v16, v17
M v,64,a,104,a,144
T 76,119,49152
T 78,119,51200
M v,68,a,104,a,148
v_cvt_pk_bf16_f32 v17, v18, v19
v_cvt_pk_bf16_f32 v18, v24, v25
s_waitcnt lgkmcnt(6)
M v,72,a,108,a,144
T 80,116,53248
T 82,116,55296
M v,76,a,108,a,148
T 84,117,53248
T 86,117,55296
M v,48,a,112,a,152
v_cvt_pk_bf16_f32 v19, v26, v27
buffer_store_dwordx4 v[16:19], v7, s[12:15], s35 offen offset:0 sc1
M v,52,a,112,a,156
T 88,118,53248
T 90,118,55296
M v,56,a,116,a,152
T 92,119,53248
T 94,119,55296
M v,60,a,116,a,156
v_cvt_pk_bf16_f32 v20, v20, v21
v_cvt_pk_bf16_f32 v21, v22, v23
M v,64,a,120,a,152
T 96,116,57344
T 98,116,59392
M v,68,a,120,a,156
T 100,117,57344
T 102,117,59392
M v,72,a,124,a,152
v_cvt_pk_bf16_f32 v22, v28, v29
v_cvt_pk_bf16_f32 v23, v30, v31
M v,76,a,124,a,156
T 104,118,57344
T 106,118,59392
M v,48,a,64,v,128
buffer_store_dwordx4 v[20:23], v7, s[12:15], s35 offen offset:1024 sc1
v_cvt_pk_bf16_f32 v32, v32, v33
M v,52,a,64,v,132
T 108,119,57344
T 110,119,59392
s_waitcnt lgkmcnt(6)
M v,56,a,68,v,128
T 112,116,61440
T 114,116,63488
M v,60,a,68,v,132
v_cvt_pk_bf16_f32 v33, v34, v35
v_cvt_pk_bf16_f32 v34, v40, v41
M v,64,a,72,v,128
T 116,117,61440
T 118,117,63488
M v,68,a,72,v,132
T 120,118,61440
T 122,118,63488
M v,72,a,76,v,128
v_cvt_pk_bf16_f32 v35, v42, v43
buffer_store_dwordx4 v[32:35], v7, s[12:15], s35 offen offset:2048 sc1
M v,76,a,76,v,132
T 124,119,61440
T 126,119,63488
M v,48,a,80,v,144
v_cvt_pk_bf16_f32 v36, v36, v37
v_cvt_pk_bf16_f32 v37, v38, v39
M v,52,a,80,v,148
v_cvt_pk_bf16_f32 v38, v44, v45
M v,56,a,84,v,144
M v,60,a,84,v,148
v_cvt_pk_bf16_f32 v39, v46, v47
M v,64,a,88,v,144
buffer_store_dwordx4 v[36:39], v7, s[12:15], s35 offen offset:3072 sc1
M v,68,a,88,v,148
M v,72,a,92,v,144
M v,76,a,92,v,148
M v,48,a,96,v,160
s_waitcnt vmcnt(20) lgkmcnt(0)
s_barrier
M v,52,a,96,v,164
T 64,120,0
T 66,120,2048
M v,56,a,100,v,160
T 68,121,0
T 70,121,2048
M v,60,a,100,v,164
T 72,122,0
T 74,122,2048
M v,64,a,104,v,160
T 76,123,0
T 78,123,2048
M v,68,a,104,v,164
T 80,120,4096
T 82,120,6144
M v,72,a,108,v,160
T 84,121,4096
T 86,121,6144
M v,76,a,108,v,164
M v,48,a,112,v,176
M v,52,a,112,v,180
M v,56,a,116,v,176
M v,60,a,116,v,180
M v,64,a,120,v,176
M v,68,a,120,v,180
M v,72,a,124,v,176
M v,76,a,124,v,180
s_waitcnt lgkmcnt(0)
M v,48,a,64,v,192
T 88,122,4096
T 90,122,6144
M v,52,a,64,v,196
T 92,123,4096
T 94,123,6144
M v,56,a,68,v,192
s_add_u32 m0, s32, 32768
M v,60,a,68,v,196
T 96,120,8192
T 98,120,10240
M v,64,a,72,v,192
T 100,121,8192
T 102,121,10240
M v,68,a,72,v,196
s_add_u32 s35, s38, 115072
M v,72,a,76,v,192
T 104,122,8192
T 106,122,10240
M v,76,a,76,v,196
T 108,123,8192
T 110,123,10240
M v,48,a,80,v,208
L 112,76,s35,0
M v,52,a,80,v,212
T 112,120,12288
T 114,120,14336
M v,56,a,84,v,208
M v,60,a,84,v,212
T 116,121,12288
T 118,121,14336
s_waitcnt lgkmcnt(6)
M v,64,a,88,v,208
T 120,122,12288
T 122,122,14336
M v,68,a,88,v,212
L 113,76,s35,1024
M v,72,a,92,v,208
T 124,123,12288
T 126,123,14336
M v,76,a,92,v,212
T 64,120,16384
T 66,120,18432
M v,48,a,96,v,224
L 114,76,s35,2048
M v,52,a,96,v,228
T 68,121,16384
T 70,121,18432
M v,56,a,100,v,224
T 72,122,16384
T 74,122,18432
M v,60,a,100,v,228
L 115,76,s35,3072
M v,64,a,104,v,224
T 76,123,16384
T 78,123,18432
M v,68,a,104,v,228
s_waitcnt lgkmcnt(6)
M v,72,a,108,v,224
T 80,120,20480
T 82,120,22528
M v,76,a,108,v,228
T 84,121,20480
T 86,121,22528
M v,48,a,112,v,240
s_add_u32 m0, s32, 49152
M v,52,a,112,v,244
T 88,122,20480
T 90,122,22528
M v,56,a,116,v,240
T 92,123,20480
T 94,123,22528
M v,60,a,116,v,244
s_add_u32 s35, s39, 512
M v,64,a,120,v,240
T 96,120,24576
T 98,120,26624
M v,68,a,120,v,244
T 100,121,24576
T 102,121,26624
M v,72,a,124,v,240
M v,76,a,124,v,244
T 104,122,24576
T 106,122,26624
Z v,16,a,64,a,128
L 112,80,s35,0
Z v,20,a,64,a,132
T 108,123,24576
T 110,123,26624
s_waitcnt lgkmcnt(6)
Z v,24,a,68,a,128
T 112,120,28672
T 114,120,30720
Z v,28,a,68,a,132
L 113,80,s35,1024
Z v,32,a,72,a,128
T 116,121,28672
T 118,121,30720
Z v,36,a,72,a,132
T 120,122,28672
T 122,122,30720
Z v,40,a,76,a,128
L 114,80,s35,2048
Z v,44,a,76,a,132
T 124,123,28672
T 126,123,30720
M v,16,a,80,a,136
M v,20,a,80,a,140
M v,24,a,84,a,136
L 115,80,s35,3072
M v,28,a,84,a,140
M v,32,a,88,a,136
M v,36,a,88,a,140
M v,40,a,92,a,136
M v,44,a,92,a,140
M v,16,a,96,a,144
s_waitcnt vmcnt(20) lgkmcnt(0)
s_barrier
M v,20,a,96,a,148
T 64,120,32768
T 66,120,34816
M v,24,a,100,a,144
T 68,121,32768
T 70,121,34816
M v,28,a,100,a,148
T 72,122,32768
T 74,122,34816
M v,32,a,104,a,144
T 76,123,32768
T 78,123,34816
M v,36,a,104,a,148
T 80,120,36864
T 82,120,38912
M v,40,a,108,a,144
T 84,121,36864
T 86,121,38912
M v,44,a,108,a,148
M v,16,a,112,a,152
M v,20,a,112,a,156
M v,24,a,116,a,152
M v,28,a,116,a,156
M v,32,a,120,a,152
M v,36,a,120,a,156
M v,40,a,124,a,152
M v,44,a,124,a,156
s_waitcnt lgkmcnt(0)
M v,16,a,64,v,128
T 88,122,36864
T 90,122,38912
M v,20,a,64,v,132
T 92,123,36864
T 94,123,38912
M v,24,a,68,v,128
s_add_u32 m0, s32, 65536
s_add_u32 s35, s38, 512
M v,28,a,68,v,132
T 96,120,40960
T 98,120,43008
M v,32,a,72,v,128
T 100,121,40960
T 102,121,43008
M v,36,a,72,v,132
L 112,76,s35,0
L 113,76,s35,1024
M v,40,a,76,v,128
T 104,122,40960
T 106,122,43008
M v,44,a,76,v,132
T 108,123,40960
T 110,123,43008
M v,16,a,80,v,144
L 114,76,s35,2048
L 115,76,s35,3072
M v,20,a,80,v,148
T 112,120,45056
T 114,120,47104
M v,24,a,84,v,144
s_add_u32 m0, s32, 81920
s_add_u32 s35, s38, 115200
M v,28,a,84,v,148
T 116,121,45056
T 118,121,47104
s_waitcnt lgkmcnt(6)
M v,32,a,88,v,144
T 120,122,45056
T 122,122,47104
M v,36,a,88,v,148
L 112,76,s35,0
L 113,76,s35,1024
M v,40,a,92,v,144
T 124,123,45056
T 126,123,47104
M v,44,a,92,v,148
T 64,120,49152
T 66,120,51200
M v,16,a,96,v,160
L 114,76,s35,2048
L 115,76,s35,3072
M v,20,a,96,v,164
T 68,121,49152
T 70,121,51200
M v,24,a,100,v,160
T 72,122,49152
T 74,122,51200
M v,28,a,100,v,164
s_add_u32 s35, s42, 4096
v_cvt_pk_bf16_f32 v48, v48, v49
M v,32,a,104,v,160
T 76,123,49152
T 78,123,51200
M v,36,a,104,v,164
v_cvt_pk_bf16_f32 v49, v50, v51
v_cvt_pk_bf16_f32 v50, v56, v57
s_waitcnt lgkmcnt(6)
M v,40,a,108,v,160
T 80,120,53248
T 82,120,55296
M v,44,a,108,v,164
T 84,121,53248
T 86,121,55296
M v,16,a,112,v,176
v_cvt_pk_bf16_f32 v51, v58, v59
buffer_store_dwordx4 v[48:51], v7, s[12:15], s35 offen offset:0 sc1
M v,20,a,112,v,180
T 88,122,53248
T 90,122,55296
M v,24,a,116,v,176
T 92,123,53248
T 94,123,55296
M v,28,a,116,v,180
v_cvt_pk_bf16_f32 v52, v52, v53
v_cvt_pk_bf16_f32 v53, v54, v55
M v,32,a,120,v,176
T 96,120,57344
T 98,120,59392
M v,36,a,120,v,180
T 100,121,57344
T 102,121,59392
M v,40,a,124,v,176
v_cvt_pk_bf16_f32 v54, v60, v61
v_cvt_pk_bf16_f32 v55, v62, v63
M v,44,a,124,v,180
T 104,122,57344
T 106,122,59392
M v,16,a,64,v,192
buffer_store_dwordx4 v[52:55], v7, s[12:15], s35 offen offset:1024 sc1
v_cvt_pk_bf16_f32 v64, v64, v65
M v,20,a,64,v,196
T 108,123,57344
T 110,123,59392
s_waitcnt lgkmcnt(6)
M v,24,a,68,v,192
T 112,120,61440
T 114,120,63488
M v,28,a,68,v,196
v_cvt_pk_bf16_f32 v65, v66, v67
v_cvt_pk_bf16_f32 v66, v72, v73
M v,32,a,72,v,192
T 116,121,61440
T 118,121,63488
M v,36,a,72,v,196
T 120,122,61440
T 122,122,63488
M v,40,a,76,v,192
v_cvt_pk_bf16_f32 v67, v74, v75
buffer_store_dwordx4 v[64:67], v7, s[12:15], s35 offen offset:2048 sc1
M v,44,a,76,v,196
T 124,123,61440
T 126,123,63488
M v,16,a,80,v,208
v_cvt_pk_bf16_f32 v68, v68, v69
v_cvt_pk_bf16_f32 v69, v70, v71
M v,20,a,80,v,212
v_cvt_pk_bf16_f32 v70, v76, v77
M v,24,a,84,v,208
M v,28,a,84,v,212
v_cvt_pk_bf16_f32 v71, v78, v79
M v,32,a,88,v,208
buffer_store_dwordx4 v[68:71], v7, s[12:15], s35 offen offset:3072 sc1
M v,36,a,88,v,212
M v,40,a,92,v,208
M v,44,a,92,v,212
M v,16,a,96,v,224
s_waitcnt vmcnt(20) lgkmcnt(0)
s_barrier
M v,20,a,96,v,228
T 64,116,0
T 66,116,2048
M v,24,a,100,v,224
T 68,117,0
T 70,117,2048
M v,28,a,100,v,228
T 72,118,0
T 74,118,2048
M v,32,a,104,v,224
T 76,119,0
T 78,119,2048
M v,36,a,104,v,228
T 80,116,4096
T 82,116,6144
M v,40,a,108,v,224
T 84,117,4096
T 86,117,6144
M v,44,a,108,v,228
M v,16,a,112,v,240
M v,20,a,112,v,244
M v,24,a,116,v,240
M v,28,a,116,v,244
M v,32,a,120,v,240
M v,36,a,120,v,244
M v,40,a,124,v,240
M v,44,a,124,v,244
s_waitcnt lgkmcnt(0)
Z v,48,a,64,a,128
T 88,118,4096
T 90,118,6144
Z v,52,a,64,a,132
T 92,119,4096
T 94,119,6144
Z v,56,a,68,a,128
s_add_u32 m0, s32, 98304
s_add_u32 s35, s39, 640
Z v,60,a,68,a,132
T 96,116,8192
T 98,116,10240
Z v,64,a,72,a,128
T 100,117,8192
T 102,117,10240
Z v,68,a,72,a,132
L 112,80,s35,0
L 113,80,s35,1024
Z v,72,a,76,a,128
T 104,118,8192
T 106,118,10240
Z v,76,a,76,a,132
T 108,119,8192
T 110,119,10240
M v,48,a,80,a,136
L 114,80,s35,2048
L 115,80,s35,3072
M v,52,a,80,a,140
T 112,116,12288
T 114,116,14336
M v,56,a,84,a,136
s_add_u32 m0, s32, 114688
s_add_u32 s35, s38, 640
M v,60,a,84,a,140
T 116,117,12288
T 118,117,14336
s_waitcnt lgkmcnt(6)
M v,64,a,88,a,136
T 120,118,12288
T 122,118,14336
M v,68,a,88,a,140
L 112,76,s35,0
L 113,76,s35,1024
M v,72,a,92,a,136
T 124,119,12288
T 126,119,14336
M v,76,a,92,a,140
T 64,116,16384
T 66,116,18432
M v,48,a,96,a,144
L 114,76,s35,2048
L 115,76,s35,3072
M v,52,a,96,a,148
T 68,117,16384
T 70,117,18432
M v,56,a,100,a,144
T 72,118,16384
T 74,118,18432
M v,60,a,100,a,148
s_add_u32 s35, s42, 8192
v_cvt_pk_bf16_f32 v16, v16, v17
M v,64,a,104,a,144
T 76,119,16384
T 78,119,18432
M v,68,a,104,a,148
v_cvt_pk_bf16_f32 v17, v18, v19
v_cvt_pk_bf16_f32 v18, v24, v25
s_waitcnt lgkmcnt(6)
M v,72,a,108,a,144
T 80,116,20480
T 82,116,22528
M v,76,a,108,a,148
T 84,117,20480
T 86,117,22528
M v,48,a,112,a,152
v_cvt_pk_bf16_f32 v19, v26, v27
buffer_store_dwordx4 v[16:19], v7, s[12:15], s35 offen offset:0 sc1
M v,52,a,112,a,156
T 88,118,20480
T 90,118,22528
M v,56,a,116,a,152
T 92,119,20480
T 94,119,22528
M v,60,a,116,a,156
v_cvt_pk_bf16_f32 v20, v20, v21
v_cvt_pk_bf16_f32 v21, v22, v23
M v,64,a,120,a,152
T 96,116,24576
T 98,116,26624
M v,68,a,120,a,156
T 100,117,24576
T 102,117,26624
M v,72,a,124,a,152
v_cvt_pk_bf16_f32 v22, v28, v29
v_cvt_pk_bf16_f32 v23, v30, v31
M v,76,a,124,a,156
T 104,118,24576
T 106,118,26624
M v,48,a,64,v,128
buffer_store_dwordx4 v[20:23], v7, s[12:15], s35 offen offset:1024 sc1
v_cvt_pk_bf16_f32 v32, v32, v33
M v,52,a,64,v,132
T 108,119,24576
T 110,119,26624
s_waitcnt lgkmcnt(6)
M v,56,a,68,v,128
T 112,116,28672
T 114,116,30720
M v,60,a,68,v,132
v_cvt_pk_bf16_f32 v33, v34, v35
v_cvt_pk_bf16_f32 v34, v40, v41
M v,64,a,72,v,128
T 116,117,28672
T 118,117,30720
M v,68,a,72,v,132
T 120,118,28672
T 122,118,30720
M v,72,a,76,v,128
v_cvt_pk_bf16_f32 v35, v42, v43
buffer_store_dwordx4 v[32:35], v7, s[12:15], s35 offen offset:2048 sc1
M v,76,a,76,v,132
T 124,119,28672
T 126,119,30720
M v,48,a,80,v,144
v_cvt_pk_bf16_f32 v36, v36, v37
v_cvt_pk_bf16_f32 v37, v38, v39
M v,52,a,80,v,148
v_cvt_pk_bf16_f32 v38, v44, v45
M v,56,a,84,v,144
M v,60,a,84,v,148
v_cvt_pk_bf16_f32 v39, v46, v47
M v,64,a,88,v,144
buffer_store_dwordx4 v[36:39], v7, s[12:15], s35 offen offset:3072 sc1
M v,68,a,88,v,148
M v,72,a,92,v,144
M v,76,a,92,v,148
M v,48,a,96,v,160
s_waitcnt vmcnt(24) lgkmcnt(0)
s_barrier
M v,52,a,96,v,164
T 64,116,32768
T 66,116,34816
M v,56,a,100,v,160
T 68,117,32768
T 70,117,34816
M v,60,a,100,v,164
T 72,118,32768
T 74,118,34816
M v,64,a,104,v,160
T 76,119,32768
T 78,119,34816
M v,68,a,104,v,164
T 80,116,36864
T 82,116,38912
M v,72,a,108,v,160
T 84,117,36864
T 86,117,38912
M v,76,a,108,v,164
M v,48,a,112,v,176
M v,52,a,112,v,180
M v,56,a,116,v,176
M v,60,a,116,v,180
M v,64,a,120,v,176
M v,68,a,120,v,180
M v,72,a,124,v,176
M v,76,a,124,v,180
s_waitcnt lgkmcnt(0)
M v,48,a,64,v,192
T 88,118,36864
T 90,118,38912
M v,52,a,64,v,196
T 92,119,36864
T 94,119,38912
M v,56,a,68,v,192
s_add_u32 m0, s32, 0
M v,60,a,68,v,196
T 96,116,40960
T 98,116,43008
M v,64,a,72,v,192
T 100,117,40960
T 102,117,43008
M v,68,a,72,v,196
s_add_u32 s35, s38, 115328
M v,72,a,76,v,192
T 104,118,40960
T 106,118,43008
M v,76,a,76,v,196
T 108,119,40960
T 110,119,43008
M v,48,a,80,v,208
L 112,76,s35,0
M v,52,a,80,v,212
T 112,116,45056
T 114,116,47104
M v,56,a,84,v,208
M v,60,a,84,v,212
T 116,117,45056
T 118,117,47104
s_waitcnt lgkmcnt(6)
M v,64,a,88,v,208
T 120,118,45056
T 122,118,47104
M v,68,a,88,v,212
L 113,76,s35,1024
M v,72,a,92,v,208
T 124,119,45056
T 126,119,47104
M v,76,a,92,v,212
T 64,116,49152
T 66,116,51200
M v,48,a,96,v,224
L 114,76,s35,2048
M v,52,a,96,v,228
T 68,117,49152
T 70,117,51200
M v,56,a,100,v,224
T 72,118,49152
T 74,118,51200
M v,60,a,100,v,228
L 115,76,s35,3072
M v,64,a,104,v,224
T 76,119,49152
T 78,119,51200
M v,68,a,104,v,228
s_waitcnt lgkmcnt(6)
M v,72,a,108,v,224
T 80,116,53248
T 82,116,55296
M v,76,a,108,v,228
T 84,117,53248
T 86,117,55296
M v,48,a,112,v,240
s_add_u32 m0, s32, 16384
M v,52,a,112,v,244
T 88,118,53248
T 90,118,55296
M v,56,a,116,v,240
T 92,119,53248
T 94,119,55296
M v,60,a,116,v,244
s_add_u32 s35, s39, 768
M v,64,a,120,v,240
T 96,116,57344
T 98,116,59392
M v,68,a,120,v,244
T 100,117,57344
T 102,117,59392
M v,72,a,124,v,240
M v,76,a,124,v,244
T 104,118,57344
T 106,118,59392
Z v,16,a,64,a,128
L 112,80,s35,0
Z v,20,a,64,a,132
T 108,119,57344
T 110,119,59392
s_waitcnt lgkmcnt(6)
Z v,24,a,68,a,128
T 112,116,61440
T 114,116,63488
Z v,28,a,68,a,132
L 113,80,s35,1024
Z v,32,a,72,a,128
T 116,117,61440
T 118,117,63488
Z v,36,a,72,a,132
T 120,118,61440
T 122,118,63488
Z v,40,a,76,a,128
L 114,80,s35,2048
Z v,44,a,76,a,132
T 124,119,61440
T 126,119,63488
M v,16,a,80,a,136
M v,20,a,80,a,140
M v,24,a,84,a,136
L 115,80,s35,3072
M v,28,a,84,a,140
M v,32,a,88,a,136
M v,36,a,88,a,140
M v,40,a,92,a,136
M v,44,a,92,a,140
M v,16,a,96,a,144
s_waitcnt vmcnt(20) lgkmcnt(0)
s_barrier
M v,20,a,96,a,148
T 64,120,0
T 66,120,2048
M v,24,a,100,a,144
T 68,121,0
T 70,121,2048
M v,28,a,100,a,148
T 72,122,0
T 74,122,2048
M v,32,a,104,a,144
T 76,123,0
T 78,123,2048
M v,36,a,104,a,148
T 80,120,4096
T 82,120,6144
M v,40,a,108,a,144
T 84,121,4096
T 86,121,6144
M v,44,a,108,a,148
M v,16,a,112,a,152
M v,20,a,112,a,156
M v,24,a,116,a,152
M v,28,a,116,a,156
M v,32,a,120,a,152
M v,36,a,120,a,156
M v,40,a,124,a,152
M v,44,a,124,a,156
s_waitcnt lgkmcnt(0)
M v,16,a,64,v,128
T 88,122,4096
T 90,122,6144
M v,20,a,64,v,132
T 92,123,4096
T 94,123,6144
M v,24,a,68,v,128
s_add_u32 m0, s32, 32768
s_add_u32 s35, s38, 768
M v,28,a,68,v,132
T 96,120,8192
T 98,120,10240
M v,32,a,72,v,128
T 100,121,8192
T 102,121,10240
M v,36,a,72,v,132
L 112,76,s35,0
L 113,76,s35,1024
M v,40,a,76,v,128
T 104,122,8192
T 106,122,10240
M v,44,a,76,v,132
T 108,123,8192
T 110,123,10240
M v,16,a,80,v,144
L 114,76,s35,2048
L 115,76,s35,3072
M v,20,a,80,v,148
T 112,120,12288
T 114,120,14336
M v,24,a,84,v,144
s_add_u32 m0, s32, 49152
s_add_u32 s35, s38, 115456
M v,28,a,84,v,148
T 116,121,12288
T 118,121,14336
s_waitcnt lgkmcnt(6)
M v,32,a,88,v,144
T 120,122,12288
T 122,122,14336
M v,36,a,88,v,148
L 112,76,s35,0
L 113,76,s35,1024
M v,40,a,92,v,144
T 124,123,12288
T 126,123,14336
M v,44,a,92,v,148
T 64,120,16384
T 66,120,18432
M v,16,a,96,v,160
L 114,76,s35,2048
L 115,76,s35,3072
M v,20,a,96,v,164
T 68,121,16384
T 70,121,18432
M v,24,a,100,v,160
T 72,122,16384
T 74,122,18432
M v,28,a,100,v,164
s_add_u32 s35, s42, 12288
v_cvt_pk_bf16_f32 v48, v48, v49
M v,32,a,104,v,160
T 76,123,16384
T 78,123,18432
M v,36,a,104,v,164
v_cvt_pk_bf16_f32 v49, v50, v51
v_cvt_pk_bf16_f32 v50, v56, v57
s_waitcnt lgkmcnt(6)
M v,40,a,108,v,160
T 80,120,20480
T 82,120,22528
M v,44,a,108,v,164
T 84,121,20480
T 86,121,22528
M v,16,a,112,v,176
v_cvt_pk_bf16_f32 v51, v58, v59
buffer_store_dwordx4 v[48:51], v7, s[12:15], s35 offen offset:0 sc1
M v,20,a,112,v,180
T 88,122,20480
T 90,122,22528
M v,24,a,116,v,176
T 92,123,20480
T 94,123,22528
M v,28,a,116,v,180
v_cvt_pk_bf16_f32 v52, v52, v53
v_cvt_pk_bf16_f32 v53, v54, v55
M v,32,a,120,v,176
T 96,120,24576
T 98,120,26624
M v,36,a,120,v,180
T 100,121,24576
T 102,121,26624
M v,40,a,124,v,176
v_cvt_pk_bf16_f32 v54, v60, v61
v_cvt_pk_bf16_f32 v55, v62, v63
M v,44,a,124,v,180
T 104,122,24576
T 106,122,26624
M v,16,a,64,v,192
buffer_store_dwordx4 v[52:55], v7, s[12:15], s35 offen offset:1024 sc1
v_cvt_pk_bf16_f32 v64, v64, v65
M v,20,a,64,v,196
T 108,123,24576
T 110,123,26624
s_waitcnt lgkmcnt(6)
M v,24,a,68,v,192
T 112,120,28672
T 114,120,30720
M v,28,a,68,v,196
v_cvt_pk_bf16_f32 v65, v66, v67
v_cvt_pk_bf16_f32 v66, v72, v73
M v,32,a,72,v,192
T 116,121,28672
T 118,121,30720
M v,36,a,72,v,196
T 120,122,28672
T 122,122,30720
M v,40,a,76,v,192
v_cvt_pk_bf16_f32 v67, v74, v75
buffer_store_dwordx4 v[64:67], v7, s[12:15], s35 offen offset:2048 sc1
M v,44,a,76,v,196
T 124,123,28672
T 126,123,30720
M v,16,a,80,v,208
v_cvt_pk_bf16_f32 v68, v68, v69
v_cvt_pk_bf16_f32 v69, v70, v71
M v,20,a,80,v,212
v_cvt_pk_bf16_f32 v70, v76, v77
M v,24,a,84,v,208
M v,28,a,84,v,212
v_cvt_pk_bf16_f32 v71, v78, v79
M v,32,a,88,v,208
buffer_store_dwordx4 v[68:71], v7, s[12:15], s35 offen offset:3072 sc1
M v,36,a,88,v,212
M v,40,a,92,v,208
M v,44,a,92,v,212
M v,16,a,96,v,224
s_waitcnt vmcnt(20) lgkmcnt(0)
s_barrier
M v,20,a,96,v,228
T 64,120,32768
T 66,120,34816
M v,24,a,100,v,224
T 68,121,32768
T 70,121,34816
M v,28,a,100,v,228
T 72,122,32768
T 74,122,34816
M v,32,a,104,v,224
T 76,123,32768
T 78,123,34816
M v,36,a,104,v,228
T 80,120,36864
T 82,120,38912
M v,40,a,108,v,224
T 84,121,36864
T 86,121,38912
M v,44,a,108,v,228
M v,16,a,112,v,240
M v,20,a,112,v,244
M v,24,a,116,v,240
M v,28,a,116,v,244
M v,32,a,120,v,240
M v,36,a,120,v,244
M v,40,a,124,v,240
M v,44,a,124,v,244
s_waitcnt lgkmcnt(0)
Z v,48,a,64,a,128
T 88,122,36864
T 90,122,38912
Z v,52,a,64,a,132
T 92,123,36864
T 94,123,38912
Z v,56,a,68,a,128
s_add_u32 s35, s42, 16384
Z v,60,a,68,a,132
T 96,120,40960
T 98,120,43008
Z v,64,a,72,a,128
T 100,121,40960
T 102,121,43008
Z v,68,a,72,a,132
v_cvt_pk_bf16_f32 v16, v16, v17
v_cvt_pk_bf16_f32 v17, v18, v19
Z v,72,a,76,a,128
T 104,122,40960
T 106,122,43008
Z v,76,a,76,a,132
T 108,123,40960
T 110,123,43008
M v,48,a,80,a,136
v_cvt_pk_bf16_f32 v18, v24, v25
M v,52,a,80,a,140
T 112,120,45056
T 114,120,47104
M v,56,a,84,a,136
v_cvt_pk_bf16_f32 v19, v26, v27
M v,60,a,84,a,140
T 116,121,45056
T 118,121,47104
s_waitcnt lgkmcnt(6)
M v,64,a,88,a,136
T 120,122,45056
T 122,122,47104
M v,68,a,88,a,140
buffer_store_dwordx4 v[16:19], v7, s[12:15], s35 offen offset:0 sc1
v_cvt_pk_bf16_f32 v20, v20, v21
M v,72,a,92,a,136
T 124,123,45056
T 126,123,47104
M v,76,a,92,a,140
T 64,120,49152
T 66,120,51200
M v,48,a,96,a,144
v_cvt_pk_bf16_f32 v21, v22, v23
M v,52,a,96,a,148
T 68,121,49152
T 70,121,51200
M v,56,a,100,a,144
T 72,122,49152
T 74,122,51200
M v,60,a,100,a,148
v_cvt_pk_bf16_f32 v22, v28, v29
M v,64,a,104,a,144
T 76,123,49152
T 78,123,51200
M v,68,a,104,a,148
v_cvt_pk_bf16_f32 v23, v30, v31
s_waitcnt lgkmcnt(6)
M v,72,a,108,a,144
T 80,120,53248
T 82,120,55296
M v,76,a,108,a,148
T 84,121,53248
T 86,121,55296
M v,48,a,112,a,152
buffer_store_dwordx4 v[20:23], v7, s[12:15], s35 offen offset:1024 sc1
v_cvt_pk_bf16_f32 v32, v32, v33
M v,52,a,112,a,156
T 88,122,53248
T 90,122,55296
M v,56,a,116,a,152
T 92,123,53248
T 94,123,55296
M v,60,a,116,a,156
v_cvt_pk_bf16_f32 v33, v34, v35
M v,64,a,120,a,152
T 96,120,57344
T 98,120,59392
M v,68,a,120,a,156
T 100,121,57344
T 102,121,59392
M v,72,a,124,a,152
v_cvt_pk_bf16_f32 v34, v40, v41
M v,76,a,124,a,156
T 104,122,57344
T 106,122,59392
M v,48,a,64,v,128
v_cvt_pk_bf16_f32 v35, v42, v43
M v,52,a,64,v,132
T 108,123,57344
T 110,123,59392
s_waitcnt lgkmcnt(6)
M v,56,a,68,v,128
T 112,120,61440
T 114,120,63488
M v,60,a,68,v,132
buffer_store_dwordx4 v[32:35], v7, s[12:15], s35 offen offset:2048 sc1
v_cvt_pk_bf16_f32 v36, v36, v37
M v,64,a,72,v,128
T 116,121,61440
T 118,121,63488
M v,68,a,72,v,132
T 120,122,61440
T 122,122,63488
M v,72,a,76,v,128
v_cvt_pk_bf16_f32 v37, v38, v39
M v,76,a,76,v,132
T 124,123,61440
T 126,123,63488
M v,48,a,80,v,144
v_cvt_pk_bf16_f32 v38, v44, v45
M v,52,a,80,v,148
v_cvt_pk_bf16_f32 v39, v46, v47
M v,56,a,84,v,144
M v,60,a,84,v,148
buffer_store_dwordx4 v[36:39], v7, s[12:15], s35 offen offset:3072 sc1
M v,64,a,88,v,144
M v,68,a,88,v,148
M v,72,a,92,v,144
M v,76,a,92,v,148
M v,48,a,96,v,160
s_waitcnt vmcnt(16) lgkmcnt(0)
s_barrier
M v,52,a,96,v,164
T 64,116,0
T 66,116,2048
M v,56,a,100,v,160
T 68,117,0
T 70,117,2048
M v,60,a,100,v,164
T 72,118,0
T 74,118,2048
M v,64,a,104,v,160
T 76,119,0
T 78,119,2048
M v,68,a,104,v,164
T 80,116,4096
T 82,116,6144
M v,72,a,108,v,160
T 84,117,4096
T 86,117,6144
M v,76,a,108,v,164
M v,48,a,112,v,176
M v,52,a,112,v,180
M v,56,a,116,v,176
M v,60,a,116,v,180
M v,64,a,120,v,176
M v,68,a,120,v,180
M v,72,a,124,v,176
M v,76,a,124,v,180
s_waitcnt lgkmcnt(0)
M v,48,a,64,v,192
T 88,118,4096
T 90,118,6144
M v,52,a,64,v,196
T 92,119,4096
T 94,119,6144
M v,56,a,68,v,192
M v,60,a,68,v,196
T 96,116,8192
T 98,116,10240
M v,64,a,72,v,192
T 100,117,8192
T 102,117,10240
M v,68,a,72,v,196
M v,72,a,76,v,192
T 104,118,8192
T 106,118,10240
M v,76,a,76,v,196
T 108,119,8192
T 110,119,10240
M v,48,a,80,v,208
M v,52,a,80,v,212
T 112,116,12288
T 114,116,14336
M v,56,a,84,v,208
M v,60,a,84,v,212
T 116,117,12288
T 118,117,14336
s_waitcnt lgkmcnt(6)
M v,64,a,88,v,208
T 120,118,12288
T 122,118,14336
M v,68,a,88,v,212
M v,72,a,92,v,208
T 124,119,12288
T 126,119,14336
M v,76,a,92,v,212
T 64,116,16384
T 66,116,18432
M v,48,a,96,v,224
M v,52,a,96,v,228
T 68,117,16384
T 70,117,18432
M v,56,a,100,v,224
T 72,118,16384
T 74,118,18432
M v,60,a,100,v,228
M v,64,a,104,v,224
T 76,119,16384
T 78,119,18432
M v,68,a,104,v,228
s_waitcnt lgkmcnt(6)
M v,72,a,108,v,224
T 80,116,20480
T 82,116,22528
M v,76,a,108,v,228
T 84,117,20480
T 86,117,22528
M v,48,a,112,v,240
M v,52,a,112,v,244
T 88,118,20480
T 90,118,22528
M v,56,a,116,v,240
T 92,119,20480
T 94,119,22528
M v,60,a,116,v,244
M v,64,a,120,v,240
T 96,116,24576
T 98,116,26624
M v,68,a,120,v,244
T 100,117,24576
T 102,117,26624
M v,72,a,124,v,240
M v,76,a,124,v,244
T 104,118,24576
T 106,118,26624
Z v,16,a,64,a,128
Z v,20,a,64,a,132
T 108,119,24576
T 110,119,26624
s_waitcnt lgkmcnt(6)
Z v,24,a,68,a,128
T 112,116,28672
T 114,116,30720
Z v,28,a,68,a,132
Z v,32,a,72,a,128
T 116,117,28672
T 118,117,30720
Z v,36,a,72,a,132
T 120,118,28672
T 122,118,30720
Z v,40,a,76,a,128
Z v,44,a,76,a,132
T 124,119,28672
T 126,119,30720
M v,16,a,80,a,136
M v,20,a,80,a,140
M v,24,a,84,a,136
M v,28,a,84,a,140
M v,32,a,88,a,136
M v,36,a,88,a,140
M v,40,a,92,a,136
M v,44,a,92,a,140
M v,16,a,96,a,144
s_waitcnt vmcnt(4) lgkmcnt(0)
s_barrier
M v,20,a,96,a,148
T 64,116,32768
T 66,116,34816
M v,24,a,100,a,144
T 68,117,32768
T 70,117,34816
M v,28,a,100,a,148
T 72,118,32768
T 74,118,34816
M v,32,a,104,a,144
T 76,119,32768
T 78,119,34816
M v,36,a,104,a,148
T 80,116,36864
T 82,116,38912
M v,40,a,108,a,144
T 84,117,36864
T 86,117,38912
M v,44,a,108,a,148
M v,16,a,112,a,152
M v,20,a,112,a,156
M v,24,a,116,a,152
M v,28,a,116,a,156
M v,32,a,120,a,152
M v,36,a,120,a,156
M v,40,a,124,a,152
M v,44,a,124,a,156
s_waitcnt lgkmcnt(0)
M v,16,a,64,v,128
T 88,118,36864
T 90,118,38912
M v,20,a,64,v,132
T 92,119,36864
T 94,119,38912
M v,24,a,68,v,128
s_add_u32 s35, s42, 20480
M v,28,a,68,v,132
T 96,116,40960
T 98,116,43008
M v,32,a,72,v,128
T 100,117,40960
T 102,117,43008
M v,36,a,72,v,132
v_cvt_pk_bf16_f32 v48, v48, v49
M v,40,a,76,v,128
T 104,118,40960
T 106,118,43008
M v,44,a,76,v,132
T 108,119,40960
T 110,119,43008
M v,16,a,80,v,144
v_cvt_pk_bf16_f32 v49, v50, v51
M v,20,a,80,v,148
T 112,116,45056
T 114,116,47104
M v,24,a,84,v,144
v_cvt_pk_bf16_f32 v50, v56, v57
M v,28,a,84,v,148
T 116,117,45056
T 118,117,47104
s_waitcnt lgkmcnt(6)
M v,32,a,88,v,144
T 120,118,45056
T 122,118,47104
M v,36,a,88,v,148
v_cvt_pk_bf16_f32 v51, v58, v59
M v,40,a,92,v,144
T 124,119,45056
T 126,119,47104
M v,44,a,92,v,148
T 64,116,49152
T 66,116,51200
M v,16,a,96,v,160
buffer_store_dwordx4 v[48:51], v7, s[12:15], s35 offen offset:0 sc1
M v,20,a,96,v,164
T 68,117,49152
T 70,117,51200
M v,24,a,100,v,160
T 72,118,49152
T 74,118,51200
M v,28,a,100,v,164
v_cvt_pk_bf16_f32 v52, v52, v53
M v,32,a,104,v,160
T 76,119,49152
T 78,119,51200
M v,36,a,104,v,164
v_cvt_pk_bf16_f32 v53, v54, v55
s_waitcnt lgkmcnt(6)
M v,40,a,108,v,160
T 80,116,53248
T 82,116,55296
M v,44,a,108,v,164
T 84,117,53248
T 86,117,55296
M v,16,a,112,v,176
v_cvt_pk_bf16_f32 v54, v60, v61
M v,20,a,112,v,180
T 88,118,53248
T 90,118,55296
M v,24,a,116,v,176
T 92,119,53248
T 94,119,55296
M v,28,a,116,v,180
v_cvt_pk_bf16_f32 v55, v62, v63
M v,32,a,120,v,176
T 96,116,57344
T 98,116,59392
M v,36,a,120,v,180
T 100,117,57344
T 102,117,59392
M v,40,a,124,v,176
buffer_store_dwordx4 v[52:55], v7, s[12:15], s35 offen offset:1024 sc1
M v,44,a,124,v,180
T 104,118,57344
T 106,118,59392
M v,16,a,64,v,192
v_cvt_pk_bf16_f32 v64, v64, v65
M v,20,a,64,v,196
T 108,119,57344
T 110,119,59392
s_waitcnt lgkmcnt(6)
M v,24,a,68,v,192
T 112,116,61440
T 114,116,63488
M v,28,a,68,v,196
v_cvt_pk_bf16_f32 v65, v66, v67
M v,32,a,72,v,192
T 116,117,61440
T 118,117,63488
M v,36,a,72,v,196
T 120,118,61440
T 122,118,63488
M v,40,a,76,v,192
v_cvt_pk_bf16_f32 v66, v72, v73
M v,44,a,76,v,196
T 124,119,61440
T 126,119,63488
M v,16,a,80,v,208
M v,20,a,80,v,212
v_cvt_pk_bf16_f32 v67, v74, v75
M v,24,a,84,v,208
M v,28,a,84,v,212
M v,32,a,88,v,208
buffer_store_dwordx4 v[64:67], v7, s[12:15], s35 offen offset:2048 sc1
M v,36,a,88,v,212
M v,40,a,92,v,208
M v,44,a,92,v,212
v_cvt_pk_bf16_f32 v68, v68, v69
M v,16,a,96,v,224
M v,20,a,96,v,228
s_waitcnt lgkmcnt(0)
M v,24,a,100,v,224
v_cvt_pk_bf16_f32 v69, v70, v71
M v,28,a,100,v,228
M v,32,a,104,v,224
M v,36,a,104,v,228
v_cvt_pk_bf16_f32 v70, v76, v77
M v,40,a,108,v,224
M v,44,a,108,v,228
M v,16,a,112,v,240
v_cvt_pk_bf16_f32 v71, v78, v79
M v,20,a,112,v,244
M v,24,a,116,v,240
M v,28,a,116,v,244
buffer_store_dwordx4 v[68:71], v7, s[12:15], s35 offen offset:3072 sc1
M v,32,a,120,v,240
M v,36,a,120,v,244
M v,40,a,124,v,240
M v,44,a,124,v,244
s_nop 7
s_add_u32 s35, s42, 24576
v_cvt_pk_bf16_f32 v16, v16, v17
v_cvt_pk_bf16_f32 v17, v18, v19
v_cvt_pk_bf16_f32 v18, v24, v25
v_cvt_pk_bf16_f32 v19, v26, v27
buffer_store_dwordx4 v[16:19], v7, s[12:15], s35 offen offset:0 sc1
v_cvt_pk_bf16_f32 v20, v20, v21
v_cvt_pk_bf16_f32 v21, v22, v23
v_cvt_pk_bf16_f32 v22, v28, v29
v_cvt_pk_bf16_f32 v23, v30, v31
buffer_store_dwordx4 v[20:23], v7, s[12:15], s35 offen offset:1024 sc1
v_cvt_pk_bf16_f32 v32, v32, v33
v_cvt_pk_bf16_f32 v33, v34, v35
v_cvt_pk_bf16_f32 v34, v40, v41
v_cvt_pk_bf16_f32 v35, v42, v43
buffer_store_dwordx4 v[32:35], v7, s[12:15], s35 offen offset:2048 sc1
v_cvt_pk_bf16_f32 v36, v36, v37
v_cvt_pk_bf16_f32 v37, v38, v39
v_cvt_pk_bf16_f32 v38, v44, v45
v_cvt_pk_bf16_f32 v39, v46, v47
buffer_store_dwordx4 v[36:39], v7, s[12:15], s35 offen offset:3072 sc1
s_endpgm
K2_n4:
s_cmp_lg_u32 s67, 0
s_cbranch_scc1 K2_h4
s_waitcnt lgkmcnt(0)
v_mfma_f32_16x16x32_bf16 v[32:35], a[64:67], a[0:3], v[72:75]
R 96,4,40960
v_mfma_f32_16x16x32_bf16 v[36:39], a[64:67], a[4:7], v[76:79]
R 100,4,41984
s_add_u32 m0, s32, 81920
M v,32,a,68,a,8
R 104,4,43008
M v,36,a,68,a,12
R 108,4,44032
C 6,12,s33,0
M v,32,a,72,a,16
R 112,4,45056
M v,36,a,72,a,20
R 116,4,46080
C 6,12,s33,1024
M v,32,a,76,a,24
R 120,4,47104
M v,36,a,76,a,28
R 124,4,48128
C 6,12,s33,2048
M v,32,a,80,a,32
v_exp_f32 v64, v16
M v,36,a,80,a,36
C 6,12,s33,3072
M v,32,a,84,a,40
v_exp_f32 v65, v17
M v,36,a,84,a,44
s_add_u32 s33, s33, 0x8000
M v,32,a,88,a,48
v_exp_f32 v66, v18
M v,36,a,88,a,52
v_add_f32 v80, v84, v64
v_add_f32 v81, v85, v65
M v,32,a,92,a,56
v_cvt_pk_bf16_f32 v48, v64, v65
M v,36,a,92,a,60
v_exp_f32 v67, v19
s_waitcnt lgkmcnt(0)
v_mfma_f32_16x16x32_bf16 v[40:43], a[96:99], a[0:3], v[72:75]
s_waitcnt vmcnt(12) lgkmcnt(0)
s_barrier
s_cmp_eq_u32 s89, 0
s_cbranch_scc1 PS_a04
s_mov_b64 exec, 1
v_mov_b32 v127, s66
buffer_store_dword v127, off, s[12:15], s89 sc1
s_mov_b64 exec, -1
s_mov_b32 s89, 0
PS_a04:
v_mfma_f32_16x16x32_bf16 v[44:47], a[96:99], a[4:7], v[76:79]
R 64,3,0
R 68,3,1024
M v,40,a,100,a,8
R 72,3,2048
R 76,3,3072
M v,44,a,100,a,12
R 80,3,4096
R 84,3,5120
M v,40,a,104,a,16
R 88,3,6144
R 92,3,7168
M v,44,a,104,a,20
v_exp_f32 v68, v24
M v,40,a,108,a,24
v_add_f32 v80, v80, v66
v_add_f32 v81, v81, v67
M v,44,a,108,a,28
v_cvt_pk_bf16_f32 v49, v66, v67
M v,40,a,112,a,32
v_exp_f32 v69, v25
M v,44,a,112,a,36
v_exp_f32 v70, v26
M v,40,a,116,a,40
v_add_f32 v80, v80, v68
v_add_f32 v81, v81, v69
M v,44,a,116,a,44
v_cvt_pk_bf16_f32 v50, v68, v69
M v,40,a,120,a,48
v_exp_f32 v71, v27
M v,44,a,120,a,52
s_nop 0
v_add_f32 v80, v80, v70
M v,40,a,124,a,56
v_add_f32 v81, v81, v71
v_cvt_pk_bf16_f32 v51, v70, v71
M v,44,a,124,a,60
v_exp_f32 v64, v20
v_exp_f32 v65, v21
v_exp_f32 v66, v22
v_add_f32 v82, v86, v64
v_add_f32 v83, v87, v65
v_cvt_pk_bf16_f32 v52, v64, v65
v_exp_f32 v67, v23
v_exp_f32 v68, v28
v_add_f32 v82, v82, v66
v_add_f32 v83, v83, v67
v_cvt_pk_bf16_f32 v53, v66, v67
v_exp_f32 v69, v29
v_exp_f32 v70, v30
v_add_f32 v82, v82, v68
v_add_f32 v83, v83, v69
v_cvt_pk_bf16_f32 v54, v68, v69
v_exp_f32 v71, v31
s_nop 0
v_add_f32 v82, v82, v70
v_add_f32 v83, v83, v71
v_cvt_pk_bf16_f32 v55, v70, v71
v_max3_f32 v14, v80, v81, v82
v_max_f32 v14, v14, v83
v_cmp_lt_f32 vcc, s37, v14
v_mov_b64 v[128:129], 0
v_mov_b64 v[130:131], 0
v_mov_b64 v[132:133], 0
v_mov_b64 v[134:135], 0
v_mov_b64 v[136:137], 0
v_mov_b64 v[138:139], 0
v_mov_b64 v[140:141], 0
v_mov_b64 v[142:143], 0
v_mov_b64 v[144:145], 0
v_mov_b64 v[146:147], 0
v_mov_b64 v[148:149], 0
v_mov_b64 v[150:151], 0
v_mov_b64 v[152:153], 0
v_mov_b64 v[154:155], 0
v_mov_b64 v[156:157], 0
v_mov_b64 v[158:159], 0
v_mov_b64 v[160:161], 0
v_mov_b64 v[162:163], 0
v_mov_b64 v[164:165], 0
v_mov_b64 v[166:167], 0
v_mov_b64 v[168:169], 0
v_mov_b64 v[170:171], 0
v_mov_b64 v[172:173], 0
v_mov_b64 v[174:175], 0
v_mov_b64 v[176:177], 0
v_mov_b64 v[178:179], 0
v_mov_b64 v[180:181], 0
v_mov_b64 v[182:183], 0
v_mov_b64 v[184:185], 0
v_mov_b64 v[186:187], 0
v_mov_b64 v[188:189], 0
v_mov_b64 v[190:191], 0
v_mov_b64 v[192:193], 0
v_mov_b64 v[194:195], 0
v_mov_b64 v[196:197], 0
v_mov_b64 v[198:199], 0
v_mov_b64 v[200:201], 0
v_mov_b64 v[202:203], 0
v_mov_b64 v[204:205], 0
v_mov_b64 v[206:207], 0
v_mov_b64 v[208:209], 0
v_mov_b64 v[210:211], 0
v_mov_b64 v[212:213], 0
v_mov_b64 v[214:215], 0
v_mov_b64 v[216:217], 0
v_mov_b64 v[218:219], 0
v_mov_b64 v[220:221], 0
v_mov_b64 v[222:223], 0
v_mov_b64 v[224:225], 0
v_mov_b64 v[226:227], 0
v_mov_b64 v[228:229], 0
v_mov_b64 v[230:231], 0
v_mov_b64 v[232:233], 0
v_mov_b64 v[234:235], 0
v_mov_b64 v[236:237], 0
v_mov_b64 v[238:239], 0
v_mov_b64 v[240:241], 0
v_mov_b64 v[242:243], 0
v_mov_b64 v[244:245], 0
v_mov_b64 v[246:247], 0
v_mov_b64 v[248:249], 0
v_mov_b64 v[250:251], 0
v_mov_b64 v[252:253], 0
v_mov_b64 v[254:255], 0
s_nop 0
s_cbranch_vccnz RARE_a04
BACK_a04:
s_branch K2_am1
K2_h4:
s_waitcnt lgkmcnt(0)
v_mfma_f32_16x16x32_bf16 v[32:35], a[64:67], a[0:3], v[72:75]
R 96,4,40960
v_mfma_f32_16x16x32_bf16 v[36:39], a[64:67], a[4:7], v[76:79]
R 100,4,41984
s_add_u32 m0, s32, 81920
M v,32,a,68,a,8
R 104,4,43008
C 6,12,s33,0
M v,36,a,68,a,12
R 108,4,44032
C 6,12,s33,1024
M v,32,a,72,a,16
R 112,4,45056
C 6,12,s33,2048
M v,36,a,72,a,20
R 116,4,46080
C 6,12,s33,3072
M v,32,a,76,a,24
R 120,4,47104
s_add_u32 s33, s33, 0x8000
M v,36,a,76,a,28
R 124,4,48128
s_add_u32 m0, s32, 65536
M v,32,a,80,a,32
C 5,12,s3,0
M v,36,a,80,a,36
C 5,12,s3,1024
M v,32,a,84,a,40
C 5,12,s3,2048
M v,36,a,84,a,44
C 5,12,s3,3072
M v,32,a,88,a,48
s_add_u32 s3, s3, 0x8000
M v,36,a,88,a,52
v_exp_f32 v64, v16
M v,32,a,92,a,56
v_exp_f32 v65, v17
M v,36,a,92,a,60
v_exp_f32 v66, v18
s_waitcnt lgkmcnt(0)
v_mfma_f32_16x16x32_bf16 v[40:43], a[96:99], a[0:3], v[72:75]
s_waitcnt vmcnt(16) lgkmcnt(0)
s_barrier
s_cmp_eq_u32 s89, 0
s_cbranch_scc1 PS_h04
s_mov_b64 exec, 1
v_mov_b32 v127, s66
buffer_store_dword v127, off, s[12:15], s89 sc1
s_mov_b64 exec, -1
s_mov_b32 s89, 0
PS_h04:
v_mfma_f32_16x16x32_bf16 v[44:47], a[96:99], a[4:7], v[76:79]
R 64,3,0
R 68,3,1024
M v,40,a,100,a,8
R 72,3,2048
R 76,3,3072
M v,44,a,100,a,12
R 80,3,4096
R 84,3,5120
M v,40,a,104,a,16
R 88,3,6144
R 92,3,7168
M v,44,a,104,a,20
v_add_f32 v80, v84, v64
v_add_f32 v81, v85, v65
M v,40,a,108,a,24
v_cvt_pk_bf16_f32 v48, v64, v65
M v,44,a,108,a,28
v_exp_f32 v67, v19
M v,40,a,112,a,32
v_exp_f32 v68, v24
M v,44,a,112,a,36
v_add_f32 v80, v80, v66
v_add_f32 v81, v81, v67
M v,40,a,116,a,40
v_cvt_pk_bf16_f32 v49, v66, v67
M v,44,a,116,a,44
v_exp_f32 v69, v25
M v,40,a,120,a,48
v_exp_f32 v70, v26
M v,44,a,120,a,52
v_add_f32 v80, v80, v68
v_add_f32 v81, v81, v69
M v,40,a,124,a,56
v_cvt_pk_bf16_f32 v50, v68, v69
M v,44,a,124,a,60
v_exp_f32 v71, v27
s_nop 0
v_add_f32 v80, v80, v70
v_add_f32 v81, v81, v71
v_cvt_pk_bf16_f32 v51, v70, v71
v_exp_f32 v64, v20
v_exp_f32 v65, v21
v_exp_f32 v66, v22
v_add_f32 v82, v86, v64
v_add_f32 v83, v87, v65
v_cvt_pk_bf16_f32 v52, v64, v65
v_exp_f32 v67, v23
v_exp_f32 v68, v28
v_add_f32 v82, v82, v66
v_add_f32 v83, v83, v67
v_cvt_pk_bf16_f32 v53, v66, v67
v_exp_f32 v69, v29
v_exp_f32 v70, v30
v_add_f32 v82, v82, v68
v_add_f32 v83, v83, v69
v_cvt_pk_bf16_f32 v54, v68, v69
v_exp_f32 v71, v31
s_nop 0
v_add_f32 v82, v82, v70
v_add_f32 v83, v83, v71
v_cvt_pk_bf16_f32 v55, v70, v71
v_max3_f32 v14, v80, v81, v82
v_max_f32 v14, v14, v83
v_cmp_lt_f32 vcc, s37, v14
v_mov_b64 v[128:129], 0
v_mov_b64 v[130:131], 0
v_mov_b64 v[132:133], 0
v_mov_b64 v[134:135], 0
v_mov_b64 v[136:137], 0
v_mov_b64 v[138:139], 0
v_mov_b64 v[140:141], 0
v_mov_b64 v[142:143], 0
v_mov_b64 v[144:145], 0
v_mov_b64 v[146:147], 0
v_mov_b64 v[148:149], 0
v_mov_b64 v[150:151], 0
v_mov_b64 v[152:153], 0
v_mov_b64 v[154:155], 0
v_mov_b64 v[156:157], 0
v_mov_b64 v[158:159], 0
v_mov_b64 v[160:161], 0
v_mov_b64 v[162:163], 0
v_mov_b64 v[164:165], 0
v_mov_b64 v[166:167], 0
v_mov_b64 v[168:169], 0
v_mov_b64 v[170:171], 0
v_mov_b64 v[172:173], 0
v_mov_b64 v[174:175], 0
v_mov_b64 v[176:177], 0
v_mov_b64 v[178:179], 0
v_mov_b64 v[180:181], 0
v_mov_b64 v[182:183], 0
v_mov_b64 v[184:185], 0
v_mov_b64 v[186:187], 0
v_mov_b64 v[188:189], 0
v_mov_b64 v[190:191], 0
v_mov_b64 v[192:193], 0
v_mov_b64 v[194:195], 0
v_mov_b64 v[196:197], 0
v_mov_b64 v[198:199], 0
v_mov_b64 v[200:201], 0
v_mov_b64 v[202:203], 0
v_mov_b64 v[204:205], 0
v_mov_b64 v[206:207], 0
v_mov_b64 v[208:209], 0
v_mov_b64 v[210:211], 0
v_mov_b64 v[212:213], 0
v_mov_b64 v[214:215], 0
v_mov_b64 v[216:217], 0
v_mov_b64 v[218:219], 0
v_mov_b64 v[220:221], 0
v_mov_b64 v[222:223], 0
v_mov_b64 v[224:225], 0
v_mov_b64 v[226:227], 0
v_mov_b64 v[228:229], 0
v_mov_b64 v[230:231], 0
v_mov_b64 v[232:233], 0
v_mov_b64 v[234:235], 0
v_mov_b64 v[236:237], 0
v_mov_b64 v[238:239], 0
v_mov_b64 v[240:241], 0
v_mov_b64 v[242:243], 0
v_mov_b64 v[244:245], 0
v_mov_b64 v[246:247], 0
v_mov_b64 v[248:249], 0
v_mov_b64 v[250:251], 0
v_mov_b64 v[252:253], 0
v_mov_b64 v[254:255], 0
s_nop 0
s_cbranch_vccnz RARE_h04
BACK_h04:
s_branch MG_hm1
MG_giver:
s_waitcnt lgkmcnt(0)
v_mfma_f32_16x16x32_bf16 v[32:35], a[64:67], a[0:3], v[72:75]
R 96,4,40960
v_subrev_u32 v11, 0, v10
v_mfma_f32_16x16x32_bf16 v[36:39], a[64:67], a[4:7], v[76:79]
R 100,4,41984
s_sub_u32 s35, 15, s26
M v,32,a,68,a,8
v_cmp_le_i32_e64 s[40:41], -16, v11
v_cmp_le_i32_e64 s[42:43], -15, v11
M v,36,a,68,a,12
R 104,4,43008
v_cmp_le_i32_e64 s[44:45], -14, v11
M v,32,a,72,a,16
s_min_u32 s35, s35, s26
v_cmp_le_i32_e64 s[46:47], -13, v11
M v,36,a,72,a,20
R 108,4,44032
v_cmp_le_i32_e64 s[48:49], 0, v11
M v,32,a,76,a,24
R 112,4,45056
v_cmp_le_i32_e64 s[50:51], 1, v11
M v,36,a,76,a,28
s_lshl_b32 s91, s25, 3
v_cmp_le_i32_e64 s[52:53], 2, v11
M v,32,a,80,a,32
R 116,4,46080
v_cmp_le_i32_e64 s[54:55], 3, v11
M v,36,a,80,a,36
v_cmp_le_i32_e64 s[56:57], 16, v11
v_cmp_le_i32_e64 s[58:59], 17, v11
M v,32,a,84,a,40
R 120,4,47104
v_cmp_le_i32_e64 s[60:61], 18, v11
M v,36,a,84,a,44
R 124,4,48128
s_add_u32 s91, s91, s35
M v,32,a,88,a,48
v_cmp_le_i32_e64 s[62:63], 19, v11
v_cndmask_b32_e64 v16, v12, v16, s[48:49]
M v,36,a,88,a,52
R 64,4,49152
v_cndmask_b32_e64 v17, v12, v17, s[50:51]
M v,32,a,92,a,56
s_lshl_b32 s91, s91, 7
v_cndmask_b32_e64 v18, v12, v18, s[52:53]
M v,36,a,92,a,60
R 68,4,50176
v_cndmask_b32_e64 v19, v12, v19, s[54:55]
s_waitcnt lgkmcnt(3)
v_mfma_f32_16x16x32_bf16 v[40:43], a[96:99], a[0:3], v[72:75]
v_cndmask_b32_e64 v24, v12, v24, s[56:57]
v_cndmask_b32_e64 v25, v12, v25, s[58:59]
v_mfma_f32_16x16x32_bf16 v[44:47], a[96:99], a[4:7], v[76:79]
R 72,4,51200
v_cndmask_b32_e64 v26, v12, v26, s[60:61]
M v,40,a,100,a,8
R 76,4,52224
s_add_u32 s91, s91, 35655744
M v,44,a,100,a,12
v_cndmask_b32_e64 v27, v12, v27, s[62:63]
v_cndmask_b32_e64 v20, v12, v20, s[40:41]
M v,40,a,104,a,16
R 80,4,53248
v_cndmask_b32_e64 v21, v12, v21, s[42:43]
M v,44,a,104,a,20
buffer_load_dword v92, off, s[12:15], s91 sc1
v_cndmask_b32_e64 v22, v12, v22, s[44:45]
M v,40,a,108,a,24
R 84,4,54272
v_cndmask_b32_e64 v23, v12, v23, s[46:47]
M v,44,a,108,a,28
R 88,4,55296
v_cndmask_b32_e64 v28, v12, v28, s[48:49]
M v,40,a,112,a,32
v_cndmask_b32_e64 v29, v12, v29, s[50:51]
v_cndmask_b32_e64 v30, v12, v30, s[52:53]
M v,44,a,112,a,36
R 92,4,56320
s_add_u32 m0, s32, 81920
M v,40,a,116,a,40
v_cndmask_b32_e64 v31, v12, v31, s[54:55]
M v,44,a,116,a,44
R 96,4,57344
M v,40,a,120,a,48
C 6,12,s33,0
M v,44,a,120,a,52
R 100,4,58368
s_waitcnt lgkmcnt(3)
M v,40,a,124,a,56
R 104,4,59392
M v,44,a,124,a,60
v_exp_f32 v64, v16
M v,128,a,64,v,56
R 108,4,60416
C 6,12,s33,1024
M v,132,a,64,v,60
v_exp_f32 v65, v17
M v,136,a,68,v,56
R 112,4,61440
M v,140,a,68,v,60
R 116,4,62464
C 6,12,s33,2048
M v,144,a,72,v,56
v_exp_f32 v66, v18
M v,148,a,72,v,60
R 120,4,63488
v_add_f32 v80, v84, v64
M v,152,a,76,v,56
v_add_f32 v81, v85, v65
v_cvt_pk_bf16_f32 v48, v64, v65
M v,156,a,76,v,60
R 124,4,64512
C 6,12,s33,3072
M v,160,a,80,v,56
v_exp_f32 v67, v19
M v,164,a,80,v,60
v_exp_f32 v68, v24
M v,168,a,84,v,56
s_add_u32 s33, s33, 0x8000
v_add_f32 v80, v80, v66
M v,172,a,84,v,60
v_add_f32 v81, v81, v67
v_cvt_pk_bf16_f32 v49, v66, v67
M v,176,a,88,v,56
v_exp_f32 v69, v25
M v,180,a,88,v,60
v_exp_f32 v70, v26
s_waitcnt lgkmcnt(0)
M v,184,a,92,v,56
v_add_f32 v80, v80, v68
v_add_f32 v81, v81, v69
M v,188,a,92,v,60
v_cvt_pk_bf16_f32 v50, v68, v69
M v,192,a,96,v,56
s_waitcnt vmcnt(13) lgkmcnt(0)
s_barrier
M v,196,a,96,v,60
R 64,3,0
R 68,3,1024
M v,200,a,100,v,56
R 72,3,2048
R 76,3,3072
M v,204,a,100,v,60
R 80,3,4096
R 84,3,5120
M v,208,a,104,v,56
R 88,3,6144
R 92,3,7168
M v,212,a,104,v,60
v_exp_f32 v71, v27
M v,216,a,108,v,56
s_nop 0
v_add_f32 v80, v80, v70
M v,220,a,108,v,60
v_add_f32 v81, v81, v71
v_cvt_pk_bf16_f32 v51, v70, v71
M v,224,a,112,v,56
v_exp_f32 v64, v20
M v,228,a,112,v,60
v_exp_f32 v65, v21
M v,232,a,116,v,56
v_exp_f32 v66, v22
M v,236,a,116,v,60
v_add_f32 v82, v86, v64
v_add_f32 v83, v87, v65
M v,240,a,120,v,56
v_cvt_pk_bf16_f32 v52, v64, v65
M v,244,a,120,v,60
v_exp_f32 v67, v23
M v,248,a,124,v,56
v_exp_f32 v68, v28
M v,252,a,124,v,60
v_add_f32 v82, v82, v66
v_add_f32 v83, v83, v67
v_cvt_pk_bf16_f32 v53, v66, v67
v_exp_f32 v69, v29
v_exp_f32 v70, v30
v_add_f32 v82, v82, v68
v_add_f32 v83, v83, v69
v_cvt_pk_bf16_f32 v54, v68, v69
v_exp_f32 v71, v31
s_nop 0
v_add_f32 v82, v82, v70
v_add_f32 v83, v83, v71
v_cvt_pk_bf16_f32 v55, v70, v71
v_max3_f32 v14, v80, v81, v82
v_max_f32 v14, v14, v83
v_cmp_lt_f32 vcc, s37, v14
s_nop 0
s_cbranch_vccnz RARE_am0B
BACK_am0B:
s_waitcnt lgkmcnt(0)
v_mfma_f32_16x16x32_bf16 v[16:19], a[64:67], a[0:3], v[72:75]
R 96,3,8192
v_subrev_u32 v11, 32, v10
v_mfma_f32_16x16x32_bf16 v[20:23], a[64:67], a[4:7], v[76:79]
R 100,3,9216
s_add_u32 m0, s32, 98304
M v,16,a,68,a,8
v_cmp_le_i32_e64 s[40:41], -16, v11
v_cmp_le_i32_e64 s[42:43], -15, v11
M v,20,a,68,a,12
R 104,3,10240
v_cmp_le_i32_e64 s[44:45], -14, v11
M v,16,a,72,a,16
s_add_u32 s35, s39, 0
v_cmp_le_i32_e64 s[46:47], -13, v11
M v,20,a,72,a,20
R 108,3,11264
v_cmp_le_i32_e64 s[48:49], 0, v11
M v,16,a,76,a,24
R 112,3,12288
v_cmp_le_i32_e64 s[50:51], 1, v11
M v,20,a,76,a,28
v_cmp_le_i32_e64 s[52:53], 2, v11
v_cmp_le_i32_e64 s[54:55], 3, v11
M v,16,a,80,a,32
R 116,3,13312
L 112,80,s35,0
M v,20,a,80,a,36
v_cmp_le_i32_e64 s[56:57], 16, v11
v_cmp_le_i32_e64 s[58:59], 17, v11
M v,16,a,84,a,40
R 120,3,14336
v_cmp_le_i32_e64 s[60:61], 18, v11
M v,20,a,84,a,44
R 124,3,15360
v_cmp_le_i32_e64 s[62:63], 19, v11
M v,16,a,88,a,48
L 113,80,s35,1024
v_cndmask_b32_e64 v32, v12, v32, s[48:49]
M v,20,a,88,a,52
R 64,3,16384
v_cndmask_b32_e64 v33, v12, v33, s[50:51]
M v,16,a,92,a,56
v_cndmask_b32_e64 v34, v12, v34, s[52:53]
v_cndmask_b32_e64 v35, v12, v35, s[54:55]
M v,20,a,92,a,60
R 68,3,17408
v_cndmask_b32_e64 v40, v12, v40, s[56:57]
s_waitcnt lgkmcnt(3)
v_mfma_f32_16x16x32_bf16 v[24:27], a[96:99], a[0:3], v[72:75]
L 114,80,s35,2048
v_cndmask_b32_e64 v41, v12, v41, s[58:59]
v_mfma_f32_16x16x32_bf16 v[28:31], a[96:99], a[4:7], v[76:79]
R 72,3,18432
v_cndmask_b32_e64 v42, v12, v42, s[60:61]
M v,24,a,100,a,8
R 76,3,19456
v_cndmask_b32_e64 v43, v12, v43, s[62:63]
M v,28,a,100,a,12
L 115,80,s35,3072
v_cndmask_b32_e64 v36, v12, v36, s[40:41]
M v,24,a,104,a,16
R 80,3,20480
v_cndmask_b32_e64 v37, v12, v37, s[42:43]
M v,28,a,104,a,20
v_cndmask_b32_e64 v38, v12, v38, s[44:45]
v_cndmask_b32_e64 v39, v12, v39, s[46:47]
M v,24,a,108,a,24
R 84,3,21504
v_cndmask_b32_e64 v44, v12, v44, s[48:49]
M v,28,a,108,a,28
R 88,3,22528
s_add_u32 m0, s32, 114688
M v,24,a,112,a,32
v_cndmask_b32_e64 v45, v12, v45, s[50:51]
v_cndmask_b32_e64 v46, v12, v46, s[52:53]
M v,28,a,112,a,36
R 92,3,23552
v_cndmask_b32_e64 v47, v12, v47, s[54:55]
M v,24,a,116,a,40
v_exp_f32 v64, v32
M v,28,a,116,a,44
R 96,3,24576
C 6,12,s33,0
M v,24,a,120,a,48
v_exp_f32 v65, v33
M v,28,a,120,a,52
R 100,3,25600
s_waitcnt lgkmcnt(3)
M v,24,a,124,a,56
R 104,3,26624
M v,28,a,124,a,60
C 6,12,s33,1024
M v,128,a,64,v,48
R 108,3,27648
M v,132,a,64,v,52
v_exp_f32 v66, v34
M v,136,a,68,v,48
R 112,3,28672
C 6,12,s33,2048
M v,140,a,68,v,52
R 116,3,29696
v_add_f32 v84, v80, v64
M v,144,a,72,v,48
v_add_f32 v85, v81, v65
v_cvt_pk_bf16_f32 v56, v64, v65
M v,148,a,72,v,52
R 120,3,30720
M v,152,a,76,v,48
C 6,12,s33,3072
M v,156,a,76,v,52
R 124,3,31744
M v,160,a,80,v,48
v_exp_f32 v67, v35
M v,164,a,80,v,52
v_exp_f32 v68, v40
M v,168,a,84,v,48
s_add_u32 s33, s33, 0x8000
v_add_f32 v84, v84, v66
M v,172,a,84,v,52
v_add_f32 v85, v85, v67
v_cvt_pk_bf16_f32 v57, v66, v67
M v,176,a,88,v,48
v_exp_f32 v69, v41
M v,180,a,88,v,52
v_exp_f32 v70, v42
s_waitcnt lgkmcnt(0)
M v,184,a,92,v,48
v_add_f32 v84, v84, v68
v_add_f32 v85, v85, v69
M v,188,a,92,v,52
v_cvt_pk_bf16_f32 v58, v68, v69
M v,192,a,96,v,48
s_waitcnt vmcnt(12) lgkmcnt(0)
s_barrier
M v,196,a,96,v,52
R 64,3,32768
R 68,3,33792
M v,200,a,100,v,48
R 72,3,34816
R 76,3,35840
M v,204,a,100,v,52
R 80,3,36864
R 84,3,37888
M v,208,a,104,v,48
R 88,3,38912
R 92,3,39936
M v,212,a,104,v,52
v_exp_f32 v71, v43
M v,216,a,108,v,48
s_nop 0
v_add_f32 v84, v84, v70
M v,220,a,108,v,52
v_add_f32 v85, v85, v71
v_cvt_pk_bf16_f32 v59, v70, v71
M v,224,a,112,v,48
v_exp_f32 v64, v36
M v,228,a,112,v,52
v_exp_f32 v65, v37
M v,232,a,116,v,48
v_exp_f32 v66, v38
M v,236,a,116,v,52
v_add_f32 v86, v82, v64
v_add_f32 v87, v83, v65
M v,240,a,120,v,48
v_cvt_pk_bf16_f32 v60, v64, v65
M v,244,a,120,v,52
v_exp_f32 v67, v39
M v,248,a,124,v,48
v_exp_f32 v68, v44
M v,252,a,124,v,52
v_add_f32 v86, v86, v66
v_add_f32 v87, v87, v67
v_cvt_pk_bf16_f32 v61, v66, v67
v_exp_f32 v69, v45
v_exp_f32 v70, v46
v_add_f32 v86, v86, v68
v_add_f32 v87, v87, v69
v_cvt_pk_bf16_f32 v62, v68, v69
v_exp_f32 v71, v47
s_nop 0
v_add_f32 v86, v86, v70
v_add_f32 v87, v87, v71
v_cvt_pk_bf16_f32 v63, v70, v71
v_max3_f32 v14, v84, v85, v86
v_max_f32 v14, v14, v87
v_cmp_lt_f32 vcc, s37, v14
s_nop 0
s_cbranch_vccnz RARE_am1B
BACK_am1B:
v_cmp_ne_u32 vcc, s66, v92
s_nop 1
s_cbranch_vccnz SP_pf
SPB_pf:
s_waitcnt lgkmcnt(0)
v_mfma_f32_16x16x32_bf16 v[32:35], a[64:67], a[0:3], v[72:75]
R 96,3,40960
v_subrev_u32 v11, 64, v10
v_mfma_f32_16x16x32_bf16 v[36:39], a[64:67], a[4:7], v[76:79]
R 100,3,41984
s_sub_u32 s35, 15, s26
M v,32,a,68,a,8
s_min_u32 s35, s35, s26
v_cmp_le_i32_e64 s[40:41], -16, v11
M v,36,a,68,a,12
R 104,3,43008
s_lshl_b32 s91, s25, 3
M v,32,a,72,a,16
s_add_u32 s91, s91, s35
v_cmp_le_i32_e64 s[42:43], -15, v11
M v,36,a,72,a,20
R 108,3,44032
s_mul_i32 s91, s91, 0x21000
M v,32,a,76,a,24
R 112,3,45056
s_mul_i32 s35, s24, 0x8400
M v,36,a,76,a,28
s_add_u32 s91, s91, s35
v_cmp_le_i32_e64 s[44:45], -14, v11
M v,32,a,80,a,32
R 116,3,46080
s_add_u32 s91, s91, 100663296
M v,36,a,80,a,36
s_add_u32 s36, s91, 0x8000
v_cmp_le_i32_e64 s[46:47], -13, v11
M v,32,a,84,a,40
R 120,3,47104
buffer_load_dwordx4 v[88:91], v7, s[12:15], s36 offen sc1
M v,36,a,84,a,44
R 124,3,48128
s_add_u32 s36, s91, 0
M v,32,a,88,a,48
buffer_load_dwordx4 a[192:195], v7, s[12:15], s36 offen offset:0 sc1
v_cmp_le_i32_e64 s[48:49], 0, v11
M v,36,a,88,a,52
R 64,3,49152
buffer_load_dwordx4 a[196:199], v7, s[12:15], s36 offen offset:1024 sc1
M v,32,a,92,a,56
buffer_load_dwordx4 a[200:203], v7, s[12:15], s36 offen offset:2048 sc1
v_cmp_le_i32_e64 s[50:51], 1, v11
M v,36,a,92,a,60
R 68,3,50176
v_cmp_le_i32_e64 s[52:53], 2, v11
s_waitcnt lgkmcnt(3)
v_mfma_f32_16x16x32_bf16 v[40:43], a[96:99], a[0:3], v[72:75]
buffer_load_dwordx4 a[204:207], v7, s[12:15], s36 offen offset:3072 sc1
v_cmp_le_i32_e64 s[54:55], 3, v11
v_mfma_f32_16x16x32_bf16 v[44:47], a[96:99], a[4:7], v[76:79]
R 72,3,51200
s_add_u32 s36, s91, 4096
M v,40,a,100,a,8
R 76,3,52224
buffer_load_dwordx4 a[208:211], v7, s[12:15], s36 offen offset:0 sc1
M v,44,a,100,a,12
buffer_load_dwordx4 a[212:215], v7, s[12:15], s36 offen offset:1024 sc1
v_cmp_le_i32_e64 s[56:57], 16, v11
M v,40,a,104,a,16
R 80,3,53248
buffer_load_dwordx4 a[216:219], v7, s[12:15], s36 offen offset:2048 sc1
M v,44,a,104,a,20
buffer_load_dwordx4 a[220:223], v7, s[12:15], s36 offen offset:3072 sc1
v_cmp_le_i32_e64 s[58:59], 17, v11
M v,40,a,108,a,24
R 84,3,54272
s_add_u32 s36, s91, 8192
M v,44,a,108,a,28
R 88,3,55296
buffer_load_dwordx4 a[224:227], v7, s[12:15], s36 offen offset:0 sc1
M v,40,a,112,a,32
buffer_load_dwordx4 a[228:231], v7, s[12:15], s36 offen offset:1024 sc1
v_cmp_le_i32_e64 s[60:61], 18, v11
M v,44,a,112,a,36
R 92,3,56320
buffer_load_dwordx4 a[232:235], v7, s[12:15], s36 offen offset:2048 sc1
M v,40,a,116,a,40
buffer_load_dwordx4 a[236:239], v7, s[12:15], s36 offen offset:3072 sc1
v_cmp_le_i32_e64 s[62:63], 19, v11
M v,44,a,116,a,44
R 96,3,57344
s_add_u32 s36, s91, 12288
M v,40,a,120,a,48
buffer_load_dwordx4 a[240:243], v7, s[12:15], s36 offen offset:0 sc1
v_cndmask_b32_e64 v16, v12, v16, s[48:49]
M v,44,a,120,a,52
R 100,3,58368
buffer_load_dwordx4 a[244:247], v7, s[12:15], s36 offen offset:1024 sc1
s_waitcnt lgkmcnt(3)
M v,40,a,124,a,56
R 104,3,59392
v_cndmask_b32_e64 v17, v12, v17, s[50:51]
M v,44,a,124,a,60
buffer_load_dwordx4 a[248:251], v7, s[12:15], s36 offen offset:2048 sc1
v_cndmask_b32_e64 v18, v12, v18, s[52:53]
M v,128,a,64,v,56
R 108,3,60416
buffer_load_dwordx4 a[252:255], v7, s[12:15], s36 offen offset:3072 sc1
M v,132,a,64,v,60
s_add_u32 m0, s32, 0
v_cndmask_b32_e64 v19, v12, v19, s[54:55]
M v,136,a,68,v,56
R 112,3,61440
s_add_u32 s35, s38, 0
M v,140,a,68,v,60
R 116,3,62464
L 112,76,s35,0
M v,144,a,72,v,56
L 113,76,s35,1024
v_cndmask_b32_e64 v24, v12, v24, s[56:57]
M v,148,a,72,v,60
R 120,3,63488
L 114,76,s35,2048
M v,152,a,76,v,56
L 115,76,s35,3072
v_cndmask_b32_e64 v25, v12, v25, s[58:59]
M v,156,a,76,v,60
R 124,3,64512
s_add_u32 m0, s32, 16384
M v,160,a,80,v,56
s_add_u32 s35, s38, 114688
v_cndmask_b32_e64 v26, v12, v26, s[60:61]
M v,164,a,80,v,60
L 112,76,s35,0
v_cndmask_b32_e64 v27, v12, v27, s[62:63]
M v,168,a,84,v,56
L 113,76,s35,1024
v_cndmask_b32_e64 v20, v12, v20, s[40:41]
M v,172,a,84,v,60
L 114,76,s35,2048
v_cndmask_b32_e64 v21, v12, v21, s[42:43]
M v,176,a,88,v,56
L 115,76,s35,3072
v_cndmask_b32_e64 v22, v12, v22, s[44:45]
M v,180,a,88,v,60
v_cndmask_b32_e64 v23, v12, v23, s[46:47]
v_cndmask_b32_e64 v28, v12, v28, s[48:49]
s_waitcnt lgkmcnt(0)
M v,184,a,92,v,56
v_cndmask_b32_e64 v29, v12, v29, s[50:51]
v_cndmask_b32_e64 v30, v12, v30, s[52:53]
M v,188,a,92,v,60
v_cndmask_b32_e64 v31, v12, v31, s[54:55]
M v,192,a,96,v,56
s_waitcnt vmcnt(33) lgkmcnt(0)
s_barrier
M v,196,a,96,v,60
R 64,4,16384
R 68,4,17408
M v,200,a,100,v,56
R 72,4,18432
R 76,4,19456
M v,204,a,100,v,60
R 80,4,20480
R 84,4,21504
M v,208,a,104,v,56
R 88,4,22528
R 92,4,23552
M v,212,a,104,v,60
v_exp_f32 v64, v16
M v,216,a,108,v,56
v_exp_f32 v65, v17
M v,220,a,108,v,60
v_exp_f32 v66, v18
M v,224,a,112,v,56
v_add_f32 v80, v84, v64
v_add_f32 v81, v85, v65
M v,228,a,112,v,60
v_cvt_pk_bf16_f32 v48, v64, v65
M v,232,a,116,v,56
v_exp_f32 v67, v19
M v,236,a,116,v,60
v_exp_f32 v68, v24
M v,240,a,120,v,56
v_add_f32 v80, v80, v66
v_add_f32 v81, v81, v67
M v,244,a,120,v,60
v_cvt_pk_bf16_f32 v49, v66, v67
M v,248,a,124,v,56
v_exp_f32 v69, v25
M v,252,a,124,v,60
v_exp_f32 v70, v26
v_add_f32 v80, v80, v68
v_add_f32 v81, v81, v69
v_cvt_pk_bf16_f32 v50, v68, v69
v_exp_f32 v71, v27
s_nop 0
v_add_f32 v80, v80, v70
v_add_f32 v81, v81, v71
v_cvt_pk_bf16_f32 v51, v70, v71
v_exp_f32 v64, v20
v_exp_f32 v65, v21
v_exp_f32 v66, v22
v_add_f32 v82, v86, v64
v_add_f32 v83, v87, v65
v_cvt_pk_bf16_f32 v52, v64, v65
v_exp_f32 v67, v23
v_exp_f32 v68, v28
v_add_f32 v82, v82, v66
v_add_f32 v83, v83, v67
v_cvt_pk_bf16_f32 v53, v66, v67
v_exp_f32 v69, v29
v_exp_f32 v70, v30
v_add_f32 v82, v82, v68
v_add_f32 v83, v83, v69
v_cvt_pk_bf16_f32 v54, v68, v69
v_exp_f32 v71, v31
s_nop 0
v_add_f32 v82, v82, v70
v_add_f32 v83, v83, v71
v_cvt_pk_bf16_f32 v55, v70, v71
v_max3_f32 v14, v80, v81, v82
v_max_f32 v14, v14, v83
v_cmp_lt_f32 vcc, s37, v14
s_nop 0
s_cbranch_vccnz RARE_am2B
BACK_am2B:
s_waitcnt lgkmcnt(0)
M v,128,a,64,v,48
R 96,4,24576
v_subrev_u32 v11, 96, v10
M v,132,a,64,v,52
R 100,4,25600
s_add_u32 m0, s32, 32768
M v,136,a,68,v,48
R 104,4,26624
s_add_u32 s35, s39, 128
M v,140,a,68,v,52
R 108,4,27648
L 112,80,s35,0
M v,144,a,72,v,48
R 112,4,28672
L 113,80,s35,1024
M v,148,a,72,v,52
R 116,4,29696
L 114,80,s35,2048
M v,152,a,76,v,48
R 120,4,30720
L 115,80,s35,3072
M v,156,a,76,v,52
R 124,4,31744
s_add_u32 m0, s32, 49152
M v,160,a,80,v,48
s_add_u32 s35, s38, 128
v_cmp_le_i32_e64 s[40:41], -16, v11
M v,164,a,80,v,52
L 112,76,s35,0
v_cmp_le_i32_e64 s[42:43], -15, v11
M v,168,a,84,v,48
L 113,76,s35,1024
v_cmp_le_i32_e64 s[44:45], -14, v11
M v,172,a,84,v,52
L 114,76,s35,2048
v_cmp_le_i32_e64 s[46:47], -13, v11
M v,176,a,88,v,48
L 115,76,s35,3072
v_cmp_le_i32_e64 s[48:49], 0, v11
M v,180,a,88,v,52
v_cmp_le_i32_e64 s[50:51], 1, v11
v_cmp_le_i32_e64 s[52:53], 2, v11
M v,184,a,92,v,48
v_cmp_le_i32_e64 s[54:55], 3, v11
v_cmp_le_i32_e64 s[56:57], 16, v11
M v,188,a,92,v,52
v_cmp_le_i32_e64 s[58:59], 17, v11
v_cmp_le_i32_e64 s[60:61], 18, v11
s_waitcnt lgkmcnt(0)
M v,192,a,96,v,48
s_waitcnt vmcnt(33) lgkmcnt(0)
s_barrier
M v,196,a,96,v,52
R 64,4,49152
R 68,4,50176
M v,200,a,100,v,48
R 72,4,51200
R 76,4,52224
M v,204,a,100,v,52
R 80,4,53248
R 84,4,54272
M v,208,a,104,v,48
R 88,4,55296
R 92,4,56320
M v,212,a,104,v,52
v_cmp_le_i32_e64 s[62:63], 19, v11
v_cndmask_b32_e64 v32, v12, v32, s[48:49]
M v,216,a,108,v,48
v_cndmask_b32_e64 v33, v12, v33, s[50:51]
v_cndmask_b32_e64 v34, v12, v34, s[52:53]
M v,220,a,108,v,52
v_cndmask_b32_e64 v35, v12, v35, s[54:55]
v_cndmask_b32_e64 v40, v12, v40, s[56:57]
M v,224,a,112,v,48
v_cndmask_b32_e64 v41, v12, v41, s[58:59]
v_cndmask_b32_e64 v42, v12, v42, s[60:61]
M v,228,a,112,v,52
v_cndmask_b32_e64 v43, v12, v43, s[62:63]
v_cndmask_b32_e64 v36, v12, v36, s[40:41]
M v,232,a,116,v,48
v_cndmask_b32_e64 v37, v12, v37, s[42:43]
v_cndmask_b32_e64 v38, v12, v38, s[44:45]
M v,236,a,116,v,52
v_cndmask_b32_e64 v39, v12, v39, s[46:47]
v_cndmask_b32_e64 v44, v12, v44, s[48:49]
M v,240,a,120,v,48
v_cndmask_b32_e64 v45, v12, v45, s[50:51]
v_cndmask_b32_e64 v46, v12, v46, s[52:53]
M v,244,a,120,v,52
v_cndmask_b32_e64 v47, v12, v47, s[54:55]
M v,248,a,124,v,48
v_exp_f32 v64, v32
M v,252,a,124,v,52
v_exp_f32 v65, v33
v_exp_f32 v66, v34
v_add_f32 v84, v80, v64
v_add_f32 v85, v81, v65
v_cvt_pk_bf16_f32 v56, v64, v65
v_exp_f32 v67, v35
v_exp_f32 v68, v40
v_add_f32 v84, v84, v66
v_add_f32 v85, v85, v67
v_cvt_pk_bf16_f32 v57, v66, v67
v_exp_f32 v69, v41
v_exp_f32 v70, v42
v_add_f32 v84, v84, v68
v_add_f32 v85, v85, v69
v_cvt_pk_bf16_f32 v58, v68, v69
v_exp_f32 v71, v43
s_nop 0
v_add_f32 v84, v84, v70
v_add_f32 v85, v85, v71
v_cvt_pk_bf16_f32 v59, v70, v71
v_exp_f32 v64, v36
v_exp_f32 v65, v37
v_exp_f32 v66, v38
v_add_f32 v86, v82, v64
v_add_f32 v87, v83, v65
v_cvt_pk_bf16_f32 v60, v64, v65
v_exp_f32 v67, v39
v_exp_f32 v68, v44
v_add_f32 v86, v86, v66
v_add_f32 v87, v87, v67
v_cvt_pk_bf16_f32 v61, v66, v67
v_exp_f32 v69, v45
v_exp_f32 v70, v46
v_add_f32 v86, v86, v68
v_add_f32 v87, v87, v69
v_cvt_pk_bf16_f32 v62, v68, v69
v_exp_f32 v71, v47
s_nop 0
v_add_f32 v86, v86, v70
v_add_f32 v87, v87, v71
v_cvt_pk_bf16_f32 v63, v70, v71
v_max3_f32 v14, v84, v85, v86
v_max_f32 v14, v14, v87
v_cmp_lt_f32 vcc, s37, v14
s_nop 0
s_cbranch_vccnz RARE_am3B
BACK_am3B:
s_lshl_b32 s42, s25, 4
s_add_u32 s42, s42, s26
s_lshl_b32 s42, s42, 2
s_add_u32 s42, s42, s24
s_mul_i32 s42, s42, 28672
s_add_u32 s42, s42, 36700160
s_waitcnt lgkmcnt(0)
M v,128,a,64,v,56
R 96,4,57344
s_waitcnt vmcnt(16)
M v,132,a,64,v,60
R 100,4,58368
v_sub_f32 v92, v72, v88
M v,136,a,68,v,56
v_sub_f32 v93, v76, v90
v_add_f32 v72, v84, v85
M v,140,a,68,v,60
R 104,4,59392
v_mov_b32 v13, v72
M v,144,a,72,v,56
s_nop 1
v_permlane32_swap_b32 v72, v13
M v,148,a,72,v,60
R 108,4,60416
s_nop 1
M v,152,a,76,v,56
R 112,4,61440
v_add_f32 v72, v72, v13
M v,156,a,76,v,60
v_mov_b32 v13, v72
s_nop 1
M v,160,a,80,v,56
R 116,4,62464
v_permlane16_swap_b32 v72, v13
M v,164,a,80,v,60
s_nop 1
v_add_f32 v72, v72, v13
M v,168,a,84,v,56
R 120,4,63488
v_min_f32 v94, 0, v92
M v,172,a,84,v,60
R 124,4,64512
v_sub_f32 v92, 0, v92
M v,176,a,88,v,56
v_min_f32 v92, 0, v92
v_exp_f32 v94, v94
M v,180,a,88,v,60
T 64,120,32768
T 66,120,34816
M v,184,a,92,v,56
v_exp_f32 v92, v92
s_nop 0
M v,188,a,92,v,60
T 68,121,32768
T 70,121,34816
s_waitcnt lgkmcnt(5)
M v,192,a,96,v,56
v_mul_f32 v72, v72, v92
v_fmac_f32 v72, v94, v89
M v,196,a,96,v,60
T 72,122,32768
T 74,122,34816
M v,200,a,100,v,56
T 76,123,32768
T 78,123,34816
M v,204,a,100,v,60
v_rcp_f32 v72, v72
s_nop 0
M v,208,a,104,v,56
T 80,120,36864
T 82,120,38912
M v,212,a,104,v,60
v_mul_f32 v72, v72, v8
v_mul_f32 v94, v94, v72
M v,216,a,108,v,56
T 84,121,36864
T 86,121,38912
M v,220,a,108,v,60
T 88,122,36864
T 90,122,38912
M v,224,a,112,v,56
v_mul_f32 v72, v72, v92
v_add_f32 v74, v86, v87
M v,228,a,112,v,60
T 92,123,36864
T 94,123,38912
M v,232,a,116,v,56
v_mov_b32 v13, v74
s_nop 1
M v,236,a,116,v,60
T 96,120,40960
T 98,120,43008
M v,240,a,120,v,56
v_permlane32_swap_b32 v74, v13
s_nop 1
M v,244,a,120,v,60
T 100,121,40960
T 102,121,43008
s_waitcnt lgkmcnt(6)
M v,248,a,124,v,56
T 104,122,40960
T 106,122,43008
M v,252,a,124,v,60
s_add_u32 m0, s32, 65536
s_add_u32 s35, s38, 114816
Z v,16,a,64,a,128
T 108,123,40960
T 110,123,43008
Z v,20,a,64,a,132
L 112,76,s35,0
v_add_f32 v74, v74, v13
Z v,24,a,68,a,128
T 112,120,45056
T 114,120,47104
Z v,28,a,68,a,132
T 116,121,45056
T 118,121,47104
Z v,32,a,72,a,128
L 113,76,s35,1024
L 114,76,s35,2048
Z v,36,a,72,a,132
T 120,122,45056
T 122,122,47104
Z v,40,a,76,a,128
L 115,76,s35,3072
s_add_u32 m0, s32, 81920
Z v,44,a,76,a,132
T 124,123,45056
T 126,123,47104
M v,16,a,80,a,136
s_add_u32 s35, s39, 256
L 112,80,s35,0
M v,20,a,80,a,140
v_mov_b32 v13, v74
s_nop 1
M v,24,a,84,a,136
L 113,80,s35,1024
v_permlane16_swap_b32 v74, v13
M v,28,a,84,a,140
L 114,80,s35,2048
s_nop 1
M v,32,a,88,a,136
L 115,80,s35,3072
v_add_f32 v74, v74, v13
M v,36,a,88,a,140
v_min_f32 v96, 0, v93
v_sub_f32 v93, 0, v93
s_waitcnt lgkmcnt(0)
M v,40,a,92,a,136
v_min_f32 v93, 0, v93
v_exp_f32 v96, v96
M v,44,a,92,a,140
v_exp_f32 v93, v93
s_nop 0
M v,16,a,96,a,144
s_waitcnt vmcnt(16) lgkmcnt(0)
s_barrier
M v,20,a,96,a,148
T 64,116,0
T 66,116,2048
M v,24,a,100,a,144
T 68,117,0
T 70,117,2048
M v,28,a,100,a,148
T 72,118,0
T 74,118,2048
M v,32,a,104,a,144
T 76,119,0
T 78,119,2048
M v,36,a,104,a,148
T 80,116,4096
T 82,116,6144
M v,40,a,108,a,144
T 84,117,4096
T 86,117,6144
M v,44,a,108,a,148
v_mul_f32 v74, v74, v93
v_fmac_f32 v74, v96, v91
M v,16,a,112,a,152
v_rcp_f32 v74, v74
s_nop 0
M v,20,a,112,a,156
v_mul_f32 v74, v74, v9
v_mul_f32 v96, v96, v74
M v,24,a,116,a,152
v_mul_f32 v74, v74, v93
v_accvgpr_read_b32 v98, a192
M v,28,a,116,a,156
v_mul_f32 v128, v72, v128
v_and_b32 v99, 0xffff0000, v98
M v,32,a,120,a,152
v_lshlrev_b32 v98, 16, v98
v_mul_f32 v129, v72, v129
M v,36,a,120,a,156
v_fmac_f32 v128, v98, v94
v_fmac_f32 v129, v99, v94
M v,40,a,124,a,152
v_accvgpr_read_b32 v100, a193
v_mul_f32 v130, v72, v130
M v,44,a,124,a,156
v_and_b32 v101, 0xffff0000, v100
v_lshlrev_b32 v100, 16, v100
v_mul_f32 v131, v72, v131
v_fmac_f32 v130, v100, v94
v_fmac_f32 v131, v101, v94
v_accvgpr_read_b32 v102, a196
v_mul_f32 v136, v72, v136
v_and_b32 v103, 0xffff0000, v102
v_lshlrev_b32 v102, 16, v102
v_mul_f32 v137, v72, v137
v_fmac_f32 v136, v102, v94
v_fmac_f32 v137, v103, v94
v_accvgpr_read_b32 v98, a197
v_mul_f32 v138, v72, v138
v_and_b32 v99, 0xffff0000, v98
v_lshlrev_b32 v98, 16, v98
v_mul_f32 v139, v72, v139
v_fmac_f32 v138, v98, v94
v_fmac_f32 v139, v99, v94
v_cvt_pk_bf16_f32 v128, v128, v129
v_cvt_pk_bf16_f32 v129, v130, v131
v_cvt_pk_bf16_f32 v130, v136, v137
v_cvt_pk_bf16_f32 v131, v138, v139
v_accvgpr_read_b32 v100, a194
v_mul_f32 v132, v74, v132
v_and_b32 v101, 0xffff0000, v100
v_lshlrev_b32 v100, 16, v100
v_mul_f32 v133, v74, v133
v_fmac_f32 v132, v100, v96
v_fmac_f32 v133, v101, v96
v_accvgpr_read_b32 v102, a195
v_mul_f32 v134, v74, v134
v_and_b32 v103, 0xffff0000, v102
v_lshlrev_b32 v102, 16, v102
v_mul_f32 v135, v74, v135
v_fmac_f32 v134, v102, v96
v_fmac_f32 v135, v103, v96
v_accvgpr_read_b32 v98, a198
v_mul_f32 v140, v74, v140
v_and_b32 v99, 0xffff0000, v98
v_lshlrev_b32 v98, 16, v98
v_mul_f32 v141, v74, v141
v_fmac_f32 v140, v98, v96
v_fmac_f32 v141, v99, v96
v_accvgpr_read_b32 v100, a199
v_mul_f32 v142, v74, v142
v_and_b32 v101, 0xffff0000, v100
v_lshlrev_b32 v100, 16, v100
v_mul_f32 v143, v74, v143
v_fmac_f32 v142, v100, v96
v_fmac_f32 v143, v101, v96
v_cvt_pk_bf16_f32 v132, v132, v133
v_cvt_pk_bf16_f32 v133, v134, v135
v_cvt_pk_bf16_f32 v134, v140, v141
v_cvt_pk_bf16_f32 v135, v142, v143
v_accvgpr_read_b32 v102, a200
v_mul_f32 v144, v72, v144
v_and_b32 v103, 0xffff0000, v102
v_lshlrev_b32 v102, 16, v102
v_mul_f32 v145, v72, v145
v_fmac_f32 v144, v102, v94
v_fmac_f32 v145, v103, v94
v_accvgpr_read_b32 v98, a201
v_mul_f32 v146, v72, v146
v_and_b32 v99, 0xffff0000, v98
v_lshlrev_b32 v98, 16, v98
v_mul_f32 v147, v72, v147
v_fmac_f32 v146, v98, v94
v_fmac_f32 v147, v99, v94
v_accvgpr_read_b32 v100, a204
v_mul_f32 v152, v72, v152
v_and_b32 v101, 0xffff0000, v100
v_lshlrev_b32 v100, 16, v100
v_mul_f32 v153, v72, v153
v_fmac_f32 v152, v100, v94
v_fmac_f32 v153, v101, v94
v_accvgpr_read_b32 v102, a205
v_mul_f32 v154, v72, v154
v_and_b32 v103, 0xffff0000, v102
v_lshlrev_b32 v102, 16, v102
v_mul_f32 v155, v72, v155
v_fmac_f32 v154, v102, v94
v_fmac_f32 v155, v103, v94
v_cvt_pk_bf16_f32 v144, v144, v145
v_cvt_pk_bf16_f32 v145, v146, v147
v_cvt_pk_bf16_f32 v146, v152, v153
v_cvt_pk_bf16_f32 v147, v154, v155
v_accvgpr_read_b32 v98, a202
v_mul_f32 v148, v74, v148
v_and_b32 v99, 0xffff0000, v98
v_lshlrev_b32 v98, 16, v98
v_mul_f32 v149, v74, v149
v_fmac_f32 v148, v98, v96
v_fmac_f32 v149, v99, v96
v_accvgpr_read_b32 v100, a203
v_mul_f32 v150, v74, v150
v_and_b32 v101, 0xffff0000, v100
v_lshlrev_b32 v100, 16, v100
v_mul_f32 v151, v74, v151
v_fmac_f32 v150, v100, v96
v_fmac_f32 v151, v101, v96
v_accvgpr_read_b32 v102, a206
v_mul_f32 v156, v74, v156
v_and_b32 v103, 0xffff0000, v102
v_lshlrev_b32 v102, 16, v102
v_mul_f32 v157, v74, v157
v_fmac_f32 v156, v102, v96
v_fmac_f32 v157, v103, v96
v_accvgpr_read_b32 v98, a207
v_mul_f32 v158, v74, v158
v_and_b32 v99, 0xffff0000, v98
v_lshlrev_b32 v98, 16, v98
v_mul_f32 v159, v74, v159
v_fmac_f32 v158, v98, v96
v_fmac_f32 v159, v99, v96
v_cvt_pk_bf16_f32 v148, v148, v149
v_cvt_pk_bf16_f32 v149, v150, v151
v_cvt_pk_bf16_f32 v150, v156, v157
v_cvt_pk_bf16_f32 v151, v158, v159
v_accvgpr_read_b32 v100, a208
v_mul_f32 v160, v72, v160
v_and_b32 v101, 0xffff0000, v100
v_lshlrev_b32 v100, 16, v100
v_mul_f32 v161, v72, v161
v_fmac_f32 v160, v100, v94
v_fmac_f32 v161, v101, v94
v_accvgpr_read_b32 v102, a209
v_mul_f32 v162, v72, v162
v_and_b32 v103, 0xffff0000, v102
v_lshlrev_b32 v102, 16, v102
v_mul_f32 v163, v72, v163
v_fmac_f32 v162, v102, v94
v_fmac_f32 v163, v103, v94
v_accvgpr_read_b32 v98, a212
v_mul_f32 v168, v72, v168
v_and_b32 v99, 0xffff0000, v98
v_lshlrev_b32 v98, 16, v98
v_mul_f32 v169, v72, v169
v_fmac_f32 v168, v98, v94
v_fmac_f32 v169, v99, v94
v_accvgpr_read_b32 v100, a213
v_mul_f32 v170, v72, v170
v_and_b32 v101, 0xffff0000, v100
v_lshlrev_b32 v100, 16, v100
v_mul_f32 v171, v72, v171
v_fmac_f32 v170, v100, v94
v_fmac_f32 v171, v101, v94
v_cvt_pk_bf16_f32 v160, v160, v161
v_cvt_pk_bf16_f32 v161, v162, v163
v_cvt_pk_bf16_f32 v162, v168, v169
v_cvt_pk_bf16_f32 v163, v170, v171
v_accvgpr_read_b32 v102, a210
v_mul_f32 v164, v74, v164
v_and_b32 v103, 0xffff0000, v102
v_lshlrev_b32 v102, 16, v102
v_mul_f32 v165, v74, v165
v_fmac_f32 v164, v102, v96
v_fmac_f32 v165, v103, v96
v_accvgpr_read_b32 v98, a211
v_mul_f32 v166, v74, v166
v_and_b32 v99, 0xffff0000, v98
v_lshlrev_b32 v98, 16, v98
v_mul_f32 v167, v74, v167
v_fmac_f32 v166, v98, v96
v_fmac_f32 v167, v99, v96
v_accvgpr_read_b32 v100, a214
v_mul_f32 v172, v74, v172
v_and_b32 v101, 0xffff0000, v100
v_lshlrev_b32 v100, 16, v100
v_mul_f32 v173, v74, v173
v_fmac_f32 v172, v100, v96
v_fmac_f32 v173, v101, v96
v_accvgpr_read_b32 v102, a215
v_mul_f32 v174, v74, v174
v_and_b32 v103, 0xffff0000, v102
v_lshlrev_b32 v102, 16, v102
v_mul_f32 v175, v74, v175
v_fmac_f32 v174, v102, v96
v_fmac_f32 v175, v103, v96
v_cvt_pk_bf16_f32 v164, v164, v165
v_cvt_pk_bf16_f32 v165, v166, v167
v_cvt_pk_bf16_f32 v166, v172, v173
v_cvt_pk_bf16_f32 v167, v174, v175
v_accvgpr_read_b32 v98, a216
v_mul_f32 v176, v72, v176
v_and_b32 v99, 0xffff0000, v98
v_lshlrev_b32 v98, 16, v98
v_mul_f32 v177, v72, v177
v_fmac_f32 v176, v98, v94
v_fmac_f32 v177, v99, v94
v_accvgpr_read_b32 v100, a217
v_mul_f32 v178, v72, v178
v_and_b32 v101, 0xffff0000, v100
v_lshlrev_b32 v100, 16, v100
v_mul_f32 v179, v72, v179
v_fmac_f32 v178, v100, v94
v_fmac_f32 v179, v101, v94
v_accvgpr_read_b32 v102, a220
v_mul_f32 v184, v72, v184
v_and_b32 v103, 0xffff0000, v102
v_lshlrev_b32 v102, 16, v102
v_mul_f32 v185, v72, v185
v_fmac_f32 v184, v102, v94
v_fmac_f32 v185, v103, v94
v_accvgpr_read_b32 v98, a221
v_mul_f32 v186, v72, v186
v_and_b32 v99, 0xffff0000, v98
v_lshlrev_b32 v98, 16, v98
v_mul_f32 v187, v72, v187
v_fmac_f32 v186, v98, v94
v_fmac_f32 v187, v99, v94
v_cvt_pk_bf16_f32 v176, v176, v177
v_cvt_pk_bf16_f32 v177, v178, v179
v_cvt_pk_bf16_f32 v178, v184, v185
v_cvt_pk_bf16_f32 v179, v186, v187
v_accvgpr_read_b32 v100, a218
v_mul_f32 v180, v74, v180
v_and_b32 v101, 0xffff0000, v100
v_lshlrev_b32 v100, 16, v100
v_mul_f32 v181, v74, v181
v_fmac_f32 v180, v100, v96
v_fmac_f32 v181, v101, v96
v_accvgpr_read_b32 v102, a219
v_mul_f32 v182, v74, v182
v_and_b32 v103, 0xffff0000, v102
v_lshlrev_b32 v102, 16, v102
v_mul_f32 v183, v74, v183
v_fmac_f32 v182, v102, v96
v_fmac_f32 v183, v103, v96
v_accvgpr_read_b32 v98, a222
v_mul_f32 v188, v74, v188
v_and_b32 v99, 0xffff0000, v98
v_lshlrev_b32 v98, 16, v98
v_mul_f32 v189, v74, v189
v_fmac_f32 v188, v98, v96
v_fmac_f32 v189, v99, v96
v_accvgpr_read_b32 v100, a223
v_mul_f32 v190, v74, v190
v_and_b32 v101, 0xffff0000, v100
v_lshlrev_b32 v100, 16, v100
v_mul_f32 v191, v74, v191
v_fmac_f32 v190, v100, v96
v_fmac_f32 v191, v101, v96
v_cvt_pk_bf16_f32 v180, v180, v181
v_cvt_pk_bf16_f32 v181, v182, v183
v_cvt_pk_bf16_f32 v182, v188, v189
v_cvt_pk_bf16_f32 v183, v190, v191
v_accvgpr_read_b32 v102, a224
v_mul_f32 v192, v72, v192
v_and_b32 v103, 0xffff0000, v102
v_lshlrev_b32 v102, 16, v102
v_mul_f32 v193, v72, v193
v_fmac_f32 v192, v102, v94
v_fmac_f32 v193, v103, v94
v_accvgpr_read_b32 v98, a225
v_mul_f32 v194, v72, v194
v_and_b32 v99, 0xffff0000, v98
v_lshlrev_b32 v98, 16, v98
v_mul_f32 v195, v72, v195
v_fmac_f32 v194, v98, v94
v_fmac_f32 v195, v99, v94
v_accvgpr_read_b32 v100, a228
v_mul_f32 v200, v72, v200
v_and_b32 v101, 0xffff0000, v100
v_lshlrev_b32 v100, 16, v100
v_mul_f32 v201, v72, v201
v_fmac_f32 v200, v100, v94
v_fmac_f32 v201, v101, v94
v_accvgpr_read_b32 v102, a229
v_mul_f32 v202, v72, v202
v_and_b32 v103, 0xffff0000, v102
v_lshlrev_b32 v102, 16, v102
v_mul_f32 v203, v72, v203
v_fmac_f32 v202, v102, v94
v_fmac_f32 v203, v103, v94
v_cvt_pk_bf16_f32 v192, v192, v193
v_cvt_pk_bf16_f32 v193, v194, v195
v_cvt_pk_bf16_f32 v194, v200, v201
v_cvt_pk_bf16_f32 v195, v202, v203
v_accvgpr_read_b32 v98, a226
v_mul_f32 v196, v74, v196
v_and_b32 v99, 0xffff0000, v98
v_lshlrev_b32 v98, 16, v98
v_mul_f32 v197, v74, v197
v_fmac_f32 v196, v98, v96
v_fmac_f32 v197, v99, v96
v_accvgpr_read_b32 v100, a227
v_mul_f32 v198, v74, v198
v_and_b32 v101, 0xffff0000, v100
v_lshlrev_b32 v100, 16, v100
v_mul_f32 v199, v74, v199
v_fmac_f32 v198, v100, v96
v_fmac_f32 v199, v101, v96
v_accvgpr_read_b32 v102, a230
v_mul_f32 v204, v74, v204
v_and_b32 v103, 0xffff0000, v102
v_lshlrev_b32 v102, 16, v102
v_mul_f32 v205, v74, v205
v_fmac_f32 v204, v102, v96
v_fmac_f32 v205, v103, v96
v_accvgpr_read_b32 v98, a231
v_mul_f32 v206, v74, v206
v_and_b32 v99, 0xffff0000, v98
v_lshlrev_b32 v98, 16, v98
v_mul_f32 v207, v74, v207
v_fmac_f32 v206, v98, v96
v_fmac_f32 v207, v99, v96
v_cvt_pk_bf16_f32 v196, v196, v197
v_cvt_pk_bf16_f32 v197, v198, v199
v_cvt_pk_bf16_f32 v198, v204, v205
v_cvt_pk_bf16_f32 v199, v206, v207
v_accvgpr_read_b32 v100, a232
v_mul_f32 v208, v72, v208
v_and_b32 v101, 0xffff0000, v100
v_lshlrev_b32 v100, 16, v100
v_mul_f32 v209, v72, v209
v_fmac_f32 v208, v100, v94
v_fmac_f32 v209, v101, v94
v_accvgpr_read_b32 v102, a233
v_mul_f32 v210, v72, v210
v_and_b32 v103, 0xffff0000, v102
v_lshlrev_b32 v102, 16, v102
v_mul_f32 v211, v72, v211
v_fmac_f32 v210, v102, v94
v_fmac_f32 v211, v103, v94
v_accvgpr_read_b32 v98, a236
v_mul_f32 v216, v72, v216
v_and_b32 v99, 0xffff0000, v98
v_lshlrev_b32 v98, 16, v98
v_mul_f32 v217, v72, v217
v_fmac_f32 v216, v98, v94
v_fmac_f32 v217, v99, v94
v_accvgpr_read_b32 v100, a237
v_mul_f32 v218, v72, v218
v_and_b32 v101, 0xffff0000, v100
v_lshlrev_b32 v100, 16, v100
v_mul_f32 v219, v72, v219
v_fmac_f32 v218, v100, v94
v_fmac_f32 v219, v101, v94
v_cvt_pk_bf16_f32 v208, v208, v209
v_cvt_pk_bf16_f32 v209, v210, v211
v_cvt_pk_bf16_f32 v210, v216, v217
v_cvt_pk_bf16_f32 v211, v218, v219
v_accvgpr_read_b32 v102, a234
v_mul_f32 v212, v74, v212
v_and_b32 v103, 0xffff0000, v102
v_lshlrev_b32 v102, 16, v102
v_mul_f32 v213, v74, v213
v_fmac_f32 v212, v102, v96
v_fmac_f32 v213, v103, v96
v_accvgpr_read_b32 v98, a235
v_mul_f32 v214, v74, v214
v_and_b32 v99, 0xffff0000, v98
v_lshlrev_b32 v98, 16, v98
v_mul_f32 v215, v74, v215
v_fmac_f32 v214, v98, v96
v_fmac_f32 v215, v99, v96
v_accvgpr_read_b32 v100, a238
v_mul_f32 v220, v74, v220
v_and_b32 v101, 0xffff0000, v100
v_lshlrev_b32 v100, 16, v100
v_mul_f32 v221, v74, v221
v_fmac_f32 v220, v100, v96
v_fmac_f32 v221, v101, v96
v_accvgpr_read_b32 v102, a239
v_mul_f32 v222, v74, v222
v_and_b32 v103, 0xffff0000, v102
v_lshlrev_b32 v102, 16, v102
v_mul_f32 v223, v74, v223
v_fmac_f32 v222, v102, v96
v_fmac_f32 v223, v103, v96
v_cvt_pk_bf16_f32 v212, v212, v213
v_cvt_pk_bf16_f32 v213, v214, v215
v_cvt_pk_bf16_f32 v214, v220, v221
v_cvt_pk_bf16_f32 v215, v222, v223
v_accvgpr_read_b32 v98, a240
v_mul_f32 v224, v72, v224
v_and_b32 v99, 0xffff0000, v98
v_lshlrev_b32 v98, 16, v98
v_mul_f32 v225, v72, v225
v_fmac_f32 v224, v98, v94
v_fmac_f32 v225, v99, v94
v_accvgpr_read_b32 v100, a241
v_mul_f32 v226, v72, v226
v_and_b32 v101, 0xffff0000, v100
v_lshlrev_b32 v100, 16, v100
v_mul_f32 v227, v72, v227
v_fmac_f32 v226, v100, v94
v_fmac_f32 v227, v101, v94
v_accvgpr_read_b32 v102, a244
v_mul_f32 v232, v72, v232
v_and_b32 v103, 0xffff0000, v102
v_lshlrev_b32 v102, 16, v102
v_mul_f32 v233, v72, v233
v_fmac_f32 v232, v102, v94
v_fmac_f32 v233, v103, v94
v_accvgpr_read_b32 v98, a245
v_mul_f32 v234, v72, v234
v_and_b32 v99, 0xffff0000, v98
v_lshlrev_b32 v98, 16, v98
v_mul_f32 v235, v72, v235
v_fmac_f32 v234, v98, v94
v_fmac_f32 v235, v99, v94
v_cvt_pk_bf16_f32 v224, v224, v225
v_cvt_pk_bf16_f32 v225, v226, v227
v_cvt_pk_bf16_f32 v226, v232, v233
v_cvt_pk_bf16_f32 v227, v234, v235
v_accvgpr_read_b32 v100, a242
v_mul_f32 v228, v74, v228
v_and_b32 v101, 0xffff0000, v100
v_lshlrev_b32 v100, 16, v100
v_mul_f32 v229, v74, v229
v_fmac_f32 v228, v100, v96
v_fmac_f32 v229, v101, v96
v_accvgpr_read_b32 v102, a243
v_mul_f32 v230, v74, v230
v_and_b32 v103, 0xffff0000, v102
v_lshlrev_b32 v102, 16, v102
v_mul_f32 v231, v74, v231
v_fmac_f32 v230, v102, v96
v_fmac_f32 v231, v103, v96
v_accvgpr_read_b32 v98, a246
v_mul_f32 v236, v74, v236
v_and_b32 v99, 0xffff0000, v98
v_lshlrev_b32 v98, 16, v98
v_mul_f32 v237, v74, v237
v_fmac_f32 v236, v98, v96
v_fmac_f32 v237, v99, v96
v_accvgpr_read_b32 v100, a247
v_mul_f32 v238, v74, v238
v_and_b32 v101, 0xffff0000, v100
v_lshlrev_b32 v100, 16, v100
v_mul_f32 v239, v74, v239
v_fmac_f32 v238, v100, v96
v_fmac_f32 v239, v101, v96
v_cvt_pk_bf16_f32 v228, v228, v229
v_cvt_pk_bf16_f32 v229, v230, v231
v_cvt_pk_bf16_f32 v230, v236, v237
v_cvt_pk_bf16_f32 v231, v238, v239
v_accvgpr_read_b32 v102, a248
v_mul_f32 v240, v72, v240
v_and_b32 v103, 0xffff0000, v102
v_lshlrev_b32 v102, 16, v102
v_mul_f32 v241, v72, v241
v_fmac_f32 v240, v102, v94
v_fmac_f32 v241, v103, v94
v_accvgpr_read_b32 v98, a249
v_mul_f32 v242, v72, v242
v_and_b32 v99, 0xffff0000, v98
v_lshlrev_b32 v98, 16, v98
v_mul_f32 v243, v72, v243
v_fmac_f32 v242, v98, v94
v_fmac_f32 v243, v99, v94
v_accvgpr_read_b32 v100, a252
v_mul_f32 v248, v72, v248
v_and_b32 v101, 0xffff0000, v100
v_lshlrev_b32 v100, 16, v100
v_mul_f32 v249, v72, v249
v_fmac_f32 v248, v100, v94
v_fmac_f32 v249, v101, v94
v_accvgpr_read_b32 v102, a253
v_mul_f32 v250, v72, v250
v_and_b32 v103, 0xffff0000, v102
v_lshlrev_b32 v102, 16, v102
v_mul_f32 v251, v72, v251
v_fmac_f32 v250, v102, v94
v_fmac_f32 v251, v103, v94
v_cvt_pk_bf16_f32 v240, v240, v241
v_cvt_pk_bf16_f32 v241, v242, v243
v_cvt_pk_bf16_f32 v242, v248, v249
v_cvt_pk_bf16_f32 v243, v250, v251
v_accvgpr_read_b32 v98, a250
v_mul_f32 v244, v74, v244
v_and_b32 v99, 0xffff0000, v98
v_lshlrev_b32 v98, 16, v98
v_mul_f32 v245, v74, v245
v_fmac_f32 v244, v98, v96
v_fmac_f32 v245, v99, v96
v_accvgpr_read_b32 v100, a251
v_mul_f32 v246, v74, v246
v_and_b32 v101, 0xffff0000, v100
v_lshlrev_b32 v100, 16, v100
v_mul_f32 v247, v74, v247
v_fmac_f32 v246, v100, v96
v_fmac_f32 v247, v101, v96
v_accvgpr_read_b32 v102, a254
v_mul_f32 v252, v74, v252
v_and_b32 v103, 0xffff0000, v102
v_lshlrev_b32 v102, 16, v102
v_mul_f32 v253, v74, v253
v_fmac_f32 v252, v102, v96
v_fmac_f32 v253, v103, v96
v_accvgpr_read_b32 v98, a255
v_mul_f32 v254, v74, v254
v_and_b32 v99, 0xffff0000, v98
v_lshlrev_b32 v98, 16, v98
v_mul_f32 v255, v74, v255
v_fmac_f32 v254, v98, v96
v_fmac_f32 v255, v99, v96
v_cvt_pk_bf16_f32 v244, v244, v245
v_cvt_pk_bf16_f32 v245, v246, v247
v_cvt_pk_bf16_f32 v246, v252, v253
v_cvt_pk_bf16_f32 v247, v254, v255
s_branch MG_out
MG_help:
s_waitcnt lgkmcnt(0)
v_mfma_f32_16x16x32_bf16 v[32:35], a[64:67], a[0:3], v[72:75]
R 96,4,40960
v_mfma_f32_16x16x32_bf16 v[36:39], a[64:67], a[4:7], v[76:79]
R 100,4,41984
s_add_u32 m0, s32, 81920
M v,32,a,68,a,8
v_exp_f32 v64, v16
M v,36,a,68,a,12
R 104,4,43008
M v,32,a,72,a,16
C 6,12,s33,0
M v,36,a,72,a,20
R 108,4,44032
M v,32,a,76,a,24
R 112,4,45056
M v,36,a,76,a,28
v_exp_f32 v65, v17
M v,32,a,80,a,32
R 116,4,46080
C 6,12,s33,1024
M v,36,a,80,a,36
v_exp_f32 v66, v18
M v,32,a,84,a,40
R 120,4,47104
v_add_f32 v80, v84, v64
M v,36,a,84,a,44
R 124,4,48128
v_add_f32 v81, v85, v65
M v,32,a,88,a,48
C 6,12,s33,2048
v_cvt_pk_bf16_f32 v48, v64, v65
M v,36,a,88,a,52
R 64,4,49152
M v,32,a,92,a,56
v_exp_f32 v67, v19
M v,36,a,92,a,60
R 68,4,50176
s_waitcnt lgkmcnt(3)
v_mfma_f32_16x16x32_bf16 v[40:43], a[96:99], a[0:3], v[72:75]
C 6,12,s33,3072
v_mfma_f32_16x16x32_bf16 v[44:47], a[96:99], a[4:7], v[76:79]
R 72,4,51200
M v,40,a,100,a,8
R 76,4,52224
M v,44,a,100,a,12
s_add_u32 s33, s33, 0x8000
M v,40,a,104,a,16
R 80,4,53248
M v,44,a,104,a,20
v_exp_f32 v68, v24
M v,40,a,108,a,24
R 84,4,54272
v_add_f32 v80, v80, v66
M v,44,a,108,a,28
R 88,4,55296
s_add_u32 m0, s32, 65536
M v,40,a,112,a,32
v_add_f32 v81, v81, v67
v_cvt_pk_bf16_f32 v49, v66, v67
M v,44,a,112,a,36
R 92,4,56320
M v,40,a,116,a,40
v_exp_f32 v69, v25
M v,44,a,116,a,44
R 96,4,57344
C 5,12,s3,0
M v,40,a,120,a,48
v_exp_f32 v70, v26
M v,44,a,120,a,52
R 100,4,58368
v_add_f32 v80, v80, v68
s_waitcnt lgkmcnt(3)
M v,40,a,124,a,56
R 104,4,59392
v_add_f32 v81, v81, v69
M v,44,a,124,a,60
C 5,12,s3,1024
v_cvt_pk_bf16_f32 v50, v68, v69
M v,128,a,64,v,56
R 108,4,60416
M v,132,a,64,v,60
v_exp_f32 v71, v27
M v,136,a,68,v,56
R 112,4,61440
C 5,12,s3,2048
M v,140,a,68,v,60
R 116,4,62464
s_nop 0
M v,144,a,72,v,56
v_add_f32 v80, v80, v70
v_add_f32 v81, v81, v71
M v,148,a,72,v,60
R 120,4,63488
v_cvt_pk_bf16_f32 v51, v70, v71
M v,152,a,76,v,56
C 5,12,s3,3072
M v,156,a,76,v,60
R 124,4,64512
M v,160,a,80,v,56
v_exp_f32 v64, v20
M v,164,a,80,v,60
v_exp_f32 v65, v21
M v,168,a,84,v,56
s_add_u32 s3, s3, 0x8000
M v,172,a,84,v,60
v_exp_f32 v66, v22
M v,176,a,88,v,56
v_add_f32 v82, v86, v64
v_add_f32 v83, v87, v65
M v,180,a,88,v,60
v_cvt_pk_bf16_f32 v52, v64, v65
s_waitcnt lgkmcnt(0)
M v,184,a,92,v,56
v_exp_f32 v67, v23
M v,188,a,92,v,60
v_exp_f32 v68, v28
M v,192,a,96,v,56
s_waitcnt vmcnt(16) lgkmcnt(0)
s_barrier
M v,196,a,96,v,60
R 64,3,0
R 68,3,1024
M v,200,a,100,v,56
R 72,3,2048
R 76,3,3072
M v,204,a,100,v,60
R 80,3,4096
R 84,3,5120
M v,208,a,104,v,56
R 88,3,6144
R 92,3,7168
M v,212,a,104,v,60
v_add_f32 v82, v82, v66
v_add_f32 v83, v83, v67
M v,216,a,108,v,56
v_cvt_pk_bf16_f32 v53, v66, v67
M v,220,a,108,v,60
v_exp_f32 v69, v29
M v,224,a,112,v,56
v_exp_f32 v70, v30
M v,228,a,112,v,60
v_add_f32 v82, v82, v68
v_add_f32 v83, v83, v69
M v,232,a,116,v,56
v_cvt_pk_bf16_f32 v54, v68, v69
M v,236,a,116,v,60
v_exp_f32 v71, v31
M v,240,a,120,v,56
s_nop 0
v_add_f32 v82, v82, v70
M v,244,a,120,v,60
v_add_f32 v83, v83, v71
v_cvt_pk_bf16_f32 v55, v70, v71
M v,248,a,124,v,56
v_max3_f32 v14, v80, v81, v82
v_max_f32 v14, v14, v83
M v,252,a,124,v,60
v_cmp_lt_f32 vcc, s37, v14
s_nop 0
s_cbranch_vccnz RARE_h0
BACK_h0:
MG_hm1:
s_waitcnt lgkmcnt(0)
v_mfma_f32_16x16x32_bf16 v[16:19], a[64:67], a[0:3], v[72:75]
R 96,3,8192
v_mfma_f32_16x16x32_bf16 v[20:23], a[64:67], a[4:7], v[76:79]
R 100,3,9216
s_add_u32 m0, s32, 114688
M v,16,a,68,a,8
v_exp_f32 v64, v32
M v,20,a,68,a,12
R 104,3,10240
M v,16,a,72,a,16
C 6,12,s33,0
M v,20,a,72,a,20
R 108,3,11264
M v,16,a,76,a,24
R 112,3,12288
M v,20,a,76,a,28
v_exp_f32 v65, v33
M v,16,a,80,a,32
R 116,3,13312
C 6,12,s33,1024
M v,20,a,80,a,36
v_exp_f32 v66, v34
M v,16,a,84,a,40
R 120,3,14336
v_add_f32 v84, v80, v64
M v,20,a,84,a,44
R 124,3,15360
v_add_f32 v85, v81, v65
M v,16,a,88,a,48
C 6,12,s33,2048
v_cvt_pk_bf16_f32 v56, v64, v65
M v,20,a,88,a,52
R 64,3,16384
M v,16,a,92,a,56
v_exp_f32 v67, v35
M v,20,a,92,a,60
R 68,3,17408
s_waitcnt lgkmcnt(3)
v_mfma_f32_16x16x32_bf16 v[24:27], a[96:99], a[0:3], v[72:75]
C 6,12,s33,3072
v_mfma_f32_16x16x32_bf16 v[28:31], a[96:99], a[4:7], v[76:79]
R 72,3,18432
M v,24,a,100,a,8
R 76,3,19456
M v,28,a,100,a,12
s_add_u32 s33, s33, 0x8000
M v,24,a,104,a,16
R 80,3,20480
M v,28,a,104,a,20
v_exp_f32 v68, v40
M v,24,a,108,a,24
R 84,3,21504
v_add_f32 v84, v84, v66
M v,28,a,108,a,28
R 88,3,22528
s_add_u32 m0, s32, 98304
M v,24,a,112,a,32
v_add_f32 v85, v85, v67
v_cvt_pk_bf16_f32 v57, v66, v67
M v,28,a,112,a,36
R 92,3,23552
M v,24,a,116,a,40
v_exp_f32 v69, v41
M v,28,a,116,a,44
R 96,3,24576
C 5,12,s3,0
M v,24,a,120,a,48
v_exp_f32 v70, v42
M v,28,a,120,a,52
R 100,3,25600
v_add_f32 v84, v84, v68
s_waitcnt lgkmcnt(3)
M v,24,a,124,a,56
R 104,3,26624
v_add_f32 v85, v85, v69
M v,28,a,124,a,60
C 5,12,s3,1024
v_cvt_pk_bf16_f32 v58, v68, v69
M v,128,a,64,v,48
R 108,3,27648
M v,132,a,64,v,52
v_exp_f32 v71, v43
M v,136,a,68,v,48
R 112,3,28672
C 5,12,s3,2048
M v,140,a,68,v,52
R 116,3,29696
s_nop 0
M v,144,a,72,v,48
v_add_f32 v84, v84, v70
v_add_f32 v85, v85, v71
M v,148,a,72,v,52
R 120,3,30720
v_cvt_pk_bf16_f32 v59, v70, v71
M v,152,a,76,v,48
C 5,12,s3,3072
M v,156,a,76,v,52
R 124,3,31744
M v,160,a,80,v,48
v_exp_f32 v64, v36
M v,164,a,80,v,52
v_exp_f32 v65, v37
M v,168,a,84,v,48
s_add_u32 s3, s3, 0x8000
M v,172,a,84,v,52
v_exp_f32 v66, v38
M v,176,a,88,v,48
v_add_f32 v86, v82, v64
v_add_f32 v87, v83, v65
M v,180,a,88,v,52
v_cvt_pk_bf16_f32 v60, v64, v65
s_waitcnt lgkmcnt(0)
M v,184,a,92,v,48
v_exp_f32 v67, v39
M v,188,a,92,v,52
v_exp_f32 v68, v44
M v,192,a,96,v,48
s_waitcnt vmcnt(16) lgkmcnt(0)
s_barrier
M v,196,a,96,v,52
R 64,3,32768
R 68,3,33792
M v,200,a,100,v,48
R 72,3,34816
R 76,3,35840
M v,204,a,100,v,52
R 80,3,36864
R 84,3,37888
M v,208,a,104,v,48
R 88,3,38912
R 92,3,39936
M v,212,a,104,v,52
v_add_f32 v86, v86, v66
v_add_f32 v87, v87, v67
M v,216,a,108,v,48
v_cvt_pk_bf16_f32 v61, v66, v67
M v,220,a,108,v,52
v_exp_f32 v69, v45
M v,224,a,112,v,48
v_exp_f32 v70, v46
M v,228,a,112,v,52
v_add_f32 v86, v86, v68
v_add_f32 v87, v87, v69
M v,232,a,116,v,48
v_cvt_pk_bf16_f32 v62, v68, v69
M v,236,a,116,v,52
v_exp_f32 v71, v47
M v,240,a,120,v,48
s_nop 0
v_add_f32 v86, v86, v70
M v,244,a,120,v,52
v_add_f32 v87, v87, v71
v_cvt_pk_bf16_f32 v63, v70, v71
M v,248,a,124,v,48
v_max3_f32 v14, v84, v85, v86
v_max_f32 v14, v14, v87
M v,252,a,124,v,52
v_cmp_lt_f32 vcc, s37, v14
s_nop 0
s_cbranch_vccnz RARE_h1
BACK_h1:
s_waitcnt lgkmcnt(0)
v_mfma_f32_16x16x32_bf16 v[32:35], a[64:67], a[0:3], v[72:75]
R 96,3,40960
v_mfma_f32_16x16x32_bf16 v[36:39], a[64:67], a[4:7], v[76:79]
R 100,3,41984
s_add_u32 m0, s32, 0
M v,32,a,68,a,8
v_exp_f32 v64, v16
M v,36,a,68,a,12
R 104,3,43008
M v,32,a,72,a,16
v_exp_f32 v65, v17
M v,36,a,72,a,20
R 108,3,44032
C 5,12,s3,0
M v,32,a,76,a,24
R 112,3,45056
M v,36,a,76,a,28
v_exp_f32 v66, v18
M v,32,a,80,a,32
R 116,3,46080
v_add_f32 v80, v84, v64
M v,36,a,80,a,36
C 5,12,s3,1024
v_add_f32 v81, v85, v65
M v,32,a,84,a,40
R 120,3,47104
v_cvt_pk_bf16_f32 v48, v64, v65
M v,36,a,84,a,44
R 124,3,48128
M v,32,a,88,a,48
v_exp_f32 v67, v19
M v,36,a,88,a,52
R 64,3,49152
C 5,12,s3,2048
M v,32,a,92,a,56
v_exp_f32 v68, v24
M v,36,a,92,a,60
R 68,3,50176
v_add_f32 v80, v80, v66
s_waitcnt lgkmcnt(3)
v_mfma_f32_16x16x32_bf16 v[40:43], a[96:99], a[0:3], v[72:75]
v_add_f32 v81, v81, v67
v_cvt_pk_bf16_f32 v49, v66, v67
v_mfma_f32_16x16x32_bf16 v[44:47], a[96:99], a[4:7], v[76:79]
R 72,3,51200
C 5,12,s3,3072
M v,40,a,100,a,8
R 76,3,52224
M v,44,a,100,a,12
v_exp_f32 v69, v25
M v,40,a,104,a,16
R 80,3,53248
M v,44,a,104,a,20
s_add_u32 m0, s32, 16384
M v,40,a,108,a,24
R 84,3,54272
M v,44,a,108,a,28
R 88,3,55296
M v,40,a,112,a,32
v_exp_f32 v70, v26
M v,44,a,112,a,36
R 92,3,56320
C 6,12,s3,0
M v,40,a,116,a,40
v_add_f32 v80, v80, v68
v_add_f32 v81, v81, v69
M v,44,a,116,a,44
R 96,3,57344
v_cvt_pk_bf16_f32 v50, v68, v69
M v,40,a,120,a,48
v_exp_f32 v71, v27
M v,44,a,120,a,52
R 100,3,58368
C 6,12,s3,1024
s_waitcnt lgkmcnt(3)
M v,40,a,124,a,56
R 104,3,59392
s_nop 0
M v,44,a,124,a,60
v_add_f32 v80, v80, v70
v_add_f32 v81, v81, v71
M v,128,a,64,v,56
R 108,3,60416
v_cvt_pk_bf16_f32 v51, v70, v71
M v,132,a,64,v,60
C 6,12,s3,2048
M v,136,a,68,v,56
R 112,3,61440
M v,140,a,68,v,60
R 116,3,62464
M v,144,a,72,v,56
v_exp_f32 v64, v20
M v,148,a,72,v,60
R 120,3,63488
C 6,12,s3,3072
M v,152,a,76,v,56
v_exp_f32 v65, v21
M v,156,a,76,v,60
R 124,3,64512
M v,160,a,80,v,56
v_exp_f32 v66, v22
M v,164,a,80,v,60
s_add_u32 s3, s3, 0x8000
v_add_f32 v82, v86, v64
M v,168,a,84,v,56
v_add_f32 v83, v87, v65
v_cvt_pk_bf16_f32 v52, v64, v65
M v,172,a,84,v,60
v_exp_f32 v67, v23
M v,176,a,88,v,56
v_exp_f32 v68, v28
M v,180,a,88,v,60
v_add_f32 v82, v82, v66
v_add_f32 v83, v83, v67
s_waitcnt lgkmcnt(0)
M v,184,a,92,v,56
v_cvt_pk_bf16_f32 v53, v66, v67
M v,188,a,92,v,60
v_exp_f32 v69, v29
M v,192,a,96,v,56
s_waitcnt vmcnt(16) lgkmcnt(0)
s_barrier
M v,196,a,96,v,60
R 64,4,16384
R 68,4,17408
M v,200,a,100,v,56
R 72,4,18432
R 76,4,19456
M v,204,a,100,v,60
R 80,4,20480
R 84,4,21504
M v,208,a,104,v,56
R 88,4,22528
R 92,4,23552
M v,212,a,104,v,60
v_exp_f32 v70, v30
M v,216,a,108,v,56
v_add_f32 v82, v82, v68
v_add_f32 v83, v83, v69
M v,220,a,108,v,60
v_cvt_pk_bf16_f32 v54, v68, v69
M v,224,a,112,v,56
v_exp_f32 v71, v31
M v,228,a,112,v,60
s_nop 0
v_add_f32 v82, v82, v70
M v,232,a,116,v,56
v_add_f32 v83, v83, v71
v_cvt_pk_bf16_f32 v55, v70, v71
M v,236,a,116,v,60
v_max3_f32 v14, v80, v81, v82
v_max_f32 v14, v14, v83
M v,240,a,120,v,56
v_cmp_lt_f32 vcc, s37, v14
M v,244,a,120,v,60
M v,248,a,124,v,56
M v,252,a,124,v,60
s_nop 0
s_cbranch_vccnz RARE_h2
BACK_h2:
s_waitcnt lgkmcnt(0)
M v,128,a,64,v,48
R 96,4,24576
M v,132,a,64,v,52
R 100,4,25600
s_add_u32 m0, s32, 32768
M v,136,a,68,v,48
R 104,4,26624
C 5,12,s3,0
M v,140,a,68,v,52
R 108,4,27648
C 5,12,s3,1024
M v,144,a,72,v,48
R 112,4,28672
C 5,12,s3,2048
M v,148,a,72,v,52
R 116,4,29696
C 5,12,s3,3072
M v,152,a,76,v,48
R 120,4,30720
s_add_u32 m0, s32, 49152
M v,156,a,76,v,52
R 124,4,31744
M v,160,a,80,v,48
C 6,12,s3,0
M v,164,a,80,v,52
C 6,12,s3,1024
M v,168,a,84,v,48
C 6,12,s3,2048
M v,172,a,84,v,52
C 6,12,s3,3072
M v,176,a,88,v,48
s_add_u32 s3, s3, 0x8000
M v,180,a,88,v,52
v_exp_f32 v64, v32
M v,184,a,92,v,48
v_exp_f32 v65, v33
M v,188,a,92,v,52
v_exp_f32 v66, v34
s_waitcnt lgkmcnt(0)
M v,192,a,96,v,48
s_waitcnt vmcnt(16) lgkmcnt(0)
s_barrier
M v,196,a,96,v,52
R 64,4,49152
R 68,4,50176
M v,200,a,100,v,48
R 72,4,51200
R 76,4,52224
M v,204,a,100,v,52
R 80,4,53248
R 84,4,54272
M v,208,a,104,v,48
R 88,4,55296
R 92,4,56320
M v,212,a,104,v,52
v_add_f32 v84, v80, v64
v_add_f32 v85, v81, v65
M v,216,a,108,v,48
v_cvt_pk_bf16_f32 v56, v64, v65
M v,220,a,108,v,52
v_exp_f32 v67, v35
M v,224,a,112,v,48
v_exp_f32 v68, v40
M v,228,a,112,v,52
v_add_f32 v84, v84, v66
v_add_f32 v85, v85, v67
M v,232,a,116,v,48
v_cvt_pk_bf16_f32 v57, v66, v67
M v,236,a,116,v,52
v_exp_f32 v69, v41
M v,240,a,120,v,48
v_exp_f32 v70, v42
M v,244,a,120,v,52
v_add_f32 v84, v84, v68
v_add_f32 v85, v85, v69
M v,248,a,124,v,48
v_cvt_pk_bf16_f32 v58, v68, v69
M v,252,a,124,v,52
v_exp_f32 v71, v43
s_nop 0
v_add_f32 v84, v84, v70
v_add_f32 v85, v85, v71
v_cvt_pk_bf16_f32 v59, v70, v71
v_exp_f32 v64, v36
v_exp_f32 v65, v37
v_exp_f32 v66, v38
v_add_f32 v86, v82, v64
v_add_f32 v87, v83, v65
v_cvt_pk_bf16_f32 v60, v64, v65
v_exp_f32 v67, v39
v_exp_f32 v68, v44
v_add_f32 v86, v86, v66
v_add_f32 v87, v87, v67
v_cvt_pk_bf16_f32 v61, v66, v67
v_exp_f32 v69, v45
v_exp_f32 v70, v46
v_add_f32 v86, v86, v68
v_add_f32 v87, v87, v69
v_cvt_pk_bf16_f32 v62, v68, v69
v_exp_f32 v71, v47
s_nop 0
v_add_f32 v86, v86, v70
v_add_f32 v87, v87, v71
v_cvt_pk_bf16_f32 v63, v70, v71
v_max3_f32 v14, v84, v85, v86
v_max_f32 v14, v14, v87
v_cmp_lt_f32 vcc, s37, v14
v_accvgpr_mov_b32 a0, a192
v_accvgpr_mov_b32 a1, a193
v_accvgpr_mov_b32 a2, a194
v_accvgpr_mov_b32 a3, a195
v_accvgpr_mov_b32 a4, a196
v_accvgpr_mov_b32 a5, a197
v_accvgpr_mov_b32 a6, a198
v_accvgpr_mov_b32 a7, a199
v_accvgpr_mov_b32 a8, a200
v_accvgpr_mov_b32 a9, a201
v_accvgpr_mov_b32 a10, a202
v_accvgpr_mov_b32 a11, a203
v_accvgpr_mov_b32 a12, a204
v_accvgpr_mov_b32 a13, a205
v_accvgpr_mov_b32 a14, a206
v_accvgpr_mov_b32 a15, a207
v_accvgpr_mov_b32 a16, a208
v_accvgpr_mov_b32 a17, a209
v_accvgpr_mov_b32 a18, a210
v_accvgpr_mov_b32 a19, a211
v_accvgpr_mov_b32 a20, a212
v_accvgpr_mov_b32 a21, a213
v_accvgpr_mov_b32 a22, a214
v_accvgpr_mov_b32 a23, a215
v_accvgpr_mov_b32 a24, a216
v_accvgpr_mov_b32 a25, a217
v_accvgpr_mov_b32 a26, a218
v_accvgpr_mov_b32 a27, a219
v_accvgpr_mov_b32 a28, a220
v_accvgpr_mov_b32 a29, a221
v_accvgpr_mov_b32 a30, a222
v_accvgpr_mov_b32 a31, a223
s_nop 0
s_cbranch_vccnz RARE_h3
BACK_h3:
s_waitcnt lgkmcnt(0)
M v,128,a,64,v,56
R 96,4,57344
v_accvgpr_mov_b32 a32, a224
M v,132,a,64,v,60
R 100,4,58368
v_accvgpr_mov_b32 a33, a225
M v,136,a,68,v,56
R 104,4,59392
v_accvgpr_mov_b32 a34, a226
M v,140,a,68,v,60
R 108,4,60416
v_accvgpr_mov_b32 a35, a227
M v,144,a,72,v,56
R 112,4,61440
v_accvgpr_mov_b32 a36, a228
M v,148,a,72,v,60
R 116,4,62464
v_accvgpr_mov_b32 a37, a229
M v,152,a,76,v,56
R 120,4,63488
v_accvgpr_mov_b32 a38, a230
M v,156,a,76,v,60
R 124,4,64512
v_accvgpr_mov_b32 a39, a231
M v,160,a,80,v,56
v_accvgpr_mov_b32 a40, a232
v_accvgpr_mov_b32 a41, a233
M v,164,a,80,v,60
v_accvgpr_mov_b32 a42, a234
v_accvgpr_mov_b32 a43, a235
M v,168,a,84,v,56
v_accvgpr_mov_b32 a44, a236
v_accvgpr_mov_b32 a45, a237
M v,172,a,84,v,60
v_accvgpr_mov_b32 a46, a238
v_accvgpr_mov_b32 a47, a239
M v,176,a,88,v,56
v_accvgpr_mov_b32 a48, a240
v_accvgpr_mov_b32 a49, a241
M v,180,a,88,v,60
v_accvgpr_mov_b32 a50, a242
v_accvgpr_mov_b32 a51, a243
M v,184,a,92,v,56
v_accvgpr_mov_b32 a52, a244
v_accvgpr_mov_b32 a53, a245
M v,188,a,92,v,60
v_accvgpr_mov_b32 a54, a246
v_accvgpr_mov_b32 a55, a247
s_waitcnt lgkmcnt(0)
M v,192,a,96,v,56
s_waitcnt vmcnt(8) lgkmcnt(0)
s_barrier
M v,196,a,96,v,60
R 64,4,0
R 68,4,1024
M v,200,a,100,v,56
R 72,4,2048
R 76,4,3072
M v,204,a,100,v,60
R 80,4,4096
R 84,4,5120
M v,208,a,104,v,56
R 88,4,6144
R 92,4,7168
M v,212,a,104,v,60
v_accvgpr_mov_b32 a56, a248
v_accvgpr_mov_b32 a57, a249
M v,216,a,108,v,56
v_accvgpr_mov_b32 a58, a250
v_accvgpr_mov_b32 a59, a251
M v,220,a,108,v,60
v_accvgpr_mov_b32 a60, a252
v_accvgpr_mov_b32 a61, a253
M v,224,a,112,v,56
v_accvgpr_mov_b32 a62, a254
v_accvgpr_mov_b32 a63, a255
M v,228,a,112,v,60
v_add_f32 v89, v84, v85
v_mov_b32 v13, v89
M v,232,a,116,v,56
s_nop 1
v_permlane32_swap_b32 v89, v13
M v,236,a,116,v,60
s_nop 1
v_add_f32 v89, v89, v13
M v,240,a,120,v,56
v_mov_b32 v13, v89
s_nop 1
M v,244,a,120,v,60
v_permlane16_swap_b32 v89, v13
s_nop 1
M v,248,a,124,v,56
v_add_f32 v89, v89, v13
v_mov_b32 v88, v72
M v,252,a,124,v,60
v_add_f32 v91, v86, v87
v_mov_b32 v13, v91
s_nop 1
v_permlane32_swap_b32 v91, v13
s_nop 1
v_add_f32 v91, v91, v13
v_mov_b32 v13, v91
s_nop 1
v_permlane16_swap_b32 v91, v13
s_nop 1
v_add_f32 v91, v91, v13
v_mov_b32 v90, v76
s_sub_u32 s35, 15, s26
s_min_u32 s35, s35, s26
s_lshl_b32 s58, s25, 3
s_add_u32 s58, s58, s35
s_mul_i32 s58, s58, 0x21000
s_mul_i32 s35, s24, 0x8400
s_add_u32 s58, s58, s35
s_add_u32 s58, s58, 100663296
s_mov_b32 s67, 0
s_mov_b32 s34, s26
s_mov_b32 s33, s3
s_sub_u32 s35, 15, s26
s_min_u32 s35, s35, s26
s_lshl_b32 s36, s25, 3
s_add_u32 s36, s36, s35
s_lshl_b32 s36, s36, 7
s_add_u32 s36, s36, 35655744
s_cmp_eq_u32 s24, 0
s_cselect_b32 s89, s36, 0
s_nop 7
s_waitcnt lgkmcnt(0)
Z v,32,a,64,a,0
R 96,4,8192
Z v,36,a,64,a,4
R 100,4,9216
s_add_u32 s57, s58, 0
M v,32,a,68,a,8
R 104,4,10240
v_cvt_pk_bf16_f32 v128, v128, v129
M v,36,a,68,a,12
R 108,4,11264
v_cvt_pk_bf16_f32 v129, v130, v131
M v,32,a,72,a,16
R 112,4,12288
v_cvt_pk_bf16_f32 v130, v132, v133
M v,36,a,72,a,20
R 116,4,13312
v_cvt_pk_bf16_f32 v131, v134, v135
M v,32,a,76,a,24
R 120,4,14336
buffer_store_dwordx4 v[128:131], v7, s[12:15], s57 offen offset:0 sc1
M v,36,a,76,a,28
R 124,4,15360
v_cvt_pk_bf16_f32 v136, v136, v137
M v,32,a,80,a,32
v_cvt_pk_bf16_f32 v137, v138, v139
v_cvt_pk_bf16_f32 v138, v140, v141
M v,36,a,80,a,36
v_cvt_pk_bf16_f32 v139, v142, v143
buffer_store_dwordx4 v[136:139], v7, s[12:15], s57 offen offset:1024 sc1
M v,32,a,84,a,40
v_cvt_pk_bf16_f32 v144, v144, v145
v_cvt_pk_bf16_f32 v145, v146, v147
M v,36,a,84,a,44
v_cvt_pk_bf16_f32 v146, v148, v149
v_cvt_pk_bf16_f32 v147, v150, v151
M v,32,a,88,a,48
buffer_store_dwordx4 v[144:147], v7, s[12:15], s57 offen offset:2048 sc1
v_cvt_pk_bf16_f32 v152, v152, v153
M v,36,a,88,a,52
v_cvt_pk_bf16_f32 v153, v154, v155
v_cvt_pk_bf16_f32 v154, v156, v157
M v,32,a,92,a,56
v_cvt_pk_bf16_f32 v155, v158, v159
buffer_store_dwordx4 v[152:155], v7, s[12:15], s57 offen offset:3072 sc1
M v,36,a,92,a,60
s_add_u32 s57, s58, 4096
v_cvt_pk_bf16_f32 v160, v160, v161
s_waitcnt lgkmcnt(0)
Z v,40,a,96,a,0
s_waitcnt vmcnt(63) lgkmcnt(0)
s_barrier
Z v,44,a,96,a,4
R 64,4,32768
R 68,4,33792
M v,40,a,100,a,8
R 72,4,34816
R 76,4,35840
M v,44,a,100,a,12
R 80,4,36864
R 84,4,37888
M v,40,a,104,a,16
R 88,4,38912
R 92,4,39936
M v,44,a,104,a,20
v_cvt_pk_bf16_f32 v161, v162, v163
v_cvt_pk_bf16_f32 v162, v164, v165
M v,40,a,108,a,24
v_cvt_pk_bf16_f32 v163, v166, v167
buffer_store_dwordx4 v[160:163], v7, s[12:15], s57 offen offset:0 sc1
M v,44,a,108,a,28
v_cvt_pk_bf16_f32 v168, v168, v169
v_cvt_pk_bf16_f32 v169, v170, v171
M v,40,a,112,a,32
v_cvt_pk_bf16_f32 v170, v172, v173
v_cvt_pk_bf16_f32 v171, v174, v175
M v,44,a,112,a,36
buffer_store_dwordx4 v[168:171], v7, s[12:15], s57 offen offset:1024 sc1
v_cvt_pk_bf16_f32 v176, v176, v177
M v,40,a,116,a,40
v_cvt_pk_bf16_f32 v177, v178, v179
v_cvt_pk_bf16_f32 v178, v180, v181
M v,44,a,116,a,44
v_cvt_pk_bf16_f32 v179, v182, v183
buffer_store_dwordx4 v[176:179], v7, s[12:15], s57 offen offset:2048 sc1
M v,40,a,120,a,48
v_cvt_pk_bf16_f32 v184, v184, v185
v_cvt_pk_bf16_f32 v185, v186, v187
M v,44,a,120,a,52
v_cvt_pk_bf16_f32 v186, v188, v189
v_cvt_pk_bf16_f32 v187, v190, v191
M v,40,a,124,a,56
buffer_store_dwordx4 v[184:187], v7, s[12:15], s57 offen offset:3072 sc1
s_add_u32 s57, s58, 8192
M v,44,a,124,a,60
v_cvt_pk_bf16_f32 v192, v192, v193
v_cvt_pk_bf16_f32 v193, v194, v195
v_cvt_pk_bf16_f32 v194, v196, v197
v_cvt_pk_bf16_f32 v195, v198, v199
buffer_store_dwordx4 v[192:195], v7, s[12:15], s57 offen offset:0 sc1
v_cvt_pk_bf16_f32 v200, v200, v201
v_cvt_pk_bf16_f32 v201, v202, v203
v_cvt_pk_bf16_f32 v202, v204, v205
v_cvt_pk_bf16_f32 v203, v206, v207
buffer_store_dwordx4 v[200:203], v7, s[12:15], s57 offen offset:1024 sc1
v_cvt_pk_bf16_f32 v208, v208, v209
v_cvt_pk_bf16_f32 v209, v210, v211
v_cvt_pk_bf16_f32 v210, v212, v213
v_cvt_pk_bf16_f32 v211, v214, v215
buffer_store_dwordx4 v[208:211], v7, s[12:15], s57 offen offset:2048 sc1
v_cvt_pk_bf16_f32 v216, v216, v217
v_cvt_pk_bf16_f32 v217, v218, v219
v_cvt_pk_bf16_f32 v218, v220, v221
v_cvt_pk_bf16_f32 v219, v222, v223
buffer_store_dwordx4 v[216:219], v7, s[12:15], s57 offen offset:3072 sc1
s_add_u32 s57, s58, 12288
v_cvt_pk_bf16_f32 v224, v224, v225
v_cvt_pk_bf16_f32 v225, v226, v227
v_cvt_pk_bf16_f32 v226, v228, v229
v_cvt_pk_bf16_f32 v227, v230, v231
buffer_store_dwordx4 v[224:227], v7, s[12:15], s57 offen offset:0 sc1
v_cvt_pk_bf16_f32 v232, v232, v233
v_cvt_pk_bf16_f32 v233, v234, v235
v_cvt_pk_bf16_f32 v234, v236, v237
v_cvt_pk_bf16_f32 v235, v238, v239
buffer_store_dwordx4 v[232:235], v7, s[12:15], s57 offen offset:1024 sc1
v_cvt_pk_bf16_f32 v240, v240, v241
v_cvt_pk_bf16_f32 v241, v242, v243
v_cvt_pk_bf16_f32 v242, v244, v245
v_cvt_pk_bf16_f32 v243, v246, v247
buffer_store_dwordx4 v[240:243], v7, s[12:15], s57 offen offset:2048 sc1
v_cvt_pk_bf16_f32 v248, v248, v249
v_cvt_pk_bf16_f32 v249, v250, v251
v_cvt_pk_bf16_f32 v250, v252, v253
v_cvt_pk_bf16_f32 v251, v254, v255
buffer_store_dwordx4 v[248:251], v7, s[12:15], s57 offen offset:3072 sc1
s_add_u32 s57, s58, 0x8000
buffer_store_dwordx4 v[88:91], v7, s[12:15], s57 offen sc1
s_nop 7
s_or_b32 s35, s34, s67
s_cmp_lg_u32 s35, 0
s_cbranch_scc1 NM_2
v_mov_b32 v11, v10
s_nop 0
v_cmp_le_i32_e64 s[40:41], -16, v11
v_cmp_le_i32_e64 s[42:43], -15, v11
v_cmp_le_i32_e64 s[44:45], -14, v11
v_cmp_le_i32_e64 s[46:47], -13, v11
v_cmp_le_i32_e64 s[48:49], 0, v11
v_cmp_le_i32_e64 s[50:51], 1, v11
v_cmp_le_i32_e64 s[52:53], 2, v11
v_cmp_le_i32_e64 s[54:55], 3, v11
v_cmp_le_i32_e64 s[56:57], 16, v11
v_cmp_le_i32_e64 s[58:59], 17, v11
v_cmp_le_i32_e64 s[60:61], 18, v11
v_cmp_le_i32_e64 s[62:63], 19, v11
v_cndmask_b32_e64 v32, v12, v32, s[48:49]
v_cndmask_b32_e64 v33, v12, v33, s[50:51]
v_cndmask_b32_e64 v34, v12, v34, s[52:53]
v_cndmask_b32_e64 v35, v12, v35, s[54:55]
v_cndmask_b32_e64 v40, v12, v40, s[56:57]
v_cndmask_b32_e64 v41, v12, v41, s[58:59]
v_cndmask_b32_e64 v42, v12, v42, s[60:61]
v_cndmask_b32_e64 v43, v12, v43, s[62:63]
v_cndmask_b32_e64 v36, v12, v36, s[40:41]
v_cndmask_b32_e64 v37, v12, v37, s[42:43]
v_cndmask_b32_e64 v38, v12, v38, s[44:45]
v_cndmask_b32_e64 v39, v12, v39, s[46:47]
v_cndmask_b32_e64 v44, v12, v44, s[48:49]
v_cndmask_b32_e64 v45, v12, v45, s[50:51]
v_cndmask_b32_e64 v46, v12, v46, s[52:53]
v_cndmask_b32_e64 v47, v12, v47, s[54:55]
NM_2:
v_max3_f32 v13, v32, v33, v34
v_max3_f32 v14, v35, v40, v41
v_max3_f32 v13, v13, v42, v43
v_max_f32 v13, v13, v14
v_mov_b32 v14, v13
s_nop 1
v_permlane32_swap_b32 v13, v14
s_nop 1
v_max_f32 v13, v13, v14
v_mov_b32 v14, v13
s_nop 1
v_permlane16_swap_b32 v13, v14
s_nop 1
v_max_f32 v13, v13, v14
v_sub_f32 v72, 0, v13
v_sub_f32 v73, 0, v13
v_sub_f32 v74, 0, v13
v_sub_f32 v75, 0, v13
v_sub_f32 v16, v32, v13
v_sub_f32 v17, v33, v13
v_sub_f32 v18, v34, v13
v_sub_f32 v19, v35, v13
v_sub_f32 v24, v40, v13
v_sub_f32 v25, v41, v13
v_sub_f32 v26, v42, v13
v_sub_f32 v27, v43, v13
v_max3_f32 v13, v36, v37, v38
v_max3_f32 v14, v39, v44, v45
v_max3_f32 v13, v13, v46, v47
v_max_f32 v13, v13, v14
v_mov_b32 v14, v13
s_nop 1
v_permlane32_swap_b32 v13, v14
s_nop 1
v_max_f32 v13, v13, v14
v_mov_b32 v14, v13
s_nop 1
v_permlane16_swap_b32 v13, v14
s_nop 1
v_max_f32 v13, v13, v14
v_sub_f32 v76, 0, v13
v_sub_f32 v77, 0, v13
v_sub_f32 v78, 0, v13
v_sub_f32 v79, 0, v13
v_sub_f32 v20, v36, v13
v_sub_f32 v21, v37, v13
v_sub_f32 v22, v38, v13
v_sub_f32 v23, v39, v13
v_sub_f32 v28, v44, v13
v_sub_f32 v29, v45, v13
v_sub_f32 v30, v46, v13
v_sub_f32 v31, v47, v13
v_mov_b32 v84, 0
v_mov_b32 v85, 0
v_mov_b32 v86, 0
v_mov_b32 v87, 0
s_waitcnt vmcnt(0)
s_branch MG_a0
RARE_a0s:
s_nop 7
s_nop 7
v_max3_f32 v13, v16, v17, v18
v_max3_f32 v14, v19, v24, v25
v_max3_f32 v13, v13, v26, v27
v_max_f32 v13, v13, v14
v_mov_b32 v14, v13
s_nop 1
v_permlane32_swap_b32 v13, v14
s_nop 1
v_max_f32 v13, v13, v14
v_mov_b32 v14, v13
s_nop 1
v_permlane16_swap_b32 v13, v14
s_nop 1
v_max_f32 v13, v13, v14
v_max_f32 v13, 0, v13
v_sub_f32 v14, 0, v13
v_exp_f32 v15, v14
s_nop 0
v_add_f32 v72, v72, v14
v_add_f32 v73, v73, v14
v_add_f32 v74, v74, v14
v_add_f32 v75, v75, v14
v_add_f32 v16, v16, v14
v_add_f32 v32, v32, v14
v_add_f32 v17, v17, v14
v_add_f32 v33, v33, v14
v_add_f32 v18, v18, v14
v_add_f32 v34, v34, v14
v_add_f32 v19, v19, v14
v_add_f32 v35, v35, v14
v_add_f32 v24, v24, v14
v_add_f32 v40, v40, v14
v_add_f32 v25, v25, v14
v_add_f32 v41, v41, v14
v_add_f32 v26, v26, v14
v_add_f32 v42, v42, v14
v_add_f32 v27, v27, v14
v_add_f32 v43, v43, v14
v_mul_f32 v128, v128, v15
v_mul_f32 v129, v129, v15
v_mul_f32 v130, v130, v15
v_mul_f32 v131, v131, v15
v_mul_f32 v136, v136, v15
v_mul_f32 v137, v137, v15
v_mul_f32 v138, v138, v15
v_mul_f32 v139, v139, v15
v_mul_f32 v144, v144, v15
v_mul_f32 v145, v145, v15
v_mul_f32 v146, v146, v15
v_mul_f32 v147, v147, v15
v_mul_f32 v152, v152, v15
v_mul_f32 v153, v153, v15
v_mul_f32 v154, v154, v15
v_mul_f32 v155, v155, v15
v_mul_f32 v160, v160, v15
v_mul_f32 v161, v161, v15
v_mul_f32 v162, v162, v15
v_mul_f32 v163, v163, v15
v_mul_f32 v168, v168, v15
v_mul_f32 v169, v169, v15
v_mul_f32 v170, v170, v15
v_mul_f32 v171, v171, v15
v_mul_f32 v176, v176, v15
v_mul_f32 v177, v177, v15
v_mul_f32 v178, v178, v15
v_mul_f32 v179, v179, v15
v_mul_f32 v184, v184, v15
v_mul_f32 v185, v185, v15
v_mul_f32 v186, v186, v15
v_mul_f32 v187, v187, v15
v_mul_f32 v192, v192, v15
v_mul_f32 v193, v193, v15
v_mul_f32 v194, v194, v15
v_mul_f32 v195, v195, v15
v_mul_f32 v200, v200, v15
v_mul_f32 v201, v201, v15
v_mul_f32 v202, v202, v15
v_mul_f32 v203, v203, v15
v_mul_f32 v208, v208, v15
v_mul_f32 v209, v209, v15
v_mul_f32 v210, v210, v15
v_mul_f32 v211, v211, v15
v_mul_f32 v216, v216, v15
v_mul_f32 v217, v217, v15
v_mul_f32 v218, v218, v15
v_mul_f32 v219, v219, v15
v_mul_f32 v224, v224, v15
v_mul_f32 v225, v225, v15
v_mul_f32 v226, v226, v15
v_mul_f32 v227, v227, v15
v_mul_f32 v232, v232, v15
v_mul_f32 v233, v233, v15
v_mul_f32 v234, v234, v15
v_mul_f32 v235, v235, v15
v_mul_f32 v240, v240, v15
v_mul_f32 v241, v241, v15
v_mul_f32 v242, v242, v15
v_mul_f32 v243, v243, v15
v_mul_f32 v248, v248, v15
v_mul_f32 v249, v249, v15
v_mul_f32 v250, v250, v15
v_mul_f32 v251, v251, v15
v_mul_f32 v84, v84, v15
v_mul_f32 v85, v85, v15
v_max3_f32 v13, v20, v21, v22
v_max3_f32 v14, v23, v28, v29
v_max3_f32 v13, v13, v30, v31
v_max_f32 v13, v13, v14
v_mov_b32 v14, v13
s_nop 1
v_permlane32_swap_b32 v13, v14
s_nop 1
v_max_f32 v13, v13, v14
v_mov_b32 v14, v13
s_nop 1
v_permlane16_swap_b32 v13, v14
s_nop 1
v_max_f32 v13, v13, v14
v_max_f32 v13, 0, v13
v_sub_f32 v14, 0, v13
v_exp_f32 v15, v14
s_nop 0
v_add_f32 v76, v76, v14
v_add_f32 v77, v77, v14
v_add_f32 v78, v78, v14
v_add_f32 v79, v79, v14
v_add_f32 v20, v20, v14
v_add_f32 v36, v36, v14
v_add_f32 v21, v21, v14
v_add_f32 v37, v37, v14
v_add_f32 v22, v22, v14
v_add_f32 v38, v38, v14
v_add_f32 v23, v23, v14
v_add_f32 v39, v39, v14
v_add_f32 v28, v28, v14
v_add_f32 v44, v44, v14
v_add_f32 v29, v29, v14
v_add_f32 v45, v45, v14
v_add_f32 v30, v30, v14
v_add_f32 v46, v46, v14
v_add_f32 v31, v31, v14
v_add_f32 v47, v47, v14
v_mul_f32 v132, v132, v15
v_mul_f32 v133, v133, v15
v_mul_f32 v134, v134, v15
v_mul_f32 v135, v135, v15
v_mul_f32 v140, v140, v15
v_mul_f32 v141, v141, v15
v_mul_f32 v142, v142, v15
v_mul_f32 v143, v143, v15
v_mul_f32 v148, v148, v15
v_mul_f32 v149, v149, v15
v_mul_f32 v150, v150, v15
v_mul_f32 v151, v151, v15
v_mul_f32 v156, v156, v15
v_mul_f32 v157, v157, v15
v_mul_f32 v158, v158, v15
v_mul_f32 v159, v159, v15
v_mul_f32 v164, v164, v15
v_mul_f32 v165, v165, v15
v_mul_f32 v166, v166, v15
v_mul_f32 v167, v167, v15
v_mul_f32 v172, v172, v15
v_mul_f32 v173, v173, v15
v_mul_f32 v174, v174, v15
v_mul_f32 v175, v175, v15
v_mul_f32 v180, v180, v15
v_mul_f32 v181, v181, v15
v_mul_f32 v182, v182, v15
v_mul_f32 v183, v183, v15
v_mul_f32 v188, v188, v15
v_mul_f32 v189, v189, v15
v_mul_f32 v190, v190, v15
v_mul_f32 v191, v191, v15
v_mul_f32 v196, v196, v15
v_mul_f32 v197, v197, v15
v_mul_f32 v198, v198, v15
v_mul_f32 v199, v199, v15
v_mul_f32 v204, v204, v15
v_mul_f32 v205, v205, v15
v_mul_f32 v206, v206, v15
v_mul_f32 v207, v207, v15
v_mul_f32 v212, v212, v15
v_mul_f32 v213, v213, v15
v_mul_f32 v214, v214, v15
v_mul_f32 v215, v215, v15
v_mul_f32 v220, v220, v15
v_mul_f32 v221, v221, v15
v_mul_f32 v222, v222, v15
v_mul_f32 v223, v223, v15
v_mul_f32 v228, v228, v15
v_mul_f32 v229, v229, v15
v_mul_f32 v230, v230, v15
v_mul_f32 v231, v231, v15
v_mul_f32 v236, v236, v15
v_mul_f32 v237, v237, v15
v_mul_f32 v238, v238, v15
v_mul_f32 v239, v239, v15
v_mul_f32 v244, v244, v15
v_mul_f32 v245, v245, v15
v_mul_f32 v246, v246, v15
v_mul_f32 v247, v247, v15
v_mul_f32 v252, v252, v15
v_mul_f32 v253, v253, v15
v_mul_f32 v254, v254, v15
v_mul_f32 v255, v255, v15
v_mul_f32 v86, v86, v15
v_mul_f32 v87, v87, v15
v_exp_f32 v64, v16
v_exp_f32 v65, v17
v_exp_f32 v66, v18
v_add_f32 v80, v84, v64
v_add_f32 v81, v85, v65
v_cvt_pk_bf16_f32 v48, v64, v65
v_exp_f32 v67, v19
v_exp_f32 v68, v24
v_add_f32 v80, v80, v66
v_add_f32 v81, v81, v67
v_cvt_pk_bf16_f32 v49, v66, v67
v_exp_f32 v69, v25
v_exp_f32 v70, v26
v_add_f32 v80, v80, v68
v_add_f32 v81, v81, v69
v_cvt_pk_bf16_f32 v50, v68, v69
v_exp_f32 v71, v27
s_nop 0
v_add_f32 v80, v80, v70
v_add_f32 v81, v81, v71
v_cvt_pk_bf16_f32 v51, v70, v71
v_exp_f32 v64, v20
v_exp_f32 v65, v21
v_exp_f32 v66, v22
v_add_f32 v82, v86, v64
v_add_f32 v83, v87, v65
v_cvt_pk_bf16_f32 v52, v64, v65
v_exp_f32 v67, v23
v_exp_f32 v68, v28
v_add_f32 v82, v82, v66
v_add_f32 v83, v83, v67
v_cvt_pk_bf16_f32 v53, v66, v67
v_exp_f32 v69, v29
v_exp_f32 v70, v30
v_add_f32 v82, v82, v68
v_add_f32 v83, v83, v69
v_cvt_pk_bf16_f32 v54, v68, v69
v_exp_f32 v71, v31
s_nop 0
v_add_f32 v82, v82, v70
v_add_f32 v83, v83, v71
v_cvt_pk_bf16_f32 v55, v70, v71
s_nop 1
s_branch BACK_a0s
RARE_an0:
s_nop 7
s_nop 7
v_max3_f32 v13, v16, v17, v18
v_max3_f32 v14, v19, v24, v25
v_max3_f32 v13, v13, v26, v27
v_max_f32 v13, v13, v14
v_mov_b32 v14, v13
s_nop 1
v_permlane32_swap_b32 v13, v14
s_nop 1
v_max_f32 v13, v13, v14
v_mov_b32 v14, v13
s_nop 1
v_permlane16_swap_b32 v13, v14
s_nop 1
v_max_f32 v13, v13, v14
v_max_f32 v13, 0, v13
v_sub_f32 v14, 0, v13
v_exp_f32 v15, v14
s_nop 0
v_add_f32 v72, v72, v14
v_add_f32 v73, v73, v14
v_add_f32 v74, v74, v14
v_add_f32 v75, v75, v14
v_add_f32 v16, v16, v14
v_add_f32 v32, v32, v14
v_add_f32 v17, v17, v14
v_add_f32 v33, v33, v14
v_add_f32 v18, v18, v14
v_add_f32 v34, v34, v14
v_add_f32 v19, v19, v14
v_add_f32 v35, v35, v14
v_add_f32 v24, v24, v14
v_add_f32 v40, v40, v14
v_add_f32 v25, v25, v14
v_add_f32 v41, v41, v14
v_add_f32 v26, v26, v14
v_add_f32 v42, v42, v14
v_add_f32 v27, v27, v14
v_add_f32 v43, v43, v14
v_mul_f32 v128, v128, v15
v_mul_f32 v129, v129, v15
v_mul_f32 v130, v130, v15
v_mul_f32 v131, v131, v15
v_mul_f32 v136, v136, v15
v_mul_f32 v137, v137, v15
v_mul_f32 v138, v138, v15
v_mul_f32 v139, v139, v15
v_mul_f32 v144, v144, v15
v_mul_f32 v145, v145, v15
v_mul_f32 v146, v146, v15
v_mul_f32 v147, v147, v15
v_mul_f32 v152, v152, v15
v_mul_f32 v153, v153, v15
v_mul_f32 v154, v154, v15
v_mul_f32 v155, v155, v15
v_mul_f32 v160, v160, v15
v_mul_f32 v161, v161, v15
v_mul_f32 v162, v162, v15
v_mul_f32 v163, v163, v15
v_mul_f32 v168, v168, v15
v_mul_f32 v169, v169, v15
v_mul_f32 v170, v170, v15
v_mul_f32 v171, v171, v15
v_mul_f32 v176, v176, v15
v_mul_f32 v177, v177, v15
v_mul_f32 v178, v178, v15
v_mul_f32 v179, v179, v15
v_mul_f32 v184, v184, v15
v_mul_f32 v185, v185, v15
v_mul_f32 v186, v186, v15
v_mul_f32 v187, v187, v15
v_mul_f32 v192, v192, v15
v_mul_f32 v193, v193, v15
v_mul_f32 v194, v194, v15
v_mul_f32 v195, v195, v15
v_mul_f32 v200, v200, v15
v_mul_f32 v201, v201, v15
v_mul_f32 v202, v202, v15
v_mul_f32 v203, v203, v15
v_mul_f32 v208, v208, v15
v_mul_f32 v209, v209, v15
v_mul_f32 v210, v210, v15
v_mul_f32 v211, v211, v15
v_mul_f32 v216, v216, v15
v_mul_f32 v217, v217, v15
v_mul_f32 v218, v218, v15
v_mul_f32 v219, v219, v15
v_mul_f32 v224, v224, v15
v_mul_f32 v225, v225, v15
v_mul_f32 v226, v226, v15
v_mul_f32 v227, v227, v15
v_mul_f32 v232, v232, v15
v_mul_f32 v233, v233, v15
v_mul_f32 v234, v234, v15
v_mul_f32 v235, v235, v15
v_mul_f32 v240, v240, v15
v_mul_f32 v241, v241, v15
v_mul_f32 v242, v242, v15
v_mul_f32 v243, v243, v15
v_mul_f32 v248, v248, v15
v_mul_f32 v249, v249, v15
v_mul_f32 v250, v250, v15
v_mul_f32 v251, v251, v15
v_mul_f32 v84, v84, v15
v_mul_f32 v85, v85, v15
v_max3_f32 v13, v20, v21, v22
v_max3_f32 v14, v23, v28, v29
v_max3_f32 v13, v13, v30, v31
v_max_f32 v13, v13, v14
v_mov_b32 v14, v13
s_nop 1
v_permlane32_swap_b32 v13, v14
s_nop 1
v_max_f32 v13, v13, v14
v_mov_b32 v14, v13
s_nop 1
v_permlane16_swap_b32 v13, v14
s_nop 1
v_max_f32 v13, v13, v14
v_max_f32 v13, 0, v13
v_sub_f32 v14, 0, v13
v_exp_f32 v15, v14
s_nop 0
v_add_f32 v76, v76, v14
v_add_f32 v77, v77, v14
v_add_f32 v78, v78, v14
v_add_f32 v79, v79, v14
v_add_f32 v20, v20, v14
v_add_f32 v36, v36, v14
v_add_f32 v21, v21, v14
v_add_f32 v37, v37, v14
v_add_f32 v22, v22, v14
v_add_f32 v38, v38, v14
v_add_f32 v23, v23, v14
v_add_f32 v39, v39, v14
v_add_f32 v28, v28, v14
v_add_f32 v44, v44, v14
v_add_f32 v29, v29, v14
v_add_f32 v45, v45, v14
v_add_f32 v30, v30, v14
v_add_f32 v46, v46, v14
v_add_f32 v31, v31, v14
v_add_f32 v47, v47, v14
v_mul_f32 v132, v132, v15
v_mul_f32 v133, v133, v15
v_mul_f32 v134, v134, v15
v_mul_f32 v135, v135, v15
v_mul_f32 v140, v140, v15
v_mul_f32 v141, v141, v15
v_mul_f32 v142, v142, v15
v_mul_f32 v143, v143, v15
v_mul_f32 v148, v148, v15
v_mul_f32 v149, v149, v15
v_mul_f32 v150, v150, v15
v_mul_f32 v151, v151, v15
v_mul_f32 v156, v156, v15
v_mul_f32 v157, v157, v15
v_mul_f32 v158, v158, v15
v_mul_f32 v159, v159, v15
v_mul_f32 v164, v164, v15
v_mul_f32 v165, v165, v15
v_mul_f32 v166, v166, v15
v_mul_f32 v167, v167, v15
v_mul_f32 v172, v172, v15
v_mul_f32 v173, v173, v15
v_mul_f32 v174, v174, v15
v_mul_f32 v175, v175, v15
v_mul_f32 v180, v180, v15
v_mul_f32 v181, v181, v15
v_mul_f32 v182, v182, v15
v_mul_f32 v183, v183, v15
v_mul_f32 v188, v188, v15
v_mul_f32 v189, v189, v15
v_mul_f32 v190, v190, v15
v_mul_f32 v191, v191, v15
v_mul_f32 v196, v196, v15
v_mul_f32 v197, v197, v15
v_mul_f32 v198, v198, v15
v_mul_f32 v199, v199, v15
v_mul_f32 v204, v204, v15
v_mul_f32 v205, v205, v15
v_mul_f32 v206, v206, v15
v_mul_f32 v207, v207, v15
v_mul_f32 v212, v212, v15
v_mul_f32 v213, v213, v15
v_mul_f32 v214, v214, v15
v_mul_f32 v215, v215, v15
v_mul_f32 v220, v220, v15
v_mul_f32 v221, v221, v15
v_mul_f32 v222, v222, v15
v_mul_f32 v223, v223, v15
v_mul_f32 v228, v228, v15
v_mul_f32 v229, v229, v15
v_mul_f32 v230, v230, v15
v_mul_f32 v231, v231, v15
v_mul_f32 v236, v236, v15
v_mul_f32 v237, v237, v15
v_mul_f32 v238, v238, v15
v_mul_f32 v239, v239, v15
v_mul_f32 v244, v244, v15
v_mul_f32 v245, v245, v15
v_mul_f32 v246, v246, v15
v_mul_f32 v247, v247, v15
v_mul_f32 v252, v252, v15
v_mul_f32 v253, v253, v15
v_mul_f32 v254, v254, v15
v_mul_f32 v255, v255, v15
v_mul_f32 v86, v86, v15
v_mul_f32 v87, v87, v15
v_exp_f32 v64, v16
v_exp_f32 v65, v17
v_exp_f32 v66, v18
v_add_f32 v80, v84, v64
v_add_f32 v81, v85, v65
v_cvt_pk_bf16_f32 v48, v64, v65
v_exp_f32 v67, v19
v_exp_f32 v68, v24
v_add_f32 v80, v80, v66
v_add_f32 v81, v81, v67
v_cvt_pk_bf16_f32 v49, v66, v67
v_exp_f32 v69, v25
v_exp_f32 v70, v26
v_add_f32 v80, v80, v68
v_add_f32 v81, v81, v69
v_cvt_pk_bf16_f32 v50, v68, v69
v_exp_f32 v71, v27
s_nop 0
v_add_f32 v80, v80, v70
v_add_f32 v81, v81, v71
v_cvt_pk_bf16_f32 v51, v70, v71
v_exp_f32 v64, v20
v_exp_f32 v65, v21
v_exp_f32 v66, v22
v_add_f32 v82, v86, v64
v_add_f32 v83, v87, v65
v_cvt_pk_bf16_f32 v52, v64, v65
v_exp_f32 v67, v23
v_exp_f32 v68, v28
v_add_f32 v82, v82, v66
v_add_f32 v83, v83, v67
v_cvt_pk_bf16_f32 v53, v66, v67
v_exp_f32 v69, v29
v_exp_f32 v70, v30
v_add_f32 v82, v82, v68
v_add_f32 v83, v83, v69
v_cvt_pk_bf16_f32 v54, v68, v69
v_exp_f32 v71, v31
s_nop 0
v_add_f32 v82, v82, v70
v_add_f32 v83, v83, v71
v_cvt_pk_bf16_f32 v55, v70, v71
s_nop 1
s_branch BACK_an0
RARE_an1:
s_nop 7
s_nop 7
v_max3_f32 v13, v32, v33, v34
v_max3_f32 v14, v35, v40, v41
v_max3_f32 v13, v13, v42, v43
v_max_f32 v13, v13, v14
v_mov_b32 v14, v13
s_nop 1
v_permlane32_swap_b32 v13, v14
s_nop 1
v_max_f32 v13, v13, v14
v_mov_b32 v14, v13
s_nop 1
v_permlane16_swap_b32 v13, v14
s_nop 1
v_max_f32 v13, v13, v14
v_max_f32 v13, 0, v13
v_sub_f32 v14, 0, v13
v_exp_f32 v15, v14
s_nop 0
v_add_f32 v72, v72, v14
v_add_f32 v73, v73, v14
v_add_f32 v74, v74, v14
v_add_f32 v75, v75, v14
v_add_f32 v32, v32, v14
v_add_f32 v16, v16, v14
v_add_f32 v33, v33, v14
v_add_f32 v17, v17, v14
v_add_f32 v34, v34, v14
v_add_f32 v18, v18, v14
v_add_f32 v35, v35, v14
v_add_f32 v19, v19, v14
v_add_f32 v40, v40, v14
v_add_f32 v24, v24, v14
v_add_f32 v41, v41, v14
v_add_f32 v25, v25, v14
v_add_f32 v42, v42, v14
v_add_f32 v26, v26, v14
v_add_f32 v43, v43, v14
v_add_f32 v27, v27, v14
v_mul_f32 v128, v128, v15
v_mul_f32 v129, v129, v15
v_mul_f32 v130, v130, v15
v_mul_f32 v131, v131, v15
v_mul_f32 v136, v136, v15
v_mul_f32 v137, v137, v15
v_mul_f32 v138, v138, v15
v_mul_f32 v139, v139, v15
v_mul_f32 v144, v144, v15
v_mul_f32 v145, v145, v15
v_mul_f32 v146, v146, v15
v_mul_f32 v147, v147, v15
v_mul_f32 v152, v152, v15
v_mul_f32 v153, v153, v15
v_mul_f32 v154, v154, v15
v_mul_f32 v155, v155, v15
v_mul_f32 v160, v160, v15
v_mul_f32 v161, v161, v15
v_mul_f32 v162, v162, v15
v_mul_f32 v163, v163, v15
v_mul_f32 v168, v168, v15
v_mul_f32 v169, v169, v15
v_mul_f32 v170, v170, v15
v_mul_f32 v171, v171, v15
v_mul_f32 v176, v176, v15
v_mul_f32 v177, v177, v15
v_mul_f32 v178, v178, v15
v_mul_f32 v179, v179, v15
v_mul_f32 v184, v184, v15
v_mul_f32 v185, v185, v15
v_mul_f32 v186, v186, v15
v_mul_f32 v187, v187, v15
v_mul_f32 v192, v192, v15
v_mul_f32 v193, v193, v15
v_mul_f32 v194, v194, v15
v_mul_f32 v195, v195, v15
v_mul_f32 v200, v200, v15
v_mul_f32 v201, v201, v15
v_mul_f32 v202, v202, v15
v_mul_f32 v203, v203, v15
v_mul_f32 v208, v208, v15
v_mul_f32 v209, v209, v15
v_mul_f32 v210, v210, v15
v_mul_f32 v211, v211, v15
v_mul_f32 v216, v216, v15
v_mul_f32 v217, v217, v15
v_mul_f32 v218, v218, v15
v_mul_f32 v219, v219, v15
v_mul_f32 v224, v224, v15
v_mul_f32 v225, v225, v15
v_mul_f32 v226, v226, v15
v_mul_f32 v227, v227, v15
v_mul_f32 v232, v232, v15
v_mul_f32 v233, v233, v15
v_mul_f32 v234, v234, v15
v_mul_f32 v235, v235, v15
v_mul_f32 v240, v240, v15
v_mul_f32 v241, v241, v15
v_mul_f32 v242, v242, v15
v_mul_f32 v243, v243, v15
v_mul_f32 v248, v248, v15
v_mul_f32 v249, v249, v15
v_mul_f32 v250, v250, v15
v_mul_f32 v251, v251, v15
v_mul_f32 v80, v80, v15
v_mul_f32 v81, v81, v15
v_max3_f32 v13, v36, v37, v38
v_max3_f32 v14, v39, v44, v45
v_max3_f32 v13, v13, v46, v47
v_max_f32 v13, v13, v14
v_mov_b32 v14, v13
s_nop 1
v_permlane32_swap_b32 v13, v14
s_nop 1
v_max_f32 v13, v13, v14
v_mov_b32 v14, v13
s_nop 1
v_permlane16_swap_b32 v13, v14
s_nop 1
v_max_f32 v13, v13, v14
v_max_f32 v13, 0, v13
v_sub_f32 v14, 0, v13
v_exp_f32 v15, v14
s_nop 0
v_add_f32 v76, v76, v14
v_add_f32 v77, v77, v14
v_add_f32 v78, v78, v14
v_add_f32 v79, v79, v14
v_add_f32 v36, v36, v14
v_add_f32 v20, v20, v14
v_add_f32 v37, v37, v14
v_add_f32 v21, v21, v14
v_add_f32 v38, v38, v14
v_add_f32 v22, v22, v14
v_add_f32 v39, v39, v14
v_add_f32 v23, v23, v14
v_add_f32 v44, v44, v14
v_add_f32 v28, v28, v14
v_add_f32 v45, v45, v14
v_add_f32 v29, v29, v14
v_add_f32 v46, v46, v14
v_add_f32 v30, v30, v14
v_add_f32 v47, v47, v14
v_add_f32 v31, v31, v14
v_mul_f32 v132, v132, v15
v_mul_f32 v133, v133, v15
v_mul_f32 v134, v134, v15
v_mul_f32 v135, v135, v15
v_mul_f32 v140, v140, v15
v_mul_f32 v141, v141, v15
v_mul_f32 v142, v142, v15
v_mul_f32 v143, v143, v15
v_mul_f32 v148, v148, v15
v_mul_f32 v149, v149, v15
v_mul_f32 v150, v150, v15
v_mul_f32 v151, v151, v15
v_mul_f32 v156, v156, v15
v_mul_f32 v157, v157, v15
v_mul_f32 v158, v158, v15
v_mul_f32 v159, v159, v15
v_mul_f32 v164, v164, v15
v_mul_f32 v165, v165, v15
v_mul_f32 v166, v166, v15
v_mul_f32 v167, v167, v15
v_mul_f32 v172, v172, v15
v_mul_f32 v173, v173, v15
v_mul_f32 v174, v174, v15
v_mul_f32 v175, v175, v15
v_mul_f32 v180, v180, v15
v_mul_f32 v181, v181, v15
v_mul_f32 v182, v182, v15
v_mul_f32 v183, v183, v15
v_mul_f32 v188, v188, v15
v_mul_f32 v189, v189, v15
v_mul_f32 v190, v190, v15
v_mul_f32 v191, v191, v15
v_mul_f32 v196, v196, v15
v_mul_f32 v197, v197, v15
v_mul_f32 v198, v198, v15
v_mul_f32 v199, v199, v15
v_mul_f32 v204, v204, v15
v_mul_f32 v205, v205, v15
v_mul_f32 v206, v206, v15
v_mul_f32 v207, v207, v15
v_mul_f32 v212, v212, v15
v_mul_f32 v213, v213, v15
v_mul_f32 v214, v214, v15
v_mul_f32 v215, v215, v15
v_mul_f32 v220, v220, v15
v_mul_f32 v221, v221, v15
v_mul_f32 v222, v222, v15
v_mul_f32 v223, v223, v15
v_mul_f32 v228, v228, v15
v_mul_f32 v229, v229, v15
v_mul_f32 v230, v230, v15
v_mul_f32 v231, v231, v15
v_mul_f32 v236, v236, v15
v_mul_f32 v237, v237, v15
v_mul_f32 v238, v238, v15
v_mul_f32 v239, v239, v15
v_mul_f32 v244, v244, v15
v_mul_f32 v245, v245, v15
v_mul_f32 v246, v246, v15
v_mul_f32 v247, v247, v15
v_mul_f32 v252, v252, v15
v_mul_f32 v253, v253, v15
v_mul_f32 v254, v254, v15
v_mul_f32 v255, v255, v15
v_mul_f32 v82, v82, v15
v_mul_f32 v83, v83, v15
v_exp_f32 v64, v32
v_exp_f32 v65, v33
v_exp_f32 v66, v34
v_add_f32 v84, v80, v64
v_add_f32 v85, v81, v65
v_cvt_pk_bf16_f32 v56, v64, v65
v_exp_f32 v67, v35
v_exp_f32 v68, v40
v_add_f32 v84, v84, v66
v_add_f32 v85, v85, v67
v_cvt_pk_bf16_f32 v57, v66, v67
v_exp_f32 v69, v41
v_exp_f32 v70, v42
v_add_f32 v84, v84, v68
v_add_f32 v85, v85, v69
v_cvt_pk_bf16_f32 v58, v68, v69
v_exp_f32 v71, v43
s_nop 0
v_add_f32 v84, v84, v70
v_add_f32 v85, v85, v71
v_cvt_pk_bf16_f32 v59, v70, v71
v_exp_f32 v64, v36
v_exp_f32 v65, v37
v_exp_f32 v66, v38
v_add_f32 v86, v82, v64
v_add_f32 v87, v83, v65
v_cvt_pk_bf16_f32 v60, v64, v65
v_exp_f32 v67, v39
v_exp_f32 v68, v44
v_add_f32 v86, v86, v66
v_add_f32 v87, v87, v67
v_cvt_pk_bf16_f32 v61, v66, v67
v_exp_f32 v69, v45
v_exp_f32 v70, v46
v_add_f32 v86, v86, v68
v_add_f32 v87, v87, v69
v_cvt_pk_bf16_f32 v62, v68, v69
v_exp_f32 v71, v47
s_nop 0
v_add_f32 v86, v86, v70
v_add_f32 v87, v87, v71
v_cvt_pk_bf16_f32 v63, v70, v71
s_nop 1
s_branch BACK_an1
RARE_an2:
s_nop 7
s_nop 7
v_max3_f32 v13, v16, v17, v18
v_max3_f32 v14, v19, v24, v25
v_max3_f32 v13, v13, v26, v27
v_max_f32 v13, v13, v14
v_mov_b32 v14, v13
s_nop 1
v_permlane32_swap_b32 v13, v14
s_nop 1
v_max_f32 v13, v13, v14
v_mov_b32 v14, v13
s_nop 1
v_permlane16_swap_b32 v13, v14
s_nop 1
v_max_f32 v13, v13, v14
v_max_f32 v13, 0, v13
v_sub_f32 v14, 0, v13
v_exp_f32 v15, v14
s_nop 0
v_add_f32 v72, v72, v14
v_add_f32 v73, v73, v14
v_add_f32 v74, v74, v14
v_add_f32 v75, v75, v14
v_add_f32 v16, v16, v14
v_add_f32 v32, v32, v14
v_add_f32 v17, v17, v14
v_add_f32 v33, v33, v14
v_add_f32 v18, v18, v14
v_add_f32 v34, v34, v14
v_add_f32 v19, v19, v14
v_add_f32 v35, v35, v14
v_add_f32 v24, v24, v14
v_add_f32 v40, v40, v14
v_add_f32 v25, v25, v14
v_add_f32 v41, v41, v14
v_add_f32 v26, v26, v14
v_add_f32 v42, v42, v14
v_add_f32 v27, v27, v14
v_add_f32 v43, v43, v14
v_mul_f32 v128, v128, v15
v_mul_f32 v129, v129, v15
v_mul_f32 v130, v130, v15
v_mul_f32 v131, v131, v15
v_mul_f32 v136, v136, v15
v_mul_f32 v137, v137, v15
v_mul_f32 v138, v138, v15
v_mul_f32 v139, v139, v15
v_mul_f32 v144, v144, v15
v_mul_f32 v145, v145, v15
v_mul_f32 v146, v146, v15
v_mul_f32 v147, v147, v15
v_mul_f32 v152, v152, v15
v_mul_f32 v153, v153, v15
v_mul_f32 v154, v154, v15
v_mul_f32 v155, v155, v15
v_mul_f32 v160, v160, v15
v_mul_f32 v161, v161, v15
v_mul_f32 v162, v162, v15
v_mul_f32 v163, v163, v15
v_mul_f32 v168, v168, v15
v_mul_f32 v169, v169, v15
v_mul_f32 v170, v170, v15
v_mul_f32 v171, v171, v15
v_mul_f32 v176, v176, v15
v_mul_f32 v177, v177, v15
v_mul_f32 v178, v178, v15
v_mul_f32 v179, v179, v15
v_mul_f32 v184, v184, v15
v_mul_f32 v185, v185, v15
v_mul_f32 v186, v186, v15
v_mul_f32 v187, v187, v15
v_mul_f32 v192, v192, v15
v_mul_f32 v193, v193, v15
v_mul_f32 v194, v194, v15
v_mul_f32 v195, v195, v15
v_mul_f32 v200, v200, v15
v_mul_f32 v201, v201, v15
v_mul_f32 v202, v202, v15
v_mul_f32 v203, v203, v15
v_mul_f32 v208, v208, v15
v_mul_f32 v209, v209, v15
v_mul_f32 v210, v210, v15
v_mul_f32 v211, v211, v15
v_mul_f32 v216, v216, v15
v_mul_f32 v217, v217, v15
v_mul_f32 v218, v218, v15
v_mul_f32 v219, v219, v15
v_mul_f32 v224, v224, v15
v_mul_f32 v225, v225, v15
v_mul_f32 v226, v226, v15
v_mul_f32 v227, v227, v15
v_mul_f32 v232, v232, v15
v_mul_f32 v233, v233, v15
v_mul_f32 v234, v234, v15
v_mul_f32 v235, v235, v15
v_mul_f32 v240, v240, v15
v_mul_f32 v241, v241, v15
v_mul_f32 v242, v242, v15
v_mul_f32 v243, v243, v15
v_mul_f32 v248, v248, v15
v_mul_f32 v249, v249, v15
v_mul_f32 v250, v250, v15
v_mul_f32 v251, v251, v15
v_mul_f32 v84, v84, v15
v_mul_f32 v85, v85, v15
v_max3_f32 v13, v20, v21, v22
v_max3_f32 v14, v23, v28, v29
v_max3_f32 v13, v13, v30, v31
v_max_f32 v13, v13, v14
v_mov_b32 v14, v13
s_nop 1
v_permlane32_swap_b32 v13, v14
s_nop 1
v_max_f32 v13, v13, v14
v_mov_b32 v14, v13
s_nop 1
v_permlane16_swap_b32 v13, v14
s_nop 1
v_max_f32 v13, v13, v14
v_max_f32 v13, 0, v13
v_sub_f32 v14, 0, v13
v_exp_f32 v15, v14
s_nop 0
v_add_f32 v76, v76, v14
v_add_f32 v77, v77, v14
v_add_f32 v78, v78, v14
v_add_f32 v79, v79, v14
v_add_f32 v20, v20, v14
v_add_f32 v36, v36, v14
v_add_f32 v21, v21, v14
v_add_f32 v37, v37, v14
v_add_f32 v22, v22, v14
v_add_f32 v38, v38, v14
v_add_f32 v23, v23, v14
v_add_f32 v39, v39, v14
v_add_f32 v28, v28, v14
v_add_f32 v44, v44, v14
v_add_f32 v29, v29, v14
v_add_f32 v45, v45, v14
v_add_f32 v30, v30, v14
v_add_f32 v46, v46, v14
v_add_f32 v31, v31, v14
v_add_f32 v47, v47, v14
v_mul_f32 v132, v132, v15
v_mul_f32 v133, v133, v15
v_mul_f32 v134, v134, v15
v_mul_f32 v135, v135, v15
v_mul_f32 v140, v140, v15
v_mul_f32 v141, v141, v15
v_mul_f32 v142, v142, v15
v_mul_f32 v143, v143, v15
v_mul_f32 v148, v148, v15
v_mul_f32 v149, v149, v15
v_mul_f32 v150, v150, v15
v_mul_f32 v151, v151, v15
v_mul_f32 v156, v156, v15
v_mul_f32 v157, v157, v15
v_mul_f32 v158, v158, v15
v_mul_f32 v159, v159, v15
v_mul_f32 v164, v164, v15
v_mul_f32 v165, v165, v15
v_mul_f32 v166, v166, v15
v_mul_f32 v167, v167, v15
v_mul_f32 v172, v172, v15
v_mul_f32 v173, v173, v15
v_mul_f32 v174, v174, v15
v_mul_f32 v175, v175, v15
v_mul_f32 v180, v180, v15
v_mul_f32 v181, v181, v15
v_mul_f32 v182, v182, v15
v_mul_f32 v183, v183, v15
v_mul_f32 v188, v188, v15
v_mul_f32 v189, v189, v15
v_mul_f32 v190, v190, v15
v_mul_f32 v191, v191, v15
v_mul_f32 v196, v196, v15
v_mul_f32 v197, v197, v15
v_mul_f32 v198, v198, v15
v_mul_f32 v199, v199, v15
v_mul_f32 v204, v204, v15
v_mul_f32 v205, v205, v15
v_mul_f32 v206, v206, v15
v_mul_f32 v207, v207, v15
v_mul_f32 v212, v212, v15
v_mul_f32 v213, v213, v15
v_mul_f32 v214, v214, v15
v_mul_f32 v215, v215, v15
v_mul_f32 v220, v220, v15
v_mul_f32 v221, v221, v15
v_mul_f32 v222, v222, v15
v_mul_f32 v223, v223, v15
v_mul_f32 v228, v228, v15
v_mul_f32 v229, v229, v15
v_mul_f32 v230, v230, v15
v_mul_f32 v231, v231, v15
v_mul_f32 v236, v236, v15
v_mul_f32 v237, v237, v15
v_mul_f32 v238, v238, v15
v_mul_f32 v239, v239, v15
v_mul_f32 v244, v244, v15
v_mul_f32 v245, v245, v15
v_mul_f32 v246, v246, v15
v_mul_f32 v247, v247, v15
v_mul_f32 v252, v252, v15
v_mul_f32 v253, v253, v15
v_mul_f32 v254, v254, v15
v_mul_f32 v255, v255, v15
v_mul_f32 v86, v86, v15
v_mul_f32 v87, v87, v15
v_exp_f32 v64, v16
v_exp_f32 v65, v17
v_exp_f32 v66, v18
v_add_f32 v80, v84, v64
v_add_f32 v81, v85, v65
v_cvt_pk_bf16_f32 v48, v64, v65
v_exp_f32 v67, v19
v_exp_f32 v68, v24
v_add_f32 v80, v80, v66
v_add_f32 v81, v81, v67
v_cvt_pk_bf16_f32 v49, v66, v67
v_exp_f32 v69, v25
v_exp_f32 v70, v26
v_add_f32 v80, v80, v68
v_add_f32 v81, v81, v69
v_cvt_pk_bf16_f32 v50, v68, v69
v_exp_f32 v71, v27
s_nop 0
v_add_f32 v80, v80, v70
v_add_f32 v81, v81, v71
v_cvt_pk_bf16_f32 v51, v70, v71
v_exp_f32 v64, v20
v_exp_f32 v65, v21
v_exp_f32 v66, v22
v_add_f32 v82, v86, v64
v_add_f32 v83, v87, v65
v_cvt_pk_bf16_f32 v52, v64, v65
v_exp_f32 v67, v23
v_exp_f32 v68, v28
v_add_f32 v82, v82, v66
v_add_f32 v83, v83, v67
v_cvt_pk_bf16_f32 v53, v66, v67
v_exp_f32 v69, v29
v_exp_f32 v70, v30
v_add_f32 v82, v82, v68
v_add_f32 v83, v83, v69
v_cvt_pk_bf16_f32 v54, v68, v69
v_exp_f32 v71, v31
s_nop 0
v_add_f32 v82, v82, v70
v_add_f32 v83, v83, v71
v_cvt_pk_bf16_f32 v55, v70, v71
s_nop 1
s_branch BACK_an2
RARE_an3:
s_nop 7
s_nop 7
v_max3_f32 v13, v32, v33, v34
v_max3_f32 v14, v35, v40, v41
v_max3_f32 v13, v13, v42, v43
v_max_f32 v13, v13, v14
v_mov_b32 v14, v13
s_nop 1
v_permlane32_swap_b32 v13, v14
s_nop 1
v_max_f32 v13, v13, v14
v_mov_b32 v14, v13
s_nop 1
v_permlane16_swap_b32 v13, v14
s_nop 1
v_max_f32 v13, v13, v14
v_max_f32 v13, 0, v13
v_sub_f32 v14, 0, v13
v_exp_f32 v15, v14
s_nop 0
v_add_f32 v72, v72, v14
v_add_f32 v73, v73, v14
v_add_f32 v74, v74, v14
v_add_f32 v75, v75, v14
v_add_f32 v32, v32, v14
v_add_f32 v16, v16, v14
v_add_f32 v33, v33, v14
v_add_f32 v17, v17, v14
v_add_f32 v34, v34, v14
v_add_f32 v18, v18, v14
v_add_f32 v35, v35, v14
v_add_f32 v19, v19, v14
v_add_f32 v40, v40, v14
v_add_f32 v24, v24, v14
v_add_f32 v41, v41, v14
v_add_f32 v25, v25, v14
v_add_f32 v42, v42, v14
v_add_f32 v26, v26, v14
v_add_f32 v43, v43, v14
v_add_f32 v27, v27, v14
v_mul_f32 v128, v128, v15
v_mul_f32 v129, v129, v15
v_mul_f32 v130, v130, v15
v_mul_f32 v131, v131, v15
v_mul_f32 v136, v136, v15
v_mul_f32 v137, v137, v15
v_mul_f32 v138, v138, v15
v_mul_f32 v139, v139, v15
v_mul_f32 v144, v144, v15
v_mul_f32 v145, v145, v15
v_mul_f32 v146, v146, v15
v_mul_f32 v147, v147, v15
v_mul_f32 v152, v152, v15
v_mul_f32 v153, v153, v15
v_mul_f32 v154, v154, v15
v_mul_f32 v155, v155, v15
v_mul_f32 v160, v160, v15
v_mul_f32 v161, v161, v15
v_mul_f32 v162, v162, v15
v_mul_f32 v163, v163, v15
v_mul_f32 v168, v168, v15
v_mul_f32 v169, v169, v15
v_mul_f32 v170, v170, v15
v_mul_f32 v171, v171, v15
v_mul_f32 v176, v176, v15
v_mul_f32 v177, v177, v15
v_mul_f32 v178, v178, v15
v_mul_f32 v179, v179, v15
v_mul_f32 v184, v184, v15
v_mul_f32 v185, v185, v15
v_mul_f32 v186, v186, v15
v_mul_f32 v187, v187, v15
v_mul_f32 v192, v192, v15
v_mul_f32 v193, v193, v15
v_mul_f32 v194, v194, v15
v_mul_f32 v195, v195, v15
v_mul_f32 v200, v200, v15
v_mul_f32 v201, v201, v15
v_mul_f32 v202, v202, v15
v_mul_f32 v203, v203, v15
v_mul_f32 v208, v208, v15
v_mul_f32 v209, v209, v15
v_mul_f32 v210, v210, v15
v_mul_f32 v211, v211, v15
v_mul_f32 v216, v216, v15
v_mul_f32 v217, v217, v15
v_mul_f32 v218, v218, v15
v_mul_f32 v219, v219, v15
v_mul_f32 v224, v224, v15
v_mul_f32 v225, v225, v15
v_mul_f32 v226, v226, v15
v_mul_f32 v227, v227, v15
v_mul_f32 v232, v232, v15
v_mul_f32 v233, v233, v15
v_mul_f32 v234, v234, v15
v_mul_f32 v235, v235, v15
v_mul_f32 v240, v240, v15
v_mul_f32 v241, v241, v15
v_mul_f32 v242, v242, v15
v_mul_f32 v243, v243, v15
v_mul_f32 v248, v248, v15
v_mul_f32 v249, v249, v15
v_mul_f32 v250, v250, v15
v_mul_f32 v251, v251, v15
v_mul_f32 v80, v80, v15
v_mul_f32 v81, v81, v15
v_max3_f32 v13, v36, v37, v38
v_max3_f32 v14, v39, v44, v45
v_max3_f32 v13, v13, v46, v47
v_max_f32 v13, v13, v14
v_mov_b32 v14, v13
s_nop 1
v_permlane32_swap_b32 v13, v14
s_nop 1
v_max_f32 v13, v13, v14
v_mov_b32 v14, v13
s_nop 1
v_permlane16_swap_b32 v13, v14
s_nop 1
v_max_f32 v13, v13, v14
v_max_f32 v13, 0, v13
v_sub_f32 v14, 0, v13
v_exp_f32 v15, v14
s_nop 0
v_add_f32 v76, v76, v14
v_add_f32 v77, v77, v14
v_add_f32 v78, v78, v14
v_add_f32 v79, v79, v14
v_add_f32 v36, v36, v14
v_add_f32 v20, v20, v14
v_add_f32 v37, v37, v14
v_add_f32 v21, v21, v14
v_add_f32 v38, v38, v14
v_add_f32 v22, v22, v14
v_add_f32 v39, v39, v14
v_add_f32 v23, v23, v14
v_add_f32 v44, v44, v14
v_add_f32 v28, v28, v14
v_add_f32 v45, v45, v14
v_add_f32 v29, v29, v14
v_add_f32 v46, v46, v14
v_add_f32 v30, v30, v14
v_add_f32 v47, v47, v14
v_add_f32 v31, v31, v14
v_mul_f32 v132, v132, v15
v_mul_f32 v133, v133, v15
v_mul_f32 v134, v134, v15
v_mul_f32 v135, v135, v15
v_mul_f32 v140, v140, v15
v_mul_f32 v141, v141, v15
v_mul_f32 v142, v142, v15
v_mul_f32 v143, v143, v15
v_mul_f32 v148, v148, v15
v_mul_f32 v149, v149, v15
v_mul_f32 v150, v150, v15
v_mul_f32 v151, v151, v15
v_mul_f32 v156, v156, v15
v_mul_f32 v157, v157, v15
v_mul_f32 v158, v158, v15
v_mul_f32 v159, v159, v15
v_mul_f32 v164, v164, v15
v_mul_f32 v165, v165, v15
v_mul_f32 v166, v166, v15
v_mul_f32 v167, v167, v15
v_mul_f32 v172, v172, v15
v_mul_f32 v173, v173, v15
v_mul_f32 v174, v174, v15
v_mul_f32 v175, v175, v15
v_mul_f32 v180, v180, v15
v_mul_f32 v181, v181, v15
v_mul_f32 v182, v182, v15
v_mul_f32 v183, v183, v15
v_mul_f32 v188, v188, v15
v_mul_f32 v189, v189, v15
v_mul_f32 v190, v190, v15
v_mul_f32 v191, v191, v15
v_mul_f32 v196, v196, v15
v_mul_f32 v197, v197, v15
v_mul_f32 v198, v198, v15
v_mul_f32 v199, v199, v15
v_mul_f32 v204, v204, v15
v_mul_f32 v205, v205, v15
v_mul_f32 v206, v206, v15
v_mul_f32 v207, v207, v15
v_mul_f32 v212, v212, v15
v_mul_f32 v213, v213, v15
v_mul_f32 v214, v214, v15
v_mul_f32 v215, v215, v15
v_mul_f32 v220, v220, v15
v_mul_f32 v221, v221, v15
v_mul_f32 v222, v222, v15
v_mul_f32 v223, v223, v15
v_mul_f32 v228, v228, v15
v_mul_f32 v229, v229, v15
v_mul_f32 v230, v230, v15
v_mul_f32 v231, v231, v15
v_mul_f32 v236, v236, v15
v_mul_f32 v237, v237, v15
v_mul_f32 v238, v238, v15
v_mul_f32 v239, v239, v15
v_mul_f32 v244, v244, v15
v_mul_f32 v245, v245, v15
v_mul_f32 v246, v246, v15
v_mul_f32 v247, v247, v15
v_mul_f32 v252, v252, v15
v_mul_f32 v253, v253, v15
v_mul_f32 v254, v254, v15
v_mul_f32 v255, v255, v15
v_mul_f32 v82, v82, v15
v_mul_f32 v83, v83, v15
v_exp_f32 v64, v32
v_exp_f32 v65, v33
v_exp_f32 v66, v34
v_add_f32 v84, v80, v64
v_add_f32 v85, v81, v65
v_cvt_pk_bf16_f32 v56, v64, v65
v_exp_f32 v67, v35
v_exp_f32 v68, v40
v_add_f32 v84, v84, v66
v_add_f32 v85, v85, v67
v_cvt_pk_bf16_f32 v57, v66, v67
v_exp_f32 v69, v41
v_exp_f32 v70, v42
v_add_f32 v84, v84, v68
v_add_f32 v85, v85, v69
v_cvt_pk_bf16_f32 v58, v68, v69
v_exp_f32 v71, v43
s_nop 0
v_add_f32 v84, v84, v70
v_add_f32 v85, v85, v71
v_cvt_pk_bf16_f32 v59, v70, v71
v_exp_f32 v64, v36
v_exp_f32 v65, v37
v_exp_f32 v66, v38
v_add_f32 v86, v82, v64
v_add_f32 v87, v83, v65
v_cvt_pk_bf16_f32 v60, v64, v65
v_exp_f32 v67, v39
v_exp_f32 v68, v44
v_add_f32 v86, v86, v66
v_add_f32 v87, v87, v67
v_cvt_pk_bf16_f32 v61, v66, v67
v_exp_f32 v69, v45
v_exp_f32 v70, v46
v_add_f32 v86, v86, v68
v_add_f32 v87, v87, v69
v_cvt_pk_bf16_f32 v62, v68, v69
v_exp_f32 v71, v47
s_nop 0
v_add_f32 v86, v86, v70
v_add_f32 v87, v87, v71
v_cvt_pk_bf16_f32 v63, v70, v71
s_nop 1
s_branch BACK_an3
RARE_a04:
s_nop 7
s_nop 7
v_max3_f32 v13, v16, v17, v18
v_max3_f32 v14, v19, v24, v25
v_max3_f32 v13, v13, v26, v27
v_max_f32 v13, v13, v14
v_mov_b32 v14, v13
s_nop 1
v_permlane32_swap_b32 v13, v14
s_nop 1
v_max_f32 v13, v13, v14
v_mov_b32 v14, v13
s_nop 1
v_permlane16_swap_b32 v13, v14
s_nop 1
v_max_f32 v13, v13, v14
v_max_f32 v13, 0, v13
v_sub_f32 v14, 0, v13
v_exp_f32 v15, v14
s_nop 0
v_add_f32 v72, v72, v14
v_add_f32 v73, v73, v14
v_add_f32 v74, v74, v14
v_add_f32 v75, v75, v14
v_add_f32 v16, v16, v14
v_add_f32 v32, v32, v14
v_add_f32 v17, v17, v14
v_add_f32 v33, v33, v14
v_add_f32 v18, v18, v14
v_add_f32 v34, v34, v14
v_add_f32 v19, v19, v14
v_add_f32 v35, v35, v14
v_add_f32 v24, v24, v14
v_add_f32 v40, v40, v14
v_add_f32 v25, v25, v14
v_add_f32 v41, v41, v14
v_add_f32 v26, v26, v14
v_add_f32 v42, v42, v14
v_add_f32 v27, v27, v14
v_add_f32 v43, v43, v14
v_mul_f32 v128, v128, v15
v_mul_f32 v129, v129, v15
v_mul_f32 v130, v130, v15
v_mul_f32 v131, v131, v15
v_mul_f32 v136, v136, v15
v_mul_f32 v137, v137, v15
v_mul_f32 v138, v138, v15
v_mul_f32 v139, v139, v15
v_mul_f32 v144, v144, v15
v_mul_f32 v145, v145, v15
v_mul_f32 v146, v146, v15
v_mul_f32 v147, v147, v15
v_mul_f32 v152, v152, v15
v_mul_f32 v153, v153, v15
v_mul_f32 v154, v154, v15
v_mul_f32 v155, v155, v15
v_mul_f32 v160, v160, v15
v_mul_f32 v161, v161, v15
v_mul_f32 v162, v162, v15
v_mul_f32 v163, v163, v15
v_mul_f32 v168, v168, v15
v_mul_f32 v169, v169, v15
v_mul_f32 v170, v170, v15
v_mul_f32 v171, v171, v15
v_mul_f32 v176, v176, v15
v_mul_f32 v177, v177, v15
v_mul_f32 v178, v178, v15
v_mul_f32 v179, v179, v15
v_mul_f32 v184, v184, v15
v_mul_f32 v185, v185, v15
v_mul_f32 v186, v186, v15
v_mul_f32 v187, v187, v15
v_mul_f32 v192, v192, v15
v_mul_f32 v193, v193, v15
v_mul_f32 v194, v194, v15
v_mul_f32 v195, v195, v15
v_mul_f32 v200, v200, v15
v_mul_f32 v201, v201, v15
v_mul_f32 v202, v202, v15
v_mul_f32 v203, v203, v15
v_mul_f32 v208, v208, v15
v_mul_f32 v209, v209, v15
v_mul_f32 v210, v210, v15
v_mul_f32 v211, v211, v15
v_mul_f32 v216, v216, v15
v_mul_f32 v217, v217, v15
v_mul_f32 v218, v218, v15
v_mul_f32 v219, v219, v15
v_mul_f32 v224, v224, v15
v_mul_f32 v225, v225, v15
v_mul_f32 v226, v226, v15
v_mul_f32 v227, v227, v15
v_mul_f32 v232, v232, v15
v_mul_f32 v233, v233, v15
v_mul_f32 v234, v234, v15
v_mul_f32 v235, v235, v15
v_mul_f32 v240, v240, v15
v_mul_f32 v241, v241, v15
v_mul_f32 v242, v242, v15
v_mul_f32 v243, v243, v15
v_mul_f32 v248, v248, v15
v_mul_f32 v249, v249, v15
v_mul_f32 v250, v250, v15
v_mul_f32 v251, v251, v15
v_mul_f32 v84, v84, v15
v_mul_f32 v85, v85, v15
v_max3_f32 v13, v20, v21, v22
v_max3_f32 v14, v23, v28, v29
v_max3_f32 v13, v13, v30, v31
v_max_f32 v13, v13, v14
v_mov_b32 v14, v13
s_nop 1
v_permlane32_swap_b32 v13, v14
s_nop 1
v_max_f32 v13, v13, v14
v_mov_b32 v14, v13
s_nop 1
v_permlane16_swap_b32 v13, v14
s_nop 1
v_max_f32 v13, v13, v14
v_max_f32 v13, 0, v13
v_sub_f32 v14, 0, v13
v_exp_f32 v15, v14
s_nop 0
v_add_f32 v76, v76, v14
v_add_f32 v77, v77, v14
v_add_f32 v78, v78, v14
v_add_f32 v79, v79, v14
v_add_f32 v20, v20, v14
v_add_f32 v36, v36, v14
v_add_f32 v21, v21, v14
v_add_f32 v37, v37, v14
v_add_f32 v22, v22, v14
v_add_f32 v38, v38, v14
v_add_f32 v23, v23, v14
v_add_f32 v39, v39, v14
v_add_f32 v28, v28, v14
v_add_f32 v44, v44, v14
v_add_f32 v29, v29, v14
v_add_f32 v45, v45, v14
v_add_f32 v30, v30, v14
v_add_f32 v46, v46, v14
v_add_f32 v31, v31, v14
v_add_f32 v47, v47, v14
v_mul_f32 v132, v132, v15
v_mul_f32 v133, v133, v15
v_mul_f32 v134, v134, v15
v_mul_f32 v135, v135, v15
v_mul_f32 v140, v140, v15
v_mul_f32 v141, v141, v15
v_mul_f32 v142, v142, v15
v_mul_f32 v143, v143, v15
v_mul_f32 v148, v148, v15
v_mul_f32 v149, v149, v15
v_mul_f32 v150, v150, v15
v_mul_f32 v151, v151, v15
v_mul_f32 v156, v156, v15
v_mul_f32 v157, v157, v15
v_mul_f32 v158, v158, v15
v_mul_f32 v159, v159, v15
v_mul_f32 v164, v164, v15
v_mul_f32 v165, v165, v15
v_mul_f32 v166, v166, v15
v_mul_f32 v167, v167, v15
v_mul_f32 v172, v172, v15
v_mul_f32 v173, v173, v15
v_mul_f32 v174, v174, v15
v_mul_f32 v175, v175, v15
v_mul_f32 v180, v180, v15
v_mul_f32 v181, v181, v15
v_mul_f32 v182, v182, v15
v_mul_f32 v183, v183, v15
v_mul_f32 v188, v188, v15
v_mul_f32 v189, v189, v15
v_mul_f32 v190, v190, v15
v_mul_f32 v191, v191, v15
v_mul_f32 v196, v196, v15
v_mul_f32 v197, v197, v15
v_mul_f32 v198, v198, v15
v_mul_f32 v199, v199, v15
v_mul_f32 v204, v204, v15
v_mul_f32 v205, v205, v15
v_mul_f32 v206, v206, v15
v_mul_f32 v207, v207, v15
v_mul_f32 v212, v212, v15
v_mul_f32 v213, v213, v15
v_mul_f32 v214, v214, v15
v_mul_f32 v215, v215, v15
v_mul_f32 v220, v220, v15
v_mul_f32 v221, v221, v15
v_mul_f32 v222, v222, v15
v_mul_f32 v223, v223, v15
v_mul_f32 v228, v228, v15
v_mul_f32 v229, v229, v15
v_mul_f32 v230, v230, v15
v_mul_f32 v231, v231, v15
v_mul_f32 v236, v236, v15
v_mul_f32 v237, v237, v15
v_mul_f32 v238, v238, v15
v_mul_f32 v239, v239, v15
v_mul_f32 v244, v244, v15
v_mul_f32 v245, v245, v15
v_mul_f32 v246, v246, v15
v_mul_f32 v247, v247, v15
v_mul_f32 v252, v252, v15
v_mul_f32 v253, v253, v15
v_mul_f32 v254, v254, v15
v_mul_f32 v255, v255, v15
v_mul_f32 v86, v86, v15
v_mul_f32 v87, v87, v15
v_exp_f32 v64, v16
v_exp_f32 v65, v17
v_exp_f32 v66, v18
v_add_f32 v80, v84, v64
v_add_f32 v81, v85, v65
v_cvt_pk_bf16_f32 v48, v64, v65
v_exp_f32 v67, v19
v_exp_f32 v68, v24
v_add_f32 v80, v80, v66
v_add_f32 v81, v81, v67
v_cvt_pk_bf16_f32 v49, v66, v67
v_exp_f32 v69, v25
v_exp_f32 v70, v26
v_add_f32 v80, v80, v68
v_add_f32 v81, v81, v69
v_cvt_pk_bf16_f32 v50, v68, v69
v_exp_f32 v71, v27
s_nop 0
v_add_f32 v80, v80, v70
v_add_f32 v81, v81, v71
v_cvt_pk_bf16_f32 v51, v70, v71
v_exp_f32 v64, v20
v_exp_f32 v65, v21
v_exp_f32 v66, v22
v_add_f32 v82, v86, v64
v_add_f32 v83, v87, v65
v_cvt_pk_bf16_f32 v52, v64, v65
v_exp_f32 v67, v23
v_exp_f32 v68, v28
v_add_f32 v82, v82, v66
v_add_f32 v83, v83, v67
v_cvt_pk_bf16_f32 v53, v66, v67
v_exp_f32 v69, v29
v_exp_f32 v70, v30
v_add_f32 v82, v82, v68
v_add_f32 v83, v83, v69
v_cvt_pk_bf16_f32 v54, v68, v69
v_exp_f32 v71, v31
s_nop 0
v_add_f32 v82, v82, v70
v_add_f32 v83, v83, v71
v_cvt_pk_bf16_f32 v55, v70, v71
s_nop 1
s_branch BACK_a04
RARE_am0:
s_nop 7
s_nop 7
v_max3_f32 v13, v16, v17, v18
v_max3_f32 v14, v19, v24, v25
v_max3_f32 v13, v13, v26, v27
v_max_f32 v13, v13, v14
v_mov_b32 v14, v13
s_nop 1
v_permlane32_swap_b32 v13, v14
s_nop 1
v_max_f32 v13, v13, v14
v_mov_b32 v14, v13
s_nop 1
v_permlane16_swap_b32 v13, v14
s_nop 1
v_max_f32 v13, v13, v14
v_max_f32 v13, 0, v13
v_sub_f32 v14, 0, v13
v_exp_f32 v15, v14
s_nop 0
v_add_f32 v72, v72, v14
v_add_f32 v73, v73, v14
v_add_f32 v74, v74, v14
v_add_f32 v75, v75, v14
v_add_f32 v16, v16, v14
v_add_f32 v32, v32, v14
v_add_f32 v17, v17, v14
v_add_f32 v33, v33, v14
v_add_f32 v18, v18, v14
v_add_f32 v34, v34, v14
v_add_f32 v19, v19, v14
v_add_f32 v35, v35, v14
v_add_f32 v24, v24, v14
v_add_f32 v40, v40, v14
v_add_f32 v25, v25, v14
v_add_f32 v41, v41, v14
v_add_f32 v26, v26, v14
v_add_f32 v42, v42, v14
v_add_f32 v27, v27, v14
v_add_f32 v43, v43, v14
v_mul_f32 v128, v128, v15
v_mul_f32 v129, v129, v15
v_mul_f32 v130, v130, v15
v_mul_f32 v131, v131, v15
v_mul_f32 v136, v136, v15
v_mul_f32 v137, v137, v15
v_mul_f32 v138, v138, v15
v_mul_f32 v139, v139, v15
v_mul_f32 v144, v144, v15
v_mul_f32 v145, v145, v15
v_mul_f32 v146, v146, v15
v_mul_f32 v147, v147, v15
v_mul_f32 v152, v152, v15
v_mul_f32 v153, v153, v15
v_mul_f32 v154, v154, v15
v_mul_f32 v155, v155, v15
v_mul_f32 v160, v160, v15
v_mul_f32 v161, v161, v15
v_mul_f32 v162, v162, v15
v_mul_f32 v163, v163, v15
v_mul_f32 v168, v168, v15
v_mul_f32 v169, v169, v15
v_mul_f32 v170, v170, v15
v_mul_f32 v171, v171, v15
v_mul_f32 v176, v176, v15
v_mul_f32 v177, v177, v15
v_mul_f32 v178, v178, v15
v_mul_f32 v179, v179, v15
v_mul_f32 v184, v184, v15
v_mul_f32 v185, v185, v15
v_mul_f32 v186, v186, v15
v_mul_f32 v187, v187, v15
v_mul_f32 v192, v192, v15
v_mul_f32 v193, v193, v15
v_mul_f32 v194, v194, v15
v_mul_f32 v195, v195, v15
v_mul_f32 v200, v200, v15
v_mul_f32 v201, v201, v15
v_mul_f32 v202, v202, v15
v_mul_f32 v203, v203, v15
v_mul_f32 v208, v208, v15
v_mul_f32 v209, v209, v15
v_mul_f32 v210, v210, v15
v_mul_f32 v211, v211, v15
v_mul_f32 v216, v216, v15
v_mul_f32 v217, v217, v15
v_mul_f32 v218, v218, v15
v_mul_f32 v219, v219, v15
v_mul_f32 v224, v224, v15
v_mul_f32 v225, v225, v15
v_mul_f32 v226, v226, v15
v_mul_f32 v227, v227, v15
v_mul_f32 v232, v232, v15
v_mul_f32 v233, v233, v15
v_mul_f32 v234, v234, v15
v_mul_f32 v235, v235, v15
v_mul_f32 v240, v240, v15
v_mul_f32 v241, v241, v15
v_mul_f32 v242, v242, v15
v_mul_f32 v243, v243, v15
v_mul_f32 v248, v248, v15
v_mul_f32 v249, v249, v15
v_mul_f32 v250, v250, v15
v_mul_f32 v251, v251, v15
v_mul_f32 v84, v84, v15
v_mul_f32 v85, v85, v15
v_max3_f32 v13, v20, v21, v22
v_max3_f32 v14, v23, v28, v29
v_max3_f32 v13, v13, v30, v31
v_max_f32 v13, v13, v14
v_mov_b32 v14, v13
s_nop 1
v_permlane32_swap_b32 v13, v14
s_nop 1
v_max_f32 v13, v13, v14
v_mov_b32 v14, v13
s_nop 1
v_permlane16_swap_b32 v13, v14
s_nop 1
v_max_f32 v13, v13, v14
v_max_f32 v13, 0, v13
v_sub_f32 v14, 0, v13
v_exp_f32 v15, v14
s_nop 0
v_add_f32 v76, v76, v14
v_add_f32 v77, v77, v14
v_add_f32 v78, v78, v14
v_add_f32 v79, v79, v14
v_add_f32 v20, v20, v14
v_add_f32 v36, v36, v14
v_add_f32 v21, v21, v14
v_add_f32 v37, v37, v14
v_add_f32 v22, v22, v14
v_add_f32 v38, v38, v14
v_add_f32 v23, v23, v14
v_add_f32 v39, v39, v14
v_add_f32 v28, v28, v14
v_add_f32 v44, v44, v14
v_add_f32 v29, v29, v14
v_add_f32 v45, v45, v14
v_add_f32 v30, v30, v14
v_add_f32 v46, v46, v14
v_add_f32 v31, v31, v14
v_add_f32 v47, v47, v14
v_mul_f32 v132, v132, v15
v_mul_f32 v133, v133, v15
v_mul_f32 v134, v134, v15
v_mul_f32 v135, v135, v15
v_mul_f32 v140, v140, v15
v_mul_f32 v141, v141, v15
v_mul_f32 v142, v142, v15
v_mul_f32 v143, v143, v15
v_mul_f32 v148, v148, v15
v_mul_f32 v149, v149, v15
v_mul_f32 v150, v150, v15
v_mul_f32 v151, v151, v15
v_mul_f32 v156, v156, v15
v_mul_f32 v157, v157, v15
v_mul_f32 v158, v158, v15
v_mul_f32 v159, v159, v15
v_mul_f32 v164, v164, v15
v_mul_f32 v165, v165, v15
v_mul_f32 v166, v166, v15
v_mul_f32 v167, v167, v15
v_mul_f32 v172, v172, v15
v_mul_f32 v173, v173, v15
v_mul_f32 v174, v174, v15
v_mul_f32 v175, v175, v15
v_mul_f32 v180, v180, v15
v_mul_f32 v181, v181, v15
v_mul_f32 v182, v182, v15
v_mul_f32 v183, v183, v15
v_mul_f32 v188, v188, v15
v_mul_f32 v189, v189, v15
v_mul_f32 v190, v190, v15
v_mul_f32 v191, v191, v15
v_mul_f32 v196, v196, v15
v_mul_f32 v197, v197, v15
v_mul_f32 v198, v198, v15
v_mul_f32 v199, v199, v15
v_mul_f32 v204, v204, v15
v_mul_f32 v205, v205, v15
v_mul_f32 v206, v206, v15
v_mul_f32 v207, v207, v15
v_mul_f32 v212, v212, v15
v_mul_f32 v213, v213, v15
v_mul_f32 v214, v214, v15
v_mul_f32 v215, v215, v15
v_mul_f32 v220, v220, v15
v_mul_f32 v221, v221, v15
v_mul_f32 v222, v222, v15
v_mul_f32 v223, v223, v15
v_mul_f32 v228, v228, v15
v_mul_f32 v229, v229, v15
v_mul_f32 v230, v230, v15
v_mul_f32 v231, v231, v15
v_mul_f32 v236, v236, v15
v_mul_f32 v237, v237, v15
v_mul_f32 v238, v238, v15
v_mul_f32 v239, v239, v15
v_mul_f32 v244, v244, v15
v_mul_f32 v245, v245, v15
v_mul_f32 v246, v246, v15
v_mul_f32 v247, v247, v15
v_mul_f32 v252, v252, v15
v_mul_f32 v253, v253, v15
v_mul_f32 v254, v254, v15
v_mul_f32 v255, v255, v15
v_mul_f32 v86, v86, v15
v_mul_f32 v87, v87, v15
v_exp_f32 v64, v16
v_exp_f32 v65, v17
v_exp_f32 v66, v18
v_add_f32 v80, v84, v64
v_add_f32 v81, v85, v65
v_cvt_pk_bf16_f32 v48, v64, v65
v_exp_f32 v67, v19
v_exp_f32 v68, v24
v_add_f32 v80, v80, v66
v_add_f32 v81, v81, v67
v_cvt_pk_bf16_f32 v49, v66, v67
v_exp_f32 v69, v25
v_exp_f32 v70, v26
v_add_f32 v80, v80, v68
v_add_f32 v81, v81, v69
v_cvt_pk_bf16_f32 v50, v68, v69
v_exp_f32 v71, v27
s_nop 0
v_add_f32 v80, v80, v70
v_add_f32 v81, v81, v71
v_cvt_pk_bf16_f32 v51, v70, v71
v_exp_f32 v64, v20
v_exp_f32 v65, v21
v_exp_f32 v66, v22
v_add_f32 v82, v86, v64
v_add_f32 v83, v87, v65
v_cvt_pk_bf16_f32 v52, v64, v65
v_exp_f32 v67, v23
v_exp_f32 v68, v28
v_add_f32 v82, v82, v66
v_add_f32 v83, v83, v67
v_cvt_pk_bf16_f32 v53, v66, v67
v_exp_f32 v69, v29
v_exp_f32 v70, v30
v_add_f32 v82, v82, v68
v_add_f32 v83, v83, v69
v_cvt_pk_bf16_f32 v54, v68, v69
v_exp_f32 v71, v31
s_nop 0
v_add_f32 v82, v82, v70
v_add_f32 v83, v83, v71
v_cvt_pk_bf16_f32 v55, v70, v71
s_nop 1
s_branch BACK_am0
RARE_am1:
s_nop 7
s_nop 7
v_max3_f32 v13, v32, v33, v34
v_max3_f32 v14, v35, v40, v41
v_max3_f32 v13, v13, v42, v43
v_max_f32 v13, v13, v14
v_mov_b32 v14, v13
s_nop 1
v_permlane32_swap_b32 v13, v14
s_nop 1
v_max_f32 v13, v13, v14
v_mov_b32 v14, v13
s_nop 1
v_permlane16_swap_b32 v13, v14
s_nop 1
v_max_f32 v13, v13, v14
v_max_f32 v13, 0, v13
v_sub_f32 v14, 0, v13
v_exp_f32 v15, v14
s_nop 0
v_add_f32 v72, v72, v14
v_add_f32 v73, v73, v14
v_add_f32 v74, v74, v14
v_add_f32 v75, v75, v14
v_add_f32 v32, v32, v14
v_add_f32 v16, v16, v14
v_add_f32 v33, v33, v14
v_add_f32 v17, v17, v14
v_add_f32 v34, v34, v14
v_add_f32 v18, v18, v14
v_add_f32 v35, v35, v14
v_add_f32 v19, v19, v14
v_add_f32 v40, v40, v14
v_add_f32 v24, v24, v14
v_add_f32 v41, v41, v14
v_add_f32 v25, v25, v14
v_add_f32 v42, v42, v14
v_add_f32 v26, v26, v14
v_add_f32 v43, v43, v14
v_add_f32 v27, v27, v14
v_mul_f32 v128, v128, v15
v_mul_f32 v129, v129, v15
v_mul_f32 v130, v130, v15
v_mul_f32 v131, v131, v15
v_mul_f32 v136, v136, v15
v_mul_f32 v137, v137, v15
v_mul_f32 v138, v138, v15
v_mul_f32 v139, v139, v15
v_mul_f32 v144, v144, v15
v_mul_f32 v145, v145, v15
v_mul_f32 v146, v146, v15
v_mul_f32 v147, v147, v15
v_mul_f32 v152, v152, v15
v_mul_f32 v153, v153, v15
v_mul_f32 v154, v154, v15
v_mul_f32 v155, v155, v15
v_mul_f32 v160, v160, v15
v_mul_f32 v161, v161, v15
v_mul_f32 v162, v162, v15
v_mul_f32 v163, v163, v15
v_mul_f32 v168, v168, v15
v_mul_f32 v169, v169, v15
v_mul_f32 v170, v170, v15
v_mul_f32 v171, v171, v15
v_mul_f32 v176, v176, v15
v_mul_f32 v177, v177, v15
v_mul_f32 v178, v178, v15
v_mul_f32 v179, v179, v15
v_mul_f32 v184, v184, v15
v_mul_f32 v185, v185, v15
v_mul_f32 v186, v186, v15
v_mul_f32 v187, v187, v15
v_mul_f32 v192, v192, v15
v_mul_f32 v193, v193, v15
v_mul_f32 v194, v194, v15
v_mul_f32 v195, v195, v15
v_mul_f32 v200, v200, v15
v_mul_f32 v201, v201, v15
v_mul_f32 v202, v202, v15
v_mul_f32 v203, v203, v15
v_mul_f32 v208, v208, v15
v_mul_f32 v209, v209, v15
v_mul_f32 v210, v210, v15
v_mul_f32 v211, v211, v15
v_mul_f32 v216, v216, v15
v_mul_f32 v217, v217, v15
v_mul_f32 v218, v218, v15
v_mul_f32 v219, v219, v15
v_mul_f32 v224, v224, v15
v_mul_f32 v225, v225, v15
v_mul_f32 v226, v226, v15
v_mul_f32 v227, v227, v15
v_mul_f32 v232, v232, v15
v_mul_f32 v233, v233, v15
v_mul_f32 v234, v234, v15
v_mul_f32 v235, v235, v15
v_mul_f32 v240, v240, v15
v_mul_f32 v241, v241, v15
v_mul_f32 v242, v242, v15
v_mul_f32 v243, v243, v15
v_mul_f32 v248, v248, v15
v_mul_f32 v249, v249, v15
v_mul_f32 v250, v250, v15
v_mul_f32 v251, v251, v15
v_mul_f32 v80, v80, v15
v_mul_f32 v81, v81, v15
v_max3_f32 v13, v36, v37, v38
v_max3_f32 v14, v39, v44, v45
v_max3_f32 v13, v13, v46, v47
v_max_f32 v13, v13, v14
v_mov_b32 v14, v13
s_nop 1
v_permlane32_swap_b32 v13, v14
s_nop 1
v_max_f32 v13, v13, v14
v_mov_b32 v14, v13
s_nop 1
v_permlane16_swap_b32 v13, v14
s_nop 1
v_max_f32 v13, v13, v14
v_max_f32 v13, 0, v13
v_sub_f32 v14, 0, v13
v_exp_f32 v15, v14
s_nop 0
v_add_f32 v76, v76, v14
v_add_f32 v77, v77, v14
v_add_f32 v78, v78, v14
v_add_f32 v79, v79, v14
v_add_f32 v36, v36, v14
v_add_f32 v20, v20, v14
v_add_f32 v37, v37, v14
v_add_f32 v21, v21, v14
v_add_f32 v38, v38, v14
v_add_f32 v22, v22, v14
v_add_f32 v39, v39, v14
v_add_f32 v23, v23, v14
v_add_f32 v44, v44, v14
v_add_f32 v28, v28, v14
v_add_f32 v45, v45, v14
v_add_f32 v29, v29, v14
v_add_f32 v46, v46, v14
v_add_f32 v30, v30, v14
v_add_f32 v47, v47, v14
v_add_f32 v31, v31, v14
v_mul_f32 v132, v132, v15
v_mul_f32 v133, v133, v15
v_mul_f32 v134, v134, v15
v_mul_f32 v135, v135, v15
v_mul_f32 v140, v140, v15
v_mul_f32 v141, v141, v15
v_mul_f32 v142, v142, v15
v_mul_f32 v143, v143, v15
v_mul_f32 v148, v148, v15
v_mul_f32 v149, v149, v15
v_mul_f32 v150, v150, v15
v_mul_f32 v151, v151, v15
v_mul_f32 v156, v156, v15
v_mul_f32 v157, v157, v15
v_mul_f32 v158, v158, v15
v_mul_f32 v159, v159, v15
v_mul_f32 v164, v164, v15
v_mul_f32 v165, v165, v15
v_mul_f32 v166, v166, v15
v_mul_f32 v167, v167, v15
v_mul_f32 v172, v172, v15
v_mul_f32 v173, v173, v15
v_mul_f32 v174, v174, v15
v_mul_f32 v175, v175, v15
v_mul_f32 v180, v180, v15
v_mul_f32 v181, v181, v15
v_mul_f32 v182, v182, v15
v_mul_f32 v183, v183, v15
v_mul_f32 v188, v188, v15
v_mul_f32 v189, v189, v15
v_mul_f32 v190, v190, v15
v_mul_f32 v191, v191, v15
v_mul_f32 v196, v196, v15
v_mul_f32 v197, v197, v15
v_mul_f32 v198, v198, v15
v_mul_f32 v199, v199, v15
v_mul_f32 v204, v204, v15
v_mul_f32 v205, v205, v15
v_mul_f32 v206, v206, v15
v_mul_f32 v207, v207, v15
v_mul_f32 v212, v212, v15
v_mul_f32 v213, v213, v15
v_mul_f32 v214, v214, v15
v_mul_f32 v215, v215, v15
v_mul_f32 v220, v220, v15
v_mul_f32 v221, v221, v15
v_mul_f32 v222, v222, v15
v_mul_f32 v223, v223, v15
v_mul_f32 v228, v228, v15
v_mul_f32 v229, v229, v15
v_mul_f32 v230, v230, v15
v_mul_f32 v231, v231, v15
v_mul_f32 v236, v236, v15
v_mul_f32 v237, v237, v15
v_mul_f32 v238, v238, v15
v_mul_f32 v239, v239, v15
v_mul_f32 v244, v244, v15
v_mul_f32 v245, v245, v15
v_mul_f32 v246, v246, v15
v_mul_f32 v247, v247, v15
v_mul_f32 v252, v252, v15
v_mul_f32 v253, v253, v15
v_mul_f32 v254, v254, v15
v_mul_f32 v255, v255, v15
v_mul_f32 v82, v82, v15
v_mul_f32 v83, v83, v15
v_exp_f32 v64, v32
v_exp_f32 v65, v33
v_exp_f32 v66, v34
v_add_f32 v84, v80, v64
v_add_f32 v85, v81, v65
v_cvt_pk_bf16_f32 v56, v64, v65
v_exp_f32 v67, v35
v_exp_f32 v68, v40
v_add_f32 v84, v84, v66
v_add_f32 v85, v85, v67
v_cvt_pk_bf16_f32 v57, v66, v67
v_exp_f32 v69, v41
v_exp_f32 v70, v42
v_add_f32 v84, v84, v68
v_add_f32 v85, v85, v69
v_cvt_pk_bf16_f32 v58, v68, v69
v_exp_f32 v71, v43
s_nop 0
v_add_f32 v84, v84, v70
v_add_f32 v85, v85, v71
v_cvt_pk_bf16_f32 v59, v70, v71
v_exp_f32 v64, v36
v_exp_f32 v65, v37
v_exp_f32 v66, v38
v_add_f32 v86, v82, v64
v_add_f32 v87, v83, v65
v_cvt_pk_bf16_f32 v60, v64, v65
v_exp_f32 v67, v39
v_exp_f32 v68, v44
v_add_f32 v86, v86, v66
v_add_f32 v87, v87, v67
v_cvt_pk_bf16_f32 v61, v66, v67
v_exp_f32 v69, v45
v_exp_f32 v70, v46
v_add_f32 v86, v86, v68
v_add_f32 v87, v87, v69
v_cvt_pk_bf16_f32 v62, v68, v69
v_exp_f32 v71, v47
s_nop 0
v_add_f32 v86, v86, v70
v_add_f32 v87, v87, v71
v_cvt_pk_bf16_f32 v63, v70, v71
s_nop 1
s_branch BACK_am1
RARE_am2:
s_nop 7
s_nop 7
v_max3_f32 v13, v16, v17, v18
v_max3_f32 v14, v19, v24, v25
v_max3_f32 v13, v13, v26, v27
v_max_f32 v13, v13, v14
v_mov_b32 v14, v13
s_nop 1
v_permlane32_swap_b32 v13, v14
s_nop 1
v_max_f32 v13, v13, v14
v_mov_b32 v14, v13
s_nop 1
v_permlane16_swap_b32 v13, v14
s_nop 1
v_max_f32 v13, v13, v14
v_max_f32 v13, 0, v13
v_sub_f32 v14, 0, v13
v_exp_f32 v15, v14
s_nop 0
v_add_f32 v72, v72, v14
v_add_f32 v73, v73, v14
v_add_f32 v74, v74, v14
v_add_f32 v75, v75, v14
v_add_f32 v16, v16, v14
v_add_f32 v32, v32, v14
v_add_f32 v17, v17, v14
v_add_f32 v33, v33, v14
v_add_f32 v18, v18, v14
v_add_f32 v34, v34, v14
v_add_f32 v19, v19, v14
v_add_f32 v35, v35, v14
v_add_f32 v24, v24, v14
v_add_f32 v40, v40, v14
v_add_f32 v25, v25, v14
v_add_f32 v41, v41, v14
v_add_f32 v26, v26, v14
v_add_f32 v42, v42, v14
v_add_f32 v27, v27, v14
v_add_f32 v43, v43, v14
v_mul_f32 v128, v128, v15
v_mul_f32 v129, v129, v15
v_mul_f32 v130, v130, v15
v_mul_f32 v131, v131, v15
v_mul_f32 v136, v136, v15
v_mul_f32 v137, v137, v15
v_mul_f32 v138, v138, v15
v_mul_f32 v139, v139, v15
v_mul_f32 v144, v144, v15
v_mul_f32 v145, v145, v15
v_mul_f32 v146, v146, v15
v_mul_f32 v147, v147, v15
v_mul_f32 v152, v152, v15
v_mul_f32 v153, v153, v15
v_mul_f32 v154, v154, v15
v_mul_f32 v155, v155, v15
v_mul_f32 v160, v160, v15
v_mul_f32 v161, v161, v15
v_mul_f32 v162, v162, v15
v_mul_f32 v163, v163, v15
v_mul_f32 v168, v168, v15
v_mul_f32 v169, v169, v15
v_mul_f32 v170, v170, v15
v_mul_f32 v171, v171, v15
v_mul_f32 v176, v176, v15
v_mul_f32 v177, v177, v15
v_mul_f32 v178, v178, v15
v_mul_f32 v179, v179, v15
v_mul_f32 v184, v184, v15
v_mul_f32 v185, v185, v15
v_mul_f32 v186, v186, v15
v_mul_f32 v187, v187, v15
v_mul_f32 v192, v192, v15
v_mul_f32 v193, v193, v15
v_mul_f32 v194, v194, v15
v_mul_f32 v195, v195, v15
v_mul_f32 v200, v200, v15
v_mul_f32 v201, v201, v15
v_mul_f32 v202, v202, v15
v_mul_f32 v203, v203, v15
v_mul_f32 v208, v208, v15
v_mul_f32 v209, v209, v15
v_mul_f32 v210, v210, v15
v_mul_f32 v211, v211, v15
v_mul_f32 v216, v216, v15
v_mul_f32 v217, v217, v15
v_mul_f32 v218, v218, v15
v_mul_f32 v219, v219, v15
v_mul_f32 v224, v224, v15
v_mul_f32 v225, v225, v15
v_mul_f32 v226, v226, v15
v_mul_f32 v227, v227, v15
v_mul_f32 v232, v232, v15
v_mul_f32 v233, v233, v15
v_mul_f32 v234, v234, v15
v_mul_f32 v235, v235, v15
v_mul_f32 v240, v240, v15
v_mul_f32 v241, v241, v15
v_mul_f32 v242, v242, v15
v_mul_f32 v243, v243, v15
v_mul_f32 v248, v248, v15
v_mul_f32 v249, v249, v15
v_mul_f32 v250, v250, v15
v_mul_f32 v251, v251, v15
v_mul_f32 v84, v84, v15
v_mul_f32 v85, v85, v15
v_max3_f32 v13, v20, v21, v22
v_max3_f32 v14, v23, v28, v29
v_max3_f32 v13, v13, v30, v31
v_max_f32 v13, v13, v14
v_mov_b32 v14, v13
s_nop 1
v_permlane32_swap_b32 v13, v14
s_nop 1
v_max_f32 v13, v13, v14
v_mov_b32 v14, v13
s_nop 1
v_permlane16_swap_b32 v13, v14
s_nop 1
v_max_f32 v13, v13, v14
v_max_f32 v13, 0, v13
v_sub_f32 v14, 0, v13
v_exp_f32 v15, v14
s_nop 0
v_add_f32 v76, v76, v14
v_add_f32 v77, v77, v14
v_add_f32 v78, v78, v14
v_add_f32 v79, v79, v14
v_add_f32 v20, v20, v14
v_add_f32 v36, v36, v14
v_add_f32 v21, v21, v14
v_add_f32 v37, v37, v14
v_add_f32 v22, v22, v14
v_add_f32 v38, v38, v14
v_add_f32 v23, v23, v14
v_add_f32 v39, v39, v14
v_add_f32 v28, v28, v14
v_add_f32 v44, v44, v14
v_add_f32 v29, v29, v14
v_add_f32 v45, v45, v14
v_add_f32 v30, v30, v14
v_add_f32 v46, v46, v14
v_add_f32 v31, v31, v14
v_add_f32 v47, v47, v14
v_mul_f32 v132, v132, v15
v_mul_f32 v133, v133, v15
v_mul_f32 v134, v134, v15
v_mul_f32 v135, v135, v15
v_mul_f32 v140, v140, v15
v_mul_f32 v141, v141, v15
v_mul_f32 v142, v142, v15
v_mul_f32 v143, v143, v15
v_mul_f32 v148, v148, v15
v_mul_f32 v149, v149, v15
v_mul_f32 v150, v150, v15
v_mul_f32 v151, v151, v15
v_mul_f32 v156, v156, v15
v_mul_f32 v157, v157, v15
v_mul_f32 v158, v158, v15
v_mul_f32 v159, v159, v15
v_mul_f32 v164, v164, v15
v_mul_f32 v165, v165, v15
v_mul_f32 v166, v166, v15
v_mul_f32 v167, v167, v15
v_mul_f32 v172, v172, v15
v_mul_f32 v173, v173, v15
v_mul_f32 v174, v174, v15
v_mul_f32 v175, v175, v15
v_mul_f32 v180, v180, v15
v_mul_f32 v181, v181, v15
v_mul_f32 v182, v182, v15
v_mul_f32 v183, v183, v15
v_mul_f32 v188, v188, v15
v_mul_f32 v189, v189, v15
v_mul_f32 v190, v190, v15
v_mul_f32 v191, v191, v15
v_mul_f32 v196, v196, v15
v_mul_f32 v197, v197, v15
v_mul_f32 v198, v198, v15
v_mul_f32 v199, v199, v15
v_mul_f32 v204, v204, v15
v_mul_f32 v205, v205, v15
v_mul_f32 v206, v206, v15
v_mul_f32 v207, v207, v15
v_mul_f32 v212, v212, v15
v_mul_f32 v213, v213, v15
v_mul_f32 v214, v214, v15
v_mul_f32 v215, v215, v15
v_mul_f32 v220, v220, v15
v_mul_f32 v221, v221, v15
v_mul_f32 v222, v222, v15
v_mul_f32 v223, v223, v15
v_mul_f32 v228, v228, v15
v_mul_f32 v229, v229, v15
v_mul_f32 v230, v230, v15
v_mul_f32 v231, v231, v15
v_mul_f32 v236, v236, v15
v_mul_f32 v237, v237, v15
v_mul_f32 v238, v238, v15
v_mul_f32 v239, v239, v15
v_mul_f32 v244, v244, v15
v_mul_f32 v245, v245, v15
v_mul_f32 v246, v246, v15
v_mul_f32 v247, v247, v15
v_mul_f32 v252, v252, v15
v_mul_f32 v253, v253, v15
v_mul_f32 v254, v254, v15
v_mul_f32 v255, v255, v15
v_mul_f32 v86, v86, v15
v_mul_f32 v87, v87, v15
v_exp_f32 v64, v16
v_exp_f32 v65, v17
v_exp_f32 v66, v18
v_add_f32 v80, v84, v64
v_add_f32 v81, v85, v65
v_cvt_pk_bf16_f32 v48, v64, v65
v_exp_f32 v67, v19
v_exp_f32 v68, v24
v_add_f32 v80, v80, v66
v_add_f32 v81, v81, v67
v_cvt_pk_bf16_f32 v49, v66, v67
v_exp_f32 v69, v25
v_exp_f32 v70, v26
v_add_f32 v80, v80, v68
v_add_f32 v81, v81, v69
v_cvt_pk_bf16_f32 v50, v68, v69
v_exp_f32 v71, v27
s_nop 0
v_add_f32 v80, v80, v70
v_add_f32 v81, v81, v71
v_cvt_pk_bf16_f32 v51, v70, v71
v_exp_f32 v64, v20
v_exp_f32 v65, v21
v_exp_f32 v66, v22
v_add_f32 v82, v86, v64
v_add_f32 v83, v87, v65
v_cvt_pk_bf16_f32 v52, v64, v65
v_exp_f32 v67, v23
v_exp_f32 v68, v28
v_add_f32 v82, v82, v66
v_add_f32 v83, v83, v67
v_cvt_pk_bf16_f32 v53, v66, v67
v_exp_f32 v69, v29
v_exp_f32 v70, v30
v_add_f32 v82, v82, v68
v_add_f32 v83, v83, v69
v_cvt_pk_bf16_f32 v54, v68, v69
v_exp_f32 v71, v31
s_nop 0
v_add_f32 v82, v82, v70
v_add_f32 v83, v83, v71
v_cvt_pk_bf16_f32 v55, v70, v71
s_nop 1
s_branch BACK_am2
RARE_am3:
s_nop 7
s_nop 7
v_max3_f32 v13, v32, v33, v34
v_max3_f32 v14, v35, v40, v41
v_max3_f32 v13, v13, v42, v43
v_max_f32 v13, v13, v14
v_mov_b32 v14, v13
s_nop 1
v_permlane32_swap_b32 v13, v14
s_nop 1
v_max_f32 v13, v13, v14
v_mov_b32 v14, v13
s_nop 1
v_permlane16_swap_b32 v13, v14
s_nop 1
v_max_f32 v13, v13, v14
v_max_f32 v13, 0, v13
v_sub_f32 v14, 0, v13
v_exp_f32 v15, v14
s_nop 0
v_add_f32 v72, v72, v14
v_add_f32 v73, v73, v14
v_add_f32 v74, v74, v14
v_add_f32 v75, v75, v14
v_add_f32 v32, v32, v14
v_add_f32 v33, v33, v14
v_add_f32 v34, v34, v14
v_add_f32 v35, v35, v14
v_add_f32 v40, v40, v14
v_add_f32 v41, v41, v14
v_add_f32 v42, v42, v14
v_add_f32 v43, v43, v14
v_mul_f32 v128, v128, v15
v_mul_f32 v129, v129, v15
v_mul_f32 v130, v130, v15
v_mul_f32 v131, v131, v15
v_mul_f32 v136, v136, v15
v_mul_f32 v137, v137, v15
v_mul_f32 v138, v138, v15
v_mul_f32 v139, v139, v15
v_mul_f32 v144, v144, v15
v_mul_f32 v145, v145, v15
v_mul_f32 v146, v146, v15
v_mul_f32 v147, v147, v15
v_mul_f32 v152, v152, v15
v_mul_f32 v153, v153, v15
v_mul_f32 v154, v154, v15
v_mul_f32 v155, v155, v15
v_mul_f32 v160, v160, v15
v_mul_f32 v161, v161, v15
v_mul_f32 v162, v162, v15
v_mul_f32 v163, v163, v15
v_mul_f32 v168, v168, v15
v_mul_f32 v169, v169, v15
v_mul_f32 v170, v170, v15
v_mul_f32 v171, v171, v15
v_mul_f32 v176, v176, v15
v_mul_f32 v177, v177, v15
v_mul_f32 v178, v178, v15
v_mul_f32 v179, v179, v15
v_mul_f32 v184, v184, v15
v_mul_f32 v185, v185, v15
v_mul_f32 v186, v186, v15
v_mul_f32 v187, v187, v15
v_mul_f32 v192, v192, v15
v_mul_f32 v193, v193, v15
v_mul_f32 v194, v194, v15
v_mul_f32 v195, v195, v15
v_mul_f32 v200, v200, v15
v_mul_f32 v201, v201, v15
v_mul_f32 v202, v202, v15
v_mul_f32 v203, v203, v15
v_mul_f32 v208, v208, v15
v_mul_f32 v209, v209, v15
v_mul_f32 v210, v210, v15
v_mul_f32 v211, v211, v15
v_mul_f32 v216, v216, v15
v_mul_f32 v217, v217, v15
v_mul_f32 v218, v218, v15
v_mul_f32 v219, v219, v15
v_mul_f32 v224, v224, v15
v_mul_f32 v225, v225, v15
v_mul_f32 v226, v226, v15
v_mul_f32 v227, v227, v15
v_mul_f32 v232, v232, v15
v_mul_f32 v233, v233, v15
v_mul_f32 v234, v234, v15
v_mul_f32 v235, v235, v15
v_mul_f32 v240, v240, v15
v_mul_f32 v241, v241, v15
v_mul_f32 v242, v242, v15
v_mul_f32 v243, v243, v15
v_mul_f32 v248, v248, v15
v_mul_f32 v249, v249, v15
v_mul_f32 v250, v250, v15
v_mul_f32 v251, v251, v15
v_mul_f32 v80, v80, v15
v_mul_f32 v81, v81, v15
v_max3_f32 v13, v36, v37, v38
v_max3_f32 v14, v39, v44, v45
v_max3_f32 v13, v13, v46, v47
v_max_f32 v13, v13, v14
v_mov_b32 v14, v13
s_nop 1
v_permlane32_swap_b32 v13, v14
s_nop 1
v_max_f32 v13, v13, v14
v_mov_b32 v14, v13
s_nop 1
v_permlane16_swap_b32 v13, v14
s_nop 1
v_max_f32 v13, v13, v14
v_max_f32 v13, 0, v13
v_sub_f32 v14, 0, v13
v_exp_f32 v15, v14
s_nop 0
v_add_f32 v76, v76, v14
v_add_f32 v77, v77, v14
v_add_f32 v78, v78, v14
v_add_f32 v79, v79, v14
v_add_f32 v36, v36, v14
v_add_f32 v37, v37, v14
v_add_f32 v38, v38, v14
v_add_f32 v39, v39, v14
v_add_f32 v44, v44, v14
v_add_f32 v45, v45, v14
v_add_f32 v46, v46, v14
v_add_f32 v47, v47, v14
v_mul_f32 v132, v132, v15
v_mul_f32 v133, v133, v15
v_mul_f32 v134, v134, v15
v_mul_f32 v135, v135, v15
v_mul_f32 v140, v140, v15
v_mul_f32 v141, v141, v15
v_mul_f32 v142, v142, v15
v_mul_f32 v143, v143, v15
v_mul_f32 v148, v148, v15
v_mul_f32 v149, v149, v15
v_mul_f32 v150, v150, v15
v_mul_f32 v151, v151, v15
v_mul_f32 v156, v156, v15
v_mul_f32 v157, v157, v15
v_mul_f32 v158, v158, v15
v_mul_f32 v159, v159, v15
v_mul_f32 v164, v164, v15
v_mul_f32 v165, v165, v15
v_mul_f32 v166, v166, v15
v_mul_f32 v167, v167, v15
v_mul_f32 v172, v172, v15
v_mul_f32 v173, v173, v15
v_mul_f32 v174, v174, v15
v_mul_f32 v175, v175, v15
v_mul_f32 v180, v180, v15
v_mul_f32 v181, v181, v15
v_mul_f32 v182, v182, v15
v_mul_f32 v183, v183, v15
v_mul_f32 v188, v188, v15
v_mul_f32 v189, v189, v15
v_mul_f32 v190, v190, v15
v_mul_f32 v191, v191, v15
v_mul_f32 v196, v196, v15
v_mul_f32 v197, v197, v15
v_mul_f32 v198, v198, v15
v_mul_f32 v199, v199, v15
v_mul_f32 v204, v204, v15
v_mul_f32 v205, v205, v15
v_mul_f32 v206, v206, v15
v_mul_f32 v207, v207, v15
v_mul_f32 v212, v212, v15
v_mul_f32 v213, v213, v15
v_mul_f32 v214, v214, v15
v_mul_f32 v215, v215, v15
v_mul_f32 v220, v220, v15
v_mul_f32 v221, v221, v15
v_mul_f32 v222, v222, v15
v_mul_f32 v223, v223, v15
v_mul_f32 v228, v228, v15
v_mul_f32 v229, v229, v15
v_mul_f32 v230, v230, v15
v_mul_f32 v231, v231, v15
v_mul_f32 v236, v236, v15
v_mul_f32 v237, v237, v15
v_mul_f32 v238, v238, v15
v_mul_f32 v239, v239, v15
v_mul_f32 v244, v244, v15
v_mul_f32 v245, v245, v15
v_mul_f32 v246, v246, v15
v_mul_f32 v247, v247, v15
v_mul_f32 v252, v252, v15
v_mul_f32 v253, v253, v15
v_mul_f32 v254, v254, v15
v_mul_f32 v255, v255, v15
v_mul_f32 v82, v82, v15
v_mul_f32 v83, v83, v15
v_exp_f32 v64, v32
v_exp_f32 v65, v33
v_exp_f32 v66, v34
v_add_f32 v84, v80, v64
v_add_f32 v85, v81, v65
v_cvt_pk_bf16_f32 v56, v64, v65
v_exp_f32 v67, v35
v_exp_f32 v68, v40
v_add_f32 v84, v84, v66
v_add_f32 v85, v85, v67
v_cvt_pk_bf16_f32 v57, v66, v67
v_exp_f32 v69, v41
v_exp_f32 v70, v42
v_add_f32 v84, v84, v68
v_add_f32 v85, v85, v69
v_cvt_pk_bf16_f32 v58, v68, v69
v_exp_f32 v71, v43
s_nop 0
v_add_f32 v84, v84, v70
v_add_f32 v85, v85, v71
v_cvt_pk_bf16_f32 v59, v70, v71
v_exp_f32 v64, v36
v_exp_f32 v65, v37
v_exp_f32 v66, v38
v_add_f32 v86, v82, v64
v_add_f32 v87, v83, v65
v_cvt_pk_bf16_f32 v60, v64, v65
v_exp_f32 v67, v39
v_exp_f32 v68, v44
v_add_f32 v86, v86, v66
v_add_f32 v87, v87, v67
v_cvt_pk_bf16_f32 v61, v66, v67
v_exp_f32 v69, v45
v_exp_f32 v70, v46
v_add_f32 v86, v86, v68
v_add_f32 v87, v87, v69
v_cvt_pk_bf16_f32 v62, v68, v69
v_exp_f32 v71, v47
s_nop 0
v_add_f32 v86, v86, v70
v_add_f32 v87, v87, v71
v_cvt_pk_bf16_f32 v63, v70, v71
s_nop 1
s_branch BACK_am3
RARE_am0B:
s_nop 7
s_nop 7
v_max3_f32 v13, v16, v17, v18
v_max3_f32 v14, v19, v24, v25
v_max3_f32 v13, v13, v26, v27
v_max_f32 v13, v13, v14
v_mov_b32 v14, v13
s_nop 1
v_permlane32_swap_b32 v13, v14
s_nop 1
v_max_f32 v13, v13, v14
v_mov_b32 v14, v13
s_nop 1
v_permlane16_swap_b32 v13, v14
s_nop 1
v_max_f32 v13, v13, v14
v_max_f32 v13, 0, v13
v_sub_f32 v14, 0, v13
v_exp_f32 v15, v14
s_nop 0
v_add_f32 v72, v72, v14
v_add_f32 v73, v73, v14
v_add_f32 v74, v74, v14
v_add_f32 v75, v75, v14
v_add_f32 v16, v16, v14
v_add_f32 v32, v32, v14
v_add_f32 v17, v17, v14
v_add_f32 v33, v33, v14
v_add_f32 v18, v18, v14
v_add_f32 v34, v34, v14
v_add_f32 v19, v19, v14
v_add_f32 v35, v35, v14
v_add_f32 v24, v24, v14
v_add_f32 v40, v40, v14
v_add_f32 v25, v25, v14
v_add_f32 v41, v41, v14
v_add_f32 v26, v26, v14
v_add_f32 v42, v42, v14
v_add_f32 v27, v27, v14
v_add_f32 v43, v43, v14
v_mul_f32 v128, v128, v15
v_mul_f32 v129, v129, v15
v_mul_f32 v130, v130, v15
v_mul_f32 v131, v131, v15
v_mul_f32 v136, v136, v15
v_mul_f32 v137, v137, v15
v_mul_f32 v138, v138, v15
v_mul_f32 v139, v139, v15
v_mul_f32 v144, v144, v15
v_mul_f32 v145, v145, v15
v_mul_f32 v146, v146, v15
v_mul_f32 v147, v147, v15
v_mul_f32 v152, v152, v15
v_mul_f32 v153, v153, v15
v_mul_f32 v154, v154, v15
v_mul_f32 v155, v155, v15
v_mul_f32 v160, v160, v15
v_mul_f32 v161, v161, v15
v_mul_f32 v162, v162, v15
v_mul_f32 v163, v163, v15
v_mul_f32 v168, v168, v15
v_mul_f32 v169, v169, v15
v_mul_f32 v170, v170, v15
v_mul_f32 v171, v171, v15
v_mul_f32 v176, v176, v15
v_mul_f32 v177, v177, v15
v_mul_f32 v178, v178, v15
v_mul_f32 v179, v179, v15
v_mul_f32 v184, v184, v15
v_mul_f32 v185, v185, v15
v_mul_f32 v186, v186, v15
v_mul_f32 v187, v187, v15
v_mul_f32 v192, v192, v15
v_mul_f32 v193, v193, v15
v_mul_f32 v194, v194, v15
v_mul_f32 v195, v195, v15
v_mul_f32 v200, v200, v15
v_mul_f32 v201, v201, v15
v_mul_f32 v202, v202, v15
v_mul_f32 v203, v203, v15
v_mul_f32 v208, v208, v15
v_mul_f32 v209, v209, v15
v_mul_f32 v210, v210, v15
v_mul_f32 v211, v211, v15
v_mul_f32 v216, v216, v15
v_mul_f32 v217, v217, v15
v_mul_f32 v218, v218, v15
v_mul_f32 v219, v219, v15
v_mul_f32 v224, v224, v15
v_mul_f32 v225, v225, v15
v_mul_f32 v226, v226, v15
v_mul_f32 v227, v227, v15
v_mul_f32 v232, v232, v15
v_mul_f32 v233, v233, v15
v_mul_f32 v234, v234, v15
v_mul_f32 v235, v235, v15
v_mul_f32 v240, v240, v15
v_mul_f32 v241, v241, v15
v_mul_f32 v242, v242, v15
v_mul_f32 v243, v243, v15
v_mul_f32 v248, v248, v15
v_mul_f32 v249, v249, v15
v_mul_f32 v250, v250, v15
v_mul_f32 v251, v251, v15
v_mul_f32 v84, v84, v15
v_mul_f32 v85, v85, v15
v_max3_f32 v13, v20, v21, v22
v_max3_f32 v14, v23, v28, v29
v_max3_f32 v13, v13, v30, v31
v_max_f32 v13, v13, v14
v_mov_b32 v14, v13
s_nop 1
v_permlane32_swap_b32 v13, v14
s_nop 1
v_max_f32 v13, v13, v14
v_mov_b32 v14, v13
s_nop 1
v_permlane16_swap_b32 v13, v14
s_nop 1
v_max_f32 v13, v13, v14
v_max_f32 v13, 0, v13
v_sub_f32 v14, 0, v13
v_exp_f32 v15, v14
s_nop 0
v_add_f32 v76, v76, v14
v_add_f32 v77, v77, v14
v_add_f32 v78, v78, v14
v_add_f32 v79, v79, v14
v_add_f32 v20, v20, v14
v_add_f32 v36, v36, v14
v_add_f32 v21, v21, v14
v_add_f32 v37, v37, v14
v_add_f32 v22, v22, v14
v_add_f32 v38, v38, v14
v_add_f32 v23, v23, v14
v_add_f32 v39, v39, v14
v_add_f32 v28, v28, v14
v_add_f32 v44, v44, v14
v_add_f32 v29, v29, v14
v_add_f32 v45, v45, v14
v_add_f32 v30, v30, v14
v_add_f32 v46, v46, v14
v_add_f32 v31, v31, v14
v_add_f32 v47, v47, v14
v_mul_f32 v132, v132, v15
v_mul_f32 v133, v133, v15
v_mul_f32 v134, v134, v15
v_mul_f32 v135, v135, v15
v_mul_f32 v140, v140, v15
v_mul_f32 v141, v141, v15
v_mul_f32 v142, v142, v15
v_mul_f32 v143, v143, v15
v_mul_f32 v148, v148, v15
v_mul_f32 v149, v149, v15
v_mul_f32 v150, v150, v15
v_mul_f32 v151, v151, v15
v_mul_f32 v156, v156, v15
v_mul_f32 v157, v157, v15
v_mul_f32 v158, v158, v15
v_mul_f32 v159, v159, v15
v_mul_f32 v164, v164, v15
v_mul_f32 v165, v165, v15
v_mul_f32 v166, v166, v15
v_mul_f32 v167, v167, v15
v_mul_f32 v172, v172, v15
v_mul_f32 v173, v173, v15
v_mul_f32 v174, v174, v15
v_mul_f32 v175, v175, v15
v_mul_f32 v180, v180, v15
v_mul_f32 v181, v181, v15
v_mul_f32 v182, v182, v15
v_mul_f32 v183, v183, v15
v_mul_f32 v188, v188, v15
v_mul_f32 v189, v189, v15
v_mul_f32 v190, v190, v15
v_mul_f32 v191, v191, v15
v_mul_f32 v196, v196, v15
v_mul_f32 v197, v197, v15
v_mul_f32 v198, v198, v15
v_mul_f32 v199, v199, v15
v_mul_f32 v204, v204, v15
v_mul_f32 v205, v205, v15
v_mul_f32 v206, v206, v15
v_mul_f32 v207, v207, v15
v_mul_f32 v212, v212, v15
v_mul_f32 v213, v213, v15
v_mul_f32 v214, v214, v15
v_mul_f32 v215, v215, v15
v_mul_f32 v220, v220, v15
v_mul_f32 v221, v221, v15
v_mul_f32 v222, v222, v15
v_mul_f32 v223, v223, v15
v_mul_f32 v228, v228, v15
v_mul_f32 v229, v229, v15
v_mul_f32 v230, v230, v15
v_mul_f32 v231, v231, v15
v_mul_f32 v236, v236, v15
v_mul_f32 v237, v237, v15
v_mul_f32 v238, v238, v15
v_mul_f32 v239, v239, v15
v_mul_f32 v244, v244, v15
v_mul_f32 v245, v245, v15
v_mul_f32 v246, v246, v15
v_mul_f32 v247, v247, v15
v_mul_f32 v252, v252, v15
v_mul_f32 v253, v253, v15
v_mul_f32 v254, v254, v15
v_mul_f32 v255, v255, v15
v_mul_f32 v86, v86, v15
v_mul_f32 v87, v87, v15
v_exp_f32 v64, v16
v_exp_f32 v65, v17
v_exp_f32 v66, v18
v_add_f32 v80, v84, v64
v_add_f32 v81, v85, v65
v_cvt_pk_bf16_f32 v48, v64, v65
v_exp_f32 v67, v19
v_exp_f32 v68, v24
v_add_f32 v80, v80, v66
v_add_f32 v81, v81, v67
v_cvt_pk_bf16_f32 v49, v66, v67
v_exp_f32 v69, v25
v_exp_f32 v70, v26
v_add_f32 v80, v80, v68
v_add_f32 v81, v81, v69
v_cvt_pk_bf16_f32 v50, v68, v69
v_exp_f32 v71, v27
s_nop 0
v_add_f32 v80, v80, v70
v_add_f32 v81, v81, v71
v_cvt_pk_bf16_f32 v51, v70, v71
v_exp_f32 v64, v20
v_exp_f32 v65, v21
v_exp_f32 v66, v22
v_add_f32 v82, v86, v64
v_add_f32 v83, v87, v65
v_cvt_pk_bf16_f32 v52, v64, v65
v_exp_f32 v67, v23
v_exp_f32 v68, v28
v_add_f32 v82, v82, v66
v_add_f32 v83, v83, v67
v_cvt_pk_bf16_f32 v53, v66, v67
v_exp_f32 v69, v29
v_exp_f32 v70, v30
v_add_f32 v82, v82, v68
v_add_f32 v83, v83, v69
v_cvt_pk_bf16_f32 v54, v68, v69
v_exp_f32 v71, v31
s_nop 0
v_add_f32 v82, v82, v70
v_add_f32 v83, v83, v71
v_cvt_pk_bf16_f32 v55, v70, v71
s_nop 1
s_branch BACK_am0B
RARE_am1B:
s_nop 7
s_nop 7
v_max3_f32 v13, v32, v33, v34
v_max3_f32 v14, v35, v40, v41
v_max3_f32 v13, v13, v42, v43
v_max_f32 v13, v13, v14
v_mov_b32 v14, v13
s_nop 1
v_permlane32_swap_b32 v13, v14
s_nop 1
v_max_f32 v13, v13, v14
v_mov_b32 v14, v13
s_nop 1
v_permlane16_swap_b32 v13, v14
s_nop 1
v_max_f32 v13, v13, v14
v_max_f32 v13, 0, v13
v_sub_f32 v14, 0, v13
v_exp_f32 v15, v14
s_nop 0
v_add_f32 v72, v72, v14
v_add_f32 v73, v73, v14
v_add_f32 v74, v74, v14
v_add_f32 v75, v75, v14
v_add_f32 v32, v32, v14
v_add_f32 v16, v16, v14
v_add_f32 v33, v33, v14
v_add_f32 v17, v17, v14
v_add_f32 v34, v34, v14
v_add_f32 v18, v18, v14
v_add_f32 v35, v35, v14
v_add_f32 v19, v19, v14
v_add_f32 v40, v40, v14
v_add_f32 v24, v24, v14
v_add_f32 v41, v41, v14
v_add_f32 v25, v25, v14
v_add_f32 v42, v42, v14
v_add_f32 v26, v26, v14
v_add_f32 v43, v43, v14
v_add_f32 v27, v27, v14
v_mul_f32 v128, v128, v15
v_mul_f32 v129, v129, v15
v_mul_f32 v130, v130, v15
v_mul_f32 v131, v131, v15
v_mul_f32 v136, v136, v15
v_mul_f32 v137, v137, v15
v_mul_f32 v138, v138, v15
v_mul_f32 v139, v139, v15
v_mul_f32 v144, v144, v15
v_mul_f32 v145, v145, v15
v_mul_f32 v146, v146, v15
v_mul_f32 v147, v147, v15
v_mul_f32 v152, v152, v15
v_mul_f32 v153, v153, v15
v_mul_f32 v154, v154, v15
v_mul_f32 v155, v155, v15
v_mul_f32 v160, v160, v15
v_mul_f32 v161, v161, v15
v_mul_f32 v162, v162, v15
v_mul_f32 v163, v163, v15
v_mul_f32 v168, v168, v15
v_mul_f32 v169, v169, v15
v_mul_f32 v170, v170, v15
v_mul_f32 v171, v171, v15
v_mul_f32 v176, v176, v15
v_mul_f32 v177, v177, v15
v_mul_f32 v178, v178, v15
v_mul_f32 v179, v179, v15
v_mul_f32 v184, v184, v15
v_mul_f32 v185, v185, v15
v_mul_f32 v186, v186, v15
v_mul_f32 v187, v187, v15
v_mul_f32 v192, v192, v15
v_mul_f32 v193, v193, v15
v_mul_f32 v194, v194, v15
v_mul_f32 v195, v195, v15
v_mul_f32 v200, v200, v15
v_mul_f32 v201, v201, v15
v_mul_f32 v202, v202, v15
v_mul_f32 v203, v203, v15
v_mul_f32 v208, v208, v15
v_mul_f32 v209, v209, v15
v_mul_f32 v210, v210, v15
v_mul_f32 v211, v211, v15
v_mul_f32 v216, v216, v15
v_mul_f32 v217, v217, v15
v_mul_f32 v218, v218, v15
v_mul_f32 v219, v219, v15
v_mul_f32 v224, v224, v15
v_mul_f32 v225, v225, v15
v_mul_f32 v226, v226, v15
v_mul_f32 v227, v227, v15
v_mul_f32 v232, v232, v15
v_mul_f32 v233, v233, v15
v_mul_f32 v234, v234, v15
v_mul_f32 v235, v235, v15
v_mul_f32 v240, v240, v15
v_mul_f32 v241, v241, v15
v_mul_f32 v242, v242, v15
v_mul_f32 v243, v243, v15
v_mul_f32 v248, v248, v15
v_mul_f32 v249, v249, v15
v_mul_f32 v250, v250, v15
v_mul_f32 v251, v251, v15
v_mul_f32 v80, v80, v15
v_mul_f32 v81, v81, v15
v_max3_f32 v13, v36, v37, v38
v_max3_f32 v14, v39, v44, v45
v_max3_f32 v13, v13, v46, v47
v_max_f32 v13, v13, v14
v_mov_b32 v14, v13
s_nop 1
v_permlane32_swap_b32 v13, v14
s_nop 1
v_max_f32 v13, v13, v14
v_mov_b32 v14, v13
s_nop 1
v_permlane16_swap_b32 v13, v14
s_nop 1
v_max_f32 v13, v13, v14
v_max_f32 v13, 0, v13
v_sub_f32 v14, 0, v13
v_exp_f32 v15, v14
s_nop 0
v_add_f32 v76, v76, v14
v_add_f32 v77, v77, v14
v_add_f32 v78, v78, v14
v_add_f32 v79, v79, v14
v_add_f32 v36, v36, v14
v_add_f32 v20, v20, v14
v_add_f32 v37, v37, v14
v_add_f32 v21, v21, v14
v_add_f32 v38, v38, v14
v_add_f32 v22, v22, v14
v_add_f32 v39, v39, v14
v_add_f32 v23, v23, v14
v_add_f32 v44, v44, v14
v_add_f32 v28, v28, v14
v_add_f32 v45, v45, v14
v_add_f32 v29, v29, v14
v_add_f32 v46, v46, v14
v_add_f32 v30, v30, v14
v_add_f32 v47, v47, v14
v_add_f32 v31, v31, v14
v_mul_f32 v132, v132, v15
v_mul_f32 v133, v133, v15
v_mul_f32 v134, v134, v15
v_mul_f32 v135, v135, v15
v_mul_f32 v140, v140, v15
v_mul_f32 v141, v141, v15
v_mul_f32 v142, v142, v15
v_mul_f32 v143, v143, v15
v_mul_f32 v148, v148, v15
v_mul_f32 v149, v149, v15
v_mul_f32 v150, v150, v15
v_mul_f32 v151, v151, v15
v_mul_f32 v156, v156, v15
v_mul_f32 v157, v157, v15
v_mul_f32 v158, v158, v15
v_mul_f32 v159, v159, v15
v_mul_f32 v164, v164, v15
v_mul_f32 v165, v165, v15
v_mul_f32 v166, v166, v15
v_mul_f32 v167, v167, v15
v_mul_f32 v172, v172, v15
v_mul_f32 v173, v173, v15
v_mul_f32 v174, v174, v15
v_mul_f32 v175, v175, v15
v_mul_f32 v180, v180, v15
v_mul_f32 v181, v181, v15
v_mul_f32 v182, v182, v15
v_mul_f32 v183, v183, v15
v_mul_f32 v188, v188, v15
v_mul_f32 v189, v189, v15
v_mul_f32 v190, v190, v15
v_mul_f32 v191, v191, v15
v_mul_f32 v196, v196, v15
v_mul_f32 v197, v197, v15
v_mul_f32 v198, v198, v15
v_mul_f32 v199, v199, v15
v_mul_f32 v204, v204, v15
v_mul_f32 v205, v205, v15
v_mul_f32 v206, v206, v15
v_mul_f32 v207, v207, v15
v_mul_f32 v212, v212, v15
v_mul_f32 v213, v213, v15
v_mul_f32 v214, v214, v15
v_mul_f32 v215, v215, v15
v_mul_f32 v220, v220, v15
v_mul_f32 v221, v221, v15
v_mul_f32 v222, v222, v15
v_mul_f32 v223, v223, v15
v_mul_f32 v228, v228, v15
v_mul_f32 v229, v229, v15
v_mul_f32 v230, v230, v15
v_mul_f32 v231, v231, v15
v_mul_f32 v236, v236, v15
v_mul_f32 v237, v237, v15
v_mul_f32 v238, v238, v15
v_mul_f32 v239, v239, v15
v_mul_f32 v244, v244, v15
v_mul_f32 v245, v245, v15
v_mul_f32 v246, v246, v15
v_mul_f32 v247, v247, v15
v_mul_f32 v252, v252, v15
v_mul_f32 v253, v253, v15
v_mul_f32 v254, v254, v15
v_mul_f32 v255, v255, v15
v_mul_f32 v82, v82, v15
v_mul_f32 v83, v83, v15
v_exp_f32 v64, v32
v_exp_f32 v65, v33
v_exp_f32 v66, v34
v_add_f32 v84, v80, v64
v_add_f32 v85, v81, v65
v_cvt_pk_bf16_f32 v56, v64, v65
v_exp_f32 v67, v35
v_exp_f32 v68, v40
v_add_f32 v84, v84, v66
v_add_f32 v85, v85, v67
v_cvt_pk_bf16_f32 v57, v66, v67
v_exp_f32 v69, v41
v_exp_f32 v70, v42
v_add_f32 v84, v84, v68
v_add_f32 v85, v85, v69
v_cvt_pk_bf16_f32 v58, v68, v69
v_exp_f32 v71, v43
s_nop 0
v_add_f32 v84, v84, v70
v_add_f32 v85, v85, v71
v_cvt_pk_bf16_f32 v59, v70, v71
v_exp_f32 v64, v36
v_exp_f32 v65, v37
v_exp_f32 v66, v38
v_add_f32 v86, v82, v64
v_add_f32 v87, v83, v65
v_cvt_pk_bf16_f32 v60, v64, v65
v_exp_f32 v67, v39
v_exp_f32 v68, v44
v_add_f32 v86, v86, v66
v_add_f32 v87, v87, v67
v_cvt_pk_bf16_f32 v61, v66, v67
v_exp_f32 v69, v45
v_exp_f32 v70, v46
v_add_f32 v86, v86, v68
v_add_f32 v87, v87, v69
v_cvt_pk_bf16_f32 v62, v68, v69
v_exp_f32 v71, v47
s_nop 0
v_add_f32 v86, v86, v70
v_add_f32 v87, v87, v71
v_cvt_pk_bf16_f32 v63, v70, v71
s_nop 1
s_branch BACK_am1B
RARE_am2B:
s_nop 7
s_nop 7
v_max3_f32 v13, v16, v17, v18
v_max3_f32 v14, v19, v24, v25
v_max3_f32 v13, v13, v26, v27
v_max_f32 v13, v13, v14
v_mov_b32 v14, v13
s_nop 1
v_permlane32_swap_b32 v13, v14
s_nop 1
v_max_f32 v13, v13, v14
v_mov_b32 v14, v13
s_nop 1
v_permlane16_swap_b32 v13, v14
s_nop 1
v_max_f32 v13, v13, v14
v_max_f32 v13, 0, v13
v_sub_f32 v14, 0, v13
v_exp_f32 v15, v14
s_nop 0
v_add_f32 v72, v72, v14
v_add_f32 v73, v73, v14
v_add_f32 v74, v74, v14
v_add_f32 v75, v75, v14
v_add_f32 v16, v16, v14
v_add_f32 v32, v32, v14
v_add_f32 v17, v17, v14
v_add_f32 v33, v33, v14
v_add_f32 v18, v18, v14
v_add_f32 v34, v34, v14
v_add_f32 v19, v19, v14
v_add_f32 v35, v35, v14
v_add_f32 v24, v24, v14
v_add_f32 v40, v40, v14
v_add_f32 v25, v25, v14
v_add_f32 v41, v41, v14
v_add_f32 v26, v26, v14
v_add_f32 v42, v42, v14
v_add_f32 v27, v27, v14
v_add_f32 v43, v43, v14
v_mul_f32 v128, v128, v15
v_mul_f32 v129, v129, v15
v_mul_f32 v130, v130, v15
v_mul_f32 v131, v131, v15
v_mul_f32 v136, v136, v15
v_mul_f32 v137, v137, v15
v_mul_f32 v138, v138, v15
v_mul_f32 v139, v139, v15
v_mul_f32 v144, v144, v15
v_mul_f32 v145, v145, v15
v_mul_f32 v146, v146, v15
v_mul_f32 v147, v147, v15
v_mul_f32 v152, v152, v15
v_mul_f32 v153, v153, v15
v_mul_f32 v154, v154, v15
v_mul_f32 v155, v155, v15
v_mul_f32 v160, v160, v15
v_mul_f32 v161, v161, v15
v_mul_f32 v162, v162, v15
v_mul_f32 v163, v163, v15
v_mul_f32 v168, v168, v15
v_mul_f32 v169, v169, v15
v_mul_f32 v170, v170, v15
v_mul_f32 v171, v171, v15
v_mul_f32 v176, v176, v15
v_mul_f32 v177, v177, v15
v_mul_f32 v178, v178, v15
v_mul_f32 v179, v179, v15
v_mul_f32 v184, v184, v15
v_mul_f32 v185, v185, v15
v_mul_f32 v186, v186, v15
v_mul_f32 v187, v187, v15
v_mul_f32 v192, v192, v15
v_mul_f32 v193, v193, v15
v_mul_f32 v194, v194, v15
v_mul_f32 v195, v195, v15
v_mul_f32 v200, v200, v15
v_mul_f32 v201, v201, v15
v_mul_f32 v202, v202, v15
v_mul_f32 v203, v203, v15
v_mul_f32 v208, v208, v15
v_mul_f32 v209, v209, v15
v_mul_f32 v210, v210, v15
v_mul_f32 v211, v211, v15
v_mul_f32 v216, v216, v15
v_mul_f32 v217, v217, v15
v_mul_f32 v218, v218, v15
v_mul_f32 v219, v219, v15
v_mul_f32 v224, v224, v15
v_mul_f32 v225, v225, v15
v_mul_f32 v226, v226, v15
v_mul_f32 v227, v227, v15
v_mul_f32 v232, v232, v15
v_mul_f32 v233, v233, v15
v_mul_f32 v234, v234, v15
v_mul_f32 v235, v235, v15
v_mul_f32 v240, v240, v15
v_mul_f32 v241, v241, v15
v_mul_f32 v242, v242, v15
v_mul_f32 v243, v243, v15
v_mul_f32 v248, v248, v15
v_mul_f32 v249, v249, v15
v_mul_f32 v250, v250, v15
v_mul_f32 v251, v251, v15
v_mul_f32 v84, v84, v15
v_mul_f32 v85, v85, v15
v_max3_f32 v13, v20, v21, v22
v_max3_f32 v14, v23, v28, v29
v_max3_f32 v13, v13, v30, v31
v_max_f32 v13, v13, v14
v_mov_b32 v14, v13
s_nop 1
v_permlane32_swap_b32 v13, v14
s_nop 1
v_max_f32 v13, v13, v14
v_mov_b32 v14, v13
s_nop 1
v_permlane16_swap_b32 v13, v14
s_nop 1
v_max_f32 v13, v13, v14
v_max_f32 v13, 0, v13
v_sub_f32 v14, 0, v13
v_exp_f32 v15, v14
s_nop 0
v_add_f32 v76, v76, v14
v_add_f32 v77, v77, v14
v_add_f32 v78, v78, v14
v_add_f32 v79, v79, v14
v_add_f32 v20, v20, v14
v_add_f32 v36, v36, v14
v_add_f32 v21, v21, v14
v_add_f32 v37, v37, v14
v_add_f32 v22, v22, v14
v_add_f32 v38, v38, v14
v_add_f32 v23, v23, v14
v_add_f32 v39, v39, v14
v_add_f32 v28, v28, v14
v_add_f32 v44, v44, v14
v_add_f32 v29, v29, v14
v_add_f32 v45, v45, v14
v_add_f32 v30, v30, v14
v_add_f32 v46, v46, v14
v_add_f32 v31, v31, v14
v_add_f32 v47, v47, v14
v_mul_f32 v132, v132, v15
v_mul_f32 v133, v133, v15
v_mul_f32 v134, v134, v15
v_mul_f32 v135, v135, v15
v_mul_f32 v140, v140, v15
v_mul_f32 v141, v141, v15
v_mul_f32 v142, v142, v15
v_mul_f32 v143, v143, v15
v_mul_f32 v148, v148, v15
v_mul_f32 v149, v149, v15
v_mul_f32 v150, v150, v15
v_mul_f32 v151, v151, v15
v_mul_f32 v156, v156, v15
v_mul_f32 v157, v157, v15
v_mul_f32 v158, v158, v15
v_mul_f32 v159, v159, v15
v_mul_f32 v164, v164, v15
v_mul_f32 v165, v165, v15
v_mul_f32 v166, v166, v15
v_mul_f32 v167, v167, v15
v_mul_f32 v172, v172, v15
v_mul_f32 v173, v173, v15
v_mul_f32 v174, v174, v15
v_mul_f32 v175, v175, v15
v_mul_f32 v180, v180, v15
v_mul_f32 v181, v181, v15
v_mul_f32 v182, v182, v15
v_mul_f32 v183, v183, v15
v_mul_f32 v188, v188, v15
v_mul_f32 v189, v189, v15
v_mul_f32 v190, v190, v15
v_mul_f32 v191, v191, v15
v_mul_f32 v196, v196, v15
v_mul_f32 v197, v197, v15
v_mul_f32 v198, v198, v15
v_mul_f32 v199, v199, v15
v_mul_f32 v204, v204, v15
v_mul_f32 v205, v205, v15
v_mul_f32 v206, v206, v15
v_mul_f32 v207, v207, v15
v_mul_f32 v212, v212, v15
v_mul_f32 v213, v213, v15
v_mul_f32 v214, v214, v15
v_mul_f32 v215, v215, v15
v_mul_f32 v220, v220, v15
v_mul_f32 v221, v221, v15
v_mul_f32 v222, v222, v15
v_mul_f32 v223, v223, v15
v_mul_f32 v228, v228, v15
v_mul_f32 v229, v229, v15
v_mul_f32 v230, v230, v15
v_mul_f32 v231, v231, v15
v_mul_f32 v236, v236, v15
v_mul_f32 v237, v237, v15
v_mul_f32 v238, v238, v15
v_mul_f32 v239, v239, v15
v_mul_f32 v244, v244, v15
v_mul_f32 v245, v245, v15
v_mul_f32 v246, v246, v15
v_mul_f32 v247, v247, v15
v_mul_f32 v252, v252, v15
v_mul_f32 v253, v253, v15
v_mul_f32 v254, v254, v15
v_mul_f32 v255, v255, v15
v_mul_f32 v86, v86, v15
v_mul_f32 v87, v87, v15
v_exp_f32 v64, v16
v_exp_f32 v65, v17
v_exp_f32 v66, v18
v_add_f32 v80, v84, v64
v_add_f32 v81, v85, v65
v_cvt_pk_bf16_f32 v48, v64, v65
v_exp_f32 v67, v19
v_exp_f32 v68, v24
v_add_f32 v80, v80, v66
v_add_f32 v81, v81, v67
v_cvt_pk_bf16_f32 v49, v66, v67
v_exp_f32 v69, v25
v_exp_f32 v70, v26
v_add_f32 v80, v80, v68
v_add_f32 v81, v81, v69
v_cvt_pk_bf16_f32 v50, v68, v69
v_exp_f32 v71, v27
s_nop 0
v_add_f32 v80, v80, v70
v_add_f32 v81, v81, v71
v_cvt_pk_bf16_f32 v51, v70, v71
v_exp_f32 v64, v20
v_exp_f32 v65, v21
v_exp_f32 v66, v22
v_add_f32 v82, v86, v64
v_add_f32 v83, v87, v65
v_cvt_pk_bf16_f32 v52, v64, v65
v_exp_f32 v67, v23
v_exp_f32 v68, v28
v_add_f32 v82, v82, v66
v_add_f32 v83, v83, v67
v_cvt_pk_bf16_f32 v53, v66, v67
v_exp_f32 v69, v29
v_exp_f32 v70, v30
v_add_f32 v82, v82, v68
v_add_f32 v83, v83, v69
v_cvt_pk_bf16_f32 v54, v68, v69
v_exp_f32 v71, v31
s_nop 0
v_add_f32 v82, v82, v70
v_add_f32 v83, v83, v71
v_cvt_pk_bf16_f32 v55, v70, v71
s_nop 1
s_branch BACK_am2B
RARE_am3B:
s_nop 7
s_nop 7
v_max3_f32 v13, v32, v33, v34
v_max3_f32 v14, v35, v40, v41
v_max3_f32 v13, v13, v42, v43
v_max_f32 v13, v13, v14
v_mov_b32 v14, v13
s_nop 1
v_permlane32_swap_b32 v13, v14
s_nop 1
v_max_f32 v13, v13, v14
v_mov_b32 v14, v13
s_nop 1
v_permlane16_swap_b32 v13, v14
s_nop 1
v_max_f32 v13, v13, v14
v_max_f32 v13, 0, v13
v_sub_f32 v14, 0, v13
v_exp_f32 v15, v14
s_nop 0
v_add_f32 v72, v72, v14
v_add_f32 v73, v73, v14
v_add_f32 v74, v74, v14
v_add_f32 v75, v75, v14
v_add_f32 v32, v32, v14
v_add_f32 v33, v33, v14
v_add_f32 v34, v34, v14
v_add_f32 v35, v35, v14
v_add_f32 v40, v40, v14
v_add_f32 v41, v41, v14
v_add_f32 v42, v42, v14
v_add_f32 v43, v43, v14
v_mul_f32 v128, v128, v15
v_mul_f32 v129, v129, v15
v_mul_f32 v130, v130, v15
v_mul_f32 v131, v131, v15
v_mul_f32 v136, v136, v15
v_mul_f32 v137, v137, v15
v_mul_f32 v138, v138, v15
v_mul_f32 v139, v139, v15
v_mul_f32 v144, v144, v15
v_mul_f32 v145, v145, v15
v_mul_f32 v146, v146, v15
v_mul_f32 v147, v147, v15
v_mul_f32 v152, v152, v15
v_mul_f32 v153, v153, v15
v_mul_f32 v154, v154, v15
v_mul_f32 v155, v155, v15
v_mul_f32 v160, v160, v15
v_mul_f32 v161, v161, v15
v_mul_f32 v162, v162, v15
v_mul_f32 v163, v163, v15
v_mul_f32 v168, v168, v15
v_mul_f32 v169, v169, v15
v_mul_f32 v170, v170, v15
v_mul_f32 v171, v171, v15
v_mul_f32 v176, v176, v15
v_mul_f32 v177, v177, v15
v_mul_f32 v178, v178, v15
v_mul_f32 v179, v179, v15
v_mul_f32 v184, v184, v15
v_mul_f32 v185, v185, v15
v_mul_f32 v186, v186, v15
v_mul_f32 v187, v187, v15
v_mul_f32 v192, v192, v15
v_mul_f32 v193, v193, v15
v_mul_f32 v194, v194, v15
v_mul_f32 v195, v195, v15
v_mul_f32 v200, v200, v15
v_mul_f32 v201, v201, v15
v_mul_f32 v202, v202, v15
v_mul_f32 v203, v203, v15
v_mul_f32 v208, v208, v15
v_mul_f32 v209, v209, v15
v_mul_f32 v210, v210, v15
v_mul_f32 v211, v211, v15
v_mul_f32 v216, v216, v15
v_mul_f32 v217, v217, v15
v_mul_f32 v218, v218, v15
v_mul_f32 v219, v219, v15
v_mul_f32 v224, v224, v15
v_mul_f32 v225, v225, v15
v_mul_f32 v226, v226, v15
v_mul_f32 v227, v227, v15
v_mul_f32 v232, v232, v15
v_mul_f32 v233, v233, v15
v_mul_f32 v234, v234, v15
v_mul_f32 v235, v235, v15
v_mul_f32 v240, v240, v15
v_mul_f32 v241, v241, v15
v_mul_f32 v242, v242, v15
v_mul_f32 v243, v243, v15
v_mul_f32 v248, v248, v15
v_mul_f32 v249, v249, v15
v_mul_f32 v250, v250, v15
v_mul_f32 v251, v251, v15
v_mul_f32 v80, v80, v15
v_mul_f32 v81, v81, v15
v_max3_f32 v13, v36, v37, v38
v_max3_f32 v14, v39, v44, v45
v_max3_f32 v13, v13, v46, v47
v_max_f32 v13, v13, v14
v_mov_b32 v14, v13
s_nop 1
v_permlane32_swap_b32 v13, v14
s_nop 1
v_max_f32 v13, v13, v14
v_mov_b32 v14, v13
s_nop 1
v_permlane16_swap_b32 v13, v14
s_nop 1
v_max_f32 v13, v13, v14
v_max_f32 v13, 0, v13
v_sub_f32 v14, 0, v13
v_exp_f32 v15, v14
s_nop 0
v_add_f32 v76, v76, v14
v_add_f32 v77, v77, v14
v_add_f32 v78, v78, v14
v_add_f32 v79, v79, v14
v_add_f32 v36, v36, v14
v_add_f32 v37, v37, v14
v_add_f32 v38, v38, v14
v_add_f32 v39, v39, v14
v_add_f32 v44, v44, v14
v_add_f32 v45, v45, v14
v_add_f32 v46, v46, v14
v_add_f32 v47, v47, v14
v_mul_f32 v132, v132, v15
v_mul_f32 v133, v133, v15
v_mul_f32 v134, v134, v15
v_mul_f32 v135, v135, v15
v_mul_f32 v140, v140, v15
v_mul_f32 v141, v141, v15
v_mul_f32 v142, v142, v15
v_mul_f32 v143, v143, v15
v_mul_f32 v148, v148, v15
v_mul_f32 v149, v149, v15
v_mul_f32 v150, v150, v15
v_mul_f32 v151, v151, v15
v_mul_f32 v156, v156, v15
v_mul_f32 v157, v157, v15
v_mul_f32 v158, v158, v15
v_mul_f32 v159, v159, v15
v_mul_f32 v164, v164, v15
v_mul_f32 v165, v165, v15
v_mul_f32 v166, v166, v15
v_mul_f32 v167, v167, v15
v_mul_f32 v172, v172, v15
v_mul_f32 v173, v173, v15
v_mul_f32 v174, v174, v15
v_mul_f32 v175, v175, v15
v_mul_f32 v180, v180, v15
v_mul_f32 v181, v181, v15
v_mul_f32 v182, v182, v15
v_mul_f32 v183, v183, v15
v_mul_f32 v188, v188, v15
v_mul_f32 v189, v189, v15
v_mul_f32 v190, v190, v15
v_mul_f32 v191, v191, v15
v_mul_f32 v196, v196, v15
v_mul_f32 v197, v197, v15
v_mul_f32 v198, v198, v15
v_mul_f32 v199, v199, v15
v_mul_f32 v204, v204, v15
v_mul_f32 v205, v205, v15
v_mul_f32 v206, v206, v15
v_mul_f32 v207, v207, v15
v_mul_f32 v212, v212, v15
v_mul_f32 v213, v213, v15
v_mul_f32 v214, v214, v15
v_mul_f32 v215, v215, v15
v_mul_f32 v220, v220, v15
v_mul_f32 v221, v221, v15
v_mul_f32 v222, v222, v15
v_mul_f32 v223, v223, v15
v_mul_f32 v228, v228, v15
v_mul_f32 v229, v229, v15
v_mul_f32 v230, v230, v15
v_mul_f32 v231, v231, v15
v_mul_f32 v236, v236, v15
v_mul_f32 v237, v237, v15
v_mul_f32 v238, v238, v15
v_mul_f32 v239, v239, v15
v_mul_f32 v244, v244, v15
v_mul_f32 v245, v245, v15
v_mul_f32 v246, v246, v15
v_mul_f32 v247, v247, v15
v_mul_f32 v252, v252, v15
v_mul_f32 v253, v253, v15
v_mul_f32 v254, v254, v15
v_mul_f32 v255, v255, v15
v_mul_f32 v82, v82, v15
v_mul_f32 v83, v83, v15
v_exp_f32 v64, v32
v_exp_f32 v65, v33
v_exp_f32 v66, v34
v_add_f32 v84, v80, v64
v_add_f32 v85, v81, v65
v_cvt_pk_bf16_f32 v56, v64, v65
v_exp_f32 v67, v35
v_exp_f32 v68, v40
v_add_f32 v84, v84, v66
v_add_f32 v85, v85, v67
v_cvt_pk_bf16_f32 v57, v66, v67
v_exp_f32 v69, v41
v_exp_f32 v70, v42
v_add_f32 v84, v84, v68
v_add_f32 v85, v85, v69
v_cvt_pk_bf16_f32 v58, v68, v69
v_exp_f32 v71, v43
s_nop 0
v_add_f32 v84, v84, v70
v_add_f32 v85, v85, v71
v_cvt_pk_bf16_f32 v59, v70, v71
v_exp_f32 v64, v36
v_exp_f32 v65, v37
v_exp_f32 v66, v38
v_add_f32 v86, v82, v64
v_add_f32 v87, v83, v65
v_cvt_pk_bf16_f32 v60, v64, v65
v_exp_f32 v67, v39
v_exp_f32 v68, v44
v_add_f32 v86, v86, v66
v_add_f32 v87, v87, v67
v_cvt_pk_bf16_f32 v61, v66, v67
v_exp_f32 v69, v45
v_exp_f32 v70, v46
v_add_f32 v86, v86, v68
v_add_f32 v87, v87, v69
v_cvt_pk_bf16_f32 v62, v68, v69
v_exp_f32 v71, v47
s_nop 0
v_add_f32 v86, v86, v70
v_add_f32 v87, v87, v71
v_cvt_pk_bf16_f32 v63, v70, v71
s_nop 1
s_branch BACK_am3B
RARE_h0:
s_nop 7
s_nop 7
v_max3_f32 v13, v16, v17, v18
v_max3_f32 v14, v19, v24, v25
v_max3_f32 v13, v13, v26, v27
v_max_f32 v13, v13, v14
v_mov_b32 v14, v13
s_nop 1
v_permlane32_swap_b32 v13, v14
s_nop 1
v_max_f32 v13, v13, v14
v_mov_b32 v14, v13
s_nop 1
v_permlane16_swap_b32 v13, v14
s_nop 1
v_max_f32 v13, v13, v14
v_max_f32 v13, 0, v13
v_sub_f32 v14, 0, v13
v_exp_f32 v15, v14
s_nop 0
v_add_f32 v72, v72, v14
v_add_f32 v73, v73, v14
v_add_f32 v74, v74, v14
v_add_f32 v75, v75, v14
v_add_f32 v16, v16, v14
v_add_f32 v32, v32, v14
v_add_f32 v17, v17, v14
v_add_f32 v33, v33, v14
v_add_f32 v18, v18, v14
v_add_f32 v34, v34, v14
v_add_f32 v19, v19, v14
v_add_f32 v35, v35, v14
v_add_f32 v24, v24, v14
v_add_f32 v40, v40, v14
v_add_f32 v25, v25, v14
v_add_f32 v41, v41, v14
v_add_f32 v26, v26, v14
v_add_f32 v42, v42, v14
v_add_f32 v27, v27, v14
v_add_f32 v43, v43, v14
v_mul_f32 v128, v128, v15
v_mul_f32 v129, v129, v15
v_mul_f32 v130, v130, v15
v_mul_f32 v131, v131, v15
v_mul_f32 v136, v136, v15
v_mul_f32 v137, v137, v15
v_mul_f32 v138, v138, v15
v_mul_f32 v139, v139, v15
v_mul_f32 v144, v144, v15
v_mul_f32 v145, v145, v15
v_mul_f32 v146, v146, v15
v_mul_f32 v147, v147, v15
v_mul_f32 v152, v152, v15
v_mul_f32 v153, v153, v15
v_mul_f32 v154, v154, v15
v_mul_f32 v155, v155, v15
v_mul_f32 v160, v160, v15
v_mul_f32 v161, v161, v15
v_mul_f32 v162, v162, v15
v_mul_f32 v163, v163, v15
v_mul_f32 v168, v168, v15
v_mul_f32 v169, v169, v15
v_mul_f32 v170, v170, v15
v_mul_f32 v171, v171, v15
v_mul_f32 v176, v176, v15
v_mul_f32 v177, v177, v15
v_mul_f32 v178, v178, v15
v_mul_f32 v179, v179, v15
v_mul_f32 v184, v184, v15
v_mul_f32 v185, v185, v15
v_mul_f32 v186, v186, v15
v_mul_f32 v187, v187, v15
v_mul_f32 v192, v192, v15
v_mul_f32 v193, v193, v15
v_mul_f32 v194, v194, v15
v_mul_f32 v195, v195, v15
v_mul_f32 v200, v200, v15
v_mul_f32 v201, v201, v15
v_mul_f32 v202, v202, v15
v_mul_f32 v203, v203, v15
v_mul_f32 v208, v208, v15
v_mul_f32 v209, v209, v15
v_mul_f32 v210, v210, v15
v_mul_f32 v211, v211, v15
v_mul_f32 v216, v216, v15
v_mul_f32 v217, v217, v15
v_mul_f32 v218, v218, v15
v_mul_f32 v219, v219, v15
v_mul_f32 v224, v224, v15
v_mul_f32 v225, v225, v15
v_mul_f32 v226, v226, v15
v_mul_f32 v227, v227, v15
v_mul_f32 v232, v232, v15
v_mul_f32 v233, v233, v15
v_mul_f32 v234, v234, v15
v_mul_f32 v235, v235, v15
v_mul_f32 v240, v240, v15
v_mul_f32 v241, v241, v15
v_mul_f32 v242, v242, v15
v_mul_f32 v243, v243, v15
v_mul_f32 v248, v248, v15
v_mul_f32 v249, v249, v15
v_mul_f32 v250, v250, v15
v_mul_f32 v251, v251, v15
v_mul_f32 v84, v84, v15
v_mul_f32 v85, v85, v15
v_max3_f32 v13, v20, v21, v22
v_max3_f32 v14, v23, v28, v29
v_max3_f32 v13, v13, v30, v31
v_max_f32 v13, v13, v14
v_mov_b32 v14, v13
s_nop 1
v_permlane32_swap_b32 v13, v14
s_nop 1
v_max_f32 v13, v13, v14
v_mov_b32 v14, v13
s_nop 1
v_permlane16_swap_b32 v13, v14
s_nop 1
v_max_f32 v13, v13, v14
v_max_f32 v13, 0, v13
v_sub_f32 v14, 0, v13
v_exp_f32 v15, v14
s_nop 0
v_add_f32 v76, v76, v14
v_add_f32 v77, v77, v14
v_add_f32 v78, v78, v14
v_add_f32 v79, v79, v14
v_add_f32 v20, v20, v14
v_add_f32 v36, v36, v14
v_add_f32 v21, v21, v14
v_add_f32 v37, v37, v14
v_add_f32 v22, v22, v14
v_add_f32 v38, v38, v14
v_add_f32 v23, v23, v14
v_add_f32 v39, v39, v14
v_add_f32 v28, v28, v14
v_add_f32 v44, v44, v14
v_add_f32 v29, v29, v14
v_add_f32 v45, v45, v14
v_add_f32 v30, v30, v14
v_add_f32 v46, v46, v14
v_add_f32 v31, v31, v14
v_add_f32 v47, v47, v14
v_mul_f32 v132, v132, v15
v_mul_f32 v133, v133, v15
v_mul_f32 v134, v134, v15
v_mul_f32 v135, v135, v15
v_mul_f32 v140, v140, v15
v_mul_f32 v141, v141, v15
v_mul_f32 v142, v142, v15
v_mul_f32 v143, v143, v15
v_mul_f32 v148, v148, v15
v_mul_f32 v149, v149, v15
v_mul_f32 v150, v150, v15
v_mul_f32 v151, v151, v15
v_mul_f32 v156, v156, v15
v_mul_f32 v157, v157, v15
v_mul_f32 v158, v158, v15
v_mul_f32 v159, v159, v15
v_mul_f32 v164, v164, v15
v_mul_f32 v165, v165, v15
v_mul_f32 v166, v166, v15
v_mul_f32 v167, v167, v15
v_mul_f32 v172, v172, v15
v_mul_f32 v173, v173, v15
v_mul_f32 v174, v174, v15
v_mul_f32 v175, v175, v15
v_mul_f32 v180, v180, v15
v_mul_f32 v181, v181, v15
v_mul_f32 v182, v182, v15
v_mul_f32 v183, v183, v15
v_mul_f32 v188, v188, v15
v_mul_f32 v189, v189, v15
v_mul_f32 v190, v190, v15
v_mul_f32 v191, v191, v15
v_mul_f32 v196, v196, v15
v_mul_f32 v197, v197, v15
v_mul_f32 v198, v198, v15
v_mul_f32 v199, v199, v15
v_mul_f32 v204, v204, v15
v_mul_f32 v205, v205, v15
v_mul_f32 v206, v206, v15
v_mul_f32 v207, v207, v15
v_mul_f32 v212, v212, v15
v_mul_f32 v213, v213, v15
v_mul_f32 v214, v214, v15
v_mul_f32 v215, v215, v15
v_mul_f32 v220, v220, v15
v_mul_f32 v221, v221, v15
v_mul_f32 v222, v222, v15
v_mul_f32 v223, v223, v15
v_mul_f32 v228, v228, v15
v_mul_f32 v229, v229, v15
v_mul_f32 v230, v230, v15
v_mul_f32 v231, v231, v15
v_mul_f32 v236, v236, v15
v_mul_f32 v237, v237, v15
v_mul_f32 v238, v238, v15
v_mul_f32 v239, v239, v15
v_mul_f32 v244, v244, v15
v_mul_f32 v245, v245, v15
v_mul_f32 v246, v246, v15
v_mul_f32 v247, v247, v15
v_mul_f32 v252, v252, v15
v_mul_f32 v253, v253, v15
v_mul_f32 v254, v254, v15
v_mul_f32 v255, v255, v15
v_mul_f32 v86, v86, v15
v_mul_f32 v87, v87, v15
v_exp_f32 v64, v16
v_exp_f32 v65, v17
v_exp_f32 v66, v18
v_add_f32 v80, v84, v64
v_add_f32 v81, v85, v65
v_cvt_pk_bf16_f32 v48, v64, v65
v_exp_f32 v67, v19
v_exp_f32 v68, v24
v_add_f32 v80, v80, v66
v_add_f32 v81, v81, v67
v_cvt_pk_bf16_f32 v49, v66, v67
v_exp_f32 v69, v25
v_exp_f32 v70, v26
v_add_f32 v80, v80, v68
v_add_f32 v81, v81, v69
v_cvt_pk_bf16_f32 v50, v68, v69
v_exp_f32 v71, v27
s_nop 0
v_add_f32 v80, v80, v70
v_add_f32 v81, v81, v71
v_cvt_pk_bf16_f32 v51, v70, v71
v_exp_f32 v64, v20
v_exp_f32 v65, v21
v_exp_f32 v66, v22
v_add_f32 v82, v86, v64
v_add_f32 v83, v87, v65
v_cvt_pk_bf16_f32 v52, v64, v65
v_exp_f32 v67, v23
v_exp_f32 v68, v28
v_add_f32 v82, v82, v66
v_add_f32 v83, v83, v67
v_cvt_pk_bf16_f32 v53, v66, v67
v_exp_f32 v69, v29
v_exp_f32 v70, v30
v_add_f32 v82, v82, v68
v_add_f32 v83, v83, v69
v_cvt_pk_bf16_f32 v54, v68, v69
v_exp_f32 v71, v31
s_nop 0
v_add_f32 v82, v82, v70
v_add_f32 v83, v83, v71
v_cvt_pk_bf16_f32 v55, v70, v71
s_nop 1
s_branch BACK_h0
RARE_h1:
s_nop 7
s_nop 7
v_max3_f32 v13, v32, v33, v34
v_max3_f32 v14, v35, v40, v41
v_max3_f32 v13, v13, v42, v43
v_max_f32 v13, v13, v14
v_mov_b32 v14, v13
s_nop 1
v_permlane32_swap_b32 v13, v14
s_nop 1
v_max_f32 v13, v13, v14
v_mov_b32 v14, v13
s_nop 1
v_permlane16_swap_b32 v13, v14
s_nop 1
v_max_f32 v13, v13, v14
v_max_f32 v13, 0, v13
v_sub_f32 v14, 0, v13
v_exp_f32 v15, v14
s_nop 0
v_add_f32 v72, v72, v14
v_add_f32 v73, v73, v14
v_add_f32 v74, v74, v14
v_add_f32 v75, v75, v14
v_add_f32 v32, v32, v14
v_add_f32 v16, v16, v14
v_add_f32 v33, v33, v14
v_add_f32 v17, v17, v14
v_add_f32 v34, v34, v14
v_add_f32 v18, v18, v14
v_add_f32 v35, v35, v14
v_add_f32 v19, v19, v14
v_add_f32 v40, v40, v14
v_add_f32 v24, v24, v14
v_add_f32 v41, v41, v14
v_add_f32 v25, v25, v14
v_add_f32 v42, v42, v14
v_add_f32 v26, v26, v14
v_add_f32 v43, v43, v14
v_add_f32 v27, v27, v14
v_mul_f32 v128, v128, v15
v_mul_f32 v129, v129, v15
v_mul_f32 v130, v130, v15
v_mul_f32 v131, v131, v15
v_mul_f32 v136, v136, v15
v_mul_f32 v137, v137, v15
v_mul_f32 v138, v138, v15
v_mul_f32 v139, v139, v15
v_mul_f32 v144, v144, v15
v_mul_f32 v145, v145, v15
v_mul_f32 v146, v146, v15
v_mul_f32 v147, v147, v15
v_mul_f32 v152, v152, v15
v_mul_f32 v153, v153, v15
v_mul_f32 v154, v154, v15
v_mul_f32 v155, v155, v15
v_mul_f32 v160, v160, v15
v_mul_f32 v161, v161, v15
v_mul_f32 v162, v162, v15
v_mul_f32 v163, v163, v15
v_mul_f32 v168, v168, v15
v_mul_f32 v169, v169, v15
v_mul_f32 v170, v170, v15
v_mul_f32 v171, v171, v15
v_mul_f32 v176, v176, v15
v_mul_f32 v177, v177, v15
v_mul_f32 v178, v178, v15
v_mul_f32 v179, v179, v15
v_mul_f32 v184, v184, v15
v_mul_f32 v185, v185, v15
v_mul_f32 v186, v186, v15
v_mul_f32 v187, v187, v15
v_mul_f32 v192, v192, v15
v_mul_f32 v193, v193, v15
v_mul_f32 v194, v194, v15
v_mul_f32 v195, v195, v15
v_mul_f32 v200, v200, v15
v_mul_f32 v201, v201, v15
v_mul_f32 v202, v202, v15
v_mul_f32 v203, v203, v15
v_mul_f32 v208, v208, v15
v_mul_f32 v209, v209, v15
v_mul_f32 v210, v210, v15
v_mul_f32 v211, v211, v15
v_mul_f32 v216, v216, v15
v_mul_f32 v217, v217, v15
v_mul_f32 v218, v218, v15
v_mul_f32 v219, v219, v15
v_mul_f32 v224, v224, v15
v_mul_f32 v225, v225, v15
v_mul_f32 v226, v226, v15
v_mul_f32 v227, v227, v15
v_mul_f32 v232, v232, v15
v_mul_f32 v233, v233, v15
v_mul_f32 v234, v234, v15
v_mul_f32 v235, v235, v15
v_mul_f32 v240, v240, v15
v_mul_f32 v241, v241, v15
v_mul_f32 v242, v242, v15
v_mul_f32 v243, v243, v15
v_mul_f32 v248, v248, v15
v_mul_f32 v249, v249, v15
v_mul_f32 v250, v250, v15
v_mul_f32 v251, v251, v15
v_mul_f32 v80, v80, v15
v_mul_f32 v81, v81, v15
v_max3_f32 v13, v36, v37, v38
v_max3_f32 v14, v39, v44, v45
v_max3_f32 v13, v13, v46, v47
v_max_f32 v13, v13, v14
v_mov_b32 v14, v13
s_nop 1
v_permlane32_swap_b32 v13, v14
s_nop 1
v_max_f32 v13, v13, v14
v_mov_b32 v14, v13
s_nop 1
v_permlane16_swap_b32 v13, v14
s_nop 1
v_max_f32 v13, v13, v14
v_max_f32 v13, 0, v13
v_sub_f32 v14, 0, v13
v_exp_f32 v15, v14
s_nop 0
v_add_f32 v76, v76, v14
v_add_f32 v77, v77, v14
v_add_f32 v78, v78, v14
v_add_f32 v79, v79, v14
v_add_f32 v36, v36, v14
v_add_f32 v20, v20, v14
v_add_f32 v37, v37, v14
v_add_f32 v21, v21, v14
v_add_f32 v38, v38, v14
v_add_f32 v22, v22, v14
v_add_f32 v39, v39, v14
v_add_f32 v23, v23, v14
v_add_f32 v44, v44, v14
v_add_f32 v28, v28, v14
v_add_f32 v45, v45, v14
v_add_f32 v29, v29, v14
v_add_f32 v46, v46, v14
v_add_f32 v30, v30, v14
v_add_f32 v47, v47, v14
v_add_f32 v31, v31, v14
v_mul_f32 v132, v132, v15
v_mul_f32 v133, v133, v15
v_mul_f32 v134, v134, v15
v_mul_f32 v135, v135, v15
v_mul_f32 v140, v140, v15
v_mul_f32 v141, v141, v15
v_mul_f32 v142, v142, v15
v_mul_f32 v143, v143, v15
v_mul_f32 v148, v148, v15
v_mul_f32 v149, v149, v15
v_mul_f32 v150, v150, v15
v_mul_f32 v151, v151, v15
v_mul_f32 v156, v156, v15
v_mul_f32 v157, v157, v15
v_mul_f32 v158, v158, v15
v_mul_f32 v159, v159, v15
v_mul_f32 v164, v164, v15
v_mul_f32 v165, v165, v15
v_mul_f32 v166, v166, v15
v_mul_f32 v167, v167, v15
v_mul_f32 v172, v172, v15
v_mul_f32 v173, v173, v15
v_mul_f32 v174, v174, v15
v_mul_f32 v175, v175, v15
v_mul_f32 v180, v180, v15
v_mul_f32 v181, v181, v15
v_mul_f32 v182, v182, v15
v_mul_f32 v183, v183, v15
v_mul_f32 v188, v188, v15
v_mul_f32 v189, v189, v15
v_mul_f32 v190, v190, v15
v_mul_f32 v191, v191, v15
v_mul_f32 v196, v196, v15
v_mul_f32 v197, v197, v15
v_mul_f32 v198, v198, v15
v_mul_f32 v199, v199, v15
v_mul_f32 v204, v204, v15
v_mul_f32 v205, v205, v15
v_mul_f32 v206, v206, v15
v_mul_f32 v207, v207, v15
v_mul_f32 v212, v212, v15
v_mul_f32 v213, v213, v15
v_mul_f32 v214, v214, v15
v_mul_f32 v215, v215, v15
v_mul_f32 v220, v220, v15
v_mul_f32 v221, v221, v15
v_mul_f32 v222, v222, v15
v_mul_f32 v223, v223, v15
v_mul_f32 v228, v228, v15
v_mul_f32 v229, v229, v15
v_mul_f32 v230, v230, v15
v_mul_f32 v231, v231, v15
v_mul_f32 v236, v236, v15
v_mul_f32 v237, v237, v15
v_mul_f32 v238, v238, v15
v_mul_f32 v239, v239, v15
v_mul_f32 v244, v244, v15
v_mul_f32 v245, v245, v15
v_mul_f32 v246, v246, v15
v_mul_f32 v247, v247, v15
v_mul_f32 v252, v252, v15
v_mul_f32 v253, v253, v15
v_mul_f32 v254, v254, v15
v_mul_f32 v255, v255, v15
v_mul_f32 v82, v82, v15
v_mul_f32 v83, v83, v15
v_exp_f32 v64, v32
v_exp_f32 v65, v33
v_exp_f32 v66, v34
v_add_f32 v84, v80, v64
v_add_f32 v85, v81, v65
v_cvt_pk_bf16_f32 v56, v64, v65
v_exp_f32 v67, v35
v_exp_f32 v68, v40
v_add_f32 v84, v84, v66
v_add_f32 v85, v85, v67
v_cvt_pk_bf16_f32 v57, v66, v67
v_exp_f32 v69, v41
v_exp_f32 v70, v42
v_add_f32 v84, v84, v68
v_add_f32 v85, v85, v69
v_cvt_pk_bf16_f32 v58, v68, v69
v_exp_f32 v71, v43
s_nop 0
v_add_f32 v84, v84, v70
v_add_f32 v85, v85, v71
v_cvt_pk_bf16_f32 v59, v70, v71
v_exp_f32 v64, v36
v_exp_f32 v65, v37
v_exp_f32 v66, v38
v_add_f32 v86, v82, v64
v_add_f32 v87, v83, v65
v_cvt_pk_bf16_f32 v60, v64, v65
v_exp_f32 v67, v39
v_exp_f32 v68, v44
v_add_f32 v86, v86, v66
v_add_f32 v87, v87, v67
v_cvt_pk_bf16_f32 v61, v66, v67
v_exp_f32 v69, v45
v_exp_f32 v70, v46
v_add_f32 v86, v86, v68
v_add_f32 v87, v87, v69
v_cvt_pk_bf16_f32 v62, v68, v69
v_exp_f32 v71, v47
s_nop 0
v_add_f32 v86, v86, v70
v_add_f32 v87, v87, v71
v_cvt_pk_bf16_f32 v63, v70, v71
s_nop 1
s_branch BACK_h1
RARE_h2:
s_nop 7
s_nop 7
v_max3_f32 v13, v16, v17, v18
v_max3_f32 v14, v19, v24, v25
v_max3_f32 v13, v13, v26, v27
v_max_f32 v13, v13, v14
v_mov_b32 v14, v13
s_nop 1
v_permlane32_swap_b32 v13, v14
s_nop 1
v_max_f32 v13, v13, v14
v_mov_b32 v14, v13
s_nop 1
v_permlane16_swap_b32 v13, v14
s_nop 1
v_max_f32 v13, v13, v14
v_max_f32 v13, 0, v13
v_sub_f32 v14, 0, v13
v_exp_f32 v15, v14
s_nop 0
v_add_f32 v72, v72, v14
v_add_f32 v73, v73, v14
v_add_f32 v74, v74, v14
v_add_f32 v75, v75, v14
v_add_f32 v16, v16, v14
v_add_f32 v32, v32, v14
v_add_f32 v17, v17, v14
v_add_f32 v33, v33, v14
v_add_f32 v18, v18, v14
v_add_f32 v34, v34, v14
v_add_f32 v19, v19, v14
v_add_f32 v35, v35, v14
v_add_f32 v24, v24, v14
v_add_f32 v40, v40, v14
v_add_f32 v25, v25, v14
v_add_f32 v41, v41, v14
v_add_f32 v26, v26, v14
v_add_f32 v42, v42, v14
v_add_f32 v27, v27, v14
v_add_f32 v43, v43, v14
v_mul_f32 v128, v128, v15
v_mul_f32 v129, v129, v15
v_mul_f32 v130, v130, v15
v_mul_f32 v131, v131, v15
v_mul_f32 v136, v136, v15
v_mul_f32 v137, v137, v15
v_mul_f32 v138, v138, v15
v_mul_f32 v139, v139, v15
v_mul_f32 v144, v144, v15
v_mul_f32 v145, v145, v15
v_mul_f32 v146, v146, v15
v_mul_f32 v147, v147, v15
v_mul_f32 v152, v152, v15
v_mul_f32 v153, v153, v15
v_mul_f32 v154, v154, v15
v_mul_f32 v155, v155, v15
v_mul_f32 v160, v160, v15
v_mul_f32 v161, v161, v15
v_mul_f32 v162, v162, v15
v_mul_f32 v163, v163, v15
v_mul_f32 v168, v168, v15
v_mul_f32 v169, v169, v15
v_mul_f32 v170, v170, v15
v_mul_f32 v171, v171, v15
v_mul_f32 v176, v176, v15
v_mul_f32 v177, v177, v15
v_mul_f32 v178, v178, v15
v_mul_f32 v179, v179, v15
v_mul_f32 v184, v184, v15
v_mul_f32 v185, v185, v15
v_mul_f32 v186, v186, v15
v_mul_f32 v187, v187, v15
v_mul_f32 v192, v192, v15
v_mul_f32 v193, v193, v15
v_mul_f32 v194, v194, v15
v_mul_f32 v195, v195, v15
v_mul_f32 v200, v200, v15
v_mul_f32 v201, v201, v15
v_mul_f32 v202, v202, v15
v_mul_f32 v203, v203, v15
v_mul_f32 v208, v208, v15
v_mul_f32 v209, v209, v15
v_mul_f32 v210, v210, v15
v_mul_f32 v211, v211, v15
v_mul_f32 v216, v216, v15
v_mul_f32 v217, v217, v15
v_mul_f32 v218, v218, v15
v_mul_f32 v219, v219, v15
v_mul_f32 v224, v224, v15
v_mul_f32 v225, v225, v15
v_mul_f32 v226, v226, v15
v_mul_f32 v227, v227, v15
v_mul_f32 v232, v232, v15
v_mul_f32 v233, v233, v15
v_mul_f32 v234, v234, v15
v_mul_f32 v235, v235, v15
v_mul_f32 v240, v240, v15
v_mul_f32 v241, v241, v15
v_mul_f32 v242, v242, v15
v_mul_f32 v243, v243, v15
v_mul_f32 v248, v248, v15
v_mul_f32 v249, v249, v15
v_mul_f32 v250, v250, v15
v_mul_f32 v251, v251, v15
v_mul_f32 v84, v84, v15
v_mul_f32 v85, v85, v15
v_max3_f32 v13, v20, v21, v22
v_max3_f32 v14, v23, v28, v29
v_max3_f32 v13, v13, v30, v31
v_max_f32 v13, v13, v14
v_mov_b32 v14, v13
s_nop 1
v_permlane32_swap_b32 v13, v14
s_nop 1
v_max_f32 v13, v13, v14
v_mov_b32 v14, v13
s_nop 1
v_permlane16_swap_b32 v13, v14
s_nop 1
v_max_f32 v13, v13, v14
v_max_f32 v13, 0, v13
v_sub_f32 v14, 0, v13
v_exp_f32 v15, v14
s_nop 0
v_add_f32 v76, v76, v14
v_add_f32 v77, v77, v14
v_add_f32 v78, v78, v14
v_add_f32 v79, v79, v14
v_add_f32 v20, v20, v14
v_add_f32 v36, v36, v14
v_add_f32 v21, v21, v14
v_add_f32 v37, v37, v14
v_add_f32 v22, v22, v14
v_add_f32 v38, v38, v14
v_add_f32 v23, v23, v14
v_add_f32 v39, v39, v14
v_add_f32 v28, v28, v14
v_add_f32 v44, v44, v14
v_add_f32 v29, v29, v14
v_add_f32 v45, v45, v14
v_add_f32 v30, v30, v14
v_add_f32 v46, v46, v14
v_add_f32 v31, v31, v14
v_add_f32 v47, v47, v14
v_mul_f32 v132, v132, v15
v_mul_f32 v133, v133, v15
v_mul_f32 v134, v134, v15
v_mul_f32 v135, v135, v15
v_mul_f32 v140, v140, v15
v_mul_f32 v141, v141, v15
v_mul_f32 v142, v142, v15
v_mul_f32 v143, v143, v15
v_mul_f32 v148, v148, v15
v_mul_f32 v149, v149, v15
v_mul_f32 v150, v150, v15
v_mul_f32 v151, v151, v15
v_mul_f32 v156, v156, v15
v_mul_f32 v157, v157, v15
v_mul_f32 v158, v158, v15
v_mul_f32 v159, v159, v15
v_mul_f32 v164, v164, v15
v_mul_f32 v165, v165, v15
v_mul_f32 v166, v166, v15
v_mul_f32 v167, v167, v15
v_mul_f32 v172, v172, v15
v_mul_f32 v173, v173, v15
v_mul_f32 v174, v174, v15
v_mul_f32 v175, v175, v15
v_mul_f32 v180, v180, v15
v_mul_f32 v181, v181, v15
v_mul_f32 v182, v182, v15
v_mul_f32 v183, v183, v15
v_mul_f32 v188, v188, v15
v_mul_f32 v189, v189, v15
v_mul_f32 v190, v190, v15
v_mul_f32 v191, v191, v15
v_mul_f32 v196, v196, v15
v_mul_f32 v197, v197, v15
v_mul_f32 v198, v198, v15
v_mul_f32 v199, v199, v15
v_mul_f32 v204, v204, v15
v_mul_f32 v205, v205, v15
v_mul_f32 v206, v206, v15
v_mul_f32 v207, v207, v15
v_mul_f32 v212, v212, v15
v_mul_f32 v213, v213, v15
v_mul_f32 v214, v214, v15
v_mul_f32 v215, v215, v15
v_mul_f32 v220, v220, v15
v_mul_f32 v221, v221, v15
v_mul_f32 v222, v222, v15
v_mul_f32 v223, v223, v15
v_mul_f32 v228, v228, v15
v_mul_f32 v229, v229, v15
v_mul_f32 v230, v230, v15
v_mul_f32 v231, v231, v15
v_mul_f32 v236, v236, v15
v_mul_f32 v237, v237, v15
v_mul_f32 v238, v238, v15
v_mul_f32 v239, v239, v15
v_mul_f32 v244, v244, v15
v_mul_f32 v245, v245, v15
v_mul_f32 v246, v246, v15
v_mul_f32 v247, v247, v15
v_mul_f32 v252, v252, v15
v_mul_f32 v253, v253, v15
v_mul_f32 v254, v254, v15
v_mul_f32 v255, v255, v15
v_mul_f32 v86, v86, v15
v_mul_f32 v87, v87, v15
v_exp_f32 v64, v16
v_exp_f32 v65, v17
v_exp_f32 v66, v18
v_add_f32 v80, v84, v64
v_add_f32 v81, v85, v65
v_cvt_pk_bf16_f32 v48, v64, v65
v_exp_f32 v67, v19
v_exp_f32 v68, v24
v_add_f32 v80, v80, v66
v_add_f32 v81, v81, v67
v_cvt_pk_bf16_f32 v49, v66, v67
v_exp_f32 v69, v25
v_exp_f32 v70, v26
v_add_f32 v80, v80, v68
v_add_f32 v81, v81, v69
v_cvt_pk_bf16_f32 v50, v68, v69
v_exp_f32 v71, v27
s_nop 0
v_add_f32 v80, v80, v70
v_add_f32 v81, v81, v71
v_cvt_pk_bf16_f32 v51, v70, v71
v_exp_f32 v64, v20
v_exp_f32 v65, v21
v_exp_f32 v66, v22
v_add_f32 v82, v86, v64
v_add_f32 v83, v87, v65
v_cvt_pk_bf16_f32 v52, v64, v65
v_exp_f32 v67, v23
v_exp_f32 v68, v28
v_add_f32 v82, v82, v66
v_add_f32 v83, v83, v67
v_cvt_pk_bf16_f32 v53, v66, v67
v_exp_f32 v69, v29
v_exp_f32 v70, v30
v_add_f32 v82, v82, v68
v_add_f32 v83, v83, v69
v_cvt_pk_bf16_f32 v54, v68, v69
v_exp_f32 v71, v31
s_nop 0
v_add_f32 v82, v82, v70
v_add_f32 v83, v83, v71
v_cvt_pk_bf16_f32 v55, v70, v71
s_nop 1
s_branch BACK_h2
RARE_h3:
s_nop 7
s_nop 7
v_max3_f32 v13, v32, v33, v34
v_max3_f32 v14, v35, v40, v41
v_max3_f32 v13, v13, v42, v43
v_max_f32 v13, v13, v14
v_mov_b32 v14, v13
s_nop 1
v_permlane32_swap_b32 v13, v14
s_nop 1
v_max_f32 v13, v13, v14
v_mov_b32 v14, v13
s_nop 1
v_permlane16_swap_b32 v13, v14
s_nop 1
v_max_f32 v13, v13, v14
v_max_f32 v13, 0, v13
v_sub_f32 v14, 0, v13
v_exp_f32 v15, v14
s_nop 0
v_add_f32 v72, v72, v14
v_add_f32 v73, v73, v14
v_add_f32 v74, v74, v14
v_add_f32 v75, v75, v14
v_add_f32 v32, v32, v14
v_add_f32 v33, v33, v14
v_add_f32 v34, v34, v14
v_add_f32 v35, v35, v14
v_add_f32 v40, v40, v14
v_add_f32 v41, v41, v14
v_add_f32 v42, v42, v14
v_add_f32 v43, v43, v14
v_mul_f32 v128, v128, v15
v_mul_f32 v129, v129, v15
v_mul_f32 v130, v130, v15
v_mul_f32 v131, v131, v15
v_mul_f32 v136, v136, v15
v_mul_f32 v137, v137, v15
v_mul_f32 v138, v138, v15
v_mul_f32 v139, v139, v15
v_mul_f32 v144, v144, v15
v_mul_f32 v145, v145, v15
v_mul_f32 v146, v146, v15
v_mul_f32 v147, v147, v15
v_mul_f32 v152, v152, v15
v_mul_f32 v153, v153, v15
v_mul_f32 v154, v154, v15
v_mul_f32 v155, v155, v15
v_mul_f32 v160, v160, v15
v_mul_f32 v161, v161, v15
v_mul_f32 v162, v162, v15
v_mul_f32 v163, v163, v15
v_mul_f32 v168, v168, v15
v_mul_f32 v169, v169, v15
v_mul_f32 v170, v170, v15
v_mul_f32 v171, v171, v15
v_mul_f32 v176, v176, v15
v_mul_f32 v177, v177, v15
v_mul_f32 v178, v178, v15
v_mul_f32 v179, v179, v15
v_mul_f32 v184, v184, v15
v_mul_f32 v185, v185, v15
v_mul_f32 v186, v186, v15
v_mul_f32 v187, v187, v15
v_mul_f32 v192, v192, v15
v_mul_f32 v193, v193, v15
v_mul_f32 v194, v194, v15
v_mul_f32 v195, v195, v15
v_mul_f32 v200, v200, v15
v_mul_f32 v201, v201, v15
v_mul_f32 v202, v202, v15
v_mul_f32 v203, v203, v15
v_mul_f32 v208, v208, v15
v_mul_f32 v209, v209, v15
v_mul_f32 v210, v210, v15
v_mul_f32 v211, v211, v15
v_mul_f32 v216, v216, v15
v_mul_f32 v217, v217, v15
v_mul_f32 v218, v218, v15
v_mul_f32 v219, v219, v15
v_mul_f32 v224, v224, v15
v_mul_f32 v225, v225, v15
v_mul_f32 v226, v226, v15
v_mul_f32 v227, v227, v15
v_mul_f32 v232, v232, v15
v_mul_f32 v233, v233, v15
v_mul_f32 v234, v234, v15
v_mul_f32 v235, v235, v15
v_mul_f32 v240, v240, v15
v_mul_f32 v241, v241, v15
v_mul_f32 v242, v242, v15
v_mul_f32 v243, v243, v15
v_mul_f32 v248, v248, v15
v_mul_f32 v249, v249, v15
v_mul_f32 v250, v250, v15
v_mul_f32 v251, v251, v15
v_mul_f32 v80, v80, v15
v_mul_f32 v81, v81, v15
v_max3_f32 v13, v36, v37, v38
v_max3_f32 v14, v39, v44, v45
v_max3_f32 v13, v13, v46, v47
v_max_f32 v13, v13, v14
v_mov_b32 v14, v13
s_nop 1
v_permlane32_swap_b32 v13, v14
s_nop 1
v_max_f32 v13, v13, v14
v_mov_b32 v14, v13
s_nop 1
v_permlane16_swap_b32 v13, v14
s_nop 1
v_max_f32 v13, v13, v14
v_max_f32 v13, 0, v13
v_sub_f32 v14, 0, v13
v_exp_f32 v15, v14
s_nop 0
v_add_f32 v76, v76, v14
v_add_f32 v77, v77, v14
v_add_f32 v78, v78, v14
v_add_f32 v79, v79, v14
v_add_f32 v36, v36, v14
v_add_f32 v37, v37, v14
v_add_f32 v38, v38, v14
v_add_f32 v39, v39, v14
v_add_f32 v44, v44, v14
v_add_f32 v45, v45, v14
v_add_f32 v46, v46, v14
v_add_f32 v47, v47, v14
v_mul_f32 v132, v132, v15
v_mul_f32 v133, v133, v15
v_mul_f32 v134, v134, v15
v_mul_f32 v135, v135, v15
v_mul_f32 v140, v140, v15
v_mul_f32 v141, v141, v15
v_mul_f32 v142, v142, v15
v_mul_f32 v143, v143, v15
v_mul_f32 v148, v148, v15
v_mul_f32 v149, v149, v15
v_mul_f32 v150, v150, v15
v_mul_f32 v151, v151, v15
v_mul_f32 v156, v156, v15
v_mul_f32 v157, v157, v15
v_mul_f32 v158, v158, v15
v_mul_f32 v159, v159, v15
v_mul_f32 v164, v164, v15
v_mul_f32 v165, v165, v15
v_mul_f32 v166, v166, v15
v_mul_f32 v167, v167, v15
v_mul_f32 v172, v172, v15
v_mul_f32 v173, v173, v15
v_mul_f32 v174, v174, v15
v_mul_f32 v175, v175, v15
v_mul_f32 v180, v180, v15
v_mul_f32 v181, v181, v15
v_mul_f32 v182, v182, v15
v_mul_f32 v183, v183, v15
v_mul_f32 v188, v188, v15
v_mul_f32 v189, v189, v15
v_mul_f32 v190, v190, v15
v_mul_f32 v191, v191, v15
v_mul_f32 v196, v196, v15
v_mul_f32 v197, v197, v15
v_mul_f32 v198, v198, v15
v_mul_f32 v199, v199, v15
v_mul_f32 v204, v204, v15
v_mul_f32 v205, v205, v15
v_mul_f32 v206, v206, v15
v_mul_f32 v207, v207, v15
v_mul_f32 v212, v212, v15
v_mul_f32 v213, v213, v15
v_mul_f32 v214, v214, v15
v_mul_f32 v215, v215, v15
v_mul_f32 v220, v220, v15
v_mul_f32 v221, v221, v15
v_mul_f32 v222, v222, v15
v_mul_f32 v223, v223, v15
v_mul_f32 v228, v228, v15
v_mul_f32 v229, v229, v15
v_mul_f32 v230, v230, v15
v_mul_f32 v231, v231, v15
v_mul_f32 v236, v236, v15
v_mul_f32 v237, v237, v15
v_mul_f32 v238, v238, v15
v_mul_f32 v239, v239, v15
v_mul_f32 v244, v244, v15
v_mul_f32 v245, v245, v15
v_mul_f32 v246, v246, v15
v_mul_f32 v247, v247, v15
v_mul_f32 v252, v252, v15
v_mul_f32 v253, v253, v15
v_mul_f32 v254, v254, v15
v_mul_f32 v255, v255, v15
v_mul_f32 v82, v82, v15
v_mul_f32 v83, v83, v15
v_exp_f32 v64, v32
v_exp_f32 v65, v33
v_exp_f32 v66, v34
v_add_f32 v84, v80, v64
v_add_f32 v85, v81, v65
v_cvt_pk_bf16_f32 v56, v64, v65
v_exp_f32 v67, v35
v_exp_f32 v68, v40
v_add_f32 v84, v84, v66
v_add_f32 v85, v85, v67
v_cvt_pk_bf16_f32 v57, v66, v67
v_exp_f32 v69, v41
v_exp_f32 v70, v42
v_add_f32 v84, v84, v68
v_add_f32 v85, v85, v69
v_cvt_pk_bf16_f32 v58, v68, v69
v_exp_f32 v71, v43
s_nop 0
v_add_f32 v84, v84, v70
v_add_f32 v85, v85, v71
v_cvt_pk_bf16_f32 v59, v70, v71
v_exp_f32 v64, v36
v_exp_f32 v65, v37
v_exp_f32 v66, v38
v_add_f32 v86, v82, v64
v_add_f32 v87, v83, v65
v_cvt_pk_bf16_f32 v60, v64, v65
v_exp_f32 v67, v39
v_exp_f32 v68, v44
v_add_f32 v86, v86, v66
v_add_f32 v87, v87, v67
v_cvt_pk_bf16_f32 v61, v66, v67
v_exp_f32 v69, v45
v_exp_f32 v70, v46
v_add_f32 v86, v86, v68
v_add_f32 v87, v87, v69
v_cvt_pk_bf16_f32 v62, v68, v69
v_exp_f32 v71, v47
s_nop 0
v_add_f32 v86, v86, v70
v_add_f32 v87, v87, v71
v_cvt_pk_bf16_f32 v63, v70, v71
s_nop 1
s_branch BACK_h3
RARE_h04:
s_nop 7
s_nop 7
v_max3_f32 v13, v16, v17, v18
v_max3_f32 v14, v19, v24, v25
v_max3_f32 v13, v13, v26, v27
v_max_f32 v13, v13, v14
v_mov_b32 v14, v13
s_nop 1
v_permlane32_swap_b32 v13, v14
s_nop 1
v_max_f32 v13, v13, v14
v_mov_b32 v14, v13
s_nop 1
v_permlane16_swap_b32 v13, v14
s_nop 1
v_max_f32 v13, v13, v14
v_max_f32 v13, 0, v13
v_sub_f32 v14, 0, v13
v_exp_f32 v15, v14
s_nop 0
v_add_f32 v72, v72, v14
v_add_f32 v73, v73, v14
v_add_f32 v74, v74, v14
v_add_f32 v75, v75, v14
v_add_f32 v16, v16, v14
v_add_f32 v32, v32, v14
v_add_f32 v17, v17, v14
v_add_f32 v33, v33, v14
v_add_f32 v18, v18, v14
v_add_f32 v34, v34, v14
v_add_f32 v19, v19, v14
v_add_f32 v35, v35, v14
v_add_f32 v24, v24, v14
v_add_f32 v40, v40, v14
v_add_f32 v25, v25, v14
v_add_f32 v41, v41, v14
v_add_f32 v26, v26, v14
v_add_f32 v42, v42, v14
v_add_f32 v27, v27, v14
v_add_f32 v43, v43, v14
v_mul_f32 v128, v128, v15
v_mul_f32 v129, v129, v15
v_mul_f32 v130, v130, v15
v_mul_f32 v131, v131, v15
v_mul_f32 v136, v136, v15
v_mul_f32 v137, v137, v15
v_mul_f32 v138, v138, v15
v_mul_f32 v139, v139, v15
v_mul_f32 v144, v144, v15
v_mul_f32 v145, v145, v15
v_mul_f32 v146, v146, v15
v_mul_f32 v147, v147, v15
v_mul_f32 v152, v152, v15
v_mul_f32 v153, v153, v15
v_mul_f32 v154, v154, v15
v_mul_f32 v155, v155, v15
v_mul_f32 v160, v160, v15
v_mul_f32 v161, v161, v15
v_mul_f32 v162, v162, v15
v_mul_f32 v163, v163, v15
v_mul_f32 v168, v168, v15
v_mul_f32 v169, v169, v15
v_mul_f32 v170, v170, v15
v_mul_f32 v171, v171, v15
v_mul_f32 v176, v176, v15
v_mul_f32 v177, v177, v15
v_mul_f32 v178, v178, v15
v_mul_f32 v179, v179, v15
v_mul_f32 v184, v184, v15
v_mul_f32 v185, v185, v15
v_mul_f32 v186, v186, v15
v_mul_f32 v187, v187, v15
v_mul_f32 v192, v192, v15
v_mul_f32 v193, v193, v15
v_mul_f32 v194, v194, v15
v_mul_f32 v195, v195, v15
v_mul_f32 v200, v200, v15
v_mul_f32 v201, v201, v15
v_mul_f32 v202, v202, v15
v_mul_f32 v203, v203, v15
v_mul_f32 v208, v208, v15
v_mul_f32 v209, v209, v15
v_mul_f32 v210, v210, v15
v_mul_f32 v211, v211, v15
v_mul_f32 v216, v216, v15
v_mul_f32 v217, v217, v15
v_mul_f32 v218, v218, v15
v_mul_f32 v219, v219, v15
v_mul_f32 v224, v224, v15
v_mul_f32 v225, v225, v15
v_mul_f32 v226, v226, v15
v_mul_f32 v227, v227, v15
v_mul_f32 v232, v232, v15
v_mul_f32 v233, v233, v15
v_mul_f32 v234, v234, v15
v_mul_f32 v235, v235, v15
v_mul_f32 v240, v240, v15
v_mul_f32 v241, v241, v15
v_mul_f32 v242, v242, v15
v_mul_f32 v243, v243, v15
v_mul_f32 v248, v248, v15
v_mul_f32 v249, v249, v15
v_mul_f32 v250, v250, v15
v_mul_f32 v251, v251, v15
v_mul_f32 v84, v84, v15
v_mul_f32 v85, v85, v15
v_max3_f32 v13, v20, v21, v22
v_max3_f32 v14, v23, v28, v29
v_max3_f32 v13, v13, v30, v31
v_max_f32 v13, v13, v14
v_mov_b32 v14, v13
s_nop 1
v_permlane32_swap_b32 v13, v14
s_nop 1
v_max_f32 v13, v13, v14
v_mov_b32 v14, v13
s_nop 1
v_permlane16_swap_b32 v13, v14
s_nop 1
v_max_f32 v13, v13, v14
v_max_f32 v13, 0, v13
v_sub_f32 v14, 0, v13
v_exp_f32 v15, v14
s_nop 0
v_add_f32 v76, v76, v14
v_add_f32 v77, v77, v14
v_add_f32 v78, v78, v14
v_add_f32 v79, v79, v14
v_add_f32 v20, v20, v14
v_add_f32 v36, v36, v14
v_add_f32 v21, v21, v14
v_add_f32 v37, v37, v14
v_add_f32 v22, v22, v14
v_add_f32 v38, v38, v14
v_add_f32 v23, v23, v14
v_add_f32 v39, v39, v14
v_add_f32 v28, v28, v14
v_add_f32 v44, v44, v14
v_add_f32 v29, v29, v14
v_add_f32 v45, v45, v14
v_add_f32 v30, v30, v14
v_add_f32 v46, v46, v14
v_add_f32 v31, v31, v14
v_add_f32 v47, v47, v14
v_mul_f32 v132, v132, v15
v_mul_f32 v133, v133, v15
v_mul_f32 v134, v134, v15
v_mul_f32 v135, v135, v15
v_mul_f32 v140, v140, v15
v_mul_f32 v141, v141, v15
v_mul_f32 v142, v142, v15
v_mul_f32 v143, v143, v15
v_mul_f32 v148, v148, v15
v_mul_f32 v149, v149, v15
v_mul_f32 v150, v150, v15
v_mul_f32 v151, v151, v15
v_mul_f32 v156, v156, v15
v_mul_f32 v157, v157, v15
v_mul_f32 v158, v158, v15
v_mul_f32 v159, v159, v15
v_mul_f32 v164, v164, v15
v_mul_f32 v165, v165, v15
v_mul_f32 v166, v166, v15
v_mul_f32 v167, v167, v15
v_mul_f32 v172, v172, v15
v_mul_f32 v173, v173, v15
v_mul_f32 v174, v174, v15
v_mul_f32 v175, v175, v15
v_mul_f32 v180, v180, v15
v_mul_f32 v181, v181, v15
v_mul_f32 v182, v182, v15
v_mul_f32 v183, v183, v15
v_mul_f32 v188, v188, v15
v_mul_f32 v189, v189, v15
v_mul_f32 v190, v190, v15
v_mul_f32 v191, v191, v15
v_mul_f32 v196, v196, v15
v_mul_f32 v197, v197, v15
v_mul_f32 v198, v198, v15
v_mul_f32 v199, v199, v15
v_mul_f32 v204, v204, v15
v_mul_f32 v205, v205, v15
v_mul_f32 v206, v206, v15
v_mul_f32 v207, v207, v15
v_mul_f32 v212, v212, v15
v_mul_f32 v213, v213, v15
v_mul_f32 v214, v214, v15
v_mul_f32 v215, v215, v15
v_mul_f32 v220, v220, v15
v_mul_f32 v221, v221, v15
v_mul_f32 v222, v222, v15
v_mul_f32 v223, v223, v15
v_mul_f32 v228, v228, v15
v_mul_f32 v229, v229, v15
v_mul_f32 v230, v230, v15
v_mul_f32 v231, v231, v15
v_mul_f32 v236, v236, v15
v_mul_f32 v237, v237, v15
v_mul_f32 v238, v238, v15
v_mul_f32 v239, v239, v15
v_mul_f32 v244, v244, v15
v_mul_f32 v245, v245, v15
v_mul_f32 v246, v246, v15
v_mul_f32 v247, v247, v15
v_mul_f32 v252, v252, v15
v_mul_f32 v253, v253, v15
v_mul_f32 v254, v254, v15
v_mul_f32 v255, v255, v15
v_mul_f32 v86, v86, v15
v_mul_f32 v87, v87, v15
v_exp_f32 v64, v16
v_exp_f32 v65, v17
v_exp_f32 v66, v18
v_add_f32 v80, v84, v64
v_add_f32 v81, v85, v65
v_cvt_pk_bf16_f32 v48, v64, v65
v_exp_f32 v67, v19
v_exp_f32 v68, v24
v_add_f32 v80, v80, v66
v_add_f32 v81, v81, v67
v_cvt_pk_bf16_f32 v49, v66, v67
v_exp_f32 v69, v25
v_exp_f32 v70, v26
v_add_f32 v80, v80, v68
v_add_f32 v81, v81, v69
v_cvt_pk_bf16_f32 v50, v68, v69
v_exp_f32 v71, v27
s_nop 0
v_add_f32 v80, v80, v70
v_add_f32 v81, v81, v71
v_cvt_pk_bf16_f32 v51, v70, v71
v_exp_f32 v64, v20
v_exp_f32 v65, v21
v_exp_f32 v66, v22
v_add_f32 v82, v86, v64
v_add_f32 v83, v87, v65
v_cvt_pk_bf16_f32 v52, v64, v65
v_exp_f32 v67, v23
v_exp_f32 v68, v28
v_add_f32 v82, v82, v66
v_add_f32 v83, v83, v67
v_cvt_pk_bf16_f32 v53, v66, v67
v_exp_f32 v69, v29
v_exp_f32 v70, v30
v_add_f32 v82, v82, v68
v_add_f32 v83, v83, v69
v_cvt_pk_bf16_f32 v54, v68, v69
v_exp_f32 v71, v31
s_nop 0
v_add_f32 v82, v82, v70
v_add_f32 v83, v83, v71
v_cvt_pk_bf16_f32 v55, v70, v71
s_nop 1
s_branch BACK_h04
SP_kv:
s_mov_b32 s59, 0
SP_kv_l:
s_sleep 1
buffer_load_dword v2, v125, s[12:15], s91 offen sc1
s_waitcnt vmcnt(0)
v_cmp_ne_u32 vcc, s66, v2
s_add_u32 s59, s59, 1
s_cmp_ge_u32 s59, 0x8000
s_cbranch_scc1 SPB_kv
s_nop 1
s_cbranch_vccnz SP_kv_l
s_branch SPB_kv
SP_pf:
s_mov_b32 s59, 0
s_sub_u32 s35, 15, s26
s_min_u32 s35, s35, s26
s_lshl_b32 s36, s25, 3
s_add_u32 s36, s36, s35
s_lshl_b32 s36, s36, 7
s_add_u32 s36, s36, 35655744
SP_pf_l:
s_sleep 1
buffer_load_dword v92, off, s[12:15], s36 sc1
s_waitcnt vmcnt(0)
v_cmp_ne_u32 vcc, s66, v92
s_add_u32 s59, s59, 1
s_cmp_ge_u32 s59, 0x8000
s_cbranch_scc1 SPB_pf
s_nop 1
s_cbranch_vccnz SP_pf_l
s_branch SPB_pf
.globl k3_kernel
.p2align 8
.type k3_kernel,@function
k3_kernel:
s_cmp_ge_u32 s2, 256
s_cbranch_scc1 K3_end
s_load_dwordx2 s[12:13], s[0:1], 96
s_load_dwordx2 s[4:5], s[0:1], 80
s_mov_b32 s14, 268435456
s_mov_b32 s15, 0x20000
s_mov_b32 s6, 1835008
s_mov_b32 s7, 0x20000
v_and_b32 v1, 63, v0
v_lshrrev_b32 v2, 6, v0
s_nop 0
v_readfirstlane_b32 s16, v2
s_mul_i32 s17, s2, 7
s_add_u32 s17, s17, s16
s_lshr_b32 s2, s17, 2
s_and_b32 s16, s17, 3
s_lshl_b32 s17, s2, 2
s_add_u32 s17, s17, s16
s_lshl_b32 s17, s17, 10
s_add_u32 s17, s17, 36700160
v_lshlrev_b32 v2, 4, v1
s_waitcnt lgkmcnt(0)
buffer_load_dwordx4 v[8:11], v2, s[12:15], s17 offen
s_add_u32 s17, s17, 1835008
buffer_load_dwordx4 v[12:15], v2, s[12:15], s17 offen
s_add_u32 s17, s17, 1835008
buffer_load_dwordx4 v[16:19], v2, s[12:15], s17 offen
s_add_u32 s17, s17, 1835008
buffer_load_dwordx4 v[20:23], v2, s[12:15], s17 offen
s_add_u32 s17, s17, 1835008
buffer_load_dwordx4 v[24:27], v2, s[12:15], s17 offen
s_add_u32 s17, s17, 1835008
buffer_load_dwordx4 v[28:31], v2, s[12:15], s17 offen
s_add_u32 s17, s17, 1835008
buffer_load_dwordx4 v[32:35], v2, s[12:15], s17 offen
s_add_u32 s17, s17, 1835008
buffer_load_dwordx4 v[36:39], v2, s[12:15], s17 offen
s_add_u32 s17, s17, 1835008
buffer_load_dwordx4 v[40:43], v2, s[12:15], s17 offen
s_add_u32 s17, s17, 1835008
buffer_load_dwordx4 v[44:47], v2, s[12:15], s17 offen
s_add_u32 s17, s17, 1835008
buffer_load_dwordx4 v[48:51], v2, s[12:15], s17 offen
s_add_u32 s17, s17, 1835008
buffer_load_dwordx4 v[52:55], v2, s[12:15], s17 offen
s_add_u32 s17, s17, 1835008
buffer_load_dwordx4 v[56:59], v2, s[12:15], s17 offen
s_add_u32 s17, s17, 1835008
buffer_load_dwordx4 v[60:63], v2, s[12:15], s17 offen
s_add_u32 s17, s17, 1835008
buffer_load_dwordx4 v[64:67], v2, s[12:15], s17 offen
s_add_u32 s17, s17, 1835008
buffer_load_dwordx4 v[68:71], v2, s[12:15], s17 offen
s_mul_i32 s18, s2, 9363
s_lshr_b32 s18, s18, 16
s_mul_i32 s19, s18, 7
s_sub_u32 s19, s2, s19
s_lshl_b32 s18, s18, 5
s_and_b32 s20, s16, 1
s_lshl_b32 s20, s20, 4
s_add_u32 s18, s18, s20
s_lshl_b32 s19, s19, 6
s_lshr_b32 s20, s16, 1
s_lshl_b32 s20, s20, 5
s_add_u32 s19, s19, s20
s_lshl_b32 s19, s19, 1
v_and_b32 v3, 15, v1
v_add_u32 v3, s18, v3
v_mul_u32_u24 v3, 896, v3
v_lshrrev_b32 v4, 4, v1
v_lshlrev_b32 v4, 3, v4
v_add_u32 v3, v3, v4
v_add_u32 v3, s19, v3
v_mov_b32 v72, 0
v_mov_b32 v73, 0
v_mov_b32 v74, 0
v_mov_b32 v75, 0
v_mov_b32 v76, 0
v_mov_b32 v77, 0
v_mov_b32 v78, 0
v_mov_b32 v79, 0
s_waitcnt vmcnt(15)
v_lshlrev_b32 v80, 16, v8
v_and_b32 v81, 0xffff0000, v8
v_pk_add_f32 v[72:73], v[72:73], v[80:81]
v_lshlrev_b32 v80, 16, v9
v_and_b32 v81, 0xffff0000, v9
v_pk_add_f32 v[74:75], v[74:75], v[80:81]
v_lshlrev_b32 v80, 16, v10
v_and_b32 v81, 0xffff0000, v10
v_pk_add_f32 v[76:77], v[76:77], v[80:81]
v_lshlrev_b32 v80, 16, v11
v_and_b32 v81, 0xffff0000, v11
v_pk_add_f32 v[78:79], v[78:79], v[80:81]
s_waitcnt vmcnt(14)
v_lshlrev_b32 v80, 16, v12
v_and_b32 v81, 0xffff0000, v12
v_pk_add_f32 v[72:73], v[72:73], v[80:81]
v_lshlrev_b32 v80, 16, v13
v_and_b32 v81, 0xffff0000, v13
v_pk_add_f32 v[74:75], v[74:75], v[80:81]
v_lshlrev_b32 v80, 16, v14
v_and_b32 v81, 0xffff0000, v14
v_pk_add_f32 v[76:77], v[76:77], v[80:81]
v_lshlrev_b32 v80, 16, v15
v_and_b32 v81, 0xffff0000, v15
v_pk_add_f32 v[78:79], v[78:79], v[80:81]
s_waitcnt vmcnt(13)
v_lshlrev_b32 v80, 16, v16
v_and_b32 v81, 0xffff0000, v16
v_pk_add_f32 v[72:73], v[72:73], v[80:81]
v_lshlrev_b32 v80, 16, v17
v_and_b32 v81, 0xffff0000, v17
v_pk_add_f32 v[74:75], v[74:75], v[80:81]
v_lshlrev_b32 v80, 16, v18
v_and_b32 v81, 0xffff0000, v18
v_pk_add_f32 v[76:77], v[76:77], v[80:81]
v_lshlrev_b32 v80, 16, v19
v_and_b32 v81, 0xffff0000, v19
v_pk_add_f32 v[78:79], v[78:79], v[80:81]
s_waitcnt vmcnt(12)
v_lshlrev_b32 v80, 16, v20
v_and_b32 v81, 0xffff0000, v20
v_pk_add_f32 v[72:73], v[72:73], v[80:81]
v_lshlrev_b32 v80, 16, v21
v_and_b32 v81, 0xffff0000, v21
v_pk_add_f32 v[74:75], v[74:75], v[80:81]
v_lshlrev_b32 v80, 16, v22
v_and_b32 v81, 0xffff0000, v22
v_pk_add_f32 v[76:77], v[76:77], v[80:81]
v_lshlrev_b32 v80, 16, v23
v_and_b32 v81, 0xffff0000, v23
v_pk_add_f32 v[78:79], v[78:79], v[80:81]
s_waitcnt vmcnt(11)
v_lshlrev_b32 v80, 16, v24
v_and_b32 v81, 0xffff0000, v24
v_pk_add_f32 v[72:73], v[72:73], v[80:81]
v_lshlrev_b32 v80, 16, v25
v_and_b32 v81, 0xffff0000, v25
v_pk_add_f32 v[74:75], v[74:75], v[80:81]
v_lshlrev_b32 v80, 16, v26
v_and_b32 v81, 0xffff0000, v26
v_pk_add_f32 v[76:77], v[76:77], v[80:81]
v_lshlrev_b32 v80, 16, v27
v_and_b32 v81, 0xffff0000, v27
v_pk_add_f32 v[78:79], v[78:79], v[80:81]
s_waitcnt vmcnt(10)
v_lshlrev_b32 v80, 16, v28
v_and_b32 v81, 0xffff0000, v28
v_pk_add_f32 v[72:73], v[72:73], v[80:81]
v_lshlrev_b32 v80, 16, v29
v_and_b32 v81, 0xffff0000, v29
v_pk_add_f32 v[74:75], v[74:75], v[80:81]
v_lshlrev_b32 v80, 16, v30
v_and_b32 v81, 0xffff0000, v30
v_pk_add_f32 v[76:77], v[76:77], v[80:81]
v_lshlrev_b32 v80, 16, v31
v_and_b32 v81, 0xffff0000, v31
v_pk_add_f32 v[78:79], v[78:79], v[80:81]
s_waitcnt vmcnt(9)
v_lshlrev_b32 v80, 16, v32
v_and_b32 v81, 0xffff0000, v32
v_pk_add_f32 v[72:73], v[72:73], v[80:81]
v_lshlrev_b32 v80, 16, v33
v_and_b32 v81, 0xffff0000, v33
v_pk_add_f32 v[74:75], v[74:75], v[80:81]
v_lshlrev_b32 v80, 16, v34
v_and_b32 v81, 0xffff0000, v34
v_pk_add_f32 v[76:77], v[76:77], v[80:81]
v_lshlrev_b32 v80, 16, v35
v_and_b32 v81, 0xffff0000, v35
v_pk_add_f32 v[78:79], v[78:79], v[80:81]
s_waitcnt vmcnt(8)
v_lshlrev_b32 v80, 16, v36
v_and_b32 v81, 0xffff0000, v36
v_pk_add_f32 v[72:73], v[72:73], v[80:81]
v_lshlrev_b32 v80, 16, v37
v_and_b32 v81, 0xffff0000, v37
v_pk_add_f32 v[74:75], v[74:75], v[80:81]
v_lshlrev_b32 v80, 16, v38
v_and_b32 v81, 0xffff0000, v38
v_pk_add_f32 v[76:77], v[76:77], v[80:81]
v_lshlrev_b32 v80, 16, v39
v_and_b32 v81, 0xffff0000, v39
v_pk_add_f32 v[78:79], v[78:79], v[80:81]
s_waitcnt vmcnt(7)
v_lshlrev_b32 v80, 16, v40
v_and_b32 v81, 0xffff0000, v40
v_pk_add_f32 v[72:73], v[72:73], v[80:81]
v_lshlrev_b32 v80, 16, v41
v_and_b32 v81, 0xffff0000, v41
v_pk_add_f32 v[74:75], v[74:75], v[80:81]
v_lshlrev_b32 v80, 16, v42
v_and_b32 v81, 0xffff0000, v42
v_pk_add_f32 v[76:77], v[76:77], v[80:81]
v_lshlrev_b32 v80, 16, v43
v_and_b32 v81, 0xffff0000, v43
v_pk_add_f32 v[78:79], v[78:79], v[80:81]
s_waitcnt vmcnt(6)
v_lshlrev_b32 v80, 16, v44
v_and_b32 v81, 0xffff0000, v44
v_pk_add_f32 v[72:73], v[72:73], v[80:81]
v_lshlrev_b32 v80, 16, v45
v_and_b32 v81, 0xffff0000, v45
v_pk_add_f32 v[74:75], v[74:75], v[80:81]
v_lshlrev_b32 v80, 16, v46
v_and_b32 v81, 0xffff0000, v46
v_pk_add_f32 v[76:77], v[76:77], v[80:81]
v_lshlrev_b32 v80, 16, v47
v_and_b32 v81, 0xffff0000, v47
v_pk_add_f32 v[78:79], v[78:79], v[80:81]
s_waitcnt vmcnt(5)
v_lshlrev_b32 v80, 16, v48
v_and_b32 v81, 0xffff0000, v48
v_pk_add_f32 v[72:73], v[72:73], v[80:81]
v_lshlrev_b32 v80, 16, v49
v_and_b32 v81, 0xffff0000, v49
v_pk_add_f32 v[74:75], v[74:75], v[80:81]
v_lshlrev_b32 v80, 16, v50
v_and_b32 v81, 0xffff0000, v50
v_pk_add_f32 v[76:77], v[76:77], v[80:81]
v_lshlrev_b32 v80, 16, v51
v_and_b32 v81, 0xffff0000, v51
v_pk_add_f32 v[78:79], v[78:79], v[80:81]
s_waitcnt vmcnt(4)
v_lshlrev_b32 v80, 16, v52
v_and_b32 v81, 0xffff0000, v52
v_pk_add_f32 v[72:73], v[72:73], v[80:81]
v_lshlrev_b32 v80, 16, v53
v_and_b32 v81, 0xffff0000, v53
v_pk_add_f32 v[74:75], v[74:75], v[80:81]
v_lshlrev_b32 v80, 16, v54
v_and_b32 v81, 0xffff0000, v54
v_pk_add_f32 v[76:77], v[76:77], v[80:81]
v_lshlrev_b32 v80, 16, v55
v_and_b32 v81, 0xffff0000, v55
v_pk_add_f32 v[78:79], v[78:79], v[80:81]
s_waitcnt vmcnt(3)
v_lshlrev_b32 v80, 16, v56
v_and_b32 v81, 0xffff0000, v56
v_pk_add_f32 v[72:73], v[72:73], v[80:81]
v_lshlrev_b32 v80, 16, v57
v_and_b32 v81, 0xffff0000, v57
v_pk_add_f32 v[74:75], v[74:75], v[80:81]
v_lshlrev_b32 v80, 16, v58
v_and_b32 v81, 0xffff0000, v58
v_pk_add_f32 v[76:77], v[76:77], v[80:81]
v_lshlrev_b32 v80, 16, v59
v_and_b32 v81, 0xffff0000, v59
v_pk_add_f32 v[78:79], v[78:79], v[80:81]
s_waitcnt vmcnt(2)
v_lshlrev_b32 v80, 16, v60
v_and_b32 v81, 0xffff0000, v60
v_pk_add_f32 v[72:73], v[72:73], v[80:81]
v_lshlrev_b32 v80, 16, v61
v_and_b32 v81, 0xffff0000, v61
v_pk_add_f32 v[74:75], v[74:75], v[80:81]
v_lshlrev_b32 v80, 16, v62
v_and_b32 v81, 0xffff0000, v62
v_pk_add_f32 v[76:77], v[76:77], v[80:81]
v_lshlrev_b32 v80, 16, v63
v_and_b32 v81, 0xffff0000, v63
v_pk_add_f32 v[78:79], v[78:79], v[80:81]
s_waitcnt vmcnt(1)
v_lshlrev_b32 v80, 16, v64
v_and_b32 v81, 0xffff0000, v64
v_pk_add_f32 v[72:73], v[72:73], v[80:81]
v_lshlrev_b32 v80, 16, v65
v_and_b32 v81, 0xffff0000, v65
v_pk_add_f32 v[74:75], v[74:75], v[80:81]
v_lshlrev_b32 v80, 16, v66
v_and_b32 v81, 0xffff0000, v66
v_pk_add_f32 v[76:77], v[76:77], v[80:81]
v_lshlrev_b32 v80, 16, v67
v_and_b32 v81, 0xffff0000, v67
v_pk_add_f32 v[78:79], v[78:79], v[80:81]
s_waitcnt vmcnt(0)
v_lshlrev_b32 v80, 16, v68
v_and_b32 v81, 0xffff0000, v68
v_pk_add_f32 v[72:73], v[72:73], v[80:81]
v_lshlrev_b32 v80, 16, v69
v_and_b32 v81, 0xffff0000, v69
v_pk_add_f32 v[74:75], v[74:75], v[80:81]
v_lshlrev_b32 v80, 16, v70
v_and_b32 v81, 0xffff0000, v70
v_pk_add_f32 v[76:77], v[76:77], v[80:81]
v_lshlrev_b32 v80, 16, v71
v_and_b32 v81, 0xffff0000, v71
v_pk_add_f32 v[78:79], v[78:79], v[80:81]
v_cvt_pk_bf16_f32 v84, v72, v73
v_cvt_pk_bf16_f32 v85, v74, v75
v_cvt_pk_bf16_f32 v86, v76, v77
v_cvt_pk_bf16_f32 v87, v78, v79
buffer_store_dwordx2 v[84:85], v3, s[4:7], 0 offen
buffer_store_dwordx2 v[86:87], v3, s[4:7], 0 offen offset:32
K3_end:
s_endpgm
.section .rodata,"a"
.p2align 6
.amdhsa_kernel mega_kernel
  .amdhsa_next_free_vgpr 512
  .amdhsa_next_free_sgpr 102
  .amdhsa_accum_offset 256
  .amdhsa_group_segment_fixed_size 0
  .amdhsa_kernarg_size 104
  .amdhsa_user_sgpr_count 2
  .amdhsa_user_sgpr_kernarg_segment_ptr 1
  .amdhsa_system_sgpr_workgroup_id_x 1
.end_amdhsa_kernel
.p2align 6
.amdhsa_kernel k3_kernel
  .amdhsa_next_free_vgpr 88
  .amdhsa_next_free_sgpr 102
  .amdhsa_accum_offset 88
  .amdhsa_group_segment_fixed_size 0
  .amdhsa_kernarg_size 104
  .amdhsa_user_sgpr_count 2
  .amdhsa_user_sgpr_kernarg_segment_ptr 1
  .amdhsa_system_sgpr_workgroup_id_x 1
.end_amdhsa_kernel
```
